```python
import torch

def _softmax(x, axis=-1):
    return torch.softmax(x, dim=axis)
def _gelu(x):
    return torch.nn.functional.gelu(x, approximate="tanh")
def _silu(x):
    return torch.nn.functional.silu(x)
def _sigmoid(x):
    return torch.sigmoid(x)
def _layernorm(x, axis=-1, eps=1e-5):
    m = x.mean(dim=axis, keepdim=True)
    v = x.var(dim=axis, keepdim=True, unbiased=False)
    return (x - m) / torch.sqrt(v + eps)
def _scatter_add(tgt, idx, src, axis=0):
    return tgt.clone().index_add_(axis, idx, src)
def _segment_sum(src, seg, n):
    out = torch.zeros((n,) + src.shape[1:], dtype=src.dtype)
    return out.index_add_(0, seg, src)
def _pad(x, pw):
    flat = tuple(v for pair in reversed(pw) for v in pair)
    return torch.nn.functional.pad(x, flat)

kernel_name = 'gated_mix__mha_block__dense_activation_relu__prompt'

def setup_inputs():

    _w = (lambda a: (lambda t: t.to(torch.bfloat16) if t.is_floating_point() else t)(torch.as_tensor(a)))
    def _A_setup():
        B, S, D, H = 1, 2048, 640, 32
        return {
            "x": _w((lambda *s: torch.randn(*s, dtype=torch.bfloat16) * 0.05)(B, S, D)),
            "wqkv": _w((lambda *s: torch.randn(*s, dtype=torch.bfloat16) * 0.8)(D, 3 * D)),
            "wo": _w((lambda *s: torch.randn(*s, dtype=torch.bfloat16) * 0.2)(D, D)),
        }
    _A_in = _A_setup()

    def _B_setup():
        B, S, D, Dff = 1, 2048, 640, 1728
        return {
            "x": _w((lambda *s: torch.randn(*s, dtype=torch.bfloat16) * 0.05)(B, S, D)),
            "w1": _w((lambda *s: torch.randn(*s, dtype=torch.bfloat16) * 0.05)(D, Dff)),
            "w2": _w((lambda *s: torch.randn(*s, dtype=torch.bfloat16) * 0.05)(Dff, D)),
        }
    _B_in = _B_setup()

    return {
        "A_x": _A_in["x"],
        "A_wqkv": _A_in["wqkv"],
        "A_wo": _A_in["wo"],
        "B_x": _B_in["x"],
        "B_w1": _B_in["w1"],
        "B_w2": _B_in["w2"],
        "gate_w": _w((lambda *s: torch.randn(*s, dtype=torch.bfloat16) * 0.05)(640) * 16.0),
    }

def reference(A_x, A_wqkv, A_wo, B_x, B_w1, B_w2, gate_w):
    def _A_ref(x, wqkv, wo):
        B, S, D = x.shape
        H = 32
        Dh = D // H
        qkv = (lambda x, *d: x.permute(*d))((x @ wqkv).reshape(B, S, 3, H, Dh), 2, 0, 3, 1, 4)
        q, k, v = qkv[0], qkv[1], qkv[2]
        scores = torch.einsum("bhqd,bhkd->bhqk", q, k) * (Dh ** -0.5)
        p = _softmax(scores, axis=-1)
        o = torch.einsum("bhqk,bhkd->bhqd", p, v)
        return (lambda x, *d: x.permute(*d))(o, 0, 2, 1, 3).reshape(B, S, D) @ wo

    def _B_ref(x, w1, w2):
        h = torch.einsum("bsd,df->bsf", x, w1)
        zero = torch.zeros_like(h)
        h = torch.maximum(h, zero)
        return torch.einsum("bsf,fd->bsd", h, w2)

    x = A_x
    g = _sigmoid((x * gate_w).sum(-1, keepdims=True))
    a = _A_ref(x, A_wqkv, A_wo)
    b = _B_ref(x, B_w1, B_w2)
    return g * a + (1 - g) * b
```

```asm
; @launch kernel=gated_mix__mha_block__dense_activation_relu__prompt_kernel grid=(256,1,1) block=(512,1,1) lds=163840
.amdgcn_target "amdgcn-amd-amdhsa--gfx950"
.text
.globl gated_mix__mha_block__dense_activation_relu__prompt_kernel
.p2align 8
.type gated_mix__mha_block__dense_activation_relu__prompt_kernel,@function
gated_mix__mha_block__dense_activation_relu__prompt_kernel:
    s_cmp_lt_u32 s2, 256
    s_cbranch_scc1 g_go
    s_endpgm
g_go:
    s_load_dwordx16 s[16:31], s[0:1], 0
    s_load_dwordx4 s[32:35], s[0:1], 64
    v_lshrrev_b32 v1, 6, v0
    s_nop 0
    v_readfirstlane_b32 s36, v1
    v_and_b32 v1, 63, v0
    s_and_b32 s42, s2, 1
    s_lshl_b32 s42, s42, 3
    s_bfe_u32 s43, s2, 0x30003
    s_add_u32 s60, s42, s43
    s_bfe_u32 s42, s2, 0x20001
    s_lshl_b32 s42, s42, 2
    s_lshr_b32 s43, s2, 6
    s_add_u32 s61, s42, s43
    s_add_u32 s61, s61, 14
    s_and_b32 s61, s61, 15
    s_cmp_ge_u32 s36, 4
    s_cbranch_scc1 g_cons
    v_lshrrev_b32 v128, 3, v1
    v_lshrrev_b32 v129, 4, v1
    s_and_b32 s42, s36, 1
    s_lshl_b32 s42, s42, 2
    v_add_u32 v131, s42, v129
    v_and_b32 v130, 7, v1
    v_xor_b32_e64 v131, v130, v131
    v_lshlrev_b32 v131, 4, v131
    s_movk_i32 s42, 1280
    v_mad_u32_u24 v124, v128, s42, v131
    v_and_b32 v129, 1, v129
    v_lshlrev_b32 v129, 2, v129
    v_xor_b32_e64 v131, v130, v129
    v_lshlrev_b32 v131, 4, v131
    s_movk_i32 s42, 3456
    v_mad_u32_u24 v126, v128, s42, v131
    s_lshl_b32 s44, s61, 8
    s_cmp_lt_u32 s61, 15
    s_cselect_b32 s43, 3840, s42
    s_cselect_b32 s44, s44, 2944
    v_mad_u32_u24 v125, v128, s43, v131
    s_lshl_b32 s98, s43, 5
    s_lshl_b32 s42, s36, 3
    s_mul_i32 s43, s43, s42
    s_add_u32 s97, s43, s44
    s_lshl_b32 s43, s60, 7
    s_add_u32 s43, s43, s42
    s_mul_i32 s96, s43, 1280
    s_lshl_b32 s41, s36, 10
    s_waitcnt lgkmcnt(0)
    s_mov_b32 s88, s16
    s_mov_b32 s89, s17
    s_mov_b32 s90, 2621440
    s_mov_b32 s91, 0x00020000
    s_cmp_lt_u32 s61, 15
    s_cselect_b32 s92, s18, s24
    s_cselect_b32 s93, s19, s25
    s_mov_b32 s42, 2211840
    s_cselect_b32 s94, 2457600, s42
    s_mov_b32 s95, 0x00020000
    s_add_u32 m0, s41, 0
    s_add_u32 s42, s96, 0
    buffer_load_dwordx4 v124, s[88:91], s42 offen lds
    s_add_u32 m0, s41, 4096
    s_add_u32 s42, s96, 40960
    buffer_load_dwordx4 v124, s[88:91], s42 offen lds
    s_add_u32 m0, s41, 8192
    s_add_u32 s42, s96, 81920
    buffer_load_dwordx4 v124, s[88:91], s42 offen lds
    s_add_u32 m0, s41, 12288
    s_add_u32 s42, s96, 122880
    buffer_load_dwordx4 v124, s[88:91], s42 offen lds
    s_add_u32 m0, s41, 16384
    s_nop 0
    buffer_load_dwordx4 v125, s[92:95], s97 offen offset:0 lds
    s_add_u32 m0, s41, 24448
    s_nop 0
    buffer_load_dwordx4 v125, s[92:95], s97 offen offset:128 lds
    s_add_u32 m0, s41, 20480
    s_add_u32 s97, s97, s98
    buffer_load_dwordx4 v125, s[92:95], s97 offen offset:0 lds
    s_add_u32 m0, s41, 28544
    s_nop 0
    buffer_load_dwordx4 v125, s[92:95], s97 offen offset:128 lds
    s_add_u32 s97, s97, s98
    s_add_u32 m0, s41, 32768
    s_add_u32 s42, s96, 128
    buffer_load_dwordx4 v124, s[88:91], s42 offen lds
    s_add_u32 m0, s41, 36864
    s_add_u32 s42, s96, 41088
    buffer_load_dwordx4 v124, s[88:91], s42 offen lds
    s_add_u32 m0, s41, 40960
    s_add_u32 s42, s96, 82048
    buffer_load_dwordx4 v124, s[88:91], s42 offen lds
    s_add_u32 m0, s41, 45056
    s_add_u32 s42, s96, 123008
    buffer_load_dwordx4 v124, s[88:91], s42 offen lds
    s_add_u32 m0, s41, 49152
    s_nop 0
    buffer_load_dwordx4 v125, s[92:95], s97 offen offset:0 lds
    s_add_u32 m0, s41, 57216
    s_nop 0
    buffer_load_dwordx4 v125, s[92:95], s97 offen offset:128 lds
    s_add_u32 m0, s41, 53248
    s_add_u32 s97, s97, s98
    buffer_load_dwordx4 v125, s[92:95], s97 offen offset:0 lds
    s_add_u32 m0, s41, 61312
    s_nop 0
    buffer_load_dwordx4 v125, s[92:95], s97 offen offset:128 lds
    s_add_u32 s97, s97, s98
    s_add_u32 m0, s41, 65536
    s_add_u32 s42, s96, 256
    buffer_load_dwordx4 v124, s[88:91], s42 offen lds
    s_add_u32 m0, s41, 69632
    s_add_u32 s42, s96, 41216
    buffer_load_dwordx4 v124, s[88:91], s42 offen lds
    s_add_u32 m0, s41, 73728
    s_add_u32 s42, s96, 82176
    buffer_load_dwordx4 v124, s[88:91], s42 offen lds
    s_add_u32 m0, s41, 77824
    s_add_u32 s42, s96, 123136
    buffer_load_dwordx4 v124, s[88:91], s42 offen lds
    s_add_u32 m0, s41, 81920
    s_nop 0
    buffer_load_dwordx4 v125, s[92:95], s97 offen offset:0 lds
    s_add_u32 m0, s41, 89984
    s_nop 0
    buffer_load_dwordx4 v125, s[92:95], s97 offen offset:128 lds
    s_add_u32 m0, s41, 86016
    s_add_u32 s97, s97, s98
    buffer_load_dwordx4 v125, s[92:95], s97 offen offset:0 lds
    s_add_u32 m0, s41, 94080
    s_nop 0
    buffer_load_dwordx4 v125, s[92:95], s97 offen offset:128 lds
    s_add_u32 s97, s97, s98
    s_mul_i32 s43, s61, 192
    s_cmp_lt_u32 s61, 15
    s_cselect_b32 s43, s43, 3200
    s_and_b32 s44, s43, 64
    s_mul_i32 s42, s36, 27648
    s_add_u32 s99, s42, s43
    s_add_u32 s99, s99, s44
    s_mul_i32 s44, s44, 3
    v_lshrrev_b32 v128, 2, v1
    v_and_b32_e64 v129, 3, v1
    v_lshlrev_b32 v129, 4, v129
    s_movk_i32 s43, 3456
    v_mad_u32_u24 v127, v128, s43, v129
    s_cmp_lt_u32 s61, 14
    s_cselect_b32 s42, s42, 0
    s_mov_b32 s73, 110592
    s_cselect_b32 s73, 221184, s73
    s_cselect_b64 vcc, -1, 0
    s_add_u32 s72, s99, s42
    s_add_u32 s72, s72, 128
    s_sub_u32 s72, s72, s44
    s_sub_u32 s72, s72, s73
    v_cndmask_b32_e64 v127, v126, v127, vcc
    s_waitcnt vmcnt(16)
    s_barrier
    s_add_u32 m0, s41, 98304
    s_add_u32 s42, s96, 384
    buffer_load_dwordx4 v124, s[88:91], s42 offen lds
    s_add_u32 m0, s41, 102400
    s_add_u32 s42, s96, 41344
    buffer_load_dwordx4 v124, s[88:91], s42 offen lds
    s_add_u32 m0, s41, 106496
    s_add_u32 s42, s96, 82304
    buffer_load_dwordx4 v124, s[88:91], s42 offen lds
    s_add_u32 m0, s41, 110592
    s_add_u32 s42, s96, 123264
    buffer_load_dwordx4 v124, s[88:91], s42 offen lds
    s_add_u32 m0, s41, 114688
    s_nop 0
    buffer_load_dwordx4 v125, s[92:95], s97 offen offset:0 lds
    s_add_u32 m0, s41, 122752
    s_nop 0
    buffer_load_dwordx4 v125, s[92:95], s97 offen offset:128 lds
    s_add_u32 m0, s41, 118784
    s_add_u32 s97, s97, s98
    buffer_load_dwordx4 v125, s[92:95], s97 offen offset:0 lds
    s_add_u32 m0, s41, 126848
    s_nop 0
    buffer_load_dwordx4 v125, s[92:95], s97 offen offset:128 lds
    s_add_u32 s97, s97, s98
    s_waitcnt vmcnt(16)
    s_barrier
    s_add_u32 m0, s41, 131072
    s_add_u32 s42, s96, 512
    buffer_load_dwordx4 v124, s[88:91], s42 offen lds
    s_add_u32 m0, s41, 135168
    s_add_u32 s42, s96, 41472
    buffer_load_dwordx4 v124, s[88:91], s42 offen lds
    s_add_u32 m0, s41, 139264
    s_add_u32 s42, s96, 82432
    buffer_load_dwordx4 v124, s[88:91], s42 offen lds
    s_add_u32 m0, s41, 143360
    s_add_u32 s42, s96, 123392
    buffer_load_dwordx4 v124, s[88:91], s42 offen lds
    s_add_u32 m0, s41, 147456
    s_nop 0
    buffer_load_dwordx4 v125, s[92:95], s97 offen offset:0 lds
    s_add_u32 m0, s41, 155520
    s_nop 0
    buffer_load_dwordx4 v125, s[92:95], s97 offen offset:128 lds
    s_add_u32 m0, s41, 151552
    s_add_u32 s97, s97, s98
    buffer_load_dwordx4 v125, s[92:95], s97 offen offset:0 lds
    s_add_u32 m0, s41, 159616
    s_nop 0
    buffer_load_dwordx4 v125, s[92:95], s97 offen offset:128 lds
    s_add_u32 s97, s97, s98
    s_mov_b32 s3, s36
    s_lshl_b32 s42, s2, 2
    s_add_u32 s42, s42, s3
    s_cmp_lt_u32 s42, 740
    s_cselect_b32 s69, 0, 0x7f000000
    s_min_u32 s42, s42, 739
    s_mul_i32 s43, s42, 205
    s_lshr_b32 s43, s43, 10
    s_mul_i32 s44, s43, 5
    s_sub_u32 s44, s42, s44
    s_mul_i32 s68, s43, 20
    s_lshl_b32 s42, s44, 2
    s_add_u32 s68, s68, s42
    s_lshl_b32 s68, s68, 10
    s_add_u32 s68, s68, s69
    s_sub_u32 s42, s43, 108
    s_mul_i32 s101, s42, 103
    s_lshr_b32 s101, s101, 10
    s_mul_i32 s75, s101, 10
    s_sub_u32 s42, s42, s75
    s_mul_i32 s101, s101, 160
    s_mul_i32 s75, s42, 20
    s_mul_i32 s62, s42, 80
    s_sub_u32 s62, s62, 624
    s_cmp_lt_u32 s42, 8
    s_cselect_b32 s75, s75, s62
    s_movk_i32 s70, 25600
    s_cselect_b32 s70, 5120, s70
    s_add_u32 s42, s101, s75
    s_lshl_b32 s101, s43, 4
    s_cmp_lt_u32 s43, 108
    s_cselect_b32 s43, s101, s42
    s_cselect_b32 s70, 5120, s70
    s_cselect_b32 s4, s26, s20
    s_cselect_b32 s5, s27, s21
    s_mov_b32 s42, 819200
    s_cselect_b32 s6, 2211840, s42
    s_mov_b32 s7, 0x00020000
    s_mul_i32 s43, s43, 1280
    s_lshl_b32 s44, s44, 8
    s_add_u32 s43, s43, s44
    s_cmp_lt_u32 s3, 2
    s_cselect_b32 s71, 0, 0x7f000000
    v_and_b32 v223, 15, v1
    v_lshrrev_b32 v221, 4, v1
    v_lshlrev_b32_e64 v220, 4, v223
    v_mul_u32_u24 v224, 1280, v221
    v_add_u32 v224, v220, v224
    v_add_u32 v222, s69, v224
    s_lshl_b32 s42, s60, 4
    s_add_u32 s42, s42, s61
    s_lshl_b32 s42, s42, 1
    s_and_b32 s44, s3, 1
    s_add_u32 s42, s42, s44
    s_lshl_b32 s62, s42, 4
    s_mul_i32 s101, s42, 5120
    s_add_u32 s43, s43, s70
    s_add_u32 s43, s43, s70
    s_add_u32 s43, s43, s70
    s_mov_b32 s8, s28
    s_mov_b32 s9, s29
    s_mov_b32 s10, 1280
    s_mov_b32 s11, 0x00020000
    v_lshlrev_b32 v226, 6, v1
    s_cmp_eq_u32 s36, 0
    s_cselect_b64 exec, -1, 0
    buffer_load_dword v226, v226, s[8:11], 0 offen
    s_mov_b64 exec, -1
    s_waitcnt vmcnt(17)
    s_barrier
    s_add_u32 m0, s41, 0
    s_add_u32 s42, s96, 640
    buffer_load_dwordx4 v124, s[88:91], s42 offen lds
    s_add_u32 m0, s41, 4096
    s_add_u32 s42, s96, 41600
    buffer_load_dwordx4 v124, s[88:91], s42 offen lds
    s_add_u32 m0, s41, 8192
    s_add_u32 s42, s96, 82560
    buffer_load_dwordx4 v124, s[88:91], s42 offen lds
    s_add_u32 m0, s41, 12288
    s_add_u32 s42, s96, 123520
    buffer_load_dwordx4 v124, s[88:91], s42 offen lds
    s_add_u32 m0, s41, 16384
    s_nop 0
    buffer_load_dwordx4 v125, s[92:95], s97 offen offset:0 lds
    s_add_u32 m0, s41, 24448
    s_nop 0
    buffer_load_dwordx4 v125, s[92:95], s97 offen offset:128 lds
    s_add_u32 m0, s41, 20480
    s_add_u32 s97, s97, s98
    buffer_load_dwordx4 v125, s[92:95], s97 offen offset:0 lds
    s_add_u32 m0, s41, 28544
    s_nop 0
    buffer_load_dwordx4 v125, s[92:95], s97 offen offset:128 lds
    s_add_u32 s97, s97, s98
    s_waitcnt vmcnt(17)
    s_barrier
    s_add_u32 m0, s41, 32768
    s_add_u32 s42, s96, 768
    buffer_load_dwordx4 v124, s[88:91], s42 offen lds
    s_add_u32 m0, s41, 36864
    s_add_u32 s42, s96, 41728
    buffer_load_dwordx4 v124, s[88:91], s42 offen lds
    s_add_u32 m0, s41, 40960
    s_add_u32 s42, s96, 82688
    buffer_load_dwordx4 v124, s[88:91], s42 offen lds
    s_add_u32 m0, s41, 45056
    s_add_u32 s42, s96, 123648
    buffer_load_dwordx4 v124, s[88:91], s42 offen lds
    s_add_u32 m0, s41, 49152
    s_nop 0
    buffer_load_dwordx4 v125, s[92:95], s97 offen offset:0 lds
    s_add_u32 m0, s41, 57216
    s_nop 0
    buffer_load_dwordx4 v125, s[92:95], s97 offen offset:128 lds
    s_add_u32 m0, s41, 53248
    s_add_u32 s97, s97, s98
    buffer_load_dwordx4 v125, s[92:95], s97 offen offset:0 lds
    s_add_u32 m0, s41, 61312
    s_nop 0
    buffer_load_dwordx4 v125, s[92:95], s97 offen offset:128 lds
    s_add_u32 s97, s97, s98
    s_add_u32 s62, s62, s71
    s_add_u32 s62, s62, 5242880
    v_lshlrev_b32 v182, 2, v221
    v_add_u32_e64 v182, s62, v182
    v_mov_b32 v183, 0x7f000000
    v_cmp_eq_u32 vcc, 0, v223
    v_lshlrev_b32 v180, 5, v221
    v_cndmask_b32 v182, v183, v182, vcc
    v_cmp_gt_u32 vcc, 8, v223
    v_and_b32_e64 v181, 3, v1
    v_lshl_add_u32 v180, v181, 7, v180
    v_bfe_u32 v181, v1, 2, 1
    v_lshl_add_u32 v180, v181, 10, v180
    v_lshrrev_b32_e64 v181, 3, v223
    v_lshl_add_u32 v180, v181, 4, v180
    v_add_u32_e64 v180, s68, v180
    v_mov_b32 v181, 0x05040100
    v_mov_b32 v183, 0x07060302
    v_cndmask_b32_e64 v181, v181, v183, vcc
    s_mul_i32 s42, s2, 10240
    s_lshl_b32 s43, s3, 10
    s_add_u32 s42, s42, s43
    v_lshlrev_b32 v183, 4, v1
    v_add_u32 v183, s42, v183
    v_add_u32_e64 v184, s71, v183
    s_waitcnt vmcnt(17)
    s_barrier
    s_add_u32 m0, s41, 65536
    s_add_u32 s42, s96, 896
    buffer_load_dwordx4 v124, s[88:91], s42 offen lds
    s_add_u32 m0, s41, 69632
    s_add_u32 s42, s96, 41856
    buffer_load_dwordx4 v124, s[88:91], s42 offen lds
    s_add_u32 m0, s41, 73728
    s_add_u32 s42, s96, 82816
    buffer_load_dwordx4 v124, s[88:91], s42 offen lds
    s_add_u32 m0, s41, 77824
    s_add_u32 s42, s96, 123776
    buffer_load_dwordx4 v124, s[88:91], s42 offen lds
    s_add_u32 m0, s41, 81920
    s_nop 0
    buffer_load_dwordx4 v125, s[92:95], s97 offen offset:0 lds
    s_add_u32 m0, s41, 89984
    s_nop 0
    buffer_load_dwordx4 v125, s[92:95], s97 offen offset:128 lds
    s_add_u32 m0, s41, 86016
    s_add_u32 s97, s97, s98
    buffer_load_dwordx4 v125, s[92:95], s97 offen offset:0 lds
    s_add_u32 m0, s41, 94080
    s_nop 0
    buffer_load_dwordx4 v125, s[92:95], s97 offen offset:128 lds
    s_add_u32 s97, s97, s98
    s_waitcnt vmcnt(16)
    s_barrier
    s_add_u32 m0, s41, 98304
    s_add_u32 s42, s96, 1024
    buffer_load_dwordx4 v124, s[88:91], s42 offen lds
    s_add_u32 m0, s41, 102400
    s_add_u32 s42, s96, 41984
    buffer_load_dwordx4 v124, s[88:91], s42 offen lds
    s_add_u32 m0, s41, 106496
    s_add_u32 s42, s96, 82944
    buffer_load_dwordx4 v124, s[88:91], s42 offen lds
    s_add_u32 m0, s41, 110592
    s_add_u32 s42, s96, 123904
    buffer_load_dwordx4 v124, s[88:91], s42 offen lds
    s_add_u32 m0, s41, 114688
    s_nop 0
    buffer_load_dwordx4 v125, s[92:95], s97 offen offset:0 lds
    s_add_u32 m0, s41, 122752
    s_nop 0
    buffer_load_dwordx4 v125, s[92:95], s97 offen offset:128 lds
    s_add_u32 m0, s41, 118784
    s_add_u32 s97, s97, s98
    buffer_load_dwordx4 v125, s[92:95], s97 offen offset:0 lds
    s_add_u32 m0, s41, 126848
    s_nop 0
    buffer_load_dwordx4 v125, s[92:95], s97 offen offset:128 lds
    s_add_u32 s97, s97, s98
    v_mov_b32 v228, -1
    v_mov_b32 v229, -1
    v_mov_b32 v230, -1
    v_mov_b32 v231, -1
    s_waitcnt vmcnt(16)
    s_barrier
    s_add_u32 m0, s41, 131072
    s_add_u32 s42, s96, 1152
    buffer_load_dwordx4 v124, s[88:91], s42 offen lds
    s_add_u32 m0, s41, 135168
    s_add_u32 s42, s96, 42112
    buffer_load_dwordx4 v124, s[88:91], s42 offen lds
    s_add_u32 m0, s41, 139264
    s_add_u32 s42, s96, 83072
    buffer_load_dwordx4 v124, s[88:91], s42 offen lds
    s_add_u32 m0, s41, 143360
    s_add_u32 s42, s96, 124032
    buffer_load_dwordx4 v124, s[88:91], s42 offen lds
    s_add_u32 m0, s41, 147456
    s_nop 0
    buffer_load_dwordx4 v125, s[92:95], s97 offen offset:0 lds
    s_add_u32 m0, s41, 155520
    s_nop 0
    buffer_load_dwordx4 v125, s[92:95], s97 offen offset:128 lds
    s_add_u32 m0, s41, 151552
    s_add_u32 s97, s97, s98
    buffer_load_dwordx4 v125, s[92:95], s97 offen offset:0 lds
    s_add_u32 m0, s41, 159616
    s_nop 0
    buffer_load_dwordx4 v125, s[92:95], s97 offen offset:128 lds
    s_add_u32 s97, s97, s98
    s_waitcnt vmcnt(16)
    s_barrier
    s_mov_b32 s92, s24
    s_mov_b32 s93, s25
    s_mov_b32 s94, 2211840
    s_mov_b32 s95, 0x00020000
    s_add_u32 m0, s41, 0
    s_add_u32 s42, s99, 0
    buffer_load_dwordx4 v126, s[92:95], s42 offen lds
    s_add_u32 m0, s41, 4096
    s_add_u32 s42, s99, 110592
    buffer_load_dwordx4 v126, s[92:95], s42 offen lds
    s_add_u32 m0, s41, 8192
    s_add_u32 s42, s99, 221184
    buffer_load_dwordx4 v126, s[92:95], s42 offen lds
    s_add_u32 m0, s41, 12288
    s_add_u32 s42, s99, 331776
    buffer_load_dwordx4 v126, s[92:95], s42 offen lds
    s_add_u32 m0, s41, 16384
    s_add_u32 s42, s99, 442368
    buffer_load_dwordx4 v126, s[92:95], s42 offen lds
    s_waitcnt vmcnt(13)
    s_barrier
    s_add_u32 m0, s41, 20480
    s_add_u32 s42, s99, 552960
    buffer_load_dwordx4 v126, s[92:95], s42 offen lds
    s_add_u32 m0, s41, 24576
    s_add_u32 s42, s99, 663552
    buffer_load_dwordx4 v126, s[92:95], s42 offen lds
    s_add_u32 m0, s41, 28672
    s_add_u32 s42, s99, 774144
    buffer_load_dwordx4 v126, s[92:95], s42 offen lds
    s_add_u32 m0, s41, 32768
    s_add_u32 s42, s99, 884736
    buffer_load_dwordx4 v126, s[92:95], s42 offen lds
    s_add_u32 m0, s41, 36864
    s_add_u32 s42, s99, 995328
    buffer_load_dwordx4 v126, s[92:95], s42 offen lds
    s_add_u32 m0, s41, 40960
    s_add_u32 s42, s99, 1105920
    buffer_load_dwordx4 v126, s[92:95], s42 offen lds
    s_add_u32 m0, s41, 45056
    s_add_u32 s42, s99, 1216512
    buffer_load_dwordx4 v126, s[92:95], s42 offen lds
    s_add_u32 m0, s41, 49152
    s_add_u32 s42, s99, 1327104
    buffer_load_dwordx4 v126, s[92:95], s42 offen lds
    s_add_u32 m0, s41, 53248
    s_add_u32 s42, s99, 1437696
    buffer_load_dwordx4 v126, s[92:95], s42 offen lds
    s_add_u32 m0, s41, 57344
    s_add_u32 s42, s99, 1548288
    buffer_load_dwordx4 v126, s[92:95], s42 offen lds
    s_waitcnt vmcnt(15)
    s_barrier
    s_add_u32 m0, s41, 61440
    s_add_u32 s42, s99, 1658880
    buffer_load_dwordx4 v126, s[92:95], s42 offen lds
    s_add_u32 m0, s41, 65536
    s_add_u32 s42, s99, 1769472
    buffer_load_dwordx4 v126, s[92:95], s42 offen lds
    s_add_u32 m0, s41, 69632
    s_add_u32 s42, s99, 1880064
    buffer_load_dwordx4 v126, s[92:95], s42 offen lds
    s_add_u32 m0, s41, 73728
    s_add_u32 s42, s99, 1990656
    buffer_load_dwordx4 v126, s[92:95], s42 offen lds
    s_add_u32 m0, s41, 77824
    s_add_u32 s42, s99, 2101248
    buffer_load_dwordx4 v126, s[92:95], s42 offen lds
    s_waitcnt vmcnt(15)
    s_barrier
    s_and_b32 s42, s2, 7
    s_lshl_b32 s42, s42, 2
    s_lshr_b32 s43, s2, 3
    s_and_b32 s43, s43, 3
    s_add_u32 s37, s42, s43
    s_lshr_b32 s42, s2, 5
    s_lshl_b32 s42, s42, 3
    s_and_b32 s74, s36, 3
    s_lshl_b32 s43, s74, 1
    s_add_u32 s38, s42, s43
    s_lshr_b32 s42, s36, 2
    s_add_u32 s38, s38, s42
    s_and_b32 s42, s2, 7
    s_lshl_b32 s42, s42, 3
    s_bfe_u32 s43, s2, 0x30003
    s_add_u32 s45, s42, s43
    s_lshr_b32 s46, s2, 6
    s_add_u32 s4, s34, 2621440
    s_addc_u32 s5, s35, 0
    s_mov_b32 s6, 5242880
    s_mov_b32 s7, 0x00020000
    s_mov_b32 s8, s34
    s_mov_b32 s9, s35
    s_mov_b32 s10, 7864320
    s_mov_b32 s11, 0x00020000
    s_lshl_b32 s41, s36, 10
    s_mul_i32 s39, s37, 163840
    s_add_u32 s39, s39, s41
    s_add_u32 s64, s34, 7864320
    s_addc_u32 s65, s35, 0
    s_mov_b32 s66, 7077888
    s_mov_b32 s67, 0x00020000
    s_add_u32 s68, s34, 20971520
    s_addc_u32 s69, s35, 0
    s_mov_b32 s70, 3031040
    s_mov_b32 s71, 0x00020000
    s_add_u32 s12, s34, 14942208
    s_addc_u32 s13, s35, 0
    s_mov_b32 s14, 5251072
    s_mov_b32 s15, 0x00020000
    s_mul_i32 s75, s74, 200
    s_add_u32 s75, s75, 4
    s_cmp_lt_u32 s36, 4
    s_cselect_b32 s75, s75, s74
    s_mul_i32 s42, s46, 5
    s_add_u32 s75, s75, s42
    s_add_u32 s75, s75, 2160
    s_lshl_b32 s75, s75, 10
    s_mul_i32 s47, s36, 10240
    s_mov_b32 s62, 0x000fffff
    s_mov_b32 s63, 0x000fffff
    s_add_u32 s48, s34, 20316160
    s_addc_u32 s49, s35, 0
    s_mov_b32 s50, 73728
    s_mov_b32 s51, 0x00020000
    s_mov_b32 s52, s32
    s_mov_b32 s53, s33
    s_mov_b32 s54, 256
    s_mov_b32 s55, 0x00020000
    v_lshlrev_b32 v119, 6, v1
    v_mov_b32 v114, 64
    v_mov_b32 v115, 64
    s_movk_i32 s44, 0x400
    v_lshlrev_b32 v2, 4, v1
    v_mov_b32 v5, v2
    v_and_b32 v8, 31, v1
    v_lshrrev_b32 v9, 5, v1
    v_lshlrev_b32_e64 v11, 3, v8
    v_mul_u32_u24 v3, 2560, v9
    v_add3_u32 v3, v3, v11, s44
    v_mov_b32 v20, 0
    v_mov_b32 v21, 0
    v_mov_b32 v22, 0
    v_mov_b32 v23, 0
    v_mov_b32 v6, 0
    v_mov_b32 v7, 0
    v_mov_b32 v254, 0
    v_mov_b32 v255, 0
    v_lshrrev_b32 v4, 3, v8
    v_xor_b32 v4, v4, v9
    v_and_b32 v4, 1, v4
    v_lshlrev_b32 v4, 6, v4
    v_lshrrev_b32_e64 v10, 2, v8
    v_lshl_add_u32 v4, v10, 7, v4
    v_and_b32_e64 v10, 3, v8
    v_lshl_add_u32 v4, v10, 4, v4
    v_add_u32 v4, 1280, v4
    v_cmp_eq_u32_e64 vcc, 20, v8
    v_cmp_eq_u32 s[58:59], 24, v8
    s_mul_i32 s42, s74, 2560
    s_add_u32 s42, s42, 71680
    s_or_b64 vcc, vcc, s[58:59]
    v_mov_b32 v10, 0x3f803f80
    s_nop 1
    v_cndmask_b32 v10, 0, v10, vcc
    v_mov_b32 v30, v10
    v_mov_b32 v31, v10
    v_mov_b32 v32, v10
    v_mov_b32 v33, v10
    v_mov_b32 v34, v10
    v_mov_b32 v35, v10
    v_mov_b32 v36, v10
    v_mov_b32 v37, v10
    v_add_u32 v10, s42, v2
    v_add_u32 v11, s42, v11
    v_and_b32 v118, 3, v1
    v_lshlrev_b32 v118, 4, v118
    s_lshl_b32 s56, s37, 11
    s_lshr_b32 s57, s2, 5
    v_and_b32 v120, 3, v1
    v_lshlrev_b32_e64 v120, 4, v120
    s_mul_i32 s42, s36, 128
    v_add_u32 v120, s42, v120
    s_lshl_b32 s42, s57, 4
    s_add_u32 s42, s42, 512
    v_mov_b32 v121, s42
    s_cmp_eq_u32 s36, 3
    s_cselect_b32 vcc_lo, 0xffff0000, 0
    s_mov_b32 vcc_hi, 0
    v_cndmask_b32 v120, v120, v121, vcc
    s_lshl_b32 s42, s37, 3
    s_add_u32 s42, s42, s57
    s_mul_i32 s42, s42, 10240
    s_mul_i32 s43, s37, 163840
    s_add_u32 s43, s43, s47
    s_add_u32 s43, s43, 2621440
    s_add_u32 s44, s43, 40960
    s_add_u32 s57, s47, 40960
    s_cmp_eq_u32 s36, 3
    s_cselect_b32 s96, s42, s43
    s_cselect_b32 s97, 71680, s47
    s_cselect_b32 s98, s43, s44
    s_cselect_b32 s99, s47, s57
    s_waitcnt vmcnt(10)
    s_barrier
    s_add_u32 m0, s41, 81920
    s_add_u32 s72, s72, s73
    buffer_load_dwordx4 v127, s[92:95], s72 offen lds
    s_add_u32 m0, s41, 86016
    s_add_u32 s72, s72, s73
    buffer_load_dwordx4 v127, s[92:95], s72 offen lds
    s_add_u32 m0, s41, 90112
    s_add_u32 s72, s72, s73
    buffer_load_dwordx4 v127, s[92:95], s72 offen lds
    s_add_u32 m0, s41, 94208
    s_add_u32 s72, s72, s73
    buffer_load_dwordx4 v127, s[92:95], s72 offen lds
    s_add_u32 m0, s41, 98304
    s_add_u32 s72, s72, s73
    buffer_load_dwordx4 v127, s[92:95], s72 offen lds
    s_add_u32 m0, s41, 102400
    s_add_u32 s72, s72, s73
    buffer_load_dwordx4 v127, s[92:95], s72 offen lds
    s_add_u32 m0, s41, 106496
    s_add_u32 s72, s72, s73
    buffer_load_dwordx4 v127, s[92:95], s72 offen lds
    s_add_u32 m0, s41, 110592
    s_add_u32 s72, s72, s73
    buffer_load_dwordx4 v127, s[92:95], s72 offen lds
    s_add_u32 m0, s41, 114688
    s_add_u32 s72, s72, s73
    buffer_load_dwordx4 v127, s[92:95], s72 offen lds
    s_add_u32 m0, s41, 118784
    s_add_u32 s72, s72, s73
    buffer_load_dwordx4 v127, s[92:95], s72 offen lds
    s_waitcnt vmcnt(15)
    s_barrier
    s_cmp_lt_u32 s61, 14
    s_cbranch_scc1 g_l16
    s_add_u32 m0, s41, 122880
    s_add_u32 s72, s72, s73
    buffer_load_dwordx4 v127, s[92:95], s72 offen lds
    s_add_u32 m0, s41, 126976
    s_add_u32 s72, s72, s73
    buffer_load_dwordx4 v127, s[92:95], s72 offen lds
    s_add_u32 m0, s41, 131072
    s_add_u32 s72, s72, s73
    buffer_load_dwordx4 v127, s[92:95], s72 offen lds
    s_add_u32 m0, s41, 135168
    s_add_u32 s72, s72, s73
    buffer_load_dwordx4 v127, s[92:95], s72 offen lds
    s_add_u32 m0, s41, 139264
    s_add_u32 s72, s72, s73
    buffer_load_dwordx4 v127, s[92:95], s72 offen lds
    s_add_u32 m0, s41, 143360
    s_add_u32 s72, s72, s73
    buffer_load_dwordx4 v127, s[92:95], s72 offen lds
    s_add_u32 m0, s41, 147456
    s_add_u32 s72, s72, s73
    buffer_load_dwordx4 v127, s[92:95], s72 offen lds
    s_add_u32 m0, s41, 151552
    s_add_u32 s72, s72, s73
    buffer_load_dwordx4 v127, s[92:95], s72 offen lds
    s_add_u32 m0, s41, 155648
    s_add_u32 s72, s72, s73
    buffer_load_dwordx4 v127, s[92:95], s72 offen lds
    s_add_u32 m0, s41, 159744
    s_add_u32 s72, s72, s73
    buffer_load_dwordx4 v127, s[92:95], s72 offen lds
g_l16:
    s_cmp_eq_u32 s36, 0
    s_cselect_b64 exec, 15, 0
    buffer_load_dword v114, v119, s[52:55], 0 offen sc1
    s_mov_b64 exec, -1
    s_mul_i32 s72, s45, 108
    s_add_u32 s72, s72, s36
    s_lshl_b32 s72, s72, 10
    s_mul_i32 s73, s36, 20
    s_mul_i32 s42, s46, 5
    s_add_u32 s73, s73, s42
    s_lshl_b32 s73, s73, 10
    s_waitcnt vmcnt(10)
    s_barrier
    s_cmp_lt_u32 s3, 2
    s_cbranch_scc0 g_br1
    s_mov_b32 s92, s28
    s_mov_b32 s93, s29
    s_mov_b32 s94, 1280
    s_mov_b32 s95, 0x00020000
    buffer_load_dwordx4 v[140:143], v220, s[92:95], 0 offen offset:0
    buffer_load_dwordx4 v[144:147], v220, s[92:95], 0 offen offset:256
    buffer_load_dwordx4 v[148:151], v220, s[92:95], 0 offen offset:512
    buffer_load_dwordx4 v[152:155], v220, s[92:95], 0 offen offset:768
    buffer_load_dwordx4 v[156:159], v220, s[92:95], 0 offen offset:1024
    buffer_load_dwordx4 v[160:163], v224, s[88:91], s101 offen offset:0
    buffer_load_dwordx4 v[164:167], v224, s[88:91], s101 offen offset:256
    buffer_load_dwordx4 v[168:171], v224, s[88:91], s101 offen offset:512
    buffer_load_dwordx4 v[172:175], v224, s[88:91], s101 offen offset:768
    buffer_load_dwordx4 v[176:179], v224, s[88:91], s101 offen offset:1024
g_br1:
    s_waitcnt vmcnt(10)
    s_cmp_lt_u32 s3, 2
    s_cbranch_scc1 g_ca
    s_waitcnt vmcnt(0)
g_ca:
    v_cmp_ne_u32_e64 vcc, 64, v114
    s_cbranch_vccnz g_car
g_caok:
    s_barrier
    s_branch g_p1
g_p1r:
    s_sleep 5
g_p1:
    buffer_load_dwordx4 v[110:113], v120, s[48:51], s56 offen sc1
    s_waitcnt vmcnt(0)
g_p1c:
    v_and_b32 v110, v110, v111
    v_and_b32 v112, v112, v113
    v_and_b32 v110, v110, v112
    v_cmp_ne_u32 vcc, 1, v110
    s_cbranch_vccnz g_p1r
g_p1ok:
    s_add_u32 m0, s97, 0
    s_add_u32 s42, s96, 0
    buffer_load_dwordx4 v2, s[8:11], s42 offen offset:0 sc1 lds
    buffer_load_dwordx4 v2, s[8:11], s42 offen offset:1024 sc1 lds
    buffer_load_dwordx4 v2, s[8:11], s42 offen offset:2048 sc1 lds
    buffer_load_dwordx4 v2, s[8:11], s42 offen offset:3072 sc1 lds
    s_add_u32 m0, s97, 4096
    s_add_u32 s42, s96, 4096
    buffer_load_dwordx4 v2, s[8:11], s42 offen offset:0 sc1 lds
    buffer_load_dwordx4 v2, s[8:11], s42 offen offset:1024 sc1 lds
    buffer_load_dwordx4 v2, s[8:11], s42 offen offset:2048 sc1 lds
    buffer_load_dwordx4 v2, s[8:11], s42 offen offset:3072 sc1 lds
    s_add_u32 m0, s97, 8192
    s_add_u32 s42, s96, 8192
    buffer_load_dwordx4 v2, s[8:11], s42 offen offset:0 sc1 lds
    buffer_load_dwordx4 v2, s[8:11], s42 offen offset:1024 sc1 lds
    s_add_u32 m0, s99, 0
    s_add_u32 s42, s98, 0
    buffer_load_dwordx4 v2, s[8:11], s42 offen offset:0 sc1 lds
    buffer_load_dwordx4 v2, s[8:11], s42 offen offset:1024 sc1 lds
    buffer_load_dwordx4 v2, s[8:11], s42 offen offset:2048 sc1 lds
    buffer_load_dwordx4 v2, s[8:11], s42 offen offset:3072 sc1 lds
    s_add_u32 m0, s99, 4096
    s_add_u32 s42, s98, 4096
    buffer_load_dwordx4 v2, s[8:11], s42 offen offset:0 sc1 lds
    buffer_load_dwordx4 v2, s[8:11], s42 offen offset:1024 sc1 lds
    buffer_load_dwordx4 v2, s[8:11], s42 offen offset:2048 sc1 lds
    buffer_load_dwordx4 v2, s[8:11], s42 offen offset:3072 sc1 lds
    s_add_u32 m0, s99, 8192
    s_add_u32 s42, s98, 8192
    buffer_load_dwordx4 v2, s[8:11], s42 offen offset:0 sc1 lds
    buffer_load_dwordx4 v2, s[8:11], s42 offen offset:1024 sc1 lds
    v_mov_b32 v185, 0
    v_mov_b32 v186, 0
    v_dot2_f32_bf16 v185, v140, v160, v185
    v_dot2_f32_bf16 v186, v141, v161, v186
    v_dot2_f32_bf16 v185, v142, v162, v185
    v_dot2_f32_bf16 v186, v143, v163, v186
    v_dot2_f32_bf16 v185, v144, v164, v185
    v_dot2_f32_bf16 v186, v145, v165, v186
    v_dot2_f32_bf16 v185, v146, v166, v185
    v_dot2_f32_bf16 v186, v147, v167, v186
    v_dot2_f32_bf16 v185, v148, v168, v185
    v_dot2_f32_bf16 v186, v149, v169, v186
    v_dot2_f32_bf16 v185, v150, v170, v185
    v_dot2_f32_bf16 v186, v151, v171, v186
    v_dot2_f32_bf16 v185, v152, v172, v185
    v_dot2_f32_bf16 v186, v153, v173, v186
    v_dot2_f32_bf16 v185, v154, v174, v185
    v_dot2_f32_bf16 v186, v155, v175, v186
    v_dot2_f32_bf16 v185, v156, v176, v185
    v_dot2_f32_bf16 v186, v157, v177, v186
    v_dot2_f32_bf16 v185, v158, v178, v185
    v_dot2_f32_bf16 v186, v159, v179, v186
    s_nop 3
    v_add_f32_e64 v185, v185, v186
    s_nop 1
    v_add_f32_dpp v185, v185, v185 row_ror:8 row_mask:0xf bank_mask:0xf
    s_nop 1
    v_add_f32_dpp v185, v185, v185 row_ror:4 row_mask:0xf bank_mask:0xf
    s_nop 1
    v_add_f32_dpp v185, v185, v185 row_ror:2 row_mask:0xf bank_mask:0xf
    s_nop 1
    v_add_f32_dpp v185, v185, v185 row_ror:1 row_mask:0xf bank_mask:0xf
    s_nop 1
    v_cvt_pk_bf16_f32 v185, v185, v185
    v_lshlrev_b32_e64 v185, 16, v185
    v_mul_f32 v185, 3216550459, v185
    v_exp_f32 v185, v185
    s_nop 0
    v_add_f32_e64 v185, 1.0, v185
    v_rcp_f32 v185, v185
    s_nop 0
    v_cvt_pk_bf16_f32 v185, v185, v185
    v_lshlrev_b32 v185, 16, v185
    s_lshl_b32 s57, s45, 7
    s_add_u32 s57, s57, 65536
    s_waitcnt vmcnt(10)
    s_barrier
    ds_read_b128 v[12:15], v10
    ds_read_b128 v[24:27], v5 offset:0
    s_mov_b32 exec_hi, 0
    ds_read_b64 v[20:21], v11 offset:1024
    ds_read_b64 v[22:23], v11 offset:2304
    s_mov_b32 exec_hi, -1
    ds_read_b64 v[28:29], v3 offset:0
    ds_read_b128 v[16:19], v10 offset:1280
    s_mov_b32 exec_lo, 0
    ds_read_b64 v[6:7], v11 offset:1024
    ds_read_b64 v[254:255], v11 offset:2304
    s_mov_b32 exec_lo, -1
    s_mov_b64 exec, s[62:63]
    ds_read_b128 v[30:33], v4 offset:0
    s_mov_b64 exec, -1
    s_waitcnt lgkmcnt(7)
    v_mfma_f32_32x32x16_bf16 v[46:61], v[24:27], v[12:15], 0
    s_waitcnt lgkmcnt(4)
    v_mfma_f32_32x32x8_bf16 v[46:61], v[28:29], v[20:21], v[46:61]
    s_add_u32 m0, s41, 81920
    s_add_u32 s42, s39, 81920
    buffer_load_dwordx4 v2, s[4:7], s42 offen sc1 lds
    s_add_u32 m0, s41, 90112
    s_add_u32 s42, s39, 90112
    buffer_load_dwordx4 v2, s[4:7], s42 offen sc1 lds
    s_waitcnt lgkmcnt(1)
    s_nop 4
    v_mfma_f32_32x32x16_bf16 v[62:77], v[24:27], v[16:19], 0
    v_exp_f32 v46, v46
    v_exp_f32 v47, v47
    v_exp_f32 v48, v48
    v_exp_f32 v49, v49
    s_setprio 3
    s_mov_b64 exec, s[62:63]
    ds_read_b128 v[34:37], v4 offset:640
    s_or_b64 exec, -1, 0x70000000
    ds_read_b128 v[24:27], v5 offset:2560
    v_exp_f32 v50, v50
    v_exp_f32 v51, v51
    v_exp_f32 v52, v52
    v_exp_f32 v53, v53
    v_mfma_f32_32x32x8_bf16 v[62:77], v[28:29], v[22:23], v[62:77]
    v_cvt_pk_bf16_f32 v38, v46, v47
    v_cvt_pk_bf16_f32 v39, v48, v49
    v_cvt_pk_bf16_f32 v40, v50, v51
    v_cvt_pk_bf16_f32 v41, v52, v53
    s_add_u32 m0, s41, 98304
    s_add_u32 s42, s39, 98304
    buffer_load_dwordx4 v2, s[4:7], s42 offen sc1 lds
    s_add_u32 m0, s41, 106496
    s_add_u32 s42, s39, 106496
    buffer_load_dwordx4 v2, s[4:7], s42 offen sc1 lds
    s_add_u32 m0, s41, 114688
    s_add_u32 s42, s39, 114688
    buffer_load_dwordx4 v2, s[4:7], s42 offen sc1 lds
    v_exp_f32_e64 v54, v54
    v_exp_f32 v55, v55
    s_waitcnt lgkmcnt(2)
    v_mfma_f32_32x32x16_bf16 v[78:93], v[30:33], v[38:41], 0
    v_exp_f32 v56, v56
    v_exp_f32 v57, v57
    v_exp_f32 v58, v58
    v_exp_f32 v59, v59
    v_exp_f32_e64 v60, v60
    v_exp_f32 v61, v61
    s_waitcnt lgkmcnt(0)
    v_cvt_pk_bf16_f32 v42, v54, v55
    v_cvt_pk_bf16_f32 v43, v56, v57
    v_cvt_pk_bf16_f32 v44, v58, v59
    v_cvt_pk_bf16_f32 v45, v60, v61
    v_mfma_f32_32x32x16_bf16 v[46:61], v[24:27], v[12:15], 0
    v_exp_f32 v62, v62
    v_exp_f32 v63, v63
    v_exp_f32 v64, v64
    v_exp_f32 v65, v65
    v_mfma_f32_32x32x16_bf16 v[78:93], v[34:37], v[42:45], v[78:93]
    v_exp_f32 v66, v66
    v_exp_f32 v67, v67
    v_exp_f32 v68, v68
    v_exp_f32 v69, v69
    v_mfma_f32_32x32x8_bf16 v[46:61], v[28:29], v[6:7], v[46:61]
    v_cvt_pk_bf16_f32 v38, v62, v63
    v_cvt_pk_bf16_f32 v39, v64, v65
    v_cvt_pk_bf16_f32 v40, v66, v67
    v_cvt_pk_bf16_f32 v41, v68, v69
    s_add_u32 m0, s41, 122880
    s_add_u32 s42, s39, 122880
    buffer_load_dwordx4 v2, s[4:7], s42 offen sc1 lds
    s_add_u32 m0, s41, 131072
    s_add_u32 s42, s39, 131072
    buffer_load_dwordx4 v2, s[4:7], s42 offen sc1 lds
    s_add_u32 m0, s41, 139264
    s_add_u32 s42, s39, 139264
    buffer_load_dwordx4 v2, s[4:7], s42 offen sc1 lds
    v_exp_f32 v70, v70
    v_exp_f32 v71, v71
    v_mfma_f32_32x32x16_bf16 v[94:109], v[30:33], v[38:41], 0
    s_andn2_b64 exec, s[62:63], 0x70000000
    ds_read_b128 v[30:33], v4 offset:2560
    s_mov_b64 exec, -1
    v_exp_f32 v72, v72
    v_exp_f32 v73, v73
    v_exp_f32 v74, v74
    v_exp_f32 v75, v75
    v_exp_f32 v76, v76
    v_exp_f32_e64 v77, v77
    v_cvt_pk_bf16_f32 v42, v70, v71
    v_cvt_pk_bf16_f32 v43, v72, v73
    v_cvt_pk_bf16_f32 v44, v74, v75
    v_cvt_pk_bf16_f32 v45, v76, v77
    v_mfma_f32_32x32x16_bf16 v[62:77], v[24:27], v[16:19], 0
    v_exp_f32 v46, v46
    v_exp_f32 v47, v47
    v_exp_f32 v48, v48
    v_exp_f32 v49, v49
    v_mfma_f32_32x32x16_bf16 v[94:109], v[34:37], v[42:45], v[94:109]
    s_waitcnt vmcnt(8)
    s_barrier
    s_andn2_b64 exec, s[62:63], 0x70000000
    ds_read_b128 v[34:37], v4 offset:3200
    s_or_b64 exec, -1, 0x70000000
    ds_read_b128 v[24:27], v5 offset:10240
    v_exp_f32 v50, v50
    v_exp_f32 v51, v51
    v_exp_f32 v52, v52
    v_exp_f32 v53, v53
    v_mfma_f32_32x32x8_bf16 v[62:77], v[28:29], v[254:255], v[62:77]
    ds_read_b64 v[28:29], v3 offset:10240
    v_cvt_pk_bf16_f32 v38, v46, v47
    v_cvt_pk_bf16_f32 v39, v48, v49
    v_cvt_pk_bf16_f32 v40, v50, v51
    v_cvt_pk_bf16_f32 v41, v52, v53
    s_add_u32 m0, s41, 65536
    s_add_u32 s42, s39, 65536
    buffer_load_dwordx4 v2, s[4:7], s42 offen sc1 lds
    s_add_u32 m0, s41, 73728
    s_add_u32 s42, s39, 73728
    buffer_load_dwordx4 v2, s[4:7], s42 offen sc1 lds
    s_add_u32 m0, s41, 147456
    s_add_u32 s42, s39, 147456
    buffer_load_dwordx4 v2, s[4:7], s42 offen sc1 lds
    v_exp_f32_e64 v54, v54
    v_exp_f32 v55, v55
    s_waitcnt lgkmcnt(3)
    v_mfma_f32_32x32x16_bf16 v[78:93], v[30:33], v[38:41], v[78:93]
    v_exp_f32 v56, v56
    v_exp_f32 v57, v57
    v_exp_f32 v58, v58
    v_exp_f32 v59, v59
    v_exp_f32_e64 v60, v60
    v_exp_f32 v61, v61
    s_waitcnt lgkmcnt(1)
    v_cvt_pk_bf16_f32 v42, v54, v55
    v_cvt_pk_bf16_f32 v43, v56, v57
    v_cvt_pk_bf16_f32 v44, v58, v59
    v_cvt_pk_bf16_f32 v45, v60, v61
    v_mfma_f32_32x32x16_bf16 v[46:61], v[24:27], v[12:15], 0
    v_exp_f32 v62, v62
    v_exp_f32 v63, v63
    v_exp_f32 v64, v64
    v_exp_f32 v65, v65
    v_mfma_f32_32x32x16_bf16 v[78:93], v[34:37], v[42:45], v[78:93]
    v_exp_f32 v66, v66
    v_exp_f32 v67, v67
    v_exp_f32_e64 v68, v68
    v_exp_f32 v69, v69
    s_waitcnt lgkmcnt(0)
    v_mfma_f32_32x32x8_bf16 v[46:61], v[28:29], v[20:21], v[46:61]
    v_cvt_pk_bf16_f32 v38, v62, v63
    v_cvt_pk_bf16_f32 v39, v64, v65
    v_cvt_pk_bf16_f32 v40, v66, v67
    v_cvt_pk_bf16_f32 v41, v68, v69
    s_add_u32 m0, s41, 155648
    s_add_u32 s42, s39, 155648
    buffer_load_dwordx4 v2, s[4:7], s42 offen sc1 lds
    v_exp_f32 v70, v70
    v_exp_f32 v71, v71
    v_mfma_f32_32x32x16_bf16 v[94:109], v[30:33], v[38:41], v[94:109]
    s_andn2_b64 exec, s[62:63], 0x70000000
    ds_read_b128 v[30:33], v4 offset:10240
    s_mov_b64 exec, -1
    v_exp_f32 v72, v72
    v_exp_f32 v73, v73
    v_exp_f32 v74, v74
    v_exp_f32 v75, v75
    v_exp_f32 v76, v76
    v_exp_f32_e64 v77, v77
    v_cvt_pk_bf16_f32 v42, v70, v71
    v_cvt_pk_bf16_f32 v43, v72, v73
    v_cvt_pk_bf16_f32 v44, v74, v75
    v_cvt_pk_bf16_f32 v45, v76, v77
    v_mfma_f32_32x32x16_bf16 v[62:77], v[24:27], v[16:19], 0
    v_exp_f32 v46, v46
    v_exp_f32 v47, v47
    v_exp_f32 v48, v48
    v_exp_f32 v49, v49
    v_mfma_f32_32x32x16_bf16 v[94:109], v[34:37], v[42:45], v[94:109]
    s_andn2_b64 exec, s[62:63], 0x70000000
    ds_read_b128 v[34:37], v4 offset:10880
    s_or_b64 exec, -1, 0x70000000
    ds_read_b128 v[24:27], v5 offset:12800
    v_exp_f32 v50, v50
    v_exp_f32 v51, v51
    v_exp_f32 v52, v52
    v_exp_f32 v53, v53
    v_mfma_f32_32x32x8_bf16 v[62:77], v[28:29], v[22:23], v[62:77]
    v_cvt_pk_bf16_f32 v38, v46, v47
    v_cvt_pk_bf16_f32 v39, v48, v49
    v_cvt_pk_bf16_f32 v40, v50, v51
    v_cvt_pk_bf16_f32 v41, v52, v53
    v_exp_f32_e64 v54, v54
    v_exp_f32 v55, v55
    s_waitcnt lgkmcnt(2)
    v_mfma_f32_32x32x16_bf16 v[78:93], v[30:33], v[38:41], v[78:93]
    v_exp_f32 v56, v56
    v_exp_f32 v57, v57
    v_exp_f32 v58, v58
    v_exp_f32 v59, v59
    v_exp_f32_e64 v60, v60
    v_exp_f32 v61, v61
    s_waitcnt lgkmcnt(0)
    v_cvt_pk_bf16_f32 v42, v54, v55
    v_cvt_pk_bf16_f32 v43, v56, v57
    v_cvt_pk_bf16_f32 v44, v58, v59
    v_cvt_pk_bf16_f32 v45, v60, v61
    v_mfma_f32_32x32x16_bf16 v[46:61], v[24:27], v[12:15], 0
    v_exp_f32 v62, v62
    v_exp_f32 v63, v63
    v_exp_f32 v64, v64
    v_exp_f32 v65, v65
    v_mfma_f32_32x32x16_bf16 v[78:93], v[34:37], v[42:45], v[78:93]
    s_setprio 2
    v_exp_f32 v66, v66
    v_exp_f32 v67, v67
    v_exp_f32 v68, v68
    v_exp_f32_e64 v69, v69
    v_mfma_f32_32x32x8_bf16 v[46:61], v[28:29], v[6:7], v[46:61]
    v_cvt_pk_bf16_f32 v38, v62, v63
    v_cvt_pk_bf16_f32 v39, v64, v65
    v_cvt_pk_bf16_f32 v40, v66, v67
    v_cvt_pk_bf16_f32 v41, v68, v69
    v_exp_f32 v70, v70
    v_exp_f32 v71, v71
    v_mfma_f32_32x32x16_bf16 v[94:109], v[30:33], v[38:41], v[94:109]
    s_andn2_b64 exec, s[62:63], 0x70000000
    ds_read_b128 v[30:33], v4 offset:12800
    s_mov_b64 exec, -1
    v_exp_f32 v72, v72
    v_exp_f32 v73, v73
    v_exp_f32 v74, v74
    v_exp_f32 v75, v75
    v_exp_f32 v76, v76
    v_exp_f32_e64 v77, v77
    v_cvt_pk_bf16_f32 v42, v70, v71
    v_cvt_pk_bf16_f32 v43, v72, v73
    v_cvt_pk_bf16_f32 v44, v74, v75
    v_cvt_pk_bf16_f32 v45, v76, v77
    v_mfma_f32_32x32x16_bf16 v[62:77], v[24:27], v[16:19], 0
    v_exp_f32 v46, v46
    v_exp_f32 v47, v47
    v_exp_f32 v48, v48
    v_exp_f32 v49, v49
    v_mfma_f32_32x32x16_bf16 v[94:109], v[34:37], v[42:45], v[94:109]
    s_andn2_b64 exec, s[62:63], 0x70000000
    ds_read_b128 v[34:37], v4 offset:13440
    s_or_b64 exec, -1, 0x70000000
    ds_read_b128 v[24:27], v5 offset:20480
    v_exp_f32 v50, v50
    v_exp_f32 v51, v51
    v_exp_f32 v52, v52
    v_exp_f32 v53, v53
    v_mfma_f32_32x32x8_bf16 v[62:77], v[28:29], v[254:255], v[62:77]
    ds_read_b64 v[28:29], v3 offset:20480
    v_cvt_pk_bf16_f32 v38, v46, v47
    v_cvt_pk_bf16_f32 v39, v48, v49
    v_cvt_pk_bf16_f32 v40, v50, v51
    v_cvt_pk_bf16_f32 v41, v52, v53
    v_exp_f32_e64 v54, v54
    v_exp_f32 v55, v55
    s_waitcnt lgkmcnt(3)
    v_mfma_f32_32x32x16_bf16 v[78:93], v[30:33], v[38:41], v[78:93]
    v_exp_f32 v56, v56
    v_exp_f32 v57, v57
    v_exp_f32 v58, v58
    v_exp_f32 v59, v59
    v_exp_f32_e64 v60, v60
    v_exp_f32 v61, v61
    s_waitcnt lgkmcnt(1)
    v_cvt_pk_bf16_f32 v42, v54, v55
    v_cvt_pk_bf16_f32 v43, v56, v57
    v_cvt_pk_bf16_f32 v44, v58, v59
    v_cvt_pk_bf16_f32 v45, v60, v61
    v_mfma_f32_32x32x16_bf16 v[46:61], v[24:27], v[12:15], 0
    v_exp_f32 v62, v62
    v_exp_f32 v63, v63
    v_exp_f32 v64, v64
    v_exp_f32 v65, v65
    v_mfma_f32_32x32x16_bf16 v[78:93], v[34:37], v[42:45], v[78:93]
    v_exp_f32 v66, v66
    v_exp_f32 v67, v67
    v_exp_f32_e64 v68, v68
    v_exp_f32 v69, v69
    s_waitcnt lgkmcnt(0)
    v_mfma_f32_32x32x8_bf16 v[46:61], v[28:29], v[20:21], v[46:61]
    v_cvt_pk_bf16_f32 v38, v62, v63
    v_cvt_pk_bf16_f32 v39, v64, v65
    v_cvt_pk_bf16_f32 v40, v66, v67
    v_cvt_pk_bf16_f32 v41, v68, v69
    s_movk_i32 s43, 0
    buffer_store_dwordx4 v[228:231], v183, s[12:15], s43 offen sc1
    v_exp_f32 v70, v70
    v_exp_f32_e64 v71, v71
    v_mfma_f32_32x32x16_bf16 v[94:109], v[30:33], v[38:41], v[94:109]
    s_andn2_b64 exec, s[62:63], 0x70000000
    ds_read_b128 v[30:33], v4 offset:20480
    s_mov_b64 exec, -1
    v_exp_f32 v72, v72
    v_exp_f32 v73, v73
    v_exp_f32 v74, v74
    v_exp_f32 v75, v75
    v_exp_f32 v76, v76
    v_exp_f32_e64 v77, v77
    v_cvt_pk_bf16_f32 v42, v70, v71
    v_cvt_pk_bf16_f32 v43, v72, v73
    v_cvt_pk_bf16_f32 v44, v74, v75
    v_cvt_pk_bf16_f32 v45, v76, v77
    v_mfma_f32_32x32x16_bf16 v[62:77], v[24:27], v[16:19], 0
    v_exp_f32 v46, v46
    v_exp_f32 v47, v47
    v_exp_f32 v48, v48
    v_exp_f32 v49, v49
    v_mfma_f32_32x32x16_bf16 v[94:109], v[34:37], v[42:45], v[94:109]
    s_andn2_b64 exec, s[62:63], 0x70000000
    ds_read_b128 v[34:37], v4 offset:21120
    s_or_b64 exec, -1, 0x70000000
    ds_read_b128 v[24:27], v5 offset:23040
    v_exp_f32 v50, v50
    v_exp_f32 v51, v51
    v_exp_f32 v52, v52
    v_exp_f32 v53, v53
    v_mfma_f32_32x32x8_bf16 v[62:77], v[28:29], v[22:23], v[62:77]
    v_cvt_pk_bf16_f32 v38, v46, v47
    v_cvt_pk_bf16_f32 v39, v48, v49
    v_cvt_pk_bf16_f32 v40, v50, v51
    v_cvt_pk_bf16_f32 v41, v52, v53
    s_movk_i32 s43, 4096
    buffer_store_dwordx4 v[228:231], v183, s[12:15], s43 offen sc1
    v_exp_f32 v54, v54
    v_exp_f32 v55, v55
    s_waitcnt lgkmcnt(2)
    v_mfma_f32_32x32x16_bf16 v[78:93], v[30:33], v[38:41], v[78:93]
    v_exp_f32 v56, v56
    v_exp_f32 v57, v57
    v_exp_f32 v58, v58
    v_exp_f32 v59, v59
    v_exp_f32_e64 v60, v60
    v_exp_f32 v61, v61
    s_waitcnt lgkmcnt(0)
    v_cvt_pk_bf16_f32 v42, v54, v55
    v_cvt_pk_bf16_f32 v43, v56, v57
    v_cvt_pk_bf16_f32 v44, v58, v59
    v_cvt_pk_bf16_f32 v45, v60, v61
    v_mfma_f32_32x32x16_bf16 v[46:61], v[24:27], v[12:15], 0
    v_exp_f32 v62, v62
    v_exp_f32 v63, v63
    v_exp_f32 v64, v64
    v_exp_f32 v65, v65
    v_mfma_f32_32x32x16_bf16 v[78:93], v[34:37], v[42:45], v[78:93]
    v_exp_f32 v66, v66
    v_exp_f32 v67, v67
    v_exp_f32 v68, v68
    v_exp_f32 v69, v69
    v_mfma_f32_32x32x8_bf16 v[46:61], v[28:29], v[6:7], v[46:61]
    v_cvt_pk_bf16_f32 v38, v62, v63
    v_cvt_pk_bf16_f32 v39, v64, v65
    v_cvt_pk_bf16_f32 v40, v66, v67
    v_cvt_pk_bf16_f32 v41, v68, v69
    s_movk_i32 s43, 8192
    buffer_store_dwordx4 v[228:231], v184, s[12:15], s43 offen sc1
    v_exp_f32 v70, v70
    v_exp_f32_e64 v71, v71
    v_mfma_f32_32x32x16_bf16 v[94:109], v[30:33], v[38:41], v[94:109]
    s_andn2_b64 exec, s[62:63], 0x70000000
    ds_read_b128 v[30:33], v4 offset:23040
    s_mov_b64 exec, -1
    v_exp_f32 v72, v72
    v_exp_f32 v73, v73
    v_exp_f32 v74, v74
    v_exp_f32 v75, v75
    v_exp_f32 v76, v76
    v_exp_f32_e64 v77, v77
    v_cvt_pk_bf16_f32 v42, v70, v71
    v_cvt_pk_bf16_f32 v43, v72, v73
    v_cvt_pk_bf16_f32 v44, v74, v75
    v_cvt_pk_bf16_f32 v45, v76, v77
    v_mfma_f32_32x32x16_bf16 v[62:77], v[24:27], v[16:19], 0
    v_exp_f32 v46, v46
    v_exp_f32 v47, v47
    v_exp_f32 v48, v48
    v_exp_f32 v49, v49
    v_mfma_f32_32x32x16_bf16 v[94:109], v[34:37], v[42:45], v[94:109]
    s_setprio 1
    s_mov_b64 exec, s[62:63]
    ds_read_b128 v[34:37], v4 offset:23680
    s_or_b64 exec, -1, 0x70000000
    ds_read_b128 v[24:27], v5 offset:30720
    v_exp_f32 v50, v50
    v_exp_f32 v51, v51
    v_exp_f32 v52, v52
    v_exp_f32 v53, v53
    v_mfma_f32_32x32x8_bf16 v[62:77], v[28:29], v[254:255], v[62:77]
    ds_read_b64 v[28:29], v3 offset:30720
    v_cvt_pk_bf16_f32 v38, v46, v47
    v_cvt_pk_bf16_f32 v39, v48, v49
    v_cvt_pk_bf16_f32 v40, v50, v51
    v_cvt_pk_bf16_f32 v41, v52, v53
    buffer_store_dword v185, v182, s[12:15], 0 offen sc1
    v_exp_f32_e64 v54, v54
    v_exp_f32 v55, v55
    s_waitcnt lgkmcnt(3)
    v_mfma_f32_32x32x16_bf16 v[78:93], v[30:33], v[38:41], v[78:93]
    v_exp_f32 v56, v56
    v_exp_f32 v57, v57
    v_exp_f32 v58, v58
    v_exp_f32 v59, v59
    v_exp_f32_e64 v60, v60
    v_exp_f32 v61, v61
    s_waitcnt lgkmcnt(1)
    v_cvt_pk_bf16_f32 v42, v54, v55
    v_cvt_pk_bf16_f32 v43, v56, v57
    v_cvt_pk_bf16_f32 v44, v58, v59
    v_cvt_pk_bf16_f32 v45, v60, v61
    v_mfma_f32_32x32x16_bf16 v[46:61], v[24:27], v[12:15], 0
    v_exp_f32 v62, v62
    v_exp_f32 v63, v63
    v_exp_f32 v64, v64
    v_exp_f32 v65, v65
    v_mfma_f32_32x32x16_bf16 v[78:93], v[34:37], v[42:45], v[78:93]
    buffer_load_dwordx4 v[110:113], v118, s[48:51], s57 offen sc1
    v_exp_f32 v66, v66
    v_exp_f32 v67, v67
    v_exp_f32_e64 v68, v68
    v_exp_f32 v69, v69
    s_waitcnt lgkmcnt(0)
    v_mfma_f32_32x32x8_bf16 v[46:61], v[28:29], v[20:21], v[46:61]
    v_cvt_pk_bf16_f32 v38, v62, v63
    v_cvt_pk_bf16_f32 v39, v64, v65
    v_cvt_pk_bf16_f32 v40, v66, v67
    v_cvt_pk_bf16_f32 v41, v68, v69
    v_exp_f32 v70, v70
    v_exp_f32 v71, v71
    v_mfma_f32_32x32x16_bf16 v[94:109], v[30:33], v[38:41], v[94:109]
    s_andn2_b64 exec, s[62:63], 0x70000000
    ds_read_b128 v[30:33], v4 offset:30720
    s_mov_b64 exec, -1
    v_exp_f32 v72, v72
    v_exp_f32 v73, v73
    v_exp_f32 v74, v74
    v_exp_f32 v75, v75
    v_exp_f32 v76, v76
    v_exp_f32_e64 v77, v77
    v_cvt_pk_bf16_f32 v42, v70, v71
    v_cvt_pk_bf16_f32 v43, v72, v73
    v_cvt_pk_bf16_f32 v44, v74, v75
    v_cvt_pk_bf16_f32 v45, v76, v77
    v_mfma_f32_32x32x16_bf16 v[62:77], v[24:27], v[16:19], 0
    v_exp_f32 v46, v46
    v_exp_f32 v47, v47
    v_exp_f32 v48, v48
    v_exp_f32 v49, v49
    v_mfma_f32_32x32x16_bf16 v[94:109], v[34:37], v[42:45], v[94:109]
    s_andn2_b64 exec, s[62:63], 0x70000000
    ds_read_b128 v[34:37], v4 offset:31360
    s_or_b64 exec, -1, 0x70000000
    ds_read_b128 v[24:27], v5 offset:33280
    v_exp_f32 v50, v50
    v_exp_f32 v51, v51
    v_exp_f32 v52, v52
    v_exp_f32 v53, v53
    v_mfma_f32_32x32x8_bf16 v[62:77], v[28:29], v[22:23], v[62:77]
    v_cvt_pk_bf16_f32 v38, v46, v47
    v_cvt_pk_bf16_f32 v39, v48, v49
    v_cvt_pk_bf16_f32 v40, v50, v51
    v_cvt_pk_bf16_f32 v41, v52, v53
    v_exp_f32_e64 v54, v54
    v_exp_f32 v55, v55
    s_waitcnt lgkmcnt(2)
    v_mfma_f32_32x32x16_bf16 v[78:93], v[30:33], v[38:41], v[78:93]
    v_exp_f32 v56, v56
    v_exp_f32 v57, v57
    v_exp_f32 v58, v58
    v_exp_f32 v59, v59
    v_exp_f32_e64 v60, v60
    v_exp_f32 v61, v61
    s_waitcnt lgkmcnt(0)
    v_cvt_pk_bf16_f32 v42, v54, v55
    v_cvt_pk_bf16_f32 v43, v56, v57
    v_cvt_pk_bf16_f32 v44, v58, v59
    v_cvt_pk_bf16_f32 v45, v60, v61
    v_mfma_f32_32x32x16_bf16 v[46:61], v[24:27], v[12:15], 0
    v_exp_f32 v62, v62
    v_exp_f32 v63, v63
    v_exp_f32 v64, v64
    v_exp_f32 v65, v65
    v_mfma_f32_32x32x16_bf16 v[78:93], v[34:37], v[42:45], v[78:93]
    s_waitcnt vmcnt(0)
g_p2:
    v_and_b32 v110, v110, v111
    v_and_b32 v112, v112, v113
    v_and_b32 v110, v110, v112
    v_cmp_ne_u32 vcc, 1, v110
    s_cbranch_vccnz g_p2r
g_p2ok:
    s_setprio 0
    v_exp_f32 v66, v66
    v_exp_f32 v67, v67
    v_exp_f32 v68, v68
    v_exp_f32_e64 v69, v69
    v_mfma_f32_32x32x8_bf16 v[46:61], v[28:29], v[6:7], v[46:61]
    v_cvt_pk_bf16_f32 v38, v62, v63
    v_cvt_pk_bf16_f32 v39, v64, v65
    v_cvt_pk_bf16_f32 v40, v66, v67
    v_cvt_pk_bf16_f32 v41, v68, v69
    s_add_u32 s42, s72, 0
    buffer_load_dwordx4 v[190:193], v2, s[64:67], s42 offen sc1
    s_add_u32 s42, s73, 0
    buffer_load_dwordx4 v[202:205], v2, s[68:71], s42 offen sc1
    s_add_u32 s42, s73, 1024
    buffer_load_dwordx4 v[206:209], v2, s[68:71], s42 offen sc1
    v_exp_f32 v70, v70
    v_exp_f32 v71, v71
    v_mfma_f32_32x32x16_bf16 v[94:109], v[30:33], v[38:41], v[94:109]
    s_andn2_b64 exec, s[62:63], 0x70000000
    ds_read_b128 v[30:33], v4 offset:33280
    s_mov_b64 exec, -1
    v_exp_f32 v72, v72
    v_exp_f32 v73, v73
    v_exp_f32 v74, v74
    v_exp_f32 v75, v75
    v_exp_f32 v76, v76
    v_exp_f32_e64 v77, v77
    v_cvt_pk_bf16_f32 v42, v70, v71
    v_cvt_pk_bf16_f32 v43, v72, v73
    v_cvt_pk_bf16_f32 v44, v74, v75
    v_cvt_pk_bf16_f32 v45, v76, v77
    v_mfma_f32_32x32x16_bf16 v[62:77], v[24:27], v[16:19], 0
    v_exp_f32 v46, v46
    v_exp_f32 v47, v47
    v_exp_f32 v48, v48
    v_exp_f32 v49, v49
    v_mfma_f32_32x32x16_bf16 v[94:109], v[34:37], v[42:45], v[94:109]
    s_waitcnt vmcnt(4)
    s_barrier
    s_setprio 3
    s_mov_b64 exec, s[62:63]
    ds_read_b128 v[34:37], v4 offset:33920
    s_or_b64 exec, -1, 0x70000000
    ds_read_b128 v[24:27], v5 offset:40960
    v_exp_f32 v50, v50
    v_exp_f32 v51, v51
    v_exp_f32 v52, v52
    v_exp_f32 v53, v53
    v_mfma_f32_32x32x8_bf16 v[62:77], v[28:29], v[254:255], v[62:77]
    ds_read_b64 v[28:29], v3 offset:40960
    v_cvt_pk_bf16_f32 v38, v46, v47
    v_cvt_pk_bf16_f32 v39, v48, v49
    v_cvt_pk_bf16_f32 v40, v50, v51
    v_cvt_pk_bf16_f32 v41, v52, v53
    s_add_u32 s42, s73, 2048
    buffer_load_dwordx4 v[210:213], v2, s[68:71], s42 offen sc1
    s_add_u32 s42, s73, 3072
    buffer_load_dwordx4 v[214:217], v2, s[68:71], s42 offen sc1
    s_add_u32 s42, s73, 4096
    buffer_load_dwordx4 v[218:221], v2, s[68:71], s42 offen sc1
    v_exp_f32_e64 v54, v54
    v_exp_f32 v55, v55
    s_waitcnt lgkmcnt(3)
    v_mfma_f32_32x32x16_bf16 v[78:93], v[30:33], v[38:41], v[78:93]
    v_exp_f32 v56, v56
    v_exp_f32 v57, v57
    v_exp_f32 v58, v58
    v_exp_f32 v59, v59
    v_exp_f32_e64 v60, v60
    v_exp_f32 v61, v61
    s_waitcnt lgkmcnt(1)
    v_cvt_pk_bf16_f32 v42, v54, v55
    v_cvt_pk_bf16_f32 v43, v56, v57
    v_cvt_pk_bf16_f32 v44, v58, v59
    v_cvt_pk_bf16_f32 v45, v60, v61
    v_mfma_f32_32x32x16_bf16 v[46:61], v[24:27], v[12:15], 0
    v_exp_f32 v62, v62
    v_exp_f32 v63, v63
    v_exp_f32 v64, v64
    v_exp_f32 v65, v65
    v_mfma_f32_32x32x16_bf16 v[78:93], v[34:37], v[42:45], v[78:93]
    v_exp_f32 v66, v66
    v_exp_f32 v67, v67
    v_exp_f32_e64 v68, v68
    v_exp_f32 v69, v69
    s_waitcnt lgkmcnt(0)
    v_mfma_f32_32x32x8_bf16 v[46:61], v[28:29], v[20:21], v[46:61]
    v_cvt_pk_bf16_f32 v38, v62, v63
    v_cvt_pk_bf16_f32 v39, v64, v65
    v_cvt_pk_bf16_f32 v40, v66, v67
    v_cvt_pk_bf16_f32 v41, v68, v69
    s_add_u32 s42, s72, 4096
    buffer_load_dwordx4 v[194:197], v2, s[64:67], s42 offen sc1
    s_add_u32 s42, s73, 81920
    buffer_load_dwordx4 v[222:225], v2, s[68:71], s42 offen sc1
    s_add_u32 s42, s73, 82944
    buffer_load_dwordx4 v[226:229], v2, s[68:71], s42 offen sc1
    v_exp_f32 v70, v70
    v_exp_f32 v71, v71
    v_mfma_f32_32x32x16_bf16 v[94:109], v[30:33], v[38:41], v[94:109]
    s_andn2_b64 exec, s[62:63], 0x70000000
    ds_read_b128 v[30:33], v4 offset:40960
    s_mov_b64 exec, -1
    v_exp_f32 v72, v72
    v_exp_f32 v73, v73
    v_exp_f32 v74, v74
    v_exp_f32 v75, v75
    v_exp_f32 v76, v76
    v_exp_f32_e64 v77, v77
    v_cvt_pk_bf16_f32 v42, v70, v71
    v_cvt_pk_bf16_f32 v43, v72, v73
    v_cvt_pk_bf16_f32 v44, v74, v75
    v_cvt_pk_bf16_f32 v45, v76, v77
    v_mfma_f32_32x32x16_bf16 v[62:77], v[24:27], v[16:19], 0
    v_exp_f32 v46, v46
    v_exp_f32 v47, v47
    v_exp_f32 v48, v48
    v_exp_f32 v49, v49
    v_mfma_f32_32x32x16_bf16 v[94:109], v[34:37], v[42:45], v[94:109]
    s_andn2_b64 exec, s[62:63], 0x70000000
    ds_read_b128 v[34:37], v4 offset:41600
    s_or_b64 exec, -1, 0x70000000
    ds_read_b128 v[24:27], v5 offset:43520
    v_exp_f32_e64 v50, v50
    v_exp_f32 v51, v51
    s_waitcnt vmcnt(7)
    v_mfma_f32_32x32x16_bf16 v[110:125], v[202:205], v[190:193], 0
    s_add_u32 s42, s73, 166912
    buffer_load_dwordx4 v[202:205], v2, s[68:71], s42 offen sc1
    v_exp_f32 v52, v52
    v_exp_f32 v53, v53
    v_mfma_f32_32x32x8_bf16 v[62:77], v[28:29], v[22:23], v[62:77]
    v_cvt_pk_bf16_f32 v38, v46, v47
    v_cvt_pk_bf16_f32 v39, v48, v49
    v_cvt_pk_bf16_f32 v40, v50, v51
    v_cvt_pk_bf16_f32 v41, v52, v53
    s_add_u32 s42, s73, 83968
    buffer_load_dwordx4 v[230:233], v2, s[68:71], s42 offen sc1
    s_add_u32 s42, s73, 84992
    buffer_load_dwordx4 v[234:237], v2, s[68:71], s42 offen sc1
    s_add_u32 s42, s73, 86016
    buffer_load_dwordx4 v[238:241], v2, s[68:71], s42 offen sc1
    v_exp_f32_e64 v54, v54
    v_exp_f32 v55, v55
    s_waitcnt lgkmcnt(2)
    v_mfma_f32_32x32x16_bf16 v[78:93], v[30:33], v[38:41], v[78:93]
    v_exp_f32 v56, v56
    v_exp_f32 v57, v57
    v_exp_f32_e64 v58, v58
    v_exp_f32 v59, v59
    s_waitcnt vmcnt(10)
    v_mfma_f32_32x32x16_bf16 v[126:141], v[206:209], v[190:193], 0
    s_add_u32 s42, s73, 167936
    buffer_load_dwordx4 v[206:209], v2, s[68:71], s42 offen sc1
    v_exp_f32_e64 v60, v60
    v_exp_f32 v61, v61
    s_waitcnt vmcnt(10) lgkmcnt(0)
    v_cvt_pk_bf16_f32 v42, v54, v55
    v_cvt_pk_bf16_f32 v43, v56, v57
    v_cvt_pk_bf16_f32 v44, v58, v59
    v_cvt_pk_bf16_f32 v45, v60, v61
    v_mfma_f32_32x32x16_bf16 v[142:157], v[210:213], v[190:193], 0
    s_add_u32 s42, s73, 245760
    buffer_load_dwordx4 v[210:213], v2, s[68:71], s42 offen sc1
    v_mfma_f32_32x32x16_bf16 v[46:61], v[24:27], v[12:15], 0
    v_exp_f32 v62, v62
    v_exp_f32 v63, v63
    v_exp_f32 v64, v64
    v_exp_f32 v65, v65
    v_mfma_f32_32x32x16_bf16 v[78:93], v[34:37], v[42:45], v[78:93]
    v_exp_f32_e64 v66, v66
    v_exp_f32 v67, v67
    s_waitcnt vmcnt(10)
    v_mfma_f32_32x32x16_bf16 v[158:173], v[214:217], v[190:193], 0
    s_add_u32 s42, s73, 246784
    buffer_load_dwordx4 v[214:217], v2, s[68:71], s42 offen sc1
    v_exp_f32 v68, v68
    v_exp_f32 v69, v69
    v_mfma_f32_32x32x8_bf16 v[46:61], v[28:29], v[6:7], v[46:61]
    v_cvt_pk_bf16_f32 v38, v62, v63
    v_cvt_pk_bf16_f32 v39, v64, v65
    v_cvt_pk_bf16_f32 v40, v66, v67
    v_cvt_pk_bf16_f32 v41, v68, v69
    s_add_u32 s42, s72, 8192
    buffer_load_dwordx4 v[198:201], v2, s[64:67], s42 offen sc1
    s_add_u32 s42, s73, 163840
    buffer_load_dwordx4 v[242:245], v2, s[68:71], s42 offen sc1
    s_add_u32 s42, s73, 164864
    buffer_load_dwordx4 v[246:249], v2, s[68:71], s42 offen sc1
    v_exp_f32 v70, v70
    v_exp_f32 v71, v71
    v_mfma_f32_32x32x16_bf16 v[94:109], v[30:33], v[38:41], v[94:109]
    s_andn2_b64 exec, s[62:63], 0x70000000
    ds_read_b128 v[30:33], v4 offset:43520
    s_mov_b64 exec, -1
    v_exp_f32 v72, v72
    v_exp_f32 v73, v73
    v_exp_f32 v74, v74
    v_exp_f32 v75, v75
    s_waitcnt vmcnt(13)
    v_mfma_f32_32x32x16_bf16 v[174:189], v[218:221], v[190:193], 0
    s_add_u32 s42, s73, 247808
    buffer_load_dwordx4 v[218:221], v2, s[68:71], s42 offen sc1
    s_add_u32 s42, s72, 12288
    buffer_load_dwordx4 v[190:193], v2, s[64:67], s42 offen sc1
    v_exp_f32_e64 v76, v76
    v_exp_f32 v77, v77
    s_waitcnt vmcnt(13)
    v_cvt_pk_bf16_f32 v42, v70, v71
    v_cvt_pk_bf16_f32 v43, v72, v73
    v_cvt_pk_bf16_f32 v44, v74, v75
    v_cvt_pk_bf16_f32 v45, v76, v77
    v_mfma_f32_32x32x16_bf16 v[110:125], v[222:225], v[194:197], v[110:125]
    s_add_u32 s42, s73, 248832
    buffer_load_dwordx4 v[222:225], v2, s[68:71], s42 offen sc1
    v_mfma_f32_32x32x16_bf16 v[62:77], v[24:27], v[16:19], 0
    v_exp_f32 v46, v46
    v_exp_f32 v47, v47
    v_exp_f32 v48, v48
    v_exp_f32 v49, v49
    v_mfma_f32_32x32x16_bf16 v[94:109], v[34:37], v[42:45], v[94:109]
    s_andn2_b64 exec, s[62:63], 0x70000000
    ds_read_b128 v[34:37], v4 offset:44160
    s_or_b64 exec, -1, 0x70000000
    ds_read_b128 v[24:27], v5 offset:51200
    v_exp_f32_e64 v50, v50
    v_exp_f32 v51, v51
    s_waitcnt vmcnt(13)
    v_mfma_f32_32x32x16_bf16 v[126:141], v[226:229], v[194:197], v[126:141]
    s_add_u32 s42, s73, 249856
    buffer_load_dwordx4 v[226:229], v2, s[68:71], s42 offen sc1
    v_exp_f32 v52, v52
    v_exp_f32 v53, v53
    v_mfma_f32_32x32x8_bf16 v[62:77], v[28:29], v[254:255], v[62:77]
    ds_read_b64 v[28:29], v3 offset:51200
    v_cvt_pk_bf16_f32 v38, v46, v47
    v_cvt_pk_bf16_f32 v39, v48, v49
    v_cvt_pk_bf16_f32 v40, v50, v51
    v_cvt_pk_bf16_f32 v41, v52, v53
    s_add_u32 s42, s73, 165888
    buffer_load_dwordx4 v[250:253], v2, s[68:71], s42 offen sc1
    v_exp_f32_e64 v54, v54
    v_exp_f32 v55, v55
    s_waitcnt lgkmcnt(3)
    v_mfma_f32_32x32x16_bf16 v[78:93], v[30:33], v[38:41], v[78:93]
    v_exp_f32 v56, v56
    v_exp_f32 v57, v57
    v_exp_f32_e64 v58, v58
    v_exp_f32 v59, v59
    s_waitcnt vmcnt(13)
    v_mfma_f32_32x32x16_bf16 v[142:157], v[230:233], v[194:197], v[142:157]
    s_add_u32 s42, s73, 327680
    buffer_load_dwordx4 v[230:233], v2, s[68:71], s42 offen sc1
    v_exp_f32_e64 v60, v60
    v_exp_f32 v61, v61
    s_waitcnt vmcnt(13) lgkmcnt(1)
    v_cvt_pk_bf16_f32 v42, v54, v55
    v_cvt_pk_bf16_f32 v43, v56, v57
    v_cvt_pk_bf16_f32 v44, v58, v59
    v_cvt_pk_bf16_f32 v45, v60, v61
    v_mfma_f32_32x32x16_bf16 v[158:173], v[234:237], v[194:197], v[158:173]
    s_add_u32 s42, s73, 328704
    buffer_load_dwordx4 v[234:237], v2, s[68:71], s42 offen sc1
    v_mfma_f32_32x32x16_bf16 v[46:61], v[24:27], v[12:15], 0
    v_exp_f32 v62, v62
    v_exp_f32 v63, v63
    v_exp_f32 v64, v64
    v_exp_f32 v65, v65
    v_mfma_f32_32x32x16_bf16 v[78:93], v[34:37], v[42:45], v[78:93]
    v_exp_f32_e64 v66, v66
    v_exp_f32 v67, v67
    s_waitcnt vmcnt(13)
    v_mfma_f32_32x32x16_bf16 v[174:189], v[238:241], v[194:197], v[174:189]
    s_add_u32 s42, s73, 329728
    buffer_load_dwordx4 v[238:241], v2, s[68:71], s42 offen sc1
    s_add_u32 s42, s72, 16384
    buffer_load_dwordx4 v[194:197], v2, s[64:67], s42 offen sc1
    v_exp_f32_e64 v68, v68
    v_exp_f32 v69, v69
    s_waitcnt lgkmcnt(0)
    v_mfma_f32_32x32x8_bf16 v[46:61], v[28:29], v[20:21], v[46:61]
    v_cvt_pk_bf16_f32 v38, v62, v63
    v_cvt_pk_bf16_f32 v39, v64, v65
    v_cvt_pk_bf16_f32 v40, v66, v67
    v_cvt_pk_bf16_f32 v41, v68, v69
    v_exp_f32 v70, v70
    v_exp_f32 v71, v71
    v_mfma_f32_32x32x16_bf16 v[94:109], v[30:33], v[38:41], v[94:109]
    s_andn2_b64 exec, s[62:63], 0x70000000
    ds_read_b128 v[30:33], v4 offset:51200
    s_mov_b64 exec, -1
    v_exp_f32 v72, v72
    v_exp_f32 v73, v73
    v_exp_f32 v74, v74
    v_exp_f32 v75, v75
    s_waitcnt vmcnt(10)
    v_mfma_f32_32x32x16_bf16 v[110:125], v[242:245], v[198:201], v[110:125]
    s_add_u32 s42, s73, 330752
    buffer_load_dwordx4 v[242:245], v2, s[68:71], s42 offen sc1
    v_exp_f32_e64 v76, v76
    v_exp_f32 v77, v77
    s_waitcnt vmcnt(10)
    v_cvt_pk_bf16_f32 v42, v70, v71
    v_cvt_pk_bf16_f32 v43, v72, v73
    v_cvt_pk_bf16_f32 v44, v74, v75
    v_cvt_pk_bf16_f32 v45, v76, v77
    v_mfma_f32_32x32x16_bf16 v[126:141], v[246:249], v[198:201], v[126:141]
    s_add_u32 s42, s73, 331776
    buffer_load_dwordx4 v[246:249], v2, s[68:71], s42 offen sc1
    v_mfma_f32_32x32x16_bf16 v[62:77], v[24:27], v[16:19], 0
    v_exp_f32 v46, v46
    v_exp_f32 v47, v47
    v_exp_f32 v48, v48
    v_exp_f32 v49, v49
    v_mfma_f32_32x32x16_bf16 v[94:109], v[34:37], v[42:45], v[94:109]
    s_andn2_b64 exec, s[62:63], 0x70000000
    ds_read_b128 v[34:37], v4 offset:51840
    s_or_b64 exec, -1, 0x70000000
    ds_read_b128 v[24:27], v5 offset:53760
    v_exp_f32_e64 v50, v50
    v_exp_f32 v51, v51
    s_waitcnt vmcnt(6)
    v_mfma_f32_32x32x16_bf16 v[142:157], v[250:253], v[198:201], v[142:157]
    s_add_u32 s42, s73, 409600
    buffer_load_dwordx4 v[250:253], v2, s[68:71], s42 offen sc1
    v_exp_f32 v52, v52
    v_exp_f32 v53, v53
    v_mfma_f32_32x32x8_bf16 v[62:77], v[28:29], v[22:23], v[62:77]
    v_cvt_pk_bf16_f32 v38, v46, v47
    v_cvt_pk_bf16_f32 v39, v48, v49
    v_cvt_pk_bf16_f32 v40, v50, v51
    v_cvt_pk_bf16_f32 v41, v52, v53
    v_exp_f32_e64 v54, v54
    v_exp_f32 v55, v55
    s_waitcnt lgkmcnt(2)
    v_mfma_f32_32x32x16_bf16 v[78:93], v[30:33], v[38:41], v[78:93]
    v_exp_f32 v56, v56
    v_exp_f32 v57, v57
    v_exp_f32_e64 v58, v58
    v_exp_f32 v59, v59
    s_waitcnt vmcnt(14)
    v_mfma_f32_32x32x16_bf16 v[158:173], v[202:205], v[198:201], v[158:173]
    s_add_u32 s42, s73, 410624
    buffer_load_dwordx4 v[202:205], v2, s[68:71], s42 offen sc1
    v_exp_f32_e64 v60, v60
    v_exp_f32 v61, v61
    s_waitcnt vmcnt(15) lgkmcnt(0)
    v_cvt_pk_bf16_f32 v42, v54, v55
    v_cvt_pk_bf16_f32 v43, v56, v57
    v_cvt_pk_bf16_f32 v44, v58, v59
    v_cvt_pk_bf16_f32 v45, v60, v61
    v_mfma_f32_32x32x16_bf16 v[174:189], v[206:209], v[198:201], v[174:189]
    s_add_u32 s42, s73, 411648
    buffer_load_dwordx4 v[206:209], v2, s[68:71], s42 offen sc1
    s_add_u32 s42, s72, 20480
    buffer_load_dwordx4 v[198:201], v2, s[64:67], s42 offen sc1
    v_mfma_f32_32x32x16_bf16 v[46:61], v[24:27], v[12:15], 0
    v_exp_f32 v62, v62
    v_exp_f32 v63, v63
    v_exp_f32 v64, v64
    v_exp_f32 v65, v65
    v_mfma_f32_32x32x16_bf16 v[78:93], v[34:37], v[42:45], v[78:93]
    s_setprio 2
    v_exp_f32 v66, v66
    v_exp_f32 v67, v67
    s_waitcnt vmcnt(13)
    v_mfma_f32_32x32x16_bf16 v[110:125], v[210:213], v[190:193], v[110:125]
    s_add_u32 s42, s73, 412672
    buffer_load_dwordx4 v[210:213], v2, s[68:71], s42 offen sc1
    v_exp_f32 v68, v68
    v_exp_f32 v69, v69
    v_mfma_f32_32x32x8_bf16 v[46:61], v[28:29], v[6:7], v[46:61]
    v_cvt_pk_bf16_f32 v38, v62, v63
    v_cvt_pk_bf16_f32 v39, v64, v65
    v_cvt_pk_bf16_f32 v40, v66, v67
    v_cvt_pk_bf16_f32 v41, v68, v69
    v_exp_f32 v70, v70
    v_exp_f32 v71, v71
    v_mfma_f32_32x32x16_bf16 v[94:109], v[30:33], v[38:41], v[94:109]
    s_andn2_b64 exec, s[62:63], 0x70000000
    ds_read_b128 v[30:33], v4 offset:53760
    s_mov_b64 exec, -1
    v_exp_f32 v72, v72
    v_exp_f32 v73, v73
    v_exp_f32 v74, v74
    v_exp_f32 v75, v75
    s_waitcnt vmcnt(14)
    v_mfma_f32_32x32x16_bf16 v[126:141], v[214:217], v[190:193], v[126:141]
    s_add_u32 s42, s73, 413696
    buffer_load_dwordx4 v[214:217], v2, s[68:71], s42 offen sc1
    v_exp_f32_e64 v76, v76
    v_exp_f32 v77, v77
    s_waitcnt vmcnt(15)
    v_cvt_pk_bf16_f32 v42, v70, v71
    v_cvt_pk_bf16_f32 v43, v72, v73
    v_cvt_pk_bf16_f32 v44, v74, v75
    v_cvt_pk_bf16_f32 v45, v76, v77
    v_mfma_f32_32x32x16_bf16 v[142:157], v[218:221], v[190:193], v[142:157]
    s_add_u32 s42, s73, 491520
    buffer_load_dwordx4 v[218:221], v2, s[68:71], s42 offen sc1
    v_mfma_f32_32x32x16_bf16 v[62:77], v[24:27], v[16:19], 0
    v_exp_f32 v46, v46
    v_exp_f32 v47, v47
    v_exp_f32 v48, v48
    v_exp_f32 v49, v49
    v_mfma_f32_32x32x16_bf16 v[94:109], v[34:37], v[42:45], v[94:109]
    s_andn2_b64 exec, s[62:63], 0x70000000
    ds_read_b128 v[34:37], v4 offset:54400
    s_or_b64 exec, -1, 0x70000000
    v_add_u32 v5, 61440, v5
    ds_read_b128 v[24:27], v5 offset:0
    v_exp_f32_e64 v50, v50
    v_exp_f32 v51, v51
    s_waitcnt vmcnt(15)
    v_mfma_f32_32x32x16_bf16 v[158:173], v[222:225], v[190:193], v[158:173]
    s_add_u32 s42, s73, 492544
    buffer_load_dwordx4 v[222:225], v2, s[68:71], s42 offen sc1
    v_exp_f32 v52, v52
    v_exp_f32 v53, v53
    v_mfma_f32_32x32x8_bf16 v[62:77], v[28:29], v[254:255], v[62:77]
    v_add_u32 v3, 61440, v3
    ds_read_b64 v[28:29], v3 offset:0
    v_cvt_pk_bf16_f32 v38, v46, v47
    v_cvt_pk_bf16_f32 v39, v48, v49
    v_cvt_pk_bf16_f32 v40, v50, v51
    v_cvt_pk_bf16_f32 v41, v52, v53
    v_exp_f32_e64 v54, v54
    v_exp_f32 v55, v55
    s_waitcnt lgkmcnt(3)
    v_mfma_f32_32x32x16_bf16 v[78:93], v[30:33], v[38:41], v[78:93]
    v_exp_f32 v56, v56
    v_exp_f32 v57, v57
    v_exp_f32_e64 v58, v58
    v_exp_f32 v59, v59
    s_waitcnt vmcnt(15)
    v_mfma_f32_32x32x16_bf16 v[174:189], v[226:229], v[190:193], v[174:189]
    s_add_u32 s42, s73, 493568
    buffer_load_dwordx4 v[226:229], v2, s[68:71], s42 offen sc1
    s_add_u32 s42, s72, 24576
    buffer_load_dwordx4 v[190:193], v2, s[64:67], s42 offen sc1
    v_exp_f32_e64 v60, v60
    v_exp_f32 v61, v61
    s_waitcnt vmcnt(12) lgkmcnt(1)
    v_cvt_pk_bf16_f32 v42, v54, v55
    v_cvt_pk_bf16_f32 v43, v56, v57
    v_cvt_pk_bf16_f32 v44, v58, v59
    v_cvt_pk_bf16_f32 v45, v60, v61
    v_mfma_f32_32x32x16_bf16 v[110:125], v[230:233], v[194:197], v[110:125]
    s_add_u32 s42, s73, 494592
    buffer_load_dwordx4 v[230:233], v2, s[68:71], s42 offen sc1
    v_mfma_f32_32x32x16_bf16 v[46:61], v[24:27], v[12:15], 0
    v_exp_f32 v62, v62
    v_exp_f32 v63, v63
    v_exp_f32 v64, v64
    v_exp_f32 v65, v65
    v_mfma_f32_32x32x16_bf16 v[78:93], v[34:37], v[42:45], v[78:93]
    v_exp_f32 v66, v66
    v_exp_f32 v67, v67
    v_exp_f32_e64 v68, v68
    v_exp_f32 v69, v69
    s_waitcnt lgkmcnt(0)
    v_mfma_f32_32x32x8_bf16 v[46:61], v[28:29], v[20:21], v[46:61]
    v_cvt_pk_bf16_f32 v38, v62, v63
    v_cvt_pk_bf16_f32 v39, v64, v65
    v_cvt_pk_bf16_f32 v40, v66, v67
    v_cvt_pk_bf16_f32 v41, v68, v69
    v_exp_f32 v70, v70
    v_exp_f32 v71, v71
    v_mfma_f32_32x32x16_bf16 v[94:109], v[30:33], v[38:41], v[94:109]
    v_add_u32 v4, 61440, v4
    s_andn2_b64 exec, s[62:63], 0x70000000
    ds_read_b128 v[30:33], v4 offset:0
    s_mov_b64 exec, -1
    v_exp_f32 v72, v72
    v_exp_f32 v73, v73
    v_exp_f32 v74, v74
    v_exp_f32 v75, v75
    s_waitcnt vmcnt(13)
    v_mfma_f32_32x32x16_bf16 v[126:141], v[234:237], v[194:197], v[126:141]
    s_add_u32 s42, s73, 495616
    buffer_load_dwordx4 v[234:237], v2, s[68:71], s42 offen sc1
    v_exp_f32_e64 v76, v76
    v_exp_f32 v77, v77
    s_waitcnt vmcnt(14)
    v_cvt_pk_bf16_f32 v42, v70, v71
    v_cvt_pk_bf16_f32 v43, v72, v73
    v_cvt_pk_bf16_f32 v44, v74, v75
    v_cvt_pk_bf16_f32 v45, v76, v77
    v_mfma_f32_32x32x16_bf16 v[142:157], v[238:241], v[194:197], v[142:157]
    s_add_u32 s42, s73, 573440
    buffer_load_dwordx4 v[238:241], v2, s[68:71], s42 offen sc1
    v_mfma_f32_32x32x16_bf16 v[62:77], v[24:27], v[16:19], 0
    v_exp_f32 v46, v46
    v_exp_f32 v47, v47
    v_exp_f32 v48, v48
    v_exp_f32 v49, v49
    v_mfma_f32_32x32x16_bf16 v[94:109], v[34:37], v[42:45], v[94:109]
    s_andn2_b64 exec, s[62:63], 0x70000000
    ds_read_b128 v[34:37], v4 offset:640
    s_or_b64 exec, -1, 0x70000000
    ds_read_b128 v[24:27], v5 offset:2560
    v_exp_f32_e64 v50, v50
    v_exp_f32 v51, v51
    s_waitcnt vmcnt(14)
    v_mfma_f32_32x32x16_bf16 v[158:173], v[242:245], v[194:197], v[158:173]
    s_add_u32 s42, s73, 574464
    buffer_load_dwordx4 v[242:245], v2, s[68:71], s42 offen sc1
    v_exp_f32 v52, v52
    v_exp_f32 v53, v53
    v_mfma_f32_32x32x8_bf16 v[62:77], v[28:29], v[22:23], v[62:77]
    v_cvt_pk_bf16_f32 v38, v46, v47
    v_cvt_pk_bf16_f32 v39, v48, v49
    v_cvt_pk_bf16_f32 v40, v50, v51
    v_cvt_pk_bf16_f32 v41, v52, v53
    v_exp_f32_e64 v54, v54
    v_exp_f32 v55, v55
    s_waitcnt lgkmcnt(2)
    v_mfma_f32_32x32x16_bf16 v[78:93], v[30:33], v[38:41], v[78:93]
    v_exp_f32 v56, v56
    v_exp_f32 v57, v57
    v_exp_f32_e64 v58, v58
    v_exp_f32 v59, v59
    s_waitcnt vmcnt(14)
    v_mfma_f32_32x32x16_bf16 v[174:189], v[246:249], v[194:197], v[174:189]
    s_add_u32 s42, s73, 575488
    buffer_load_dwordx4 v[246:249], v2, s[68:71], s42 offen sc1
    s_add_u32 s42, s72, 28672
    buffer_load_dwordx4 v[194:197], v2, s[64:67], s42 offen sc1
    v_exp_f32_e64 v60, v60
    v_exp_f32 v61, v61
    s_waitcnt vmcnt(12) lgkmcnt(0)
    v_cvt_pk_bf16_f32 v42, v54, v55
    v_cvt_pk_bf16_f32 v43, v56, v57
    v_cvt_pk_bf16_f32 v44, v58, v59
    v_cvt_pk_bf16_f32 v45, v60, v61
    v_mfma_f32_32x32x16_bf16 v[110:125], v[250:253], v[198:201], v[110:125]
    s_add_u32 s42, s73, 576512
    buffer_load_dwordx4 v[250:253], v2, s[68:71], s42 offen sc1
    v_mfma_f32_32x32x16_bf16 v[46:61], v[24:27], v[12:15], 0
    v_exp_f32 v62, v62
    v_exp_f32 v63, v63
    v_exp_f32 v64, v64
    v_exp_f32 v65, v65
    v_mfma_f32_32x32x16_bf16 v[78:93], v[34:37], v[42:45], v[78:93]
    v_exp_f32_e64 v66, v66
    v_exp_f32 v67, v67
    s_waitcnt vmcnt(13)
    v_mfma_f32_32x32x16_bf16 v[126:141], v[202:205], v[198:201], v[126:141]
    s_add_u32 s42, s73, 577536
    buffer_load_dwordx4 v[202:205], v2, s[68:71], s42 offen sc1
    v_exp_f32 v68, v68
    v_exp_f32 v69, v69
    v_mfma_f32_32x32x8_bf16 v[46:61], v[28:29], v[6:7], v[46:61]
    v_cvt_pk_bf16_f32 v38, v62, v63
    v_cvt_pk_bf16_f32 v39, v64, v65
    v_cvt_pk_bf16_f32 v40, v66, v67
    v_cvt_pk_bf16_f32 v41, v68, v69
    v_exp_f32 v70, v70
    v_exp_f32 v71, v71
    v_mfma_f32_32x32x16_bf16 v[94:109], v[30:33], v[38:41], v[94:109]
    s_andn2_b64 exec, s[62:63], 0x70000000
    ds_read_b128 v[30:33], v4 offset:2560
    s_mov_b64 exec, -1
    v_exp_f32 v72, v72
    v_exp_f32 v73, v73
    v_exp_f32 v74, v74
    v_exp_f32 v75, v75
    s_waitcnt vmcnt(14)
    v_mfma_f32_32x32x16_bf16 v[142:157], v[206:209], v[198:201], v[142:157]
    s_add_u32 s42, s73, 655360
    buffer_load_dwordx4 v[206:209], v2, s[68:71], s42 offen sc1
    v_exp_f32_e64 v76, v76
    v_exp_f32 v77, v77
    s_waitcnt vmcnt(14)
    v_cvt_pk_bf16_f32 v42, v70, v71
    v_cvt_pk_bf16_f32 v43, v72, v73
    v_cvt_pk_bf16_f32 v44, v74, v75
    v_cvt_pk_bf16_f32 v45, v76, v77
    v_mfma_f32_32x32x16_bf16 v[158:173], v[210:213], v[198:201], v[158:173]
    s_add_u32 s42, s73, 656384
    buffer_load_dwordx4 v[210:213], v2, s[68:71], s42 offen sc1
    v_mfma_f32_32x32x16_bf16 v[62:77], v[24:27], v[16:19], 0
    v_exp_f32 v46, v46
    v_exp_f32 v47, v47
    v_exp_f32 v48, v48
    v_exp_f32 v49, v49
    v_mfma_f32_32x32x16_bf16 v[94:109], v[34:37], v[42:45], v[94:109]
    s_setprio 1
    s_mov_b64 exec, s[62:63]
    ds_read_b128 v[34:37], v4 offset:3200
    s_or_b64 exec, -1, 0x70000000
    ds_read_b128 v[24:27], v5 offset:10240
    v_exp_f32_e64 v50, v50
    v_exp_f32 v51, v51
    s_waitcnt vmcnt(14)
    v_mfma_f32_32x32x16_bf16 v[174:189], v[214:217], v[198:201], v[174:189]
    s_add_u32 s42, s73, 657408
    buffer_load_dwordx4 v[214:217], v2, s[68:71], s42 offen sc1
    s_add_u32 s42, s72, 32768
    buffer_load_dwordx4 v[198:201], v2, s[64:67], s42 offen sc1
    v_exp_f32 v52, v52
    v_exp_f32 v53, v53
    v_mfma_f32_32x32x8_bf16 v[62:77], v[28:29], v[254:255], v[62:77]
    ds_read_b64 v[28:29], v3 offset:10240
    v_cvt_pk_bf16_f32 v38, v46, v47
    v_cvt_pk_bf16_f32 v39, v48, v49
    v_cvt_pk_bf16_f32 v40, v50, v51
    v_cvt_pk_bf16_f32 v41, v52, v53
    v_exp_f32_e64 v54, v54
    v_exp_f32 v55, v55
    s_waitcnt lgkmcnt(3)
    v_mfma_f32_32x32x16_bf16 v[78:93], v[30:33], v[38:41], v[78:93]
    v_exp_f32 v56, v56
    v_exp_f32 v57, v57
    v_exp_f32_e64 v58, v58
    v_exp_f32 v59, v59
    s_waitcnt vmcnt(12)
    v_mfma_f32_32x32x16_bf16 v[110:125], v[218:221], v[190:193], v[110:125]
    s_add_u32 s42, s73, 658432
    buffer_load_dwordx4 v[218:221], v2, s[68:71], s42 offen sc1
    v_exp_f32_e64 v60, v60
    v_exp_f32 v61, v61
    s_waitcnt vmcnt(13) lgkmcnt(1)
    v_cvt_pk_bf16_f32 v42, v54, v55
    v_cvt_pk_bf16_f32 v43, v56, v57
    v_cvt_pk_bf16_f32 v44, v58, v59
    v_cvt_pk_bf16_f32 v45, v60, v61
    v_mfma_f32_32x32x16_bf16 v[126:141], v[222:225], v[190:193], v[126:141]
    s_add_u32 s42, s73, 659456
    buffer_load_dwordx4 v[222:225], v2, s[68:71], s42 offen sc1
    v_mfma_f32_32x32x16_bf16 v[46:61], v[24:27], v[12:15], 0
    v_exp_f32 v62, v62
    v_exp_f32 v63, v63
    v_exp_f32 v64, v64
    v_exp_f32 v65, v65
    v_mfma_f32_32x32x16_bf16 v[78:93], v[34:37], v[42:45], v[78:93]
    v_exp_f32_e64 v66, v66
    v_exp_f32 v67, v67
    s_waitcnt vmcnt(14)
    v_mfma_f32_32x32x16_bf16 v[142:157], v[226:229], v[190:193], v[142:157]
    s_add_u32 s42, s73, 737280
    buffer_load_dwordx4 v[226:229], v2, s[68:71], s42 offen sc1
    v_exp_f32_e64 v68, v68
    v_exp_f32 v69, v69
    s_waitcnt lgkmcnt(0)
    v_mfma_f32_32x32x8_bf16 v[46:61], v[28:29], v[20:21], v[46:61]
    v_cvt_pk_bf16_f32 v38, v62, v63
    v_cvt_pk_bf16_f32 v39, v64, v65
    v_cvt_pk_bf16_f32 v40, v66, v67
    v_cvt_pk_bf16_f32 v41, v68, v69
    v_exp_f32 v70, v70
    v_exp_f32 v71, v71
    v_mfma_f32_32x32x16_bf16 v[94:109], v[30:33], v[38:41], v[94:109]
    s_andn2_b64 exec, s[62:63], 0x70000000
    ds_read_b128 v[30:33], v4 offset:10240
    s_mov_b64 exec, -1
    v_exp_f32 v72, v72
    v_exp_f32 v73, v73
    v_exp_f32 v74, v74
    v_exp_f32 v75, v75
    s_waitcnt vmcnt(14)
    v_mfma_f32_32x32x16_bf16 v[158:173], v[230:233], v[190:193], v[158:173]
    s_add_u32 s42, s73, 738304
    buffer_load_dwordx4 v[230:233], v2, s[68:71], s42 offen sc1
    v_exp_f32_e64 v76, v76
    v_exp_f32 v77, v77
    s_waitcnt vmcnt(14)
    v_cvt_pk_bf16_f32 v42, v70, v71
    v_cvt_pk_bf16_f32 v43, v72, v73
    v_cvt_pk_bf16_f32 v44, v74, v75
    v_cvt_pk_bf16_f32 v45, v76, v77
    v_mfma_f32_32x32x16_bf16 v[174:189], v[234:237], v[190:193], v[174:189]
    s_add_u32 s42, s73, 739328
    buffer_load_dwordx4 v[234:237], v2, s[68:71], s42 offen sc1
    s_add_u32 s42, s72, 36864
    buffer_load_dwordx4 v[190:193], v2, s[64:67], s42 offen sc1
    v_mfma_f32_32x32x16_bf16 v[62:77], v[24:27], v[16:19], 0
    v_exp_f32 v46, v46
    v_exp_f32 v47, v47
    v_exp_f32 v48, v48
    v_exp_f32 v49, v49
    v_mfma_f32_32x32x16_bf16 v[94:109], v[34:37], v[42:45], v[94:109]
    s_andn2_b64 exec, s[62:63], 0x70000000
    ds_read_b128 v[34:37], v4 offset:10880
    s_or_b64 exec, -1, 0x70000000
    ds_read_b128 v[24:27], v5 offset:12800
    v_exp_f32_e64 v50, v50
    v_exp_f32 v51, v51
    s_waitcnt vmcnt(12)
    v_mfma_f32_32x32x16_bf16 v[110:125], v[238:241], v[194:197], v[110:125]
    s_add_u32 s42, s73, 740352
    buffer_load_dwordx4 v[238:241], v2, s[68:71], s42 offen sc1
    v_exp_f32 v52, v52
    v_exp_f32 v53, v53
    v_mfma_f32_32x32x8_bf16 v[62:77], v[28:29], v[22:23], v[62:77]
    v_cvt_pk_bf16_f32 v38, v46, v47
    v_cvt_pk_bf16_f32 v39, v48, v49
    v_cvt_pk_bf16_f32 v40, v50, v51
    v_cvt_pk_bf16_f32 v41, v52, v53
    v_exp_f32_e64 v54, v54
    v_exp_f32 v55, v55
    s_waitcnt lgkmcnt(2)
    v_mfma_f32_32x32x16_bf16 v[78:93], v[30:33], v[38:41], v[78:93]
    v_exp_f32 v56, v56
    v_exp_f32 v57, v57
    v_exp_f32_e64 v58, v58
    v_exp_f32 v59, v59
    s_waitcnt vmcnt(13)
    v_mfma_f32_32x32x16_bf16 v[126:141], v[242:245], v[194:197], v[126:141]
    s_add_u32 s42, s73, 741376
    buffer_load_dwordx4 v[242:245], v2, s[68:71], s42 offen sc1
    v_exp_f32_e64 v60, v60
    v_exp_f32 v61, v61
    s_waitcnt vmcnt(14) lgkmcnt(0)
    v_cvt_pk_bf16_f32 v42, v54, v55
    v_cvt_pk_bf16_f32 v43, v56, v57
    v_cvt_pk_bf16_f32 v44, v58, v59
    v_cvt_pk_bf16_f32 v45, v60, v61
    v_mfma_f32_32x32x16_bf16 v[142:157], v[246:249], v[194:197], v[142:157]
    s_add_u32 s42, s73, 819200
    buffer_load_dwordx4 v[246:249], v2, s[68:71], s42 offen sc1
    v_mfma_f32_32x32x16_bf16 v[46:61], v[24:27], v[12:15], 0
    v_exp_f32 v62, v62
    v_exp_f32 v63, v63
    v_exp_f32 v64, v64
    v_exp_f32 v65, v65
    v_mfma_f32_32x32x16_bf16 v[78:93], v[34:37], v[42:45], v[78:93]
    s_setprio 0
    v_exp_f32 v66, v66
    v_exp_f32 v67, v67
    s_waitcnt vmcnt(14)
    v_mfma_f32_32x32x16_bf16 v[158:173], v[250:253], v[194:197], v[158:173]
    s_add_u32 s42, s73, 820224
    buffer_load_dwordx4 v[250:253], v2, s[68:71], s42 offen sc1
    v_exp_f32 v68, v68
    v_exp_f32 v69, v69
    v_mfma_f32_32x32x8_bf16 v[46:61], v[28:29], v[6:7], v[46:61]
    v_cvt_pk_bf16_f32 v38, v62, v63
    v_cvt_pk_bf16_f32 v39, v64, v65
    v_cvt_pk_bf16_f32 v40, v66, v67
    v_cvt_pk_bf16_f32 v41, v68, v69
    v_exp_f32 v70, v70
    v_exp_f32 v71, v71
    v_mfma_f32_32x32x16_bf16 v[94:109], v[30:33], v[38:41], v[94:109]
    s_andn2_b64 exec, s[62:63], 0x70000000
    ds_read_b128 v[30:33], v4 offset:12800
    s_mov_b64 exec, -1
    v_exp_f32 v72, v72
    v_exp_f32 v73, v73
    v_exp_f32 v74, v74
    v_exp_f32 v75, v75
    s_waitcnt vmcnt(14)
    v_mfma_f32_32x32x16_bf16 v[174:189], v[202:205], v[194:197], v[174:189]
    s_add_u32 s42, s73, 821248
    buffer_load_dwordx4 v[202:205], v2, s[68:71], s42 offen sc1
    s_add_u32 s42, s72, 40960
    buffer_load_dwordx4 v[194:197], v2, s[64:67], s42 offen sc1
    v_exp_f32_e64 v76, v76
    v_exp_f32 v77, v77
    s_waitcnt vmcnt(12)
    v_cvt_pk_bf16_f32 v42, v70, v71
    v_cvt_pk_bf16_f32 v43, v72, v73
    v_cvt_pk_bf16_f32 v44, v74, v75
    v_cvt_pk_bf16_f32 v45, v76, v77
    v_mfma_f32_32x32x16_bf16 v[110:125], v[206:209], v[198:201], v[110:125]
    s_add_u32 s42, s73, 822272
    buffer_load_dwordx4 v[206:209], v2, s[68:71], s42 offen sc1
    v_mfma_f32_32x32x16_bf16 v[62:77], v[24:27], v[16:19], 0
    v_exp_f32 v46, v46
    v_exp_f32 v47, v47
    v_exp_f32 v48, v48
    v_exp_f32 v49, v49
    v_mfma_f32_32x32x16_bf16 v[94:109], v[34:37], v[42:45], v[94:109]
    s_waitcnt vmcnt(60)
    s_barrier
    s_setprio 3
    s_mov_b64 exec, s[62:63]
    ds_read_b128 v[34:37], v4 offset:13440
    s_or_b64 exec, -1, 0x70000000
    ds_read_b128 v[24:27], v5 offset:20480
    v_exp_f32_e64 v50, v50
    v_exp_f32 v51, v51
    s_waitcnt vmcnt(13)
    v_mfma_f32_32x32x16_bf16 v[126:141], v[210:213], v[198:201], v[126:141]
    s_add_u32 s42, s73, 823296
    buffer_load_dwordx4 v[210:213], v2, s[68:71], s42 offen sc1
    v_exp_f32 v52, v52
    v_exp_f32 v53, v53
    v_mfma_f32_32x32x8_bf16 v[62:77], v[28:29], v[254:255], v[62:77]
    ds_read_b64 v[28:29], v3 offset:20480
    v_cvt_pk_bf16_f32 v38, v46, v47
    v_cvt_pk_bf16_f32 v39, v48, v49
    v_cvt_pk_bf16_f32 v40, v50, v51
    v_cvt_pk_bf16_f32 v41, v52, v53
    s_add_u32 s52, s34, 20185088
    s_addc_u32 s53, s35, 0
    s_mov_b32 s54, 8192
    s_mov_b32 s55, 0x00020000
    v_lshlrev_b32_e64 v11, 2, v8
    s_lshl_b32 s42, s45, 7
    buffer_load_dword v0, v11, s[52:55], s42 offen sc1
    s_lshl_b32 s42, s38, 7
    buffer_load_dword v9, v11, s[52:55], s42 offen sc1
    s_lshr_b32 s43, s37, 3
    s_mul_i32 s43, s43, 10
    s_mul_i32 s42, s38, 40
    s_add_u32 s43, s43, s42
    s_and_b32 s44, s37, 7
    s_add_u32 s42, s43, s44
    s_lshl_b32 s89, s42, 10
    s_lshl_b32 s43, s43, 10
    s_lshl_b32 s44, s44, 8
    s_add_u32 s43, s43, s44
    s_add_u32 s90, s43, 8192
    s_mul_i32 s94, s74, 10240
    s_mul_i32 s91, s45, 40960
    s_add_u32 s88, s91, s94
    s_mul_i32 s42, s46, 320
    s_add_u32 s91, s91, s42
    s_add_u32 s91, s91, s94
    s_mov_b32 s8, s30
    s_mov_b32 s9, s31
    s_mov_b32 s10, 2621440
    s_mov_b32 s11, 0x00020000
    s_mov_b32 s92, 3
    s_mov_b32 s93, 0
    s_lshl_b32 s42, s74, 12
    s_add_u32 s42, s42, 81920
    v_add_u32 v10, s42, v2
    v_lshlrev_b32 v11, 3, v1
    v_exp_f32 v54, v54
    v_exp_f32 v55, v55
    s_waitcnt lgkmcnt(3)
    v_mfma_f32_32x32x16_bf16 v[78:93], v[30:33], v[38:41], v[78:93]
    v_exp_f32 v56, v56
    v_exp_f32 v57, v57
    v_exp_f32_e64 v58, v58
    v_exp_f32 v59, v59
    s_waitcnt vmcnt(16)
    v_mfma_f32_32x32x16_bf16 v[142:157], v[214:217], v[198:201], v[142:157]
    s_add_u32 s42, s73, 901120
    buffer_load_dwordx4 v[214:217], v2, s[68:71], s42 offen sc1
    v_exp_f32_e64 v60, v60
    v_exp_f32 v61, v61
    s_waitcnt vmcnt(16) lgkmcnt(1)
    v_cvt_pk_bf16_f32 v42, v54, v55
    v_cvt_pk_bf16_f32 v43, v56, v57
    v_cvt_pk_bf16_f32 v44, v58, v59
    v_cvt_pk_bf16_f32 v45, v60, v61
    v_mfma_f32_32x32x16_bf16 v[158:173], v[218:221], v[198:201], v[158:173]
    s_add_u32 s42, s73, 902144
    buffer_load_dwordx4 v[218:221], v2, s[68:71], s42 offen sc1
    v_mfma_f32_32x32x16_bf16 v[46:61], v[24:27], v[12:15], 0
    v_exp_f32 v62, v62
    v_exp_f32 v63, v63
    v_exp_f32 v64, v64
    v_exp_f32 v65, v65
    v_mfma_f32_32x32x16_bf16 v[78:93], v[34:37], v[42:45], v[78:93]
    v_exp_f32 v66, v66
    v_exp_f32 v67, v67
    v_exp_f32_e64 v68, v68
    v_exp_f32 v69, v69
    s_waitcnt lgkmcnt(0)
    v_mfma_f32_32x32x8_bf16 v[46:61], v[28:29], v[20:21], v[46:61]
    v_cvt_pk_bf16_f32 v38, v62, v63
    v_cvt_pk_bf16_f32 v39, v64, v65
    v_cvt_pk_bf16_f32 v40, v66, v67
    v_cvt_pk_bf16_f32 v41, v68, v69
    v_exp_f32 v70, v70
    v_exp_f32 v71, v71
    v_mfma_f32_32x32x16_bf16 v[94:109], v[30:33], v[38:41], v[94:109]
    s_andn2_b64 exec, s[62:63], 0x70000000
    ds_read_b128 v[30:33], v4 offset:20480
    s_mov_b64 exec, -1
    v_exp_f32 v72, v72
    v_exp_f32 v73, v73
    v_exp_f32 v74, v74
    v_exp_f32 v75, v75
    s_waitcnt vmcnt(16)
    v_mfma_f32_32x32x16_bf16 v[174:189], v[222:225], v[198:201], v[174:189]
    s_add_u32 s42, s73, 903168
    buffer_load_dwordx4 v[222:225], v2, s[68:71], s42 offen sc1
    s_add_u32 s42, s72, 45056
    buffer_load_dwordx4 v[198:201], v2, s[64:67], s42 offen sc1
    v_exp_f32_e64 v76, v76
    v_exp_f32 v77, v77
    s_waitcnt vmcnt(14)
    v_cvt_pk_bf16_f32 v42, v70, v71
    v_cvt_pk_bf16_f32 v43, v72, v73
    v_cvt_pk_bf16_f32 v44, v74, v75
    v_cvt_pk_bf16_f32 v45, v76, v77
    v_mfma_f32_32x32x16_bf16 v[110:125], v[226:229], v[190:193], v[110:125]
    s_add_u32 s42, s73, 904192
    buffer_load_dwordx4 v[226:229], v2, s[68:71], s42 offen sc1
    v_mfma_f32_32x32x16_bf16 v[62:77], v[24:27], v[16:19], 0
    v_exp_f32 v46, v46
    v_exp_f32 v47, v47
    v_exp_f32 v48, v48
    v_exp_f32 v49, v49
    v_mfma_f32_32x32x16_bf16 v[94:109], v[34:37], v[42:45], v[94:109]
    s_andn2_b64 exec, s[62:63], 0x70000000
    ds_read_b128 v[34:37], v4 offset:21120
    s_or_b64 exec, -1, 0x70000000
    ds_read_b128 v[24:27], v5 offset:23040
    v_exp_f32_e64 v50, v50
    v_exp_f32 v51, v51
    s_waitcnt vmcnt(15)
    v_mfma_f32_32x32x16_bf16 v[126:141], v[230:233], v[190:193], v[126:141]
    s_add_u32 s42, s73, 905216
    buffer_load_dwordx4 v[230:233], v2, s[68:71], s42 offen sc1
    v_exp_f32 v52, v52
    v_exp_f32 v53, v53
    v_mfma_f32_32x32x8_bf16 v[62:77], v[28:29], v[22:23], v[62:77]
    v_cvt_pk_bf16_f32 v38, v46, v47
    v_cvt_pk_bf16_f32 v39, v48, v49
    v_cvt_pk_bf16_f32 v40, v50, v51
    v_cvt_pk_bf16_f32 v41, v52, v53
    v_exp_f32_e64 v54, v54
    v_exp_f32 v55, v55
    s_waitcnt lgkmcnt(2)
    v_mfma_f32_32x32x16_bf16 v[78:93], v[30:33], v[38:41], v[78:93]
    v_exp_f32 v56, v56
    v_exp_f32 v57, v57
    v_exp_f32_e64 v58, v58
    v_exp_f32 v59, v59
    s_waitcnt vmcnt(16)
    v_mfma_f32_32x32x16_bf16 v[142:157], v[234:237], v[190:193], v[142:157]
    s_add_u32 s42, s73, 983040
    buffer_load_dwordx4 v[234:237], v2, s[68:71], s42 offen sc1
    v_exp_f32_e64 v60, v60
    v_exp_f32 v61, v61
    s_waitcnt vmcnt(16) lgkmcnt(0)
    v_cvt_pk_bf16_f32 v42, v54, v55
    v_cvt_pk_bf16_f32 v43, v56, v57
    v_cvt_pk_bf16_f32 v44, v58, v59
    v_cvt_pk_bf16_f32 v45, v60, v61
    v_mfma_f32_32x32x16_bf16 v[158:173], v[238:241], v[190:193], v[158:173]
    s_add_u32 s42, s73, 984064
    buffer_load_dwordx4 v[238:241], v2, s[68:71], s42 offen sc1
    v_mfma_f32_32x32x16_bf16 v[46:61], v[24:27], v[12:15], 0
    v_exp_f32 v62, v62
    v_exp_f32 v63, v63
    v_exp_f32 v64, v64
    v_exp_f32 v65, v65
    v_mfma_f32_32x32x16_bf16 v[78:93], v[34:37], v[42:45], v[78:93]
    v_exp_f32_e64 v66, v66
    v_exp_f32 v67, v67
    s_waitcnt vmcnt(16)
    v_mfma_f32_32x32x16_bf16 v[174:189], v[242:245], v[190:193], v[174:189]
    s_add_u32 s42, s73, 985088
    buffer_load_dwordx4 v[242:245], v2, s[68:71], s42 offen sc1
    s_add_u32 s42, s72, 49152
    buffer_load_dwordx4 v[190:193], v2, s[64:67], s42 offen sc1
    v_exp_f32 v68, v68
    v_exp_f32 v69, v69
    v_mfma_f32_32x32x8_bf16 v[46:61], v[28:29], v[6:7], v[46:61]
    v_cvt_pk_bf16_f32 v38, v62, v63
    v_cvt_pk_bf16_f32 v39, v64, v65
    v_cvt_pk_bf16_f32 v40, v66, v67
    v_cvt_pk_bf16_f32 v41, v68, v69
    v_exp_f32 v70, v70
    v_exp_f32 v71, v71
    v_mfma_f32_32x32x16_bf16 v[94:109], v[30:33], v[38:41], v[94:109]
    s_andn2_b64 exec, s[62:63], 0x70000000
    ds_read_b128 v[30:33], v4 offset:23040
    s_mov_b64 exec, -1
    v_exp_f32 v72, v72
    v_exp_f32 v73, v73
    v_exp_f32 v74, v74
    v_exp_f32 v75, v75
    s_waitcnt vmcnt(14)
    v_mfma_f32_32x32x16_bf16 v[110:125], v[246:249], v[194:197], v[110:125]
    s_add_u32 s42, s73, 986112
    buffer_load_dwordx4 v[246:249], v2, s[68:71], s42 offen sc1
    v_exp_f32_e64 v76, v76
    v_exp_f32 v77, v77
    s_waitcnt vmcnt(15)
    v_cvt_pk_bf16_f32 v42, v70, v71
    v_cvt_pk_bf16_f32 v43, v72, v73
    v_cvt_pk_bf16_f32 v44, v74, v75
    v_cvt_pk_bf16_f32 v45, v76, v77
    v_mfma_f32_32x32x16_bf16 v[126:141], v[250:253], v[194:197], v[126:141]
    s_add_u32 s42, s73, 987136
    buffer_load_dwordx4 v[250:253], v2, s[68:71], s42 offen sc1
    v_mfma_f32_32x32x16_bf16 v[62:77], v[24:27], v[16:19], 0
    v_exp_f32 v46, v46
    v_exp_f32 v47, v47
    v_exp_f32 v48, v48
    v_exp_f32 v49, v49
    v_mfma_f32_32x32x16_bf16 v[94:109], v[34:37], v[42:45], v[94:109]
    s_andn2_b64 exec, s[62:63], 0x70000000
    ds_read_b128 v[34:37], v4 offset:23680
    s_or_b64 exec, -1, 0x70000000
    ds_read_b128 v[24:27], v5 offset:30720
    v_exp_f32_e64 v50, v50
    v_exp_f32 v51, v51
    s_waitcnt vmcnt(16)
    v_mfma_f32_32x32x16_bf16 v[142:157], v[202:205], v[194:197], v[142:157]
    s_add_u32 s42, s73, 1064960
    buffer_load_dwordx4 v[202:205], v2, s[68:71], s42 offen sc1
    v_exp_f32 v52, v52
    v_exp_f32 v53, v53
    v_mfma_f32_32x32x8_bf16 v[62:77], v[28:29], v[254:255], v[62:77]
    ds_read_b64 v[28:29], v3 offset:30720
    v_cvt_pk_bf16_f32 v38, v46, v47
    v_cvt_pk_bf16_f32 v39, v48, v49
    v_cvt_pk_bf16_f32 v40, v50, v51
    v_cvt_pk_bf16_f32 v41, v52, v53
    v_exp_f32_e64 v54, v54
    v_exp_f32 v55, v55
    s_waitcnt lgkmcnt(3)
    v_mfma_f32_32x32x16_bf16 v[78:93], v[30:33], v[38:41], v[78:93]
    v_exp_f32 v56, v56
    v_exp_f32 v57, v57
    v_exp_f32_e64 v58, v58
    v_exp_f32 v59, v59
    s_waitcnt vmcnt(16)
    v_mfma_f32_32x32x16_bf16 v[158:173], v[206:209], v[194:197], v[158:173]
    s_add_u32 s42, s73, 1065984
    buffer_load_dwordx4 v[206:209], v2, s[68:71], s42 offen sc1
    v_exp_f32_e64 v60, v60
    v_exp_f32 v61, v61
    s_waitcnt vmcnt(16) lgkmcnt(1)
    v_cvt_pk_bf16_f32 v42, v54, v55
    v_cvt_pk_bf16_f32 v43, v56, v57
    v_cvt_pk_bf16_f32 v44, v58, v59
    v_cvt_pk_bf16_f32 v45, v60, v61
    v_mfma_f32_32x32x16_bf16 v[174:189], v[210:213], v[194:197], v[174:189]
    s_add_u32 s42, s73, 1067008
    buffer_load_dwordx4 v[210:213], v2, s[68:71], s42 offen sc1
    s_add_u32 s42, s72, 53248
    buffer_load_dwordx4 v[194:197], v2, s[64:67], s42 offen sc1
    v_mfma_f32_32x32x16_bf16 v[46:61], v[24:27], v[12:15], 0
    v_exp_f32 v62, v62
    v_exp_f32 v63, v63
    v_exp_f32 v64, v64
    v_exp_f32 v65, v65
    v_mfma_f32_32x32x16_bf16 v[78:93], v[34:37], v[42:45], v[78:93]
    v_exp_f32_e64 v66, v66
    v_exp_f32 v67, v67
    s_waitcnt vmcnt(12)
    v_mfma_f32_32x32x16_bf16 v[110:125], v[214:217], v[198:201], v[110:125]
    s_add_u32 s42, s73, 1068032
    buffer_load_dwordx4 v[214:217], v2, s[68:71], s42 offen sc1
    v_exp_f32_e64 v68, v68
    v_exp_f32 v69, v69
    s_waitcnt lgkmcnt(0)
    v_mfma_f32_32x32x8_bf16 v[46:61], v[28:29], v[20:21], v[46:61]
    v_cvt_pk_bf16_f32 v38, v62, v63
    v_cvt_pk_bf16_f32 v39, v64, v65
    v_cvt_pk_bf16_f32 v40, v66, v67
    v_cvt_pk_bf16_f32 v41, v68, v69
    v_exp_f32 v70, v70
    v_exp_f32 v71, v71
    v_mfma_f32_32x32x16_bf16 v[94:109], v[30:33], v[38:41], v[94:109]
    s_andn2_b64 exec, s[62:63], 0x70000000
    ds_read_b128 v[30:33], v4 offset:30720
    s_mov_b64 exec, -1
    v_exp_f32 v72, v72
    v_exp_f32 v73, v73
    v_exp_f32 v74, v74
    v_exp_f32 v75, v75
    s_waitcnt vmcnt(13)
    v_mfma_f32_32x32x16_bf16 v[126:141], v[218:221], v[198:201], v[126:141]
    s_add_u32 s42, s73, 1069056
    buffer_load_dwordx4 v[218:221], v2, s[68:71], s42 offen sc1
    v_exp_f32_e64 v76, v76
    v_exp_f32 v77, v77
    s_waitcnt vmcnt(14)
    v_cvt_pk_bf16_f32 v42, v70, v71
    v_cvt_pk_bf16_f32 v43, v72, v73
    v_cvt_pk_bf16_f32 v44, v74, v75
    v_cvt_pk_bf16_f32 v45, v76, v77
    v_mfma_f32_32x32x16_bf16 v[142:157], v[222:225], v[198:201], v[142:157]
    s_add_u32 s42, s73, 1146880
    buffer_load_dwordx4 v[222:225], v2, s[68:71], s42 offen sc1
    v_mfma_f32_32x32x16_bf16 v[62:77], v[24:27], v[16:19], 0
    v_exp_f32 v46, v46
    v_exp_f32 v47, v47
    v_exp_f32 v48, v48
    v_exp_f32 v49, v49
    v_mfma_f32_32x32x16_bf16 v[94:109], v[34:37], v[42:45], v[94:109]
    s_andn2_b64 exec, s[62:63], 0x70000000
    ds_read_b128 v[34:37], v4 offset:31360
    s_or_b64 exec, -1, 0x70000000
    ds_read_b128 v[24:27], v5 offset:33280
    v_exp_f32_e64 v50, v50
    v_exp_f32 v51, v51
    s_waitcnt vmcnt(14)
    v_mfma_f32_32x32x16_bf16 v[158:173], v[226:229], v[198:201], v[158:173]
    s_add_u32 s42, s73, 1147904
    buffer_load_dwordx4 v[226:229], v2, s[68:71], s42 offen sc1
    v_exp_f32 v52, v52
    v_exp_f32 v53, v53
    v_mfma_f32_32x32x8_bf16 v[62:77], v[28:29], v[22:23], v[62:77]
    v_cvt_pk_bf16_f32 v38, v46, v47
    v_cvt_pk_bf16_f32 v39, v48, v49
    v_cvt_pk_bf16_f32 v40, v50, v51
    v_cvt_pk_bf16_f32 v41, v52, v53
    v_exp_f32_e64 v54, v54
    v_exp_f32 v55, v55
    s_waitcnt lgkmcnt(2)
    v_mfma_f32_32x32x16_bf16 v[78:93], v[30:33], v[38:41], v[78:93]
    v_exp_f32 v56, v56
    v_exp_f32 v57, v57
    v_exp_f32_e64 v58, v58
    v_exp_f32 v59, v59
    s_waitcnt vmcnt(14)
    v_mfma_f32_32x32x16_bf16 v[174:189], v[230:233], v[198:201], v[174:189]
    s_add_u32 s42, s73, 1148928
    buffer_load_dwordx4 v[230:233], v2, s[68:71], s42 offen sc1
    s_add_u32 s42, s72, 57344
    buffer_load_dwordx4 v[198:201], v2, s[64:67], s42 offen sc1
    v_exp_f32_e64 v60, v60
    v_exp_f32 v61, v61
    s_waitcnt vmcnt(12) lgkmcnt(0)
    v_cvt_pk_bf16_f32 v42, v54, v55
    v_cvt_pk_bf16_f32 v43, v56, v57
    v_cvt_pk_bf16_f32 v44, v58, v59
    v_cvt_pk_bf16_f32 v45, v60, v61
    v_mfma_f32_32x32x16_bf16 v[110:125], v[234:237], v[190:193], v[110:125]
    s_add_u32 s42, s73, 1149952
    buffer_load_dwordx4 v[234:237], v2, s[68:71], s42 offen sc1
    v_mfma_f32_32x32x16_bf16 v[46:61], v[24:27], v[12:15], 0
    v_exp_f32 v62, v62
    v_exp_f32 v63, v63
    v_exp_f32 v64, v64
    v_exp_f32 v65, v65
    v_mfma_f32_32x32x16_bf16 v[78:93], v[34:37], v[42:45], v[78:93]
    s_setprio 2
    v_exp_f32 v66, v66
    v_exp_f32 v67, v67
    s_waitcnt vmcnt(13)
    v_mfma_f32_32x32x16_bf16 v[126:141], v[238:241], v[190:193], v[126:141]
    s_add_u32 s42, s73, 1150976
    buffer_load_dwordx4 v[238:241], v2, s[68:71], s42 offen sc1
    v_exp_f32 v68, v68
    v_exp_f32 v69, v69
    v_mfma_f32_32x32x8_bf16 v[46:61], v[28:29], v[6:7], v[46:61]
    v_cvt_pk_bf16_f32 v38, v62, v63
    v_cvt_pk_bf16_f32 v39, v64, v65
    v_cvt_pk_bf16_f32 v40, v66, v67
    v_cvt_pk_bf16_f32 v41, v68, v69
    v_exp_f32 v70, v70
    v_exp_f32 v71, v71
    v_mfma_f32_32x32x16_bf16 v[94:109], v[30:33], v[38:41], v[94:109]
    s_andn2_b64 exec, s[62:63], 0x70000000
    ds_read_b128 v[30:33], v4 offset:33280
    s_mov_b64 exec, -1
    v_exp_f32 v72, v72
    v_exp_f32 v73, v73
    v_exp_f32 v74, v74
    v_exp_f32 v75, v75
    s_waitcnt vmcnt(14)
    v_mfma_f32_32x32x16_bf16 v[142:157], v[242:245], v[190:193], v[142:157]
    s_add_u32 s42, s73, 1228800
    buffer_load_dwordx4 v[242:245], v2, s[68:71], s42 offen sc1
    v_exp_f32_e64 v76, v76
    v_exp_f32 v77, v77
    s_waitcnt vmcnt(14)
    v_cvt_pk_bf16_f32 v42, v70, v71
    v_cvt_pk_bf16_f32 v43, v72, v73
    v_cvt_pk_bf16_f32 v44, v74, v75
    v_cvt_pk_bf16_f32 v45, v76, v77
    v_mfma_f32_32x32x16_bf16 v[158:173], v[246:249], v[190:193], v[158:173]
    s_add_u32 s42, s73, 1229824
    buffer_load_dwordx4 v[246:249], v2, s[68:71], s42 offen sc1
    v_mfma_f32_32x32x16_bf16 v[62:77], v[24:27], v[16:19], 0
    v_exp_f32 v46, v46
    v_exp_f32 v47, v47
    v_exp_f32 v48, v48
    v_exp_f32 v49, v49
    v_mfma_f32_32x32x16_bf16 v[94:109], v[34:37], v[42:45], v[94:109]
    s_andn2_b64 exec, s[62:63], 0x70000000
    ds_read_b128 v[34:37], v4 offset:33920
    s_or_b64 exec, -1, 0x70000000
    ds_read_b128 v[24:27], v5 offset:40960
    v_exp_f32_e64 v50, v50
    v_exp_f32 v51, v51
    s_waitcnt vmcnt(14)
    v_mfma_f32_32x32x16_bf16 v[174:189], v[250:253], v[190:193], v[174:189]
    s_add_u32 s42, s73, 1230848
    buffer_load_dwordx4 v[250:253], v2, s[68:71], s42 offen sc1
    s_add_u32 s42, s72, 61440
    buffer_load_dwordx4 v[190:193], v2, s[64:67], s42 offen sc1
    v_exp_f32 v52, v52
    v_exp_f32 v53, v53
    v_mfma_f32_32x32x8_bf16 v[62:77], v[28:29], v[254:255], v[62:77]
    ds_read_b64 v[28:29], v3 offset:40960
    v_cvt_pk_bf16_f32 v38, v46, v47
    v_cvt_pk_bf16_f32 v39, v48, v49
    v_cvt_pk_bf16_f32 v40, v50, v51
    v_cvt_pk_bf16_f32 v41, v52, v53
    v_exp_f32_e64 v54, v54
    v_exp_f32 v55, v55
    s_waitcnt lgkmcnt(3)
    v_mfma_f32_32x32x16_bf16 v[78:93], v[30:33], v[38:41], v[78:93]
    v_exp_f32 v56, v56
    v_exp_f32 v57, v57
    v_exp_f32_e64 v58, v58
    v_exp_f32 v59, v59
    s_waitcnt vmcnt(12)
    v_mfma_f32_32x32x16_bf16 v[110:125], v[202:205], v[194:197], v[110:125]
    s_add_u32 s42, s73, 1231872
    buffer_load_dwordx4 v[202:205], v2, s[68:71], s42 offen sc1
    v_exp_f32_e64 v60, v60
    v_exp_f32 v61, v61
    s_waitcnt vmcnt(13) lgkmcnt(1)
    v_cvt_pk_bf16_f32 v42, v54, v55
    v_cvt_pk_bf16_f32 v43, v56, v57
    v_cvt_pk_bf16_f32 v44, v58, v59
    v_cvt_pk_bf16_f32 v45, v60, v61
    v_mfma_f32_32x32x16_bf16 v[126:141], v[206:209], v[194:197], v[126:141]
    s_add_u32 s42, s73, 1232896
    buffer_load_dwordx4 v[206:209], v2, s[68:71], s42 offen sc1
    v_mfma_f32_32x32x16_bf16 v[46:61], v[24:27], v[12:15], 0
    v_exp_f32 v62, v62
    v_exp_f32 v63, v63
    v_exp_f32 v64, v64
    v_exp_f32 v65, v65
    v_mfma_f32_32x32x16_bf16 v[78:93], v[34:37], v[42:45], v[78:93]
    v_exp_f32 v66, v66
    v_exp_f32 v67, v67
    v_exp_f32_e64 v68, v68
    v_exp_f32 v69, v69
    s_waitcnt lgkmcnt(0)
    v_mfma_f32_32x32x8_bf16 v[46:61], v[28:29], v[20:21], v[46:61]
    v_cvt_pk_bf16_f32 v38, v62, v63
    v_cvt_pk_bf16_f32 v39, v64, v65
    v_cvt_pk_bf16_f32 v40, v66, v67
    v_cvt_pk_bf16_f32 v41, v68, v69
    v_exp_f32 v70, v70
    v_exp_f32 v71, v71
    v_mfma_f32_32x32x16_bf16 v[94:109], v[30:33], v[38:41], v[94:109]
    s_andn2_b64 exec, s[62:63], 0x70000000
    ds_read_b128 v[30:33], v4 offset:40960
    s_mov_b64 exec, -1
    v_exp_f32 v72, v72
    v_exp_f32 v73, v73
    v_exp_f32 v74, v74
    v_exp_f32 v75, v75
    s_waitcnt vmcnt(14)
    v_mfma_f32_32x32x16_bf16 v[142:157], v[210:213], v[194:197], v[142:157]
    s_add_u32 s42, s73, 1310720
    buffer_load_dwordx4 v[210:213], v2, s[68:71], s42 offen sc1
    v_exp_f32_e64 v76, v76
    v_exp_f32 v77, v77
    s_waitcnt vmcnt(14)
    v_cvt_pk_bf16_f32 v42, v70, v71
    v_cvt_pk_bf16_f32 v43, v72, v73
    v_cvt_pk_bf16_f32 v44, v74, v75
    v_cvt_pk_bf16_f32 v45, v76, v77
    v_mfma_f32_32x32x16_bf16 v[158:173], v[214:217], v[194:197], v[158:173]
    s_add_u32 s42, s73, 1311744
    buffer_load_dwordx4 v[214:217], v2, s[68:71], s42 offen sc1
    v_mfma_f32_32x32x16_bf16 v[62:77], v[24:27], v[16:19], 0
    v_exp_f32 v46, v46
    v_exp_f32 v47, v47
    v_exp_f32 v48, v48
    v_exp_f32 v49, v49
    v_mfma_f32_32x32x16_bf16 v[94:109], v[34:37], v[42:45], v[94:109]
    s_andn2_b64 exec, s[62:63], 0x70000000
    ds_read_b128 v[34:37], v4 offset:41600
    s_or_b64 exec, -1, 0x70000000
    ds_read_b128 v[24:27], v5 offset:43520
    v_exp_f32_e64 v50, v50
    v_exp_f32 v51, v51
    s_waitcnt vmcnt(14)
    v_mfma_f32_32x32x16_bf16 v[174:189], v[218:221], v[194:197], v[174:189]
    s_add_u32 s42, s73, 1312768
    buffer_load_dwordx4 v[218:221], v2, s[68:71], s42 offen sc1
    s_add_u32 s42, s72, 65536
    buffer_load_dwordx4 v[194:197], v2, s[64:67], s42 offen sc1
    v_exp_f32 v52, v52
    v_exp_f32 v53, v53
    v_mfma_f32_32x32x8_bf16 v[62:77], v[28:29], v[22:23], v[62:77]
    v_cvt_pk_bf16_f32 v38, v46, v47
    v_cvt_pk_bf16_f32 v39, v48, v49
    v_cvt_pk_bf16_f32 v40, v50, v51
    v_cvt_pk_bf16_f32 v41, v52, v53
    v_exp_f32_e64 v54, v54
    v_exp_f32 v55, v55
    s_waitcnt lgkmcnt(2)
    v_mfma_f32_32x32x16_bf16 v[78:93], v[30:33], v[38:41], v[78:93]
    v_exp_f32 v56, v56
    v_exp_f32 v57, v57
    v_exp_f32_e64 v58, v58
    v_exp_f32 v59, v59
    s_waitcnt vmcnt(12)
    v_mfma_f32_32x32x16_bf16 v[110:125], v[222:225], v[198:201], v[110:125]
    s_add_u32 s42, s73, 1313792
    buffer_load_dwordx4 v[222:225], v2, s[68:71], s42 offen sc1
    v_exp_f32_e64 v60, v60
    v_exp_f32 v61, v61
    s_waitcnt vmcnt(13) lgkmcnt(0)
    v_cvt_pk_bf16_f32 v42, v54, v55
    v_cvt_pk_bf16_f32 v43, v56, v57
    v_cvt_pk_bf16_f32 v44, v58, v59
    v_cvt_pk_bf16_f32 v45, v60, v61
    v_mfma_f32_32x32x16_bf16 v[126:141], v[226:229], v[198:201], v[126:141]
    s_add_u32 s42, s73, 1314816
    buffer_load_dwordx4 v[226:229], v2, s[68:71], s42 offen sc1
    v_mfma_f32_32x32x16_bf16 v[46:61], v[24:27], v[12:15], 0
    v_exp_f32 v62, v62
    v_exp_f32 v63, v63
    v_exp_f32 v64, v64
    v_exp_f32 v65, v65
    v_mfma_f32_32x32x16_bf16 v[78:93], v[34:37], v[42:45], v[78:93]
    v_exp_f32_e64 v66, v66
    v_exp_f32 v67, v67
    s_waitcnt vmcnt(14)
    v_mfma_f32_32x32x16_bf16 v[142:157], v[230:233], v[198:201], v[142:157]
    s_add_u32 s42, s73, 1392640
    buffer_load_dwordx4 v[230:233], v2, s[68:71], s42 offen sc1
    v_exp_f32 v68, v68
    v_exp_f32 v69, v69
    v_mfma_f32_32x32x8_bf16 v[46:61], v[28:29], v[6:7], v[46:61]
    v_cvt_pk_bf16_f32 v38, v62, v63
    v_cvt_pk_bf16_f32 v39, v64, v65
    v_cvt_pk_bf16_f32 v40, v66, v67
    v_cvt_pk_bf16_f32 v41, v68, v69
    v_exp_f32 v70, v70
    v_exp_f32 v71, v71
    v_mfma_f32_32x32x16_bf16 v[94:109], v[30:33], v[38:41], v[94:109]
    s_andn2_b64 exec, s[62:63], 0x70000000
    ds_read_b128 v[30:33], v4 offset:43520
    s_mov_b64 exec, -1
    v_exp_f32 v72, v72
    v_exp_f32 v73, v73
    v_exp_f32 v74, v74
    v_exp_f32 v75, v75
    s_waitcnt vmcnt(14)
    v_mfma_f32_32x32x16_bf16 v[158:173], v[234:237], v[198:201], v[158:173]
    s_add_u32 s42, s73, 1393664
    buffer_load_dwordx4 v[234:237], v2, s[68:71], s42 offen sc1
    v_exp_f32_e64 v76, v76
    v_exp_f32 v77, v77
    s_waitcnt vmcnt(14)
    v_cvt_pk_bf16_f32 v42, v70, v71
    v_cvt_pk_bf16_f32 v43, v72, v73
    v_cvt_pk_bf16_f32 v44, v74, v75
    v_cvt_pk_bf16_f32 v45, v76, v77
    v_mfma_f32_32x32x16_bf16 v[174:189], v[238:241], v[198:201], v[174:189]
    s_add_u32 s42, s73, 1394688
    buffer_load_dwordx4 v[238:241], v2, s[68:71], s42 offen sc1
    s_add_u32 s42, s72, 69632
    buffer_load_dwordx4 v[198:201], v2, s[64:67], s42 offen sc1
    v_mfma_f32_32x32x16_bf16 v[62:77], v[24:27], v[16:19], 0
    v_exp_f32 v46, v46
    v_exp_f32 v47, v47
    v_exp_f32 v48, v48
    v_exp_f32 v49, v49
    v_mfma_f32_32x32x16_bf16 v[94:109], v[34:37], v[42:45], v[94:109]
    s_setprio 1
    s_mov_b64 exec, s[62:63]
    ds_read_b128 v[34:37], v4 offset:44160
    s_or_b64 exec, -1, 0x70000000
    ds_read_b128 v[24:27], v5 offset:51200
    v_exp_f32_e64 v50, v50
    v_exp_f32 v51, v51
    s_waitcnt vmcnt(12)
    v_mfma_f32_32x32x16_bf16 v[110:125], v[242:245], v[190:193], v[110:125]
    s_add_u32 s42, s73, 1395712
    buffer_load_dwordx4 v[242:245], v2, s[68:71], s42 offen sc1
    v_exp_f32 v52, v52
    v_exp_f32 v53, v53
    v_mfma_f32_32x32x8_bf16 v[62:77], v[28:29], v[254:255], v[62:77]
    ds_read_b64 v[28:29], v3 offset:51200
    v_cvt_pk_bf16_f32 v38, v46, v47
    v_cvt_pk_bf16_f32 v39, v48, v49
    v_cvt_pk_bf16_f32 v40, v50, v51
    v_cvt_pk_bf16_f32 v41, v52, v53
    v_exp_f32_e64 v54, v54
    v_exp_f32 v55, v55
    s_waitcnt lgkmcnt(3)
    v_mfma_f32_32x32x16_bf16 v[78:93], v[30:33], v[38:41], v[78:93]
    v_exp_f32 v56, v56
    v_exp_f32 v57, v57
    v_exp_f32_e64 v58, v58
    v_exp_f32 v59, v59
    s_waitcnt vmcnt(13)
    v_mfma_f32_32x32x16_bf16 v[126:141], v[246:249], v[190:193], v[126:141]
    s_add_u32 s42, s73, 1396736
    buffer_load_dwordx4 v[246:249], v2, s[68:71], s42 offen sc1
    v_exp_f32_e64 v60, v60
    v_exp_f32 v61, v61
    s_waitcnt vmcnt(14) lgkmcnt(1)
    v_cvt_pk_bf16_f32 v42, v54, v55
    v_cvt_pk_bf16_f32 v43, v56, v57
    v_cvt_pk_bf16_f32 v44, v58, v59
    v_cvt_pk_bf16_f32 v45, v60, v61
    v_mfma_f32_32x32x16_bf16 v[142:157], v[250:253], v[190:193], v[142:157]
    s_add_u32 s42, s73, 1474560
    buffer_load_dwordx4 v[250:253], v2, s[68:71], s42 offen sc1
    v_mfma_f32_32x32x16_bf16 v[46:61], v[24:27], v[12:15], 0
    v_exp_f32 v62, v62
    v_exp_f32 v63, v63
    v_exp_f32 v64, v64
    v_exp_f32 v65, v65
    v_mfma_f32_32x32x16_bf16 v[78:93], v[34:37], v[42:45], v[78:93]
    v_exp_f32_e64 v66, v66
    v_exp_f32 v67, v67
    s_waitcnt vmcnt(14)
    v_mfma_f32_32x32x16_bf16 v[158:173], v[202:205], v[190:193], v[158:173]
    s_add_u32 s42, s73, 1475584
    buffer_load_dwordx4 v[202:205], v2, s[68:71], s42 offen sc1
    v_exp_f32_e64 v68, v68
    v_exp_f32 v69, v69
    s_waitcnt lgkmcnt(0)
    v_mfma_f32_32x32x8_bf16 v[46:61], v[28:29], v[20:21], v[46:61]
    v_cvt_pk_bf16_f32 v38, v62, v63
    v_cvt_pk_bf16_f32 v39, v64, v65
    v_cvt_pk_bf16_f32 v40, v66, v67
    v_cvt_pk_bf16_f32 v41, v68, v69
    v_exp_f32 v70, v70
    v_exp_f32 v71, v71
    v_mfma_f32_32x32x16_bf16 v[94:109], v[30:33], v[38:41], v[94:109]
    s_andn2_b64 exec, s[62:63], 0x70000000
    ds_read_b128 v[30:33], v4 offset:51200
    s_mov_b64 exec, -1
    v_exp_f32 v72, v72
    v_exp_f32 v73, v73
    v_exp_f32 v74, v74
    v_exp_f32 v75, v75
    s_waitcnt vmcnt(14)
    v_mfma_f32_32x32x16_bf16 v[174:189], v[206:209], v[190:193], v[174:189]
    s_add_u32 s42, s73, 1476608
    buffer_load_dwordx4 v[206:209], v2, s[68:71], s42 offen sc1
    s_add_u32 s42, s72, 73728
    buffer_load_dwordx4 v[190:193], v2, s[64:67], s42 offen sc1
    v_exp_f32_e64 v76, v76
    v_exp_f32 v77, v77
    s_waitcnt vmcnt(12)
    v_cvt_pk_bf16_f32 v42, v70, v71
    v_cvt_pk_bf16_f32 v43, v72, v73
    v_cvt_pk_bf16_f32 v44, v74, v75
    v_cvt_pk_bf16_f32 v45, v76, v77
    v_mfma_f32_32x32x16_bf16 v[110:125], v[210:213], v[194:197], v[110:125]
    s_add_u32 s42, s73, 1477632
    buffer_load_dwordx4 v[210:213], v2, s[68:71], s42 offen sc1
    v_mfma_f32_32x32x16_bf16 v[62:77], v[24:27], v[16:19], 0
    v_exp_f32 v46, v46
    v_exp_f32 v47, v47
    v_exp_f32 v48, v48
    v_exp_f32 v49, v49
    v_mfma_f32_32x32x16_bf16 v[94:109], v[34:37], v[42:45], v[94:109]
    s_andn2_b64 exec, s[62:63], 0x70000000
    ds_read_b128 v[34:37], v4 offset:51840
    s_or_b64 exec, -1, 0x70000000
    ds_read_b128 v[24:27], v5 offset:53760
    v_exp_f32_e64 v50, v50
    v_exp_f32 v51, v51
    s_waitcnt vmcnt(13)
    v_mfma_f32_32x32x16_bf16 v[126:141], v[214:217], v[194:197], v[126:141]
    s_add_u32 s42, s73, 1478656
    buffer_load_dwordx4 v[214:217], v2, s[68:71], s42 offen sc1
    v_exp_f32 v52, v52
    v_exp_f32 v53, v53
    v_mfma_f32_32x32x8_bf16 v[62:77], v[28:29], v[22:23], v[62:77]
    v_cvt_pk_bf16_f32 v38, v46, v47
    v_cvt_pk_bf16_f32 v39, v48, v49
    v_cvt_pk_bf16_f32 v40, v50, v51
    v_cvt_pk_bf16_f32 v41, v52, v53
    v_exp_f32_e64 v54, v54
    v_exp_f32 v55, v55
    s_waitcnt lgkmcnt(2)
    v_mfma_f32_32x32x16_bf16 v[78:93], v[30:33], v[38:41], v[78:93]
    v_exp_f32 v56, v56
    v_exp_f32 v57, v57
    v_exp_f32_e64 v58, v58
    v_exp_f32 v59, v59
    s_waitcnt vmcnt(14)
    v_mfma_f32_32x32x16_bf16 v[142:157], v[218:221], v[194:197], v[142:157]
    s_add_u32 s42, s73, 1556480
    buffer_load_dwordx4 v[218:221], v2, s[68:71], s42 offen sc1
    v_exp_f32_e64 v60, v60
    v_exp_f32 v61, v61
    s_waitcnt vmcnt(14) lgkmcnt(0)
    v_cvt_pk_bf16_f32 v42, v54, v55
    v_cvt_pk_bf16_f32 v43, v56, v57
    v_cvt_pk_bf16_f32 v44, v58, v59
    v_cvt_pk_bf16_f32 v45, v60, v61
    v_mfma_f32_32x32x16_bf16 v[158:173], v[222:225], v[194:197], v[158:173]
    s_add_u32 s42, s73, 1557504
    buffer_load_dwordx4 v[222:225], v2, s[68:71], s42 offen sc1
    v_mfma_f32_32x32x16_bf16 v[46:61], v[24:27], v[12:15], 0
    v_exp_f32 v62, v62
    v_exp_f32 v63, v63
    v_exp_f32 v64, v64
    v_exp_f32 v65, v65
    v_mfma_f32_32x32x16_bf16 v[78:93], v[34:37], v[42:45], v[78:93]
    s_setprio 0
    v_exp_f32 v66, v66
    v_exp_f32 v67, v67
    s_waitcnt vmcnt(14)
    v_mfma_f32_32x32x16_bf16 v[174:189], v[226:229], v[194:197], v[174:189]
    s_add_u32 s42, s73, 1558528
    buffer_load_dwordx4 v[226:229], v2, s[68:71], s42 offen sc1
    s_add_u32 s42, s72, 77824
    buffer_load_dwordx4 v[194:197], v2, s[64:67], s42 offen sc1
    v_exp_f32 v68, v68
    v_exp_f32 v69, v69
    v_mfma_f32_32x32x8_bf16 v[46:61], v[28:29], v[6:7], v[46:61]
    v_cvt_pk_bf16_f32 v38, v62, v63
    v_cvt_pk_bf16_f32 v39, v64, v65
    v_cvt_pk_bf16_f32 v40, v66, v67
    v_cvt_pk_bf16_f32 v41, v68, v69
    v_exp_f32 v70, v70
    v_exp_f32 v71, v71
    v_mfma_f32_32x32x16_bf16 v[94:109], v[30:33], v[38:41], v[94:109]
    s_andn2_b64 exec, s[62:63], 0x70000000
    ds_read_b128 v[30:33], v4 offset:53760
    s_mov_b64 exec, -1
    v_exp_f32 v72, v72
    v_exp_f32 v73, v73
    v_exp_f32 v74, v74
    v_exp_f32 v75, v75
    s_waitcnt vmcnt(12)
    v_mfma_f32_32x32x16_bf16 v[110:125], v[230:233], v[198:201], v[110:125]
    s_add_u32 s42, s73, 1559552
    buffer_load_dwordx4 v[230:233], v2, s[68:71], s42 offen sc1
    v_exp_f32_e64 v76, v76
    v_exp_f32 v77, v77
    s_waitcnt vmcnt(13)
    v_cvt_pk_bf16_f32 v42, v70, v71
    v_cvt_pk_bf16_f32 v43, v72, v73
    v_cvt_pk_bf16_f32 v44, v74, v75
    v_cvt_pk_bf16_f32 v45, v76, v77
    v_mfma_f32_32x32x16_bf16 v[126:141], v[234:237], v[198:201], v[126:141]
    s_add_u32 s42, s73, 1560576
    buffer_load_dwordx4 v[234:237], v2, s[68:71], s42 offen sc1
    v_mfma_f32_32x32x16_bf16 v[62:77], v[24:27], v[16:19], 0
    v_exp_f32 v46, v46
    v_exp_f32 v47, v47
    v_exp_f32 v48, v48
    v_exp_f32 v49, v49
    v_mfma_f32_32x32x16_bf16 v[94:109], v[34:37], v[42:45], v[94:109]
    s_waitcnt vmcnt(54)
    s_barrier
    v_sub_f32_e64 v0, 1.0, v0
    v_cvt_pk_bf16_f32 v0, v0, v0
    v_lshlrev_b32 v0, 16, v0
    s_setprio 3
    s_andn2_b64 exec, s[62:63], 0x70000000
    ds_read_b128 v[34:37], v4 offset:54400
    s_or_b64 exec, -1, 0x70000000
    v_add_u32 v5, 61440, v5
    ds_read_b128 v[24:27], v5 offset:0
    v_exp_f32_e64 v50, v50
    v_exp_f32 v51, v51
    s_waitcnt vmcnt(14)
    v_mfma_f32_32x32x16_bf16 v[142:157], v[238:241], v[198:201], v[142:157]
    s_add_u32 s42, s73, 1638400
    buffer_load_dwordx4 v[238:241], v2, s[68:71], s42 offen sc1
    v_exp_f32 v52, v52
    v_exp_f32 v53, v53
    v_mfma_f32_32x32x8_bf16 v[62:77], v[28:29], v[254:255], v[62:77]
    v_add_u32 v3, 61440, v3
    ds_read_b64 v[28:29], v3 offset:0
    v_cvt_pk_bf16_f32 v38, v46, v47
    v_cvt_pk_bf16_f32 v39, v48, v49
    v_cvt_pk_bf16_f32 v40, v50, v51
    v_cvt_pk_bf16_f32 v41, v52, v53
    v_exp_f32_e64 v54, v54
    v_exp_f32 v55, v55
    s_waitcnt lgkmcnt(3)
    v_mfma_f32_32x32x16_bf16 v[78:93], v[30:33], v[38:41], v[78:93]
    v_exp_f32 v56, v56
    v_exp_f32 v57, v57
    v_exp_f32_e64 v58, v58
    v_exp_f32 v59, v59
    s_waitcnt vmcnt(14)
    v_mfma_f32_32x32x16_bf16 v[158:173], v[242:245], v[198:201], v[158:173]
    s_add_u32 s42, s73, 1639424
    buffer_load_dwordx4 v[242:245], v2, s[68:71], s42 offen sc1
    v_exp_f32_e64 v60, v60
    v_exp_f32 v61, v61
    s_waitcnt vmcnt(14) lgkmcnt(1)
    v_cvt_pk_bf16_f32 v42, v54, v55
    v_cvt_pk_bf16_f32 v43, v56, v57
    v_cvt_pk_bf16_f32 v44, v58, v59
    v_cvt_pk_bf16_f32 v45, v60, v61
    v_mfma_f32_32x32x16_bf16 v[174:189], v[246:249], v[198:201], v[174:189]
    s_add_u32 s42, s73, 1640448
    buffer_load_dwordx4 v[246:249], v2, s[68:71], s42 offen sc1
    s_add_u32 s42, s72, 81920
    buffer_load_dwordx4 v[198:201], v2, s[64:67], s42 offen sc1
    v_mfma_f32_32x32x16_bf16 v[46:61], v[24:27], v[12:15], 0
    v_exp_f32 v62, v62
    v_exp_f32 v63, v63
    v_exp_f32 v64, v64
    v_exp_f32 v65, v65
    v_mfma_f32_32x32x16_bf16 v[78:93], v[34:37], v[42:45], v[78:93]
    v_exp_f32 v66, v66
    v_exp_f32 v67, v67
    v_exp_f32_e64 v68, v68
    v_exp_f32 v69, v69
    s_waitcnt lgkmcnt(0)
    v_mfma_f32_32x32x8_bf16 v[46:61], v[28:29], v[20:21], v[46:61]
    v_cvt_pk_bf16_f32 v38, v62, v63
    v_cvt_pk_bf16_f32 v39, v64, v65
    v_cvt_pk_bf16_f32 v40, v66, v67
    v_cvt_pk_bf16_f32 v41, v68, v69
    v_exp_f32 v70, v70
    v_exp_f32 v71, v71
    v_mfma_f32_32x32x16_bf16 v[94:109], v[30:33], v[38:41], v[94:109]
    v_add_u32 v4, 61440, v4
    s_andn2_b64 exec, s[62:63], 0x70000000
    ds_read_b128 v[30:33], v4 offset:0
    s_mov_b64 exec, -1
    v_exp_f32 v72, v72
    v_exp_f32 v73, v73
    v_exp_f32 v74, v74
    v_exp_f32 v75, v75
    s_waitcnt vmcnt(12)
    v_mfma_f32_32x32x16_bf16 v[110:125], v[250:253], v[190:193], v[110:125]
    s_add_u32 s42, s73, 1641472
    buffer_load_dwordx4 v[250:253], v2, s[68:71], s42 offen sc1
    v_exp_f32_e64 v76, v76
    v_exp_f32 v77, v77
    s_waitcnt vmcnt(13)
    v_cvt_pk_bf16_f32 v42, v70, v71
    v_cvt_pk_bf16_f32 v43, v72, v73
    v_cvt_pk_bf16_f32 v44, v74, v75
    v_cvt_pk_bf16_f32 v45, v76, v77
    v_mfma_f32_32x32x16_bf16 v[126:141], v[202:205], v[190:193], v[126:141]
    s_add_u32 s42, s73, 1642496
    buffer_load_dwordx4 v[202:205], v2, s[68:71], s42 offen sc1
    v_mfma_f32_32x32x16_bf16 v[62:77], v[24:27], v[16:19], 0
    v_exp_f32 v46, v46
    v_exp_f32 v47, v47
    v_exp_f32 v48, v48
    v_exp_f32 v49, v49
    v_mfma_f32_32x32x16_bf16 v[94:109], v[34:37], v[42:45], v[94:109]
    s_andn2_b64 exec, s[62:63], 0x70000000
    ds_read_b128 v[34:37], v4 offset:640
    s_or_b64 exec, -1, 0x70000000
    ds_read_b128 v[24:27], v5 offset:2560
    v_exp_f32_e64 v50, v50
    v_exp_f32 v51, v51
    s_waitcnt vmcnt(14)
    v_mfma_f32_32x32x16_bf16 v[142:157], v[206:209], v[190:193], v[142:157]
    s_add_u32 s42, s73, 1720320
    buffer_load_dwordx4 v[206:209], v2, s[68:71], s42 offen sc1
    v_exp_f32 v52, v52
    v_exp_f32 v53, v53
    v_mfma_f32_32x32x8_bf16 v[62:77], v[28:29], v[22:23], v[62:77]
    v_cvt_pk_bf16_f32 v38, v46, v47
    v_cvt_pk_bf16_f32 v39, v48, v49
    v_cvt_pk_bf16_f32 v40, v50, v51
    v_cvt_pk_bf16_f32 v41, v52, v53
    v_exp_f32_e64 v54, v54
    v_exp_f32 v55, v55
    s_waitcnt lgkmcnt(2)
    v_mfma_f32_32x32x16_bf16 v[78:93], v[30:33], v[38:41], v[78:93]
    v_exp_f32 v56, v56
    v_exp_f32 v57, v57
    v_exp_f32_e64 v58, v58
    v_exp_f32 v59, v59
    s_waitcnt vmcnt(14)
    v_mfma_f32_32x32x16_bf16 v[158:173], v[210:213], v[190:193], v[158:173]
    s_add_u32 s42, s73, 1721344
    buffer_load_dwordx4 v[210:213], v2, s[68:71], s42 offen sc1
    v_exp_f32_e64 v60, v60
    v_exp_f32 v61, v61
    s_waitcnt vmcnt(14) lgkmcnt(0)
    v_cvt_pk_bf16_f32 v42, v54, v55
    v_cvt_pk_bf16_f32 v43, v56, v57
    v_cvt_pk_bf16_f32 v44, v58, v59
    v_cvt_pk_bf16_f32 v45, v60, v61
    v_mfma_f32_32x32x16_bf16 v[174:189], v[214:217], v[190:193], v[174:189]
    s_add_u32 s42, s73, 1722368
    buffer_load_dwordx4 v[214:217], v2, s[68:71], s42 offen sc1
    s_add_u32 s42, s72, 86016
    buffer_load_dwordx4 v[190:193], v2, s[64:67], s42 offen sc1
    v_mfma_f32_32x32x16_bf16 v[46:61], v[24:27], v[12:15], 0
    v_exp_f32 v62, v62
    v_exp_f32 v63, v63
    v_exp_f32 v64, v64
    v_exp_f32 v65, v65
    v_mfma_f32_32x32x16_bf16 v[78:93], v[34:37], v[42:45], v[78:93]
    v_exp_f32_e64 v66, v66
    v_exp_f32 v67, v67
    s_waitcnt vmcnt(12)
    v_mfma_f32_32x32x16_bf16 v[110:125], v[218:221], v[194:197], v[110:125]
    s_add_u32 s42, s73, 1723392
    buffer_load_dwordx4 v[218:221], v2, s[68:71], s42 offen sc1
    v_exp_f32 v68, v68
    v_exp_f32 v69, v69
    v_mfma_f32_32x32x8_bf16 v[46:61], v[28:29], v[6:7], v[46:61]
    v_cvt_pk_bf16_f32 v38, v62, v63
    v_cvt_pk_bf16_f32 v39, v64, v65
    v_cvt_pk_bf16_f32 v40, v66, v67
    v_cvt_pk_bf16_f32 v41, v68, v69
    v_exp_f32 v70, v70
    v_exp_f32 v71, v71
    v_mfma_f32_32x32x16_bf16 v[94:109], v[30:33], v[38:41], v[94:109]
    s_andn2_b64 exec, s[62:63], 0x70000000
    ds_read_b128 v[30:33], v4 offset:2560
    s_mov_b64 exec, -1
    v_exp_f32 v72, v72
    v_exp_f32 v73, v73
    v_exp_f32 v74, v74
    v_exp_f32 v75, v75
    s_waitcnt vmcnt(13)
    v_mfma_f32_32x32x16_bf16 v[126:141], v[222:225], v[194:197], v[126:141]
    s_add_u32 s42, s73, 1724416
    buffer_load_dwordx4 v[222:225], v2, s[68:71], s42 offen sc1
    v_exp_f32_e64 v76, v76
    v_exp_f32 v77, v77
    s_waitcnt vmcnt(14)
    v_cvt_pk_bf16_f32 v42, v70, v71
    v_cvt_pk_bf16_f32 v43, v72, v73
    v_cvt_pk_bf16_f32 v44, v74, v75
    v_cvt_pk_bf16_f32 v45, v76, v77
    v_mfma_f32_32x32x16_bf16 v[142:157], v[226:229], v[194:197], v[142:157]
    s_add_u32 s42, s73, 1802240
    buffer_load_dwordx4 v[226:229], v2, s[68:71], s42 offen sc1
    v_mfma_f32_32x32x16_bf16 v[62:77], v[24:27], v[16:19], 0
    v_exp_f32 v46, v46
    v_exp_f32 v47, v47
    v_exp_f32 v48, v48
    v_exp_f32 v49, v49
    v_mfma_f32_32x32x16_bf16 v[94:109], v[34:37], v[42:45], v[94:109]
    s_andn2_b64 exec, s[62:63], 0x70000000
    ds_read_b128 v[34:37], v4 offset:3200
    s_or_b64 exec, -1, 0x70000000
    ds_read_b128 v[24:27], v5 offset:10240
    v_exp_f32_e64 v50, v50
    v_exp_f32 v51, v51
    s_waitcnt vmcnt(14)
    v_mfma_f32_32x32x16_bf16 v[158:173], v[230:233], v[194:197], v[158:173]
    s_add_u32 s42, s73, 1803264
    buffer_load_dwordx4 v[230:233], v2, s[68:71], s42 offen sc1
    v_exp_f32 v52, v52
    v_exp_f32 v53, v53
    v_mfma_f32_32x32x8_bf16 v[62:77], v[28:29], v[254:255], v[62:77]
    ds_read_b64 v[28:29], v3 offset:10240
    v_cvt_pk_bf16_f32 v38, v46, v47
    v_cvt_pk_bf16_f32 v39, v48, v49
    v_cvt_pk_bf16_f32 v40, v50, v51
    v_cvt_pk_bf16_f32 v41, v52, v53
    v_exp_f32_e64 v54, v54
    v_exp_f32 v55, v55
    s_waitcnt lgkmcnt(3)
    v_mfma_f32_32x32x16_bf16 v[78:93], v[30:33], v[38:41], v[78:93]
    v_exp_f32 v56, v56
    v_exp_f32 v57, v57
    v_exp_f32_e64 v58, v58
    v_exp_f32 v59, v59
    s_waitcnt vmcnt(14)
    v_mfma_f32_32x32x16_bf16 v[174:189], v[234:237], v[194:197], v[174:189]
    s_add_u32 s42, s73, 1804288
    buffer_load_dwordx4 v[234:237], v2, s[68:71], s42 offen sc1
    s_add_u32 s42, s72, 90112
    buffer_load_dwordx4 v[194:197], v2, s[64:67], s42 offen sc1
    v_exp_f32_e64 v60, v60
    v_exp_f32 v61, v61
    s_waitcnt vmcnt(12) lgkmcnt(1)
    v_cvt_pk_bf16_f32 v42, v54, v55
    v_cvt_pk_bf16_f32 v43, v56, v57
    v_cvt_pk_bf16_f32 v44, v58, v59
    v_cvt_pk_bf16_f32 v45, v60, v61
    v_mfma_f32_32x32x16_bf16 v[110:125], v[238:241], v[198:201], v[110:125]
    s_add_u32 s42, s73, 1805312
    buffer_load_dwordx4 v[238:241], v2, s[68:71], s42 offen sc1
    v_mfma_f32_32x32x16_bf16 v[46:61], v[24:27], v[12:15], 0
    v_exp_f32 v62, v62
    v_exp_f32 v63, v63
    v_exp_f32 v64, v64
    v_exp_f32 v65, v65
    v_mfma_f32_32x32x16_bf16 v[78:93], v[34:37], v[42:45], v[78:93]
    v_exp_f32_e64 v66, v66
    v_exp_f32 v67, v67
    s_waitcnt vmcnt(13)
    v_mfma_f32_32x32x16_bf16 v[126:141], v[242:245], v[198:201], v[126:141]
    s_add_u32 s42, s73, 1806336
    buffer_load_dwordx4 v[242:245], v2, s[68:71], s42 offen sc1
    v_exp_f32_e64 v68, v68
    v_exp_f32 v69, v69
    s_waitcnt lgkmcnt(0)
    v_mfma_f32_32x32x8_bf16 v[46:61], v[28:29], v[20:21], v[46:61]
    v_cvt_pk_bf16_f32 v38, v62, v63
    v_cvt_pk_bf16_f32 v39, v64, v65
    v_cvt_pk_bf16_f32 v40, v66, v67
    v_cvt_pk_bf16_f32 v41, v68, v69
    v_exp_f32 v70, v70
    v_exp_f32 v71, v71
    v_mfma_f32_32x32x16_bf16 v[94:109], v[30:33], v[38:41], v[94:109]
    s_andn2_b64 exec, s[62:63], 0x70000000
    ds_read_b128 v[30:33], v4 offset:10240
    s_mov_b64 exec, -1
    v_exp_f32 v72, v72
    v_exp_f32 v73, v73
    v_exp_f32 v74, v74
    v_exp_f32 v75, v75
    s_waitcnt vmcnt(14)
    v_mfma_f32_32x32x16_bf16 v[142:157], v[246:249], v[198:201], v[142:157]
    s_add_u32 s42, s73, 1884160
    buffer_load_dwordx4 v[246:249], v2, s[68:71], s42 offen sc1
    v_exp_f32_e64 v76, v76
    v_exp_f32 v77, v77
    s_waitcnt vmcnt(14)
    v_cvt_pk_bf16_f32 v42, v70, v71
    v_cvt_pk_bf16_f32 v43, v72, v73
    v_cvt_pk_bf16_f32 v44, v74, v75
    v_cvt_pk_bf16_f32 v45, v76, v77
    v_mfma_f32_32x32x16_bf16 v[158:173], v[250:253], v[198:201], v[158:173]
    s_add_u32 s42, s73, 1885184
    buffer_load_dwordx4 v[250:253], v2, s[68:71], s42 offen sc1
    v_mfma_f32_32x32x16_bf16 v[62:77], v[24:27], v[16:19], 0
    v_exp_f32 v46, v46
    v_exp_f32 v47, v47
    v_exp_f32 v48, v48
    v_exp_f32 v49, v49
    v_mfma_f32_32x32x16_bf16 v[94:109], v[34:37], v[42:45], v[94:109]
    s_andn2_b64 exec, s[62:63], 0x70000000
    ds_read_b128 v[34:37], v4 offset:10880
    s_or_b64 exec, -1, 0x70000000
    ds_read_b128 v[24:27], v5 offset:12800
    v_exp_f32_e64 v50, v50
    v_exp_f32 v51, v51
    s_waitcnt vmcnt(14)
    v_mfma_f32_32x32x16_bf16 v[174:189], v[202:205], v[198:201], v[174:189]
    s_add_u32 s42, s73, 1886208
    buffer_load_dwordx4 v[202:205], v2, s[68:71], s42 offen sc1
    s_add_u32 s42, s72, 94208
    buffer_load_dwordx4 v[198:201], v2, s[64:67], s42 offen sc1
    v_exp_f32 v52, v52
    v_exp_f32 v53, v53
    v_mfma_f32_32x32x8_bf16 v[62:77], v[28:29], v[22:23], v[62:77]
    v_cvt_pk_bf16_f32 v38, v46, v47
    v_cvt_pk_bf16_f32 v39, v48, v49
    v_cvt_pk_bf16_f32 v40, v50, v51
    v_cvt_pk_bf16_f32 v41, v52, v53
    v_exp_f32_e64 v54, v54
    v_exp_f32 v55, v55
    s_waitcnt lgkmcnt(2)
    v_mfma_f32_32x32x16_bf16 v[78:93], v[30:33], v[38:41], v[78:93]
    v_exp_f32 v56, v56
    v_exp_f32 v57, v57
    v_exp_f32_e64 v58, v58
    v_exp_f32 v59, v59
    s_waitcnt vmcnt(12)
    v_mfma_f32_32x32x16_bf16 v[110:125], v[206:209], v[190:193], v[110:125]
    s_add_u32 s42, s73, 1887232
    buffer_load_dwordx4 v[206:209], v2, s[68:71], s42 offen sc1
    v_exp_f32_e64 v60, v60
    v_exp_f32 v61, v61
    s_waitcnt vmcnt(13) lgkmcnt(0)
    v_cvt_pk_bf16_f32 v42, v54, v55
    v_cvt_pk_bf16_f32 v43, v56, v57
    v_cvt_pk_bf16_f32 v44, v58, v59
    v_cvt_pk_bf16_f32 v45, v60, v61
    v_mfma_f32_32x32x16_bf16 v[126:141], v[210:213], v[190:193], v[126:141]
    s_add_u32 s42, s73, 1888256
    buffer_load_dwordx4 v[210:213], v2, s[68:71], s42 offen sc1
    v_mfma_f32_32x32x16_bf16 v[46:61], v[24:27], v[12:15], 0
    v_exp_f32 v62, v62
    v_exp_f32 v63, v63
    v_exp_f32 v64, v64
    v_exp_f32 v65, v65
    v_mfma_f32_32x32x16_bf16 v[78:93], v[34:37], v[42:45], v[78:93]
    v_exp_f32_e64 v66, v66
    v_exp_f32 v67, v67
    s_waitcnt vmcnt(14)
    v_mfma_f32_32x32x16_bf16 v[142:157], v[214:217], v[190:193], v[142:157]
    s_add_u32 s42, s73, 1966080
    buffer_load_dwordx4 v[214:217], v2, s[68:71], s42 offen sc1
    v_exp_f32 v68, v68
    v_exp_f32 v69, v69
    v_mfma_f32_32x32x8_bf16 v[46:61], v[28:29], v[6:7], v[46:61]
    v_cvt_pk_bf16_f32 v38, v62, v63
    v_cvt_pk_bf16_f32 v39, v64, v65
    v_cvt_pk_bf16_f32 v40, v66, v67
    v_cvt_pk_bf16_f32 v41, v68, v69
    v_exp_f32 v70, v70
    v_exp_f32 v71, v71
    v_mfma_f32_32x32x16_bf16 v[94:109], v[30:33], v[38:41], v[94:109]
    s_andn2_b64 exec, s[62:63], 0x70000000
    ds_read_b128 v[30:33], v4 offset:12800
    s_mov_b64 exec, -1
    v_exp_f32 v72, v72
    v_exp_f32 v73, v73
    v_exp_f32 v74, v74
    v_exp_f32 v75, v75
    s_waitcnt vmcnt(14)
    v_mfma_f32_32x32x16_bf16 v[158:173], v[218:221], v[190:193], v[158:173]
    s_add_u32 s42, s73, 1967104
    buffer_load_dwordx4 v[218:221], v2, s[68:71], s42 offen sc1
    v_exp_f32_e64 v76, v76
    v_exp_f32 v77, v77
    s_waitcnt vmcnt(14)
    v_cvt_pk_bf16_f32 v42, v70, v71
    v_cvt_pk_bf16_f32 v43, v72, v73
    v_cvt_pk_bf16_f32 v44, v74, v75
    v_cvt_pk_bf16_f32 v45, v76, v77
    v_mfma_f32_32x32x16_bf16 v[174:189], v[222:225], v[190:193], v[174:189]
    s_add_u32 s42, s73, 1968128
    buffer_load_dwordx4 v[222:225], v2, s[68:71], s42 offen sc1
    s_add_u32 s42, s72, 98304
    buffer_load_dwordx4 v[190:193], v2, s[64:67], s42 offen sc1
    v_mfma_f32_32x32x16_bf16 v[62:77], v[24:27], v[16:19], 0
    v_exp_f32 v46, v46
    v_exp_f32 v47, v47
    v_exp_f32 v48, v48
    v_exp_f32 v49, v49
    v_mfma_f32_32x32x16_bf16 v[94:109], v[34:37], v[42:45], v[94:109]
    s_andn2_b64 exec, s[62:63], 0x70000000
    ds_read_b128 v[34:37], v4 offset:13440
    s_or_b64 exec, -1, 0x70000000
    ds_read_b128 v[24:27], v5 offset:20480
    v_exp_f32_e64 v50, v50
    v_exp_f32 v51, v51
    s_waitcnt vmcnt(12)
    v_mfma_f32_32x32x16_bf16 v[110:125], v[226:229], v[194:197], v[110:125]
    s_add_u32 s42, s73, 1969152
    buffer_load_dwordx4 v[226:229], v2, s[68:71], s42 offen sc1
    v_exp_f32 v52, v52
    v_exp_f32 v53, v53
    v_mfma_f32_32x32x8_bf16 v[62:77], v[28:29], v[254:255], v[62:77]
    ds_read_b64 v[28:29], v3 offset:20480
    v_cvt_pk_bf16_f32 v38, v46, v47
    v_cvt_pk_bf16_f32 v39, v48, v49
    v_cvt_pk_bf16_f32 v40, v50, v51
    v_cvt_pk_bf16_f32 v41, v52, v53
    v_exp_f32_e64 v54, v54
    v_exp_f32 v55, v55
    s_waitcnt lgkmcnt(3)
    v_mfma_f32_32x32x16_bf16 v[78:93], v[30:33], v[38:41], v[78:93]
    v_exp_f32 v56, v56
    v_exp_f32 v57, v57
    v_exp_f32_e64 v58, v58
    v_exp_f32 v59, v59
    s_waitcnt vmcnt(13)
    v_mfma_f32_32x32x16_bf16 v[126:141], v[230:233], v[194:197], v[126:141]
    s_add_u32 s42, s73, 1970176
    buffer_load_dwordx4 v[230:233], v2, s[68:71], s42 offen sc1
    v_exp_f32_e64 v60, v60
    v_exp_f32 v61, v61
    s_waitcnt vmcnt(14) lgkmcnt(1)
    v_cvt_pk_bf16_f32 v42, v54, v55
    v_cvt_pk_bf16_f32 v43, v56, v57
    v_cvt_pk_bf16_f32 v44, v58, v59
    v_cvt_pk_bf16_f32 v45, v60, v61
    v_mfma_f32_32x32x16_bf16 v[142:157], v[234:237], v[194:197], v[142:157]
    s_add_u32 s42, s73, 2048000
    buffer_load_dwordx4 v[234:237], v2, s[68:71], s42 offen sc1
    v_mfma_f32_32x32x16_bf16 v[46:61], v[24:27], v[12:15], 0
    v_exp_f32 v62, v62
    v_exp_f32 v63, v63
    v_exp_f32 v64, v64
    v_exp_f32 v65, v65
    v_mfma_f32_32x32x16_bf16 v[78:93], v[34:37], v[42:45], v[78:93]
    s_setprio 2
    v_exp_f32 v66, v66
    v_exp_f32 v67, v67
    v_exp_f32 v68, v68
    v_exp_f32 v69, v69
    s_waitcnt lgkmcnt(0)
    v_mfma_f32_32x32x8_bf16 v[46:61], v[28:29], v[20:21], v[46:61]
    v_cvt_pk_bf16_f32 v38, v62, v63
    v_cvt_pk_bf16_f32 v39, v64, v65
    v_cvt_pk_bf16_f32 v40, v66, v67
    v_cvt_pk_bf16_f32 v41, v68, v69
    v_exp_f32 v70, v70
    v_exp_f32 v71, v71
    v_mfma_f32_32x32x16_bf16 v[94:109], v[30:33], v[38:41], v[94:109]
    s_andn2_b64 exec, s[62:63], 0x70000000
    ds_read_b128 v[30:33], v4 offset:20480
    s_mov_b64 exec, -1
    v_exp_f32 v72, v72
    v_exp_f32 v73, v73
    v_exp_f32 v74, v74
    v_exp_f32 v75, v75
    s_waitcnt vmcnt(14)
    v_mfma_f32_32x32x16_bf16 v[158:173], v[238:241], v[194:197], v[158:173]
    s_add_u32 s42, s73, 2049024
    buffer_load_dwordx4 v[238:241], v2, s[68:71], s42 offen sc1
    v_exp_f32_e64 v76, v76
    v_exp_f32 v77, v77
    s_waitcnt vmcnt(14)
    v_cvt_pk_bf16_f32 v42, v70, v71
    v_cvt_pk_bf16_f32 v43, v72, v73
    v_cvt_pk_bf16_f32 v44, v74, v75
    v_cvt_pk_bf16_f32 v45, v76, v77
    v_mfma_f32_32x32x16_bf16 v[174:189], v[242:245], v[194:197], v[174:189]
    s_add_u32 s42, s73, 2050048
    buffer_load_dwordx4 v[242:245], v2, s[68:71], s42 offen sc1
    s_add_u32 s42, s72, 102400
    buffer_load_dwordx4 v[194:197], v2, s[64:67], s42 offen sc1
    v_mfma_f32_32x32x16_bf16 v[62:77], v[24:27], v[16:19], 0
    v_exp_f32 v46, v46
    v_exp_f32 v47, v47
    v_exp_f32 v48, v48
    v_exp_f32 v49, v49
    v_mfma_f32_32x32x16_bf16 v[94:109], v[34:37], v[42:45], v[94:109]
    s_andn2_b64 exec, s[62:63], 0x70000000
    ds_read_b128 v[34:37], v4 offset:21120
    s_or_b64 exec, -1, 0x70000000
    ds_read_b128 v[24:27], v5 offset:23040
    v_exp_f32_e64 v50, v50
    v_exp_f32 v51, v51
    s_waitcnt vmcnt(12)
    v_mfma_f32_32x32x16_bf16 v[110:125], v[246:249], v[198:201], v[110:125]
    s_add_u32 s42, s73, 2051072
    buffer_load_dwordx4 v[246:249], v2, s[68:71], s42 offen sc1
    v_exp_f32 v52, v52
    v_exp_f32 v53, v53
    v_mfma_f32_32x32x8_bf16 v[62:77], v[28:29], v[22:23], v[62:77]
    v_cvt_pk_bf16_f32 v38, v46, v47
    v_cvt_pk_bf16_f32 v39, v48, v49
    v_cvt_pk_bf16_f32 v40, v50, v51
    v_cvt_pk_bf16_f32 v41, v52, v53
    v_exp_f32_e64 v54, v54
    v_exp_f32 v55, v55
    s_waitcnt lgkmcnt(2)
    v_mfma_f32_32x32x16_bf16 v[78:93], v[30:33], v[38:41], v[78:93]
    v_exp_f32 v56, v56
    v_exp_f32 v57, v57
    v_exp_f32_e64 v58, v58
    v_exp_f32 v59, v59
    s_waitcnt vmcnt(13)
    v_mfma_f32_32x32x16_bf16 v[126:141], v[250:253], v[198:201], v[126:141]
    s_add_u32 s42, s73, 2052096
    buffer_load_dwordx4 v[250:253], v2, s[68:71], s42 offen sc1
    v_exp_f32_e64 v60, v60
    v_exp_f32 v61, v61
    s_waitcnt vmcnt(14) lgkmcnt(0)
    v_cvt_pk_bf16_f32 v42, v54, v55
    v_cvt_pk_bf16_f32 v43, v56, v57
    v_cvt_pk_bf16_f32 v44, v58, v59
    v_cvt_pk_bf16_f32 v45, v60, v61
    v_mfma_f32_32x32x16_bf16 v[142:157], v[202:205], v[198:201], v[142:157]
    s_add_u32 s42, s73, 2129920
    buffer_load_dwordx4 v[202:205], v2, s[68:71], s42 offen sc1
    v_mfma_f32_32x32x16_bf16 v[46:61], v[24:27], v[12:15], 0
    v_exp_f32 v62, v62
    v_exp_f32 v63, v63
    v_exp_f32 v64, v64
    v_exp_f32 v65, v65
    v_mfma_f32_32x32x16_bf16 v[78:93], v[34:37], v[42:45], v[78:93]
    v_exp_f32_e64 v66, v66
    v_exp_f32 v67, v67
    s_waitcnt vmcnt(14)
    v_mfma_f32_32x32x16_bf16 v[158:173], v[206:209], v[198:201], v[158:173]
    s_add_u32 s42, s73, 2130944
    buffer_load_dwordx4 v[206:209], v2, s[68:71], s42 offen sc1
    v_exp_f32 v68, v68
    v_exp_f32 v69, v69
    v_mfma_f32_32x32x8_bf16 v[46:61], v[28:29], v[6:7], v[46:61]
    v_cvt_pk_bf16_f32 v38, v62, v63
    v_cvt_pk_bf16_f32 v39, v64, v65
    v_cvt_pk_bf16_f32 v40, v66, v67
    v_cvt_pk_bf16_f32 v41, v68, v69
    v_exp_f32 v70, v70
    v_exp_f32 v71, v71
    v_mfma_f32_32x32x16_bf16 v[94:109], v[30:33], v[38:41], v[94:109]
    s_andn2_b64 exec, s[62:63], 0x70000000
    ds_read_b128 v[30:33], v4 offset:23040
    s_mov_b64 exec, -1
    v_exp_f32 v72, v72
    v_exp_f32 v73, v73
    v_exp_f32 v74, v74
    v_exp_f32 v75, v75
    s_waitcnt vmcnt(14)
    v_mfma_f32_32x32x16_bf16 v[174:189], v[210:213], v[198:201], v[174:189]
    s_add_u32 s42, s73, 2131968
    buffer_load_dwordx4 v[210:213], v2, s[68:71], s42 offen sc1
    s_add_u32 s42, s72, 106496
    buffer_load_dwordx4 v[198:201], v2, s[64:67], s42 offen sc1
    v_exp_f32_e64 v76, v76
    v_exp_f32 v77, v77
    s_waitcnt vmcnt(12)
    v_cvt_pk_bf16_f32 v42, v70, v71
    v_cvt_pk_bf16_f32 v43, v72, v73
    v_cvt_pk_bf16_f32 v44, v74, v75
    v_cvt_pk_bf16_f32 v45, v76, v77
    v_mfma_f32_32x32x16_bf16 v[110:125], v[214:217], v[190:193], v[110:125]
    s_add_u32 s42, s73, 2132992
    buffer_load_dwordx4 v[214:217], v2, s[68:71], s42 offen sc1
    v_mfma_f32_32x32x16_bf16 v[62:77], v[24:27], v[16:19], 0
    v_exp_f32 v46, v46
    v_exp_f32 v47, v47
    v_exp_f32 v48, v48
    v_exp_f32 v49, v49
    v_mfma_f32_32x32x16_bf16 v[94:109], v[34:37], v[42:45], v[94:109]
    s_andn2_b64 exec, s[62:63], 0x70000000
    ds_read_b128 v[34:37], v4 offset:23680
    s_or_b64 exec, -1, 0x70000000
    ds_read_b128 v[24:27], v5 offset:30720
    v_exp_f32_e64 v50, v50
    v_exp_f32 v51, v51
    s_waitcnt vmcnt(13)
    v_mfma_f32_32x32x16_bf16 v[126:141], v[218:221], v[190:193], v[126:141]
    s_add_u32 s42, s73, 2134016
    buffer_load_dwordx4 v[218:221], v2, s[68:71], s42 offen sc1
    v_exp_f32 v52, v52
    v_exp_f32 v53, v53
    v_mfma_f32_32x32x8_bf16 v[62:77], v[28:29], v[254:255], v[62:77]
    ds_read_b64 v[28:29], v3 offset:30720
    v_cvt_pk_bf16_f32 v38, v46, v47
    v_cvt_pk_bf16_f32 v39, v48, v49
    v_cvt_pk_bf16_f32 v40, v50, v51
    v_cvt_pk_bf16_f32 v41, v52, v53
    v_exp_f32_e64 v54, v54
    v_exp_f32 v55, v55
    s_waitcnt lgkmcnt(3)
    v_mfma_f32_32x32x16_bf16 v[78:93], v[30:33], v[38:41], v[78:93]
    v_exp_f32 v56, v56
    v_exp_f32 v57, v57
    v_exp_f32_e64 v58, v58
    v_exp_f32 v59, v59
    s_waitcnt vmcnt(14)
    v_mfma_f32_32x32x16_bf16 v[142:157], v[222:225], v[190:193], v[142:157]
    s_add_u32 s42, s75, 0
    buffer_load_dwordx4 v[222:225], v2, s[68:71], s42 offen sc1
    v_exp_f32 v60, v60
    v_exp_f32 v61, v61
    s_waitcnt vmcnt(14) lgkmcnt(1)
    v_cvt_pk_bf16_f32 v42, v54, v55
    v_cvt_pk_bf16_f32 v43, v56, v57
    v_cvt_pk_bf16_f32 v44, v58, v59
    v_cvt_pk_bf16_f32 v45, v60, v61
    v_mfma_f32_32x32x16_bf16 v[158:173], v[226:229], v[190:193], v[158:173]
    s_add_u32 s42, s75, 20480
    buffer_load_dwordx4 v[226:229], v2, s[68:71], s42 offen sc1
    v_mfma_f32_32x32x16_bf16 v[46:61], v[24:27], v[12:15], 0
    v_exp_f32 v62, v62
    v_exp_f32 v63, v63
    v_exp_f32 v64, v64
    v_exp_f32 v65, v65
    v_mfma_f32_32x32x16_bf16 v[78:93], v[34:37], v[42:45], v[78:93]
    v_exp_f32_e64 v66, v66
    v_exp_f32 v67, v67
    s_waitcnt vmcnt(14)
    v_mfma_f32_32x32x16_bf16 v[174:189], v[230:233], v[190:193], v[174:189]
    s_add_u32 s42, s75, 40960
    buffer_load_dwordx4 v[230:233], v2, s[68:71], s42 offen sc1
    s_add_u32 s42, s75, 61440
    buffer_load_dwordx4 v[190:193], v2, s[68:71], s42 offen sc1
    v_exp_f32_e64 v68, v68
    v_exp_f32 v69, v69
    s_waitcnt lgkmcnt(0)
    v_mfma_f32_32x32x8_bf16 v[46:61], v[28:29], v[20:21], v[46:61]
    v_cvt_pk_bf16_f32 v38, v62, v63
    v_cvt_pk_bf16_f32 v39, v64, v65
    v_cvt_pk_bf16_f32 v40, v66, v67
    v_cvt_pk_bf16_f32 v41, v68, v69
    v_exp_f32 v70, v70
    v_exp_f32 v71, v71
    v_mfma_f32_32x32x16_bf16 v[94:109], v[30:33], v[38:41], v[94:109]
    s_andn2_b64 exec, s[62:63], 0x70000000
    ds_read_b128 v[30:33], v4 offset:30720
    s_mov_b64 exec, -1
    v_exp_f32 v72, v72
    v_exp_f32 v73, v73
    v_exp_f32 v74, v74
    v_exp_f32 v75, v75
    s_waitcnt vmcnt(12)
    v_mfma_f32_32x32x16_bf16 v[110:125], v[234:237], v[194:197], v[110:125]
    s_add_u32 s42, s75, 163840
    buffer_load_dwordx4 v[234:237], v2, s[68:71], s42 offen sc1
    v_exp_f32_e64 v76, v76
    v_exp_f32 v77, v77
    s_waitcnt vmcnt(13)
    v_cvt_pk_bf16_f32 v42, v70, v71
    v_cvt_pk_bf16_f32 v43, v72, v73
    v_cvt_pk_bf16_f32 v44, v74, v75
    v_cvt_pk_bf16_f32 v45, v76, v77
    v_mfma_f32_32x32x16_bf16 v[126:141], v[238:241], v[194:197], v[126:141]
    s_add_u32 s42, s75, 81920
    buffer_load_dwordx4 v[238:241], v2, s[68:71], s42 offen sc1
    v_mfma_f32_32x32x16_bf16 v[62:77], v[24:27], v[16:19], 0
    v_exp_f32 v46, v46
    v_exp_f32 v47, v47
    v_exp_f32 v48, v48
    v_exp_f32 v49, v49
    v_mfma_f32_32x32x16_bf16 v[94:109], v[34:37], v[42:45], v[94:109]
    s_setprio 1
    s_mov_b64 exec, s[62:63]
    ds_read_b128 v[34:37], v4 offset:31360
    s_or_b64 exec, -1, 0x70000000
    ds_read_b128 v[24:27], v5 offset:33280
    v_exp_f32_e64 v50, v50
    v_exp_f32 v51, v51
    s_waitcnt vmcnt(14)
    v_mfma_f32_32x32x16_bf16 v[142:157], v[242:245], v[194:197], v[142:157]
    s_add_u32 s42, s75, 102400
    buffer_load_dwordx4 v[242:245], v2, s[68:71], s42 offen sc1
    v_exp_f32 v52, v52
    v_exp_f32 v53, v53
    v_mfma_f32_32x32x8_bf16 v[62:77], v[28:29], v[22:23], v[62:77]
    v_cvt_pk_bf16_f32 v38, v46, v47
    v_cvt_pk_bf16_f32 v39, v48, v49
    v_cvt_pk_bf16_f32 v40, v50, v51
    v_cvt_pk_bf16_f32 v41, v52, v53
    v_exp_f32_e64 v54, v54
    v_exp_f32 v55, v55
    s_waitcnt lgkmcnt(2)
    v_mfma_f32_32x32x16_bf16 v[78:93], v[30:33], v[38:41], v[78:93]
    v_exp_f32 v56, v56
    v_exp_f32 v57, v57
    v_exp_f32_e64 v58, v58
    v_exp_f32 v59, v59
    s_waitcnt vmcnt(14)
    v_mfma_f32_32x32x16_bf16 v[158:173], v[246:249], v[194:197], v[158:173]
    s_add_u32 s42, s75, 122880
    buffer_load_dwordx4 v[246:249], v2, s[68:71], s42 offen sc1
    v_exp_f32_e64 v60, v60
    v_exp_f32 v61, v61
    s_waitcnt vmcnt(14) lgkmcnt(0)
    v_cvt_pk_bf16_f32 v42, v54, v55
    v_cvt_pk_bf16_f32 v43, v56, v57
    v_cvt_pk_bf16_f32 v44, v58, v59
    v_cvt_pk_bf16_f32 v45, v60, v61
    v_mfma_f32_32x32x16_bf16 v[174:189], v[250:253], v[194:197], v[174:189]
    s_add_u32 s42, s75, 143360
    buffer_load_dwordx4 v[250:253], v2, s[68:71], s42 offen sc1
    s_add_u32 s42, s75, 184320
    buffer_load_dwordx4 v[194:197], v2, s[68:71], s42 offen sc1
    v_mfma_f32_32x32x16_bf16 v[46:61], v[24:27], v[12:15], 0
    v_exp_f32 v62, v62
    v_exp_f32 v63, v63
    v_exp_f32 v64, v64
    v_exp_f32 v65, v65
    v_mfma_f32_32x32x16_bf16 v[78:93], v[34:37], v[42:45], v[78:93]
    v_exp_f32_e64 v66, v66
    v_exp_f32 v67, v67
    s_waitcnt vmcnt(12)
    v_mfma_f32_32x32x16_bf16 v[110:125], v[202:205], v[198:201], v[110:125]
    v_exp_f32 v68, v68
    v_exp_f32 v69, v69
    v_mfma_f32_32x32x8_bf16 v[46:61], v[28:29], v[6:7], v[46:61]
    v_cvt_pk_bf16_f32 v38, v62, v63
    v_cvt_pk_bf16_f32 v39, v64, v65
    v_cvt_pk_bf16_f32 v40, v66, v67
    v_cvt_pk_bf16_f32 v41, v68, v69
    v_exp_f32 v70, v70
    v_exp_f32 v71, v71
    v_mfma_f32_32x32x16_bf16 v[94:109], v[30:33], v[38:41], v[94:109]
    s_andn2_b64 exec, s[62:63], 0x70000000
    ds_read_b128 v[30:33], v4 offset:33280
    s_mov_b64 exec, -1
    v_exp_f32 v72, v72
    v_exp_f32 v73, v73
    v_exp_f32 v74, v74
    v_exp_f32 v75, v75
    s_waitcnt vmcnt(12)
    v_mfma_f32_32x32x16_bf16 v[126:141], v[206:209], v[198:201], v[126:141]
    v_exp_f32_e64 v76, v76
    v_exp_f32 v77, v77
    s_waitcnt vmcnt(12)
    v_cvt_pk_bf16_f32 v42, v70, v71
    v_cvt_pk_bf16_f32 v43, v72, v73
    v_cvt_pk_bf16_f32 v44, v74, v75
    v_cvt_pk_bf16_f32 v45, v76, v77
    v_mfma_f32_32x32x16_bf16 v[142:157], v[210:213], v[198:201], v[142:157]
    v_mfma_f32_32x32x16_bf16 v[62:77], v[24:27], v[16:19], 0
    v_exp_f32 v46, v46
    v_exp_f32 v47, v47
    v_exp_f32 v48, v48
    v_exp_f32 v49, v49
    v_mfma_f32_32x32x16_bf16 v[94:109], v[34:37], v[42:45], v[94:109]
    s_andn2_b64 exec, s[62:63], 0x70000000
    ds_read_b128 v[34:37], v4 offset:33920
    s_mov_b64 exec, -1
    v_exp_f32 v50, v50
    v_exp_f32 v51, v51
    v_exp_f32 v52, v52
    v_exp_f32_e64 v53, v53
    v_mfma_f32_32x32x8_bf16 v[62:77], v[28:29], v[254:255], v[62:77]
    v_cvt_pk_bf16_f32 v38, v46, v47
    v_cvt_pk_bf16_f32 v39, v48, v49
    v_cvt_pk_bf16_f32 v40, v50, v51
    v_cvt_pk_bf16_f32 v41, v52, v53
    v_exp_f32_e64 v54, v54
    v_exp_f32 v55, v55
    s_waitcnt lgkmcnt(1)
    v_mfma_f32_32x32x16_bf16 v[78:93], v[30:33], v[38:41], v[78:93]
    v_exp_f32 v56, v56
    v_exp_f32 v57, v57
    v_exp_f32_e64 v58, v58
    v_exp_f32 v59, v59
    s_waitcnt vmcnt(11)
    v_mfma_f32_32x32x16_bf16 v[158:173], v[214:217], v[198:201], v[158:173]
    v_exp_f32_e64 v60, v60
    v_exp_f32 v61, v61
    s_waitcnt vmcnt(10)
    v_cvt_pk_bf16_f32 v42, v54, v55
    v_cvt_pk_bf16_f32 v43, v56, v57
    v_cvt_pk_bf16_f32 v44, v58, v59
    v_cvt_pk_bf16_f32 v45, v60, v61
    v_mfma_f32_32x32x16_bf16 v[174:189], v[218:221], v[198:201], v[174:189]
    s_waitcnt lgkmcnt(0)
    v_exp_f32 v62, v62
    v_exp_f32 v63, v63
    v_exp_f32 v64, v64
    v_exp_f32_e64 v65, v65
    v_mfma_f32_32x32x16_bf16 v[78:93], v[34:37], v[42:45], v[78:93]
    s_setprio 0
    v_exp_f32 v66, v66
    v_exp_f32 v67, v67
    v_exp_f32 v68, v68
    v_exp_f32_e64 v69, v69
    v_cvt_pk_bf16_f32 v38, v62, v63
    v_cvt_pk_bf16_f32 v39, v64, v65
    v_cvt_pk_bf16_f32 v40, v66, v67
    v_cvt_pk_bf16_f32 v41, v68, v69
    v_exp_f32 v70, v70
    v_exp_f32 v71, v71
    v_mfma_f32_32x32x16_bf16 v[94:109], v[30:33], v[38:41], v[94:109]
    v_exp_f32 v72, v72
    v_exp_f32 v73, v73
    v_exp_f32 v74, v74
    v_exp_f32 v75, v75
    v_exp_f32 v76, v76
    v_exp_f32 v77, v77
    v_cvt_pk_bf16_f32 v42, v70, v71
    v_cvt_pk_bf16_f32 v43, v72, v73
    v_cvt_pk_bf16_f32 v44, v74, v75
    v_cvt_pk_bf16_f32 v45, v76, v77
    s_nop 1
    v_mfma_f32_32x32x16_bf16 v[94:109], v[34:37], v[42:45], v[94:109]
    s_lshl_b32 s43, s74, 2
    s_add_u32 s43, s43, 73728
    v_mov_b32 v3, s43
    v_mov_b32 v255, 0
    v_lshlrev_b32_e64 v7, 7, v1
    v_add_u32 v7, 8192, v7
    s_mov_b64 exec, 1
    ds_write2_b32 v3, v255, v255 offset1:4
    s_mov_b64 exec, 0xffff
    buffer_load_dword v254, v7, s[12:15], s88 offen sc1
    s_mov_b64 exec, -1
    s_nop 6
    ds_write_b128 v10, v[94:97] offset:0
    ds_write_b128 v10, v[98:101] offset:1024
    ds_write_b128 v10, v[102:105] offset:2048
    ds_write_b32 v10, v106 offset:3072
    v_cmp_gt_u32 vcc, 32, v1
    s_mov_b32 s42, 0x5f800000
    s_mov_b32 s43, 0x1f800000
    s_waitcnt lgkmcnt(0)
    s_barrier
    ds_read_b32 v255, v3 offset:32
    ds_read_b128 v[24:27], v10 offset:16384
    ds_read_b128 v[28:31], v10 offset:17408
    ds_read_b128 v[32:35], v10 offset:18432
    ds_read_b32 v36, v10 offset:19456
    s_waitcnt lgkmcnt(3)
    v_add_f32 v78, v78, v24
    v_add_f32 v79, v79, v25
    v_add_f32 v80, v80, v26
    v_add_f32 v81, v81, v27
    v_mul_f32 v37, 0, v78
    v_fmac_f32 v37, 0, v79
    v_fmac_f32 v37, 0, v80
    v_fmac_f32 v37, 0, v81
    s_waitcnt lgkmcnt(2)
    v_add_f32 v82, v82, v28
    v_add_f32 v83, v83, v29
    v_add_f32 v84, v84, v30
    v_add_f32 v85, v85, v31
    v_mul_f32 v38, 0, v82
    v_fmac_f32 v38, 0, v83
    v_fmac_f32 v38, 0, v84
    v_fmac_f32 v38, 0, v85
    s_waitcnt lgkmcnt(1)
    v_add_f32 v86, v86, v32
    v_add_f32 v87, v87, v33
    v_add_f32 v88, v88, v34
    v_add_f32 v89, v89, v35
    v_mul_f32 v39, 0, v86
    v_fmac_f32 v39, 0, v87
    v_fmac_f32 v39, 0, v88
    v_fmac_f32 v39, 0, v89
    s_waitcnt lgkmcnt(0)
    v_add_f32 v90, v90, v36
    v_cndmask_b32 v8, v86, v90, vcc
    v_add_f32 v37, v37, v38
    v_add_f32 v8, v8, v39
    v_add_f32_e64 v8, v8, v37
    v_cmp_nlt_f32 vcc, v8, s42
    v_cmp_ngt_f32 s[58:59], v8, s43
    v_rcp_f32_e64 v8, v8
    s_or_b64 vcc, vcc, s[58:59]
    s_cbranch_vccnz k2_fb_0
k2_norm_0:
    v_mul_f32 v8, v8, v9
    s_nop 0
    v_pk_mul_f32 v[78:79], v[78:79], v[8:9] op_sel_hi:[1,0]
    v_pk_mul_f32 v[80:81], v[80:81], v[8:9] op_sel_hi:[1,0]
    v_pk_mul_f32 v[82:83], v[82:83], v[8:9] op_sel_hi:[1,0]
    v_pk_mul_f32 v[84:85], v[84:85], v[8:9] op_sel_hi:[1,0]
    v_pk_mul_f32 v[86:87], v[86:87], v[8:9] op_sel_hi:[1,0]
    v_pk_mul_f32 v[88:89], v[88:89], v[8:9] op_sel_hi:[1,0]
    v_cvt_pk_bf16_f32 v78, v78, v79
    v_cvt_pk_bf16_f32 v79, v80, v81
    v_cvt_pk_bf16_f32 v80, v82, v83
    v_cvt_pk_bf16_f32 v81, v84, v85
    v_cvt_pk_bf16_f32 v82, v86, v87
    v_cvt_pk_bf16_f32 v83, v88, v89
    v_min_u32 v78, -2, v78
    v_min_u32 v79, -2, v79
    v_min_u32 v80, -2, v80
    v_min_u32 v81, -2, v81
    v_min_u32 v82, -2, v82
    v_min_u32 v83, -2, v83
    buffer_store_dwordx4 v[78:81], v2, s[12:15], s89 offen sc1
    s_mov_b32 exec_hi, 0
    buffer_store_dwordx2 v[82:83], v11, s[12:15], s90 offen sc1
    s_mov_b32 exec_hi, -1
    s_barrier
    v_readfirstlane_b32 s93, v255
    s_waitcnt vmcnt(2)
    v_cmp_eq_u32 vcc, -1, v254
    s_bitcmp1_b32 s93, 0
    s_cbranch_scc1 k2_f00
    s_and_b32 s42, vcc_lo, 255
    s_cbranch_scc1 k2_f00
    s_add_u32 m0, s94, 0
    s_add_u32 s42, s88, 0
    buffer_load_dwordx4 v2, s[12:15], s42 offen offset:0 sc1 lds
    buffer_load_dwordx4 v2, s[12:15], s42 offen offset:1024 sc1 lds
    buffer_load_dwordx4 v2, s[12:15], s42 offen offset:2048 sc1 lds
    buffer_load_dwordx4 v2, s[12:15], s42 offen offset:3072 sc1 lds
    s_add_u32 m0, s94, 8192
    s_add_u32 s42, s88, 8192
    buffer_load_dwordx4 v2, s[12:15], s42 offen sc1 lds
    s_bitset1_b32 s93, 0
k2_f00:
    s_bitcmp1_b32 s93, 1
    s_cbranch_scc1 k2_f01
    s_and_b32 s42, vcc_lo, 65280
    s_cbranch_scc1 k2_f01
    s_add_u32 m0, s94, 4096
    s_add_u32 s42, s88, 4096
    buffer_load_dwordx4 v2, s[12:15], s42 offen offset:0 sc1 lds
    buffer_load_dwordx4 v2, s[12:15], s42 offen offset:1024 sc1 lds
    buffer_load_dwordx4 v2, s[12:15], s42 offen offset:2048 sc1 lds
    buffer_load_dwordx4 v2, s[12:15], s42 offen offset:3072 sc1 lds
    s_add_u32 m0, s94, 9216
    s_add_u32 s42, s88, 9216
    buffer_load_dwordx4 v2, s[12:15], s42 offen sc1 lds
    s_bitset1_b32 s93, 1
k2_f01:
    s_mov_b64 exec, 0xffff
    buffer_load_dword v254, v7, s[12:15], s88 offen sc1
    s_mov_b64 exec, -1
    s_lshl_b32 s42, s74, 12
    s_add_u32 s42, s42, 40960
    v_add_u32_e64 v4, s42, v2
    v_add_u32 v5, 73728, v4
    v_mov_b32_e64 v8, 1
    v_pk_mul_f32 v[110:111], v[110:111], v[0:1] op_sel_hi:[1,0]
    v_pk_mul_f32 v[112:113], v[112:113], v[0:1] op_sel_hi:[1,0]
    v_pk_mul_f32 v[114:115], v[114:115], v[0:1] op_sel_hi:[1,0]
    v_pk_mul_f32 v[116:117], v[116:117], v[0:1] op_sel_hi:[1,0]
    v_pk_mul_f32 v[118:119], v[118:119], v[0:1] op_sel_hi:[1,0]
    v_pk_mul_f32 v[120:121], v[120:121], v[0:1] op_sel_hi:[1,0]
    v_pk_mul_f32 v[122:123], v[122:123], v[0:1] op_sel_hi:[1,0]
    v_pk_mul_f32 v[124:125], v[124:125], v[0:1] op_sel_hi:[1,0]
    ds_write_b128 v4, v[110:113] offset:0
    ds_write_b128 v4, v[114:117] offset:1024
    ds_write_b128 v4, v[118:121] offset:2048
    ds_write_b128 v4, v[122:125] offset:3072
    v_pk_mul_f32 v[126:127], v[126:127], v[0:1] op_sel_hi:[1,0]
    v_pk_mul_f32 v[128:129], v[128:129], v[0:1] op_sel_hi:[1,0]
    v_pk_mul_f32 v[130:131], v[130:131], v[0:1] op_sel_hi:[1,0]
    v_pk_mul_f32 v[132:133], v[132:133], v[0:1] op_sel_hi:[1,0]
    v_pk_mul_f32 v[134:135], v[134:135], v[0:1] op_sel_hi:[1,0]
    v_pk_mul_f32 v[136:137], v[136:137], v[0:1] op_sel_hi:[1,0]
    v_pk_mul_f32 v[138:139], v[138:139], v[0:1] op_sel_hi:[1,0]
    v_pk_mul_f32 v[140:141], v[140:141], v[0:1] op_sel_hi:[1,0]
    ds_write_b128 v4, v[126:129] offset:16384
    ds_write_b128 v4, v[130:133] offset:17408
    ds_write_b128 v4, v[134:137] offset:18432
    ds_write_b128 v4, v[138:141] offset:19456
    v_pk_mul_f32 v[142:143], v[142:143], v[0:1] op_sel_hi:[1,0]
    v_pk_mul_f32 v[144:145], v[144:145], v[0:1] op_sel_hi:[1,0]
    v_pk_mul_f32 v[146:147], v[146:147], v[0:1] op_sel_hi:[1,0]
    v_pk_mul_f32 v[148:149], v[148:149], v[0:1] op_sel_hi:[1,0]
    v_pk_mul_f32 v[150:151], v[150:151], v[0:1] op_sel_hi:[1,0]
    v_pk_mul_f32 v[152:153], v[152:153], v[0:1] op_sel_hi:[1,0]
    v_pk_mul_f32 v[154:155], v[154:155], v[0:1] op_sel_hi:[1,0]
    v_pk_mul_f32 v[156:157], v[156:157], v[0:1] op_sel_hi:[1,0]
    ds_write_b128 v5, v[142:145] offset:0
    ds_write_b128 v5, v[146:149] offset:1024
    ds_write_b128 v5, v[150:153] offset:2048
    ds_write_b128 v5, v[154:157] offset:3072
    v_pk_mul_f32 v[158:159], v[158:159], v[0:1] op_sel_hi:[1,0]
    v_pk_mul_f32 v[160:161], v[160:161], v[0:1] op_sel_hi:[1,0]
    v_pk_mul_f32 v[162:163], v[162:163], v[0:1] op_sel_hi:[1,0]
    v_pk_mul_f32 v[164:165], v[164:165], v[0:1] op_sel_hi:[1,0]
    v_pk_mul_f32 v[166:167], v[166:167], v[0:1] op_sel_hi:[1,0]
    v_pk_mul_f32 v[168:169], v[168:169], v[0:1] op_sel_hi:[1,0]
    v_pk_mul_f32 v[170:171], v[170:171], v[0:1] op_sel_hi:[1,0]
    v_pk_mul_f32 v[172:173], v[172:173], v[0:1] op_sel_hi:[1,0]
    ds_write_b128 v5, v[158:161] offset:16384
    ds_write_b128 v5, v[162:165] offset:17408
    ds_write_b128 v5, v[166:169] offset:18432
    ds_write_b128 v5, v[170:173] offset:19456
    s_mov_b64 exec, 1
    ds_write_b32 v3, v8
    s_mov_b64 exec, -1
    v_pk_mul_f32 v[174:175], v[174:175], v[0:1] op_sel_hi:[1,0]
    v_pk_mul_f32 v[176:177], v[176:177], v[0:1] op_sel_hi:[1,0]
    v_pk_mul_f32 v[178:179], v[178:179], v[0:1] op_sel_hi:[1,0]
    v_pk_mul_f32 v[180:181], v[180:181], v[0:1] op_sel_hi:[1,0]
    v_pk_mul_f32 v[182:183], v[182:183], v[0:1] op_sel_hi:[1,0]
    v_pk_mul_f32 v[184:185], v[184:185], v[0:1] op_sel_hi:[1,0]
    v_pk_mul_f32 v[186:187], v[186:187], v[0:1] op_sel_hi:[1,0]
    v_pk_mul_f32 v[188:189], v[188:189], v[0:1] op_sel_hi:[1,0]
    v_add_u32 v6, s94, v2
    v_add_u32 v11, s94, v11
    v_and_b32 v36, 31, v1
    v_lshrrev_b32 v37, 5, v1
    v_xor_b32 v37, v37, v1
    v_and_b32 v37, 7, v37
    v_lshlrev_b32_e64 v37, 4, v37
    v_lshl_add_u32 v36, v36, 7, v37
    s_add_u32 s42, s42, 106496
    v_add_u32 v32, s42, v36
    v_xor_b32 v33, 32, v32
    v_xor_b32_e64 v34, 64, v32
    v_xor_b32 v35, 96, v32
    v_lshrrev_b32 v37, 3, v1
    v_xor_b32 v36, v37, v1
    v_and_b32 v36, 7, v36
    v_lshlrev_b32 v36, 4, v36
    v_lshl_add_u32 v36, v37, 7, v36
    s_lshl_b32 s42, s74, 10
    s_add_u32 s42, s42, 147456
    v_add_u32 v36, s42, v36
    v_mul_u32_u24 v37, 1280, v37
    v_and_b32_e64 v38, 7, v1
    v_lshl_add_u32 v37, v38, 3, v37
    v_mov_b32 v38, 73744
k2_fl:
    s_waitcnt vmcnt(0)
    v_cmp_eq_u32 vcc, -1, v254
    s_andn2_b32 s43, s92, s93
    s_mov_b32 s95, 0
    s_bitcmp1_b32 s93, 0
    s_cbranch_scc0 k2_fa0
    ds_read_b128 v[12:15], v6 offset:0
    ds_read_b128 v[16:19], v6 offset:1024
    ds_read_b128 v[20:23], v6 offset:2048
    ds_read_b128 v[24:27], v6 offset:3072
    ds_read2st64_b64 v[28:31], v11 offset0:16 offset1:17
k2_fa0:
    s_bitcmp1_b32 s93, 1
    s_cbranch_scc0 k2_fa1
    ds_read_b128 v[46:49], v6 offset:4096
    ds_read_b128 v[50:53], v6 offset:5120
    ds_read_b128 v[54:57], v6 offset:6144
    ds_read_b128 v[58:61], v6 offset:7168
    ds_read2st64_b64 v[62:65], v11 offset0:18 offset1:19
k2_fa1:
    s_bitcmp1_b32 s43, 0
    s_cbranch_scc0 k2_fb0
    s_and_b32 s42, vcc_lo, 255
    s_cbranch_scc1 k2_fb0
    s_add_u32 m0, s94, 0
    s_add_u32 s42, s88, 0
    buffer_load_dwordx4 v2, s[12:15], s42 offen offset:0 sc1 lds
    buffer_load_dwordx4 v2, s[12:15], s42 offen offset:1024 sc1 lds
    buffer_load_dwordx4 v2, s[12:15], s42 offen offset:2048 sc1 lds
    buffer_load_dwordx4 v2, s[12:15], s42 offen offset:3072 sc1 lds
    s_add_u32 m0, s94, 8192
    s_add_u32 s42, s88, 8192
    buffer_load_dwordx4 v2, s[12:15], s42 offen sc1 lds
    s_bitset1_b32 s95, 0
k2_fb0:
    s_bitcmp1_b32 s43, 1
    s_cbranch_scc0 k2_fb1
    s_and_b32 s42, vcc_lo, 65280
    s_cbranch_scc1 k2_fb1
    s_add_u32 m0, s94, 4096
    s_add_u32 s42, s88, 4096
    buffer_load_dwordx4 v2, s[12:15], s42 offen offset:0 sc1 lds
    buffer_load_dwordx4 v2, s[12:15], s42 offen offset:1024 sc1 lds
    buffer_load_dwordx4 v2, s[12:15], s42 offen offset:2048 sc1 lds
    buffer_load_dwordx4 v2, s[12:15], s42 offen offset:3072 sc1 lds
    s_add_u32 m0, s94, 9216
    s_add_u32 s42, s88, 9216
    buffer_load_dwordx4 v2, s[12:15], s42 offen sc1 lds
    s_bitset1_b32 s95, 1
k2_fb1:
    s_waitcnt lgkmcnt(0)
    s_bitcmp1_b32 s93, 0
    s_cbranch_scc0 k2_fc0
    v_max3_u32 v40, v12, v13, v14
    v_max3_u32 v41, v22, v23, v24
    v_max3_u32 v40, v40, v15, v16
    v_max3_u32 v41, v41, v25, v26
    v_max3_u32 v40, v40, v17, v18
    v_max3_u32 v41, v41, v27, v28
    v_max3_u32 v40, v40, v19, v20
    v_max3_u32 v41, v41, v29, v30
    v_max3_u32 v40, v40, v21, v31
    v_max_u32 v40, v40, v41
    v_cmp_eq_u32 s[58:59], -1, v40
    s_cmp_lg_u64 s[58:59], 0
    s_cbranch_scc1 k2_fr0
    v_mfma_f32_32x32x16_bf16 v[174:189], v[222:225], v[12:15], v[174:189]
    v_mfma_f32_32x32x16_bf16 v[174:189], v[226:229], v[16:19], v[174:189]
    v_mfma_f32_32x32x16_bf16 v[174:189], v[230:233], v[20:23], v[174:189]
    v_mfma_f32_32x32x16_bf16 v[174:189], v[190:193], v[24:27], v[174:189]
    v_mfma_f32_32x32x16_bf16 v[174:189], v[234:237], v[28:31], v[174:189]
    s_bitset0_b32 s92, 0
k2_fc0:
    s_bitcmp1_b32 s93, 1
    s_cbranch_scc0 k2_fc1
    v_max3_u32 v40, v46, v47, v48
    v_max3_u32 v41, v56, v57, v58
    v_max3_u32 v40, v40, v49, v50
    v_max3_u32 v41, v41, v59, v60
    v_max3_u32 v40, v40, v51, v52
    v_max3_u32 v41, v41, v61, v62
    v_max3_u32 v40, v40, v53, v54
    v_max3_u32 v41, v41, v63, v64
    v_max3_u32 v40, v40, v55, v65
    v_max_u32 v40, v40, v41
    v_cmp_eq_u32 s[58:59], -1, v40
    s_cmp_lg_u64 s[58:59], 0
    s_cbranch_scc1 k2_fr1
    v_mfma_f32_32x32x16_bf16 v[94:109], v[238:241], v[46:49], 0
    v_mfma_f32_32x32x16_bf16 v[94:109], v[242:245], v[50:53], v[94:109]
    v_mfma_f32_32x32x16_bf16 v[94:109], v[246:249], v[54:57], v[94:109]
    v_mfma_f32_32x32x16_bf16 v[94:109], v[250:253], v[58:61], v[94:109]
    v_mfma_f32_32x32x16_bf16 v[94:109], v[194:197], v[62:65], v[94:109]
    s_bitset0_b32 s92, 1
k2_fc1:
    s_cmp_lg_u32 s92, 0
    s_cbranch_scc1 k2_fw
k2_fd:
    s_nop 13
    v_pk_add_f32 v[174:175], v[174:175], v[94:95]
    v_pk_add_f32 v[176:177], v[176:177], v[96:97]
    ds_write_b128 v32, v[174:177]
    v_pk_add_f32 v[178:179], v[178:179], v[98:99]
    v_pk_add_f32 v[180:181], v[180:181], v[100:101]
    ds_write_b128 v33, v[178:181]
    v_pk_add_f32 v[182:183], v[182:183], v[102:103]
    v_pk_add_f32 v[184:185], v[184:185], v[104:105]
    ds_write_b128 v34, v[182:185]
    v_pk_add_f32 v[186:187], v[186:187], v[106:107]
    v_pk_add_f32 v[188:189], v[188:189], v[108:109]
    ds_write_b128 v35, v[186:189]
    s_mov_b64 exec, 1
    ds_write_b32 v3, v8 offset:16
    s_mov_b64 exec, -1
k2_fs:
    ds_read_b128 v[12:15], v38
    ds_read_b128 v[16:19], v36 offset:0
    ds_read_b128 v[20:23], v36 offset:4096
    ds_read_b128 v[24:27], v36 offset:8192
    ds_read_b128 v[28:31], v36 offset:12288
    s_waitcnt lgkmcnt(4)
    v_and_b32 v12, v12, v13
    v_and_b32 v14, v14, v15
    v_and_b32 v12, v12, v14
    v_cmp_ne_u32_e64 vcc, 1, v12
    s_cbranch_vccnz k2_ft
k2_fu:
    s_waitcnt lgkmcnt(0)
    v_pk_add_f32 v[16:17], v[16:17], v[20:21]
    v_pk_add_f32 v[18:19], v[18:19], v[22:23]
    v_pk_add_f32 v[24:25], v[24:25], v[28:29]
    v_pk_add_f32 v[26:27], v[26:27], v[30:31]
    v_pk_add_f32 v[16:17], v[16:17], v[24:25]
    v_pk_add_f32 v[18:19], v[18:19], v[26:27]
    v_cvt_pk_bf16_f32 v20, v16, v17
    v_cvt_pk_bf16_f32 v21, v18, v19
    buffer_store_dwordx2 v[20:21], v37, s[8:11], s91 offen offset:256
    s_endpgm
k2_fr0:
    s_and_b32 s42, vcc_lo, 255
    s_cbranch_scc1 k2_fc0
    s_add_u32 m0, s94, 0
    s_add_u32 s42, s88, 0
    buffer_load_dwordx4 v2, s[12:15], s42 offen offset:0 sc1 lds
    buffer_load_dwordx4 v2, s[12:15], s42 offen offset:1024 sc1 lds
    buffer_load_dwordx4 v2, s[12:15], s42 offen offset:2048 sc1 lds
    buffer_load_dwordx4 v2, s[12:15], s42 offen offset:3072 sc1 lds
    s_add_u32 m0, s94, 8192
    s_add_u32 s42, s88, 8192
    buffer_load_dwordx4 v2, s[12:15], s42 offen sc1 lds
    s_bitset1_b32 s95, 0
    s_branch k2_fc0
k2_fr1:
    s_and_b32 s42, vcc_lo, 65280
    s_cbranch_scc1 k2_fc1
    s_add_u32 m0, s94, 4096
    s_add_u32 s42, s88, 4096
    buffer_load_dwordx4 v2, s[12:15], s42 offen offset:0 sc1 lds
    buffer_load_dwordx4 v2, s[12:15], s42 offen offset:1024 sc1 lds
    buffer_load_dwordx4 v2, s[12:15], s42 offen offset:2048 sc1 lds
    buffer_load_dwordx4 v2, s[12:15], s42 offen offset:3072 sc1 lds
    s_add_u32 m0, s94, 9216
    s_add_u32 s42, s88, 9216
    buffer_load_dwordx4 v2, s[12:15], s42 offen sc1 lds
    s_bitset1_b32 s95, 1
    s_branch k2_fc1
k2_fw:
    s_mov_b32 s93, s95
    s_mov_b64 exec, 0xffff
    buffer_load_dword v254, v7, s[12:15], s88 offen sc1
    s_mov_b64 exec, -1
    s_branch k2_fl
k2_ft:
    s_sleep 1
    s_branch k2_fs
k2_fb_0:
    s_waitcnt vmcnt(0)
    v_mov_b32 v102, 0xff800000
    v_and_b32 v5, 31, v1
    v_cmp_eq_u32_e64 vcc, 20, v5
    v_cmp_eq_u32 s[58:59], 24, v5
    v_lshlrev_b32_e64 v5, 3, v5
    v_subrev_u32 v4, 122880, v4
    s_or_b64 vcc, vcc, s[58:59]
    v_mov_b32 v8, 0x3f803f80
    s_nop 1
    v_cndmask_b32 v8, 0, v8, vcc
    v_mov_b32 v30, v8
    v_mov_b32 v31, v8
    v_mov_b32 v32, v8
    v_mov_b32 v33, v8
    v_mov_b32 v34, v8
    v_mov_b32 v35, v8
    v_mov_b32 v36, v8
    v_mov_b32 v37, v8
    v_mov_b32 v78, 0
    v_mov_b32 v79, 0
    v_mov_b32 v80, 0
    v_mov_b32 v81, 0
    v_mov_b32 v82, 0
    v_mov_b32 v83, 0
    v_mov_b32 v84, 0
    v_mov_b32 v85, 0
    v_mov_b32 v86, 0
    v_mov_b32 v87, 0
    v_mov_b32 v88, 0
    v_mov_b32 v89, 0
    v_mov_b32 v90, 0
    v_mov_b32 v91, 0
    v_mov_b32 v92, 0
    v_mov_b32_e64 v93, 0
    s_mul_i32 s42, s37, 163840
    s_mov_b32 s43, 64
k2_slow_0:
    buffer_load_dwordx4 v[24:27], v2, s[4:7], s42 offen sc1
    buffer_load_dwordx2 v[28:29], v5, s[4:7], s42 offen offset:1024 sc1
    s_mov_b64 exec, s[62:63]
    buffer_load_dwordx4 v[30:33], v4, s[4:7], s42 offen sc1
    buffer_load_dwordx4 v[34:37], v4, s[4:7], s42 offen offset:640 sc1
    s_mov_b64 exec, -1
    s_waitcnt vmcnt(0)
    v_mfma_f32_32x32x16_bf16 v[46:61], v[24:27], v[12:15], 0
    v_mfma_f32_32x32x8_bf16 v[46:61], v[28:29], v[20:21], v[46:61]
    s_nop 15
    s_nop 3
    v_max3_f32 v8, v46, v47, v48
    v_max3_f32 v8, v8, v49, v50
    v_max3_f32 v8, v8, v51, v52
    v_max3_f32 v8, v8, v53, v54
    v_max3_f32 v8, v8, v55, v56
    v_max3_f32 v8, v8, v57, v58
    v_max3_f32 v8, v8, v59, v60
    v_max_f32_e64 v8, v8, v61
    v_mov_b32 v103, v8
    s_nop 1
    v_permlane32_swap_b32 v8, v103
    s_nop 1
    v_max3_f32 v8, v8, v103, v102
    v_sub_f32 v103, v102, v8
    v_exp_f32 v103, v103
    v_mov_b32 v102, v8
    v_sub_f32 v46, v46, v8
    v_exp_f32 v46, v46
    v_sub_f32 v47, v47, v8
    v_exp_f32 v47, v47
    v_sub_f32 v48, v48, v8
    v_exp_f32 v48, v48
    v_sub_f32 v49, v49, v8
    v_exp_f32 v49, v49
    v_sub_f32 v50, v50, v8
    v_exp_f32 v50, v50
    v_sub_f32 v51, v51, v8
    v_exp_f32 v51, v51
    v_sub_f32 v52, v52, v8
    v_exp_f32 v52, v52
    v_sub_f32 v53, v53, v8
    v_exp_f32 v53, v53
    v_sub_f32 v54, v54, v8
    v_exp_f32 v54, v54
    v_sub_f32 v55, v55, v8
    v_exp_f32 v55, v55
    v_sub_f32 v56, v56, v8
    v_exp_f32 v56, v56
    v_sub_f32 v57, v57, v8
    v_exp_f32 v57, v57
    v_sub_f32 v58, v58, v8
    v_exp_f32 v58, v58
    v_sub_f32 v59, v59, v8
    v_exp_f32 v59, v59
    v_sub_f32 v60, v60, v8
    v_exp_f32 v60, v60
    v_sub_f32 v61, v61, v8
    v_exp_f32 v61, v61
    v_mul_f32 v78, v78, v103
    v_mul_f32 v79, v79, v103
    v_mul_f32 v80, v80, v103
    v_mul_f32 v81, v81, v103
    v_mul_f32 v82, v82, v103
    v_mul_f32 v83, v83, v103
    v_mul_f32 v84, v84, v103
    v_mul_f32 v85, v85, v103
    v_mul_f32 v86, v86, v103
    v_mul_f32 v87, v87, v103
    v_mul_f32 v88, v88, v103
    v_mul_f32 v89, v89, v103
    v_mul_f32 v90, v90, v103
    v_mul_f32 v91, v91, v103
    v_mul_f32 v92, v92, v103
    v_mul_f32_e64 v93, v93, v103
    v_cvt_pk_bf16_f32 v38, v46, v47
    v_cvt_pk_bf16_f32 v39, v48, v49
    v_cvt_pk_bf16_f32 v40, v50, v51
    v_cvt_pk_bf16_f32 v41, v52, v53
    v_cvt_pk_bf16_f32 v42, v54, v55
    v_cvt_pk_bf16_f32 v43, v56, v57
    v_cvt_pk_bf16_f32 v44, v58, v59
    v_cvt_pk_bf16_f32 v45, v60, v61
    s_nop 3
    v_mfma_f32_32x32x16_bf16 v[78:93], v[30:33], v[38:41], v[78:93]
    v_mfma_f32_32x32x16_bf16 v[78:93], v[34:37], v[42:45], v[78:93]
    s_nop 15
    s_nop 3
    s_add_u32 s42, s42, 2560
    s_sub_u32 s43, s43, 1
    s_cmp_lg_u32 s43, 0
    s_cbranch_scc1 k2_slow_0
    v_cmp_gt_u32 vcc, 32, v1
    s_nop 1
    v_cndmask_b32_e64 v8, v86, v90, vcc
    v_rcp_f32 v8, v8
    s_waitcnt vmcnt(0)
    s_branch k2_norm_0
g_p2r:
    s_sleep 4
    buffer_load_dwordx4 v[110:113], v118, s[48:51], s57 offen sc1
    s_waitcnt vmcnt(0)
    s_branch g_p2
g_car:
    s_sleep 16
    s_cmp_eq_u32 s36, 0
    s_cselect_b64 exec, 15, 0
    buffer_load_dword v114, v119, s[52:55], 0 offen sc1
    s_mov_b64 exec, -1
    s_waitcnt vmcnt(0)
    s_branch g_ca
g_cons:
    s_setprio 3
    s_and_b32 s3, s36, 3
    s_getpc_b64 s[88:89]
g_pc:
    s_sub_u32 s88, s88, g_pc-gated_mix__mha_block__dense_activation_relu__prompt_kernel
    s_subb_u32 s89, s89, 0
    s_mov_b32 s90, g_end-gated_mix__mha_block__dense_activation_relu__prompt_kernel
    s_mov_b32 s91, 0x00020000
    s_lshr_b32 s42, s2, 3
    s_lshl_b32 s43, s3, 5
    s_add_u32 s42, s42, s43
    s_lshl_b32 s42, s42, 11
    v_lshlrev_b32 v140, 5, v1
    v_add_u32 v140, s42, v140
    buffer_load_dword v141, v140, s[88:91], 0 offen
    v_and_b32 v0, 31, v1
    v_lshrrev_b32 v31, 5, v1
    v_bfe_u32 v32, v1, 1, 3
    s_lshl_b32 s42, s3, 12
    v_lshlrev_b32 v33, 7, v0
    v_add_u32 v33, s42, v33
    v_add_u32 v34, 0, v31
    v_xor_b32 v34, v34, v32
    v_lshlrev_b32 v34, 4, v34
    v_add_u32 v174, v33, v34
    v_add_u32 v34, 2, v31
    v_xor_b32 v34, v34, v32
    v_lshlrev_b32 v34, 4, v34
    v_add_u32 v178, v33, v34
    v_add_u32 v34, 4, v31
    v_xor_b32 v34, v34, v32
    v_lshlrev_b32 v34, 4, v34
    v_add_u32 v182, v33, v34
    v_add_u32 v34, 6, v31
    v_xor_b32 v34, v34, v32
    v_lshlrev_b32 v34, 4, v34
    v_add_u32_e64 v186, v33, v34
    v_bfe_u32 v30, v1, 2, 2
    v_and_b32_e64 v32, 3, v1
    v_bfe_u32 v33, v1, 4, 1
    v_lshl_add_u32 v34, v31, 3, v30
    v_lshlrev_b32_e64 v35, 3, v32
    v_lshl_add_u32 v35, v33, 5, v35
    v_lshl_add_u32 v5, v34, 6, v35
    v_add_u32 v5, 81920, v5
    v_lshl_add_u32 v36, v34, 7, v35
    v_lshrrev_b32 v37, 1, v30
    v_xor_b32 v38, 0, v37
    v_lshl_add_u32 v3, v38, 6, v36
    v_xor_b32_e64 v38, 1, v37
    v_lshl_add_u32 v4, v38, 6, v36
    v_lshlrev_b32 v2, 4, v1
    s_mul_i32 s42, s61, 13
    s_lshr_b32 s56, s42, 6
    s_mul_i32 s43, s56, 5
    s_sub_u32 s57, s61, s43
    s_cmp_lt_u32 s61, 15
    s_cselect_b32 s43, s57, 99
    s_cmp_eq_u32 s3, 0
    s_cselect_b32 s43, s43, 99
    v_lshrrev_b32 v30, 1, v1
    v_and_b32 v31, 1, v1
    v_mul_u32_u24 v32, 20, v30
    v_mad_u32_u24 v32, v31, 19, v32
    v_lshrrev_b32 v32, 7, v32
    v_lshlrev_b32 v30, 11, v30
    v_lshl_add_u32 v30, v31, 2, v30
    v_cmp_eq_u32_e64 vcc, s43, v32
    v_mov_b32 v31, 0x7f000000
    s_lshl_b32 s44, s60, 2
    s_add_u32 s92, s44, s3
    v_cndmask_b32 v255, v31, v30, vcc
    s_and_b32 s98, s60, 3
    s_mul_i32 s98, s98, 128
    s_lshl_b32 s42, s56, 2
    s_lshr_b32 s43, s60, 2
    s_add_u32 s42, s42, s43
    s_sub_u32 s42, s42, 4
    s_lshl_b32 s42, s42, 3
    s_add_u32 s98, s98, s42
    s_lshl_b32 s42, s60, 3
    s_add_u32 s42, s42, 512
    s_cmp_eq_u32 s56, 0
    s_cselect_b32 s98, s42, s98
    s_lshl_b32 s99, s92, 7
    s_lshl_b32 s42, s61, 2
    s_add_u32 s99, s99, s42
    s_add_u32 s99, s99, 65536
    v_mov_b32 v50, 0
    s_waitcnt lgkmcnt(0)
    s_lshl_b32 s42, s2, 6
    v_add_u32 v122, s42, v1
    v_lshrrev_b32 v123, 3, v122
    v_lshlrev_b32 v122, 7, v122
    v_lshlrev_b32 v123, 8, v123
    s_cmp_eq_u32 s3, 0
    s_cselect_b64 vcc, -1, 0
    v_cndmask_b32 v123, 0, v123, vcc
    s_mov_b32 s42, 737280
    s_cselect_b32 s42, 384, s42
    s_cselect_b32 s48, s16, s18
    s_cselect_b32 s49, s17, s19
    s_mov_b32 s43, 2457600
    s_cselect_b32 s50, 2621440, s43
    s_and_b32 s43, s3, 1
    s_lshl_b32 s43, s43, 21
    s_cmp_lt_u32 s3, 2
    s_cselect_b32 s42, s42, s43
    s_cselect_b32 s48, s48, s24
    s_cselect_b32 s49, s49, s25
    s_cselect_b32 s50, s50, 2211840
    s_mov_b32 s51, 0x00020000
    v_add3_u32 v122, v122, v123, s42
    s_cbranch_scc0 g_dl
    buffer_load_dword v124, v122, s[48:51], 0 offen
g_dl:
    s_add_u32 s48, s34, 20316160
    s_addc_u32 s49, s35, 0
    s_mov_b32 s50, 73728
    s_mov_b32 s51, 0x00020000
    buffer_store_dword v50, v255, s[48:51], s98 offen sc1
    s_mov_b64 exec, 1
    buffer_store_dword v50, off, s[48:51], s99 sc1
    s_mov_b64 exec, -1
    s_cmp_eq_u32 s56, 2
    s_cbranch_scc1 g_cv
    s_barrier
    ds_read_b128 v[30:33], v174 offset:0
    ds_read_b64_tr_b16 v[6:7], v3 offset:16384
    ds_read_b64_tr_b16 v[8:9], v3 offset:16896
    ds_read_b64_tr_b16 v[10:11], v4 offset:16384
    ds_read_b64_tr_b16 v[12:13], v4 offset:16896
    ds_read_b64_tr_b16 v[14:15], v3 offset:24576
    ds_read_b64_tr_b16 v[16:17], v3 offset:25088
    ds_read_b64_tr_b16 v[18:19], v4 offset:24576
    ds_read_b64_tr_b16 v[20:21], v4 offset:25088
    s_waitcnt lgkmcnt(4)
    v_mfma_f32_32x32x16_bf16 v[222:237], v[6:9], v[30:33], 0
    ds_read_b128 v[34:37], v178 offset:0
    ds_read_b64_tr_b16 v[22:23], v3 offset:18432
    ds_read_b64_tr_b16 v[24:25], v3 offset:18944
    ds_read_b64_tr_b16 v[26:27], v4 offset:18432
    ds_read_b64_tr_b16 v[28:29], v4 offset:18944
    s_lshl_b32 s42, s2, 2
    s_add_u32 s42, s42, s3
    s_cmp_lt_u32 s42, 740
    s_cselect_b32 s89, 0, 0x7f000000
    s_min_u32 s42, s42, 739
    s_mul_i32 s43, s42, 205
    v_mfma_f32_32x32x16_bf16 v[238:253], v[10:13], v[30:33], 0
    s_lshr_b32 s43, s43, 10
    s_mul_i32 s44, s43, 5
    s_sub_u32 s44, s42, s44
    s_mul_i32 s88, s43, 20
    s_lshl_b32 s42, s44, 2
    s_add_u32 s88, s88, s42
    s_waitcnt lgkmcnt(5)
    v_mfma_f32_32x32x16_bf16 v[190:205], v[14:17], v[30:33], 0
    ds_read_b64_tr_b16 v[6:7], v3 offset:26624
    ds_read_b64_tr_b16 v[8:9], v3 offset:27136
    ds_read_b64_tr_b16 v[10:11], v4 offset:26624
    ds_read_b64_tr_b16 v[12:13], v4 offset:27136
    s_lshl_b32 s88, s88, 10
    s_add_u32 s88, s88, s89
    s_sub_u32 s42, s43, 108
    s_mul_i32 s93, s42, 103
    s_lshr_b32 s93, s93, 10
    s_mul_i32 s94, s93, 10
    v_mfma_f32_32x32x16_bf16 v[206:221], v[18:21], v[30:33], 0
    s_sub_u32 s42, s42, s94
    s_mul_i32 s93, s93, 160
    s_mul_i32 s94, s42, 20
    s_mul_i32 s95, s42, 80
    s_sub_u32 s95, s95, 624
    s_cmp_lt_u32 s42, 8
    s_waitcnt lgkmcnt(4)
    v_mfma_f32_32x32x16_bf16 v[222:237], v[22:25], v[34:37], v[222:237]
    ds_read_b128 v[38:41], v182 offset:0
    ds_read_b64_tr_b16 v[14:15], v3 offset:20480
    ds_read_b64_tr_b16 v[16:17], v3 offset:20992
    ds_read_b64_tr_b16 v[18:19], v4 offset:20480
    ds_read_b64_tr_b16 v[20:21], v4 offset:20992
    s_cselect_b32 s94, s94, s95
    s_movk_i32 s90, 25600
    s_cselect_b32 s90, 5120, s90
    s_add_u32 s42, s93, s94
    s_lshl_b32 s93, s43, 4
    s_cmp_lt_u32 s43, 108
    v_mfma_f32_32x32x16_bf16 v[238:253], v[26:29], v[34:37], v[238:253]
    s_cselect_b32 s43, s93, s42
    s_cselect_b32 s90, 5120, s90
    s_cselect_b32 s4, s26, s20
    s_cselect_b32 s5, s27, s21
    s_mov_b32 s42, 819200
    s_cselect_b32 s6, 2211840, s42
    s_waitcnt lgkmcnt(5)
    v_mfma_f32_32x32x16_bf16 v[190:205], v[6:9], v[34:37], v[190:205]
    ds_read_b64_tr_b16 v[22:23], v3 offset:28672
    ds_read_b64_tr_b16 v[24:25], v3 offset:29184
    ds_read_b64_tr_b16 v[26:27], v4 offset:28672
    ds_read_b64_tr_b16 v[28:29], v4 offset:29184
    s_mov_b32 s7, 0x00020000
    s_mul_i32 s43, s43, 1280
    s_lshl_b32 s44, s44, 8
    s_add_u32 s43, s43, s44
    s_mov_b32 s8, s28
    s_mov_b32 s9, s29
    v_mfma_f32_32x32x16_bf16 v[206:221], v[10:13], v[34:37], v[206:221]
    s_mov_b32 s10, 1280
    s_mov_b32 s11, 0x00020000
    s_mov_b32 s64, s16
    s_mov_b32 s65, s17
    s_mov_b32 s66, 2621440
    s_mov_b32 s67, 0x00020000
    s_waitcnt lgkmcnt(4)
    v_mfma_f32_32x32x16_bf16 v[222:237], v[14:17], v[38:41], v[222:237]
    ds_read_b128 v[42:45], v186 offset:0
    ds_read_b64_tr_b16 v[6:7], v3 offset:22528
    ds_read_b64_tr_b16 v[8:9], v3 offset:23040
    ds_read_b64_tr_b16 v[10:11], v4 offset:22528
    ds_read_b64_tr_b16 v[12:13], v4 offset:23040
    s_cmp_lt_u32 s3, 2
    s_cselect_b32 s91, 0, 0x7f000000
    v_and_b32 v145, 15, v1
    v_lshrrev_b32 v143, 4, v1
    v_lshlrev_b32 v142, 4, v145
    v_mul_u32_u24 v146, 1280, v143
    v_mfma_f32_32x32x16_bf16 v[238:253], v[18:21], v[38:41], v[238:253]
    v_add_u32_e64 v146, v142, v146
    v_add_u32 v144, s89, v146
    s_lshl_b32 s42, s60, 4
    s_add_u32 s42, s42, s61
    s_lshl_b32 s42, s42, 1
    s_and_b32 s44, s3, 1
    s_waitcnt lgkmcnt(5)
    v_mfma_f32_32x32x16_bf16 v[190:205], v[22:25], v[38:41], v[190:205]
    ds_read_b64_tr_b16 v[14:15], v3 offset:30720
    ds_read_b64_tr_b16 v[16:17], v3 offset:31232
    ds_read_b64_tr_b16 v[18:19], v4 offset:30720
    ds_read_b64_tr_b16 v[20:21], v4 offset:31232
    s_add_u32 s42, s42, s44
    s_lshl_b32 s95, s42, 4
    s_mul_i32 s93, s42, 5120
    buffer_load_dwordx4 v[158:161], v144, s[4:7], s43 offen
    s_add_u32 s43, s43, s90
    v_mfma_f32_32x32x16_bf16 v[206:221], v[26:29], v[38:41], v[206:221]
    buffer_load_dwordx4 v[162:165], v144, s[4:7], s43 offen
    s_add_u32 s43, s43, s90
    buffer_load_dwordx4 v[166:169], v144, s[4:7], s43 offen
    s_add_u32 s43, s43, s90
    s_waitcnt lgkmcnt(4)
    v_mfma_f32_32x32x16_bf16 v[222:237], v[6:9], v[42:45], v[222:237]
    buffer_load_dwordx4 v[170:173], v144, s[4:7], s43 offen
    s_add_u32 s95, s95, s91
    s_add_u32 s95, s95, 5242880
    v_lshlrev_b32 v136, 2, v143
    v_add_u32_e64 v136, s95, v136
    v_mfma_f32_32x32x16_bf16 v[238:253], v[10:13], v[42:45], v[238:253]
    v_mov_b32 v137, 0x7f000000
    v_cmp_eq_u32 vcc, 0, v145
    v_lshlrev_b32 v134, 5, v143
    v_cndmask_b32 v136, v137, v136, vcc
    v_cmp_gt_u32 vcc, 8, v145
    v_and_b32 v135, 3, v1
    s_barrier
    ds_read_b128 v[46:49], v174 offset:32768
    ds_read_b64_tr_b16 v[22:23], v3 offset:49152
    ds_read_b64_tr_b16 v[24:25], v3 offset:49664
    ds_read_b64_tr_b16 v[26:27], v4 offset:49152
    ds_read_b64_tr_b16 v[28:29], v4 offset:49664
    s_waitcnt lgkmcnt(5)
    v_mfma_f32_32x32x16_bf16 v[190:205], v[14:17], v[42:45], v[190:205]
    ds_read_b64_tr_b16 v[6:7], v3 offset:57344
    ds_read_b64_tr_b16 v[8:9], v3 offset:57856
    ds_read_b64_tr_b16 v[10:11], v4 offset:57344
    ds_read_b64_tr_b16 v[12:13], v4 offset:57856
    v_lshl_add_u32 v134, v135, 7, v134
    v_bfe_u32 v135, v1, 2, 1
    v_lshl_add_u32 v134, v135, 10, v134
    v_lshrrev_b32 v135, 3, v145
    v_lshl_add_u32 v134, v135, 4, v134
    v_add_u32_e64 v134, s88, v134
    v_mfma_f32_32x32x16_bf16 v[206:221], v[18:21], v[42:45], v[206:221]
    v_mov_b32 v135, 0x05040100
    v_mov_b32 v137, 0x07060302
    v_cndmask_b32_e64 v135, v135, v137, vcc
    s_mul_i32 s42, s2, 10240
    s_lshl_b32 s43, s3, 10
    s_add_u32 s42, s42, s43
    s_waitcnt lgkmcnt(4)
    v_mfma_f32_32x32x16_bf16 v[222:237], v[22:25], v[46:49], v[222:237]
    ds_read_b128 v[50:53], v178 offset:32768
    ds_read_b64_tr_b16 v[14:15], v3 offset:51200
    ds_read_b64_tr_b16 v[16:17], v3 offset:51712
    ds_read_b64_tr_b16 v[18:19], v4 offset:51200
    ds_read_b64_tr_b16 v[20:21], v4 offset:51712
    v_lshlrev_b32 v137, 4, v1
    v_add_u32 v137, s42, v137
    v_add_u32 v138, s91, v137
    s_mul_i32 s94, s92, 110592
    s_mul_i32 s43, s61, 6144
    s_cmp_lt_u32 s61, 15
    v_mfma_f32_32x32x16_bf16 v[238:253], v[26:29], v[46:49], v[238:253]
    s_cselect_b32 s43, s43, 94208
    s_add_u32 s94, s94, s43
    s_and_b32 s43, s43, 2048
    s_add_u32 s94, s94, s43
    s_mul_i32 s43, s43, 3
    s_sub_u32 s101, 4096, s43
    s_waitcnt lgkmcnt(5)
    v_mfma_f32_32x32x16_bf16 v[190:205], v[6:9], v[46:49], v[190:205]
    ds_read_b64_tr_b16 v[22:23], v3 offset:59392
    ds_read_b64_tr_b16 v[24:25], v3 offset:59904
    ds_read_b64_tr_b16 v[26:27], v4 offset:59392
    ds_read_b64_tr_b16 v[28:29], v4 offset:59904
    s_mov_b32 s42, 1051011932
    s_cmp_lt_u32 s61, 5
    s_cselect_b32 s96, s42, 1.0
    s_mov_b32 s97, s96
    s_movk_i32 s44, 2560
    s_cselect_b32 s44, 1280, s44
    v_mfma_f32_32x32x16_bf16 v[206:221], v[10:13], v[46:49], v[206:221]
    s_mov_b32 s42, 2621440
    s_cselect_b32 s42, 0, s42
    s_mov_b32 s43, 5242880
    s_cselect_b32 s90, 2621440, s43
    s_add_u32 s88, s34, s42
    s_addc_u32 s89, s35, 0
    s_waitcnt lgkmcnt(4)
    v_mfma_f32_32x32x16_bf16 v[222:237], v[14:17], v[50:53], v[222:237]
    ds_read_b128 v[54:57], v182 offset:32768
    ds_read_b64_tr_b16 v[6:7], v3 offset:53248
    ds_read_b64_tr_b16 v[8:9], v3 offset:53760
    ds_read_b64_tr_b16 v[10:11], v4 offset:53248
    ds_read_b64_tr_b16 v[12:13], v4 offset:53760
    s_mov_b32 s91, 0x00020000
    s_mul_i32 s92, s92, s44
    s_lshl_b32 s93, s44, 6
    s_and_b32 s42, s2, 7
    s_lshl_b32 s42, s42, 2
    s_lshr_b32 s43, s2, 3
    v_mfma_f32_32x32x16_bf16 v[238:253], v[18:21], v[50:53], v[238:253]
    s_and_b32 s43, s43, 3
    s_add_u32 s37, s42, s43
    s_lshr_b32 s42, s2, 5
    s_lshl_b32 s42, s42, 3
    s_and_b32 s74, s36, 3
    s_lshl_b32 s43, s74, 1
    s_waitcnt lgkmcnt(5)
    v_mfma_f32_32x32x16_bf16 v[190:205], v[22:25], v[50:53], v[190:205]
    ds_read_b64_tr_b16 v[14:15], v3 offset:61440
    ds_read_b64_tr_b16 v[16:17], v3 offset:61952
    ds_read_b64_tr_b16 v[18:19], v4 offset:61440
    ds_read_b64_tr_b16 v[20:21], v4 offset:61952
    s_add_u32 s38, s42, s43
    s_lshr_b32 s42, s36, 2
    s_add_u32 s38, s38, s42
    s_and_b32 s42, s2, 7
    s_lshl_b32 s42, s42, 3
    s_bfe_u32 s43, s2, 0x30003
    v_mfma_f32_32x32x16_bf16 v[206:221], v[26:29], v[50:53], v[206:221]
    s_add_u32 s45, s42, s43
    s_lshr_b32 s46, s2, 6
    s_mul_i32 s72, s45, 108
    s_add_u32 s72, s72, s36
    s_lshl_b32 s72, s72, 10
    s_mul_i32 s73, s36, 20
    s_waitcnt lgkmcnt(4)
    v_mfma_f32_32x32x16_bf16 v[222:237], v[6:9], v[54:57], v[222:237]
    ds_read_b128 v[58:61], v186 offset:32768
    ds_read_b64_tr_b16 v[22:23], v3 offset:55296
    ds_read_b64_tr_b16 v[24:25], v3 offset:55808
    ds_read_b64_tr_b16 v[26:27], v4 offset:55296
    ds_read_b64_tr_b16 v[28:29], v4 offset:55808
    s_mul_i32 s42, s46, 5
    s_add_u32 s73, s73, s42
    s_lshl_b32 s73, s73, 10
    s_add_u32 s4, s34, 2621440
    s_addc_u32 s5, s35, 0
    s_mov_b32 s6, 5242880
    v_mfma_f32_32x32x16_bf16 v[238:253], v[10:13], v[54:57], v[238:253]
    s_mov_b32 s7, 0x00020000
    s_mov_b32 s8, s34
    s_mov_b32 s9, s35
    s_mov_b32 s10, 7864320
    s_mov_b32 s11, 0x00020000
    s_lshl_b32 s41, s36, 10
    s_waitcnt lgkmcnt(5)
    v_mfma_f32_32x32x16_bf16 v[190:205], v[14:17], v[54:57], v[190:205]
    ds_read_b64_tr_b16 v[6:7], v3 offset:63488
    ds_read_b64_tr_b16 v[8:9], v3 offset:64000
    ds_read_b64_tr_b16 v[10:11], v4 offset:63488
    ds_read_b64_tr_b16 v[12:13], v4 offset:64000
    s_mul_i32 s39, s37, 163840
    s_add_u32 s39, s39, s41
    s_add_u32 s64, s34, 7864320
    s_addc_u32 s65, s35, 0
    s_mov_b32 s66, 7077888
    s_mov_b32 s67, 0x00020000
    v_mfma_f32_32x32x16_bf16 v[206:221], v[18:21], v[54:57], v[206:221]
    s_add_u32 s68, s34, 20971520
    s_addc_u32 s69, s35, 0
    s_mov_b32 s70, 3031040
    s_mov_b32 s71, 0x00020000
    s_add_u32 s12, s34, 14942208
    s_addc_u32 s13, s35, 0
    s_waitcnt lgkmcnt(4)
    v_mfma_f32_32x32x16_bf16 v[222:237], v[22:25], v[58:61], v[222:237]
    s_mov_b32 s14, 5251072
    s_mov_b32 s15, 0x00020000
    s_mul_i32 s75, s74, 200
    s_add_u32 s75, s75, 4
    s_cmp_lt_u32 s36, 4
    s_cselect_b32 s75, s75, s74
    v_mfma_f32_32x32x16_bf16 v[238:253], v[26:29], v[58:61], v[238:253]
    s_mul_i32 s42, s46, 5
    s_add_u32 s75, s75, s42
    s_add_u32 s75, s75, 2160
    s_lshl_b32 s75, s75, 10
    s_mul_i32 s47, s36, 10240
    s_mov_b32 s62, 0x000fffff
    s_barrier
    v_add_u32 v174, 65536, v174
    v_add_u32 v178, 65536, v178
    v_add_u32 v182, 65536, v182
    v_add_u32 v186, 65536, v186
    ds_read_b128 v[62:65], v174 offset:0
    v_add_u32 v3, 65536, v3
    v_add_u32 v4, 65536, v4
    ds_read_b64_tr_b16 v[14:15], v3 offset:16384
    ds_read_b64_tr_b16 v[16:17], v3 offset:16896
    ds_read_b64_tr_b16 v[18:19], v4 offset:16384
    ds_read_b64_tr_b16 v[20:21], v4 offset:16896
    s_waitcnt lgkmcnt(5)
    v_mfma_f32_32x32x16_bf16 v[190:205], v[6:9], v[58:61], v[190:205]
    ds_read_b64_tr_b16 v[22:23], v3 offset:24576
    ds_read_b64_tr_b16 v[24:25], v3 offset:25088
    ds_read_b64_tr_b16 v[26:27], v4 offset:24576
    ds_read_b64_tr_b16 v[28:29], v4 offset:25088
    s_mov_b32 s63, 0x000fffff
    s_add_u32 s48, s34, 20316160
    s_addc_u32 s49, s35, 0
    s_mov_b32 s50, 73728
    s_mov_b32 s51, 0x00020000
    s_mov_b32 s52, s32
    v_mfma_f32_32x32x16_bf16 v[206:221], v[10:13], v[58:61], v[206:221]
    s_mov_b32 s53, s33
    s_mov_b32 s54, 256
    s_mov_b32 s55, 0x00020000
    s_mov_b32 s58, 0x55555555
    s_mov_b32 s59, 0x55555555
    v_lshrrev_b32 v187, 5, v1
    s_waitcnt lgkmcnt(4)
    v_mfma_f32_32x32x16_bf16 v[222:237], v[14:17], v[62:65], v[222:237]
    ds_read_b128 v[66:69], v178 offset:0
    ds_read_b64_tr_b16 v[6:7], v3 offset:18432
    ds_read_b64_tr_b16 v[8:9], v3 offset:18944
    ds_read_b64_tr_b16 v[10:11], v4 offset:18432
    ds_read_b64_tr_b16 v[12:13], v4 offset:18944
    v_lshlrev_b32_e64 v254, 3, v0
    v_mad_u32_u24 v254, v187, s93, v254
    v_mfma_f32_32x32x16_bf16 v[238:253], v[18:21], v[62:65], v[238:253]
    s_cmp_ge_u32 s3, 2
    s_cbranch_scc0 g_br2
    s_mov_b32 s8, s24
    s_mov_b32 s9, s25
    s_mov_b32 s10, 2211840
    s_mov_b32 s11, 0x00020000
    buffer_load_dword v124, v122, s[8:11], 0 offen
g_br2:
    s_waitcnt lgkmcnt(5)
    v_mfma_f32_32x32x16_bf16 v[190:205], v[22:25], v[62:65], v[190:205]
    ds_read_b64_tr_b16 v[14:15], v3 offset:26624
    ds_read_b64_tr_b16 v[16:17], v3 offset:27136
    ds_read_b64_tr_b16 v[18:19], v4 offset:26624
    ds_read_b64_tr_b16 v[20:21], v4 offset:27136
    v_mfma_f32_32x32x16_bf16 v[206:221], v[26:29], v[62:65], v[206:221]
    s_waitcnt lgkmcnt(4)
    v_mfma_f32_32x32x16_bf16 v[222:237], v[6:9], v[66:69], v[222:237]
    ds_read_b128 v[70:73], v182 offset:0
    ds_read_b64_tr_b16 v[22:23], v3 offset:20480
    ds_read_b64_tr_b16 v[24:25], v3 offset:20992
    ds_read_b64_tr_b16 v[26:27], v4 offset:20480
    ds_read_b64_tr_b16 v[28:29], v4 offset:20992
    v_mfma_f32_32x32x16_bf16 v[238:253], v[10:13], v[66:69], v[238:253]
    s_waitcnt lgkmcnt(5)
    v_mfma_f32_32x32x16_bf16 v[190:205], v[14:17], v[66:69], v[190:205]
    ds_read_b64_tr_b16 v[6:7], v3 offset:28672
    ds_read_b64_tr_b16 v[8:9], v3 offset:29184
    ds_read_b64_tr_b16 v[10:11], v4 offset:28672
    ds_read_b64_tr_b16 v[12:13], v4 offset:29184
    v_mfma_f32_32x32x16_bf16 v[206:221], v[18:21], v[66:69], v[206:221]
    s_waitcnt lgkmcnt(4)
    v_mfma_f32_32x32x16_bf16 v[222:237], v[22:25], v[70:73], v[222:237]
    ds_read_b128 v[74:77], v186 offset:0
    ds_read_b64_tr_b16 v[14:15], v3 offset:22528
    ds_read_b64_tr_b16 v[16:17], v3 offset:23040
    ds_read_b64_tr_b16 v[18:19], v4 offset:22528
    ds_read_b64_tr_b16 v[20:21], v4 offset:23040
    v_mfma_f32_32x32x16_bf16 v[238:253], v[26:29], v[70:73], v[238:253]
    s_waitcnt lgkmcnt(5)
    v_mfma_f32_32x32x16_bf16 v[190:205], v[6:9], v[70:73], v[190:205]
    ds_read_b64_tr_b16 v[22:23], v3 offset:30720
    ds_read_b64_tr_b16 v[24:25], v3 offset:31232
    ds_read_b64_tr_b16 v[26:27], v4 offset:30720
    ds_read_b64_tr_b16 v[28:29], v4 offset:31232
    v_mfma_f32_32x32x16_bf16 v[206:221], v[10:13], v[70:73], v[206:221]
    s_waitcnt lgkmcnt(4)
    v_mfma_f32_32x32x16_bf16 v[222:237], v[14:17], v[74:77], v[222:237]
    v_mfma_f32_32x32x16_bf16 v[238:253], v[18:21], v[74:77], v[238:253]
    s_barrier
    ds_read_b128 v[78:81], v174 offset:32768
    ds_read_b64_tr_b16 v[6:7], v3 offset:49152
    ds_read_b64_tr_b16 v[8:9], v3 offset:49664
    ds_read_b64_tr_b16 v[10:11], v4 offset:49152
    ds_read_b64_tr_b16 v[12:13], v4 offset:49664
    s_waitcnt lgkmcnt(5)
    v_mfma_f32_32x32x16_bf16 v[190:205], v[22:25], v[74:77], v[190:205]
    ds_read_b64_tr_b16 v[14:15], v3 offset:57344
    ds_read_b64_tr_b16 v[16:17], v3 offset:57856
    ds_read_b64_tr_b16 v[18:19], v4 offset:57344
    ds_read_b64_tr_b16 v[20:21], v4 offset:57856
    v_mfma_f32_32x32x16_bf16 v[206:221], v[26:29], v[74:77], v[206:221]
    s_waitcnt lgkmcnt(4)
    v_mfma_f32_32x32x16_bf16 v[222:237], v[6:9], v[78:81], v[222:237]
    ds_read_b128 v[82:85], v178 offset:32768
    ds_read_b64_tr_b16 v[22:23], v3 offset:51200
    ds_read_b64_tr_b16 v[24:25], v3 offset:51712
    ds_read_b64_tr_b16 v[26:27], v4 offset:51200
    ds_read_b64_tr_b16 v[28:29], v4 offset:51712
    v_mfma_f32_32x32x16_bf16 v[238:253], v[10:13], v[78:81], v[238:253]
    s_waitcnt lgkmcnt(5)
    v_mfma_f32_32x32x16_bf16 v[190:205], v[14:17], v[78:81], v[190:205]
    ds_read_b64_tr_b16 v[6:7], v3 offset:59392
    ds_read_b64_tr_b16 v[8:9], v3 offset:59904
    ds_read_b64_tr_b16 v[10:11], v4 offset:59392
    ds_read_b64_tr_b16 v[12:13], v4 offset:59904
    v_mfma_f32_32x32x16_bf16 v[206:221], v[18:21], v[78:81], v[206:221]
    s_waitcnt lgkmcnt(4)
    v_mfma_f32_32x32x16_bf16 v[222:237], v[22:25], v[82:85], v[222:237]
    ds_read_b128 v[86:89], v182 offset:32768
    ds_read_b64_tr_b16 v[14:15], v3 offset:53248
    ds_read_b64_tr_b16 v[16:17], v3 offset:53760
    ds_read_b64_tr_b16 v[18:19], v4 offset:53248
    ds_read_b64_tr_b16 v[20:21], v4 offset:53760
    v_mfma_f32_32x32x16_bf16 v[238:253], v[26:29], v[82:85], v[238:253]
    s_waitcnt lgkmcnt(5)
    v_mfma_f32_32x32x16_bf16 v[190:205], v[6:9], v[82:85], v[190:205]
    ds_read_b64_tr_b16 v[22:23], v3 offset:61440
    ds_read_b64_tr_b16 v[24:25], v3 offset:61952
    ds_read_b64_tr_b16 v[26:27], v4 offset:61440
    ds_read_b64_tr_b16 v[28:29], v4 offset:61952
    v_mfma_f32_32x32x16_bf16 v[206:221], v[10:13], v[82:85], v[206:221]
    s_waitcnt lgkmcnt(4)
    v_mfma_f32_32x32x16_bf16 v[222:237], v[14:17], v[86:89], v[222:237]
    ds_read_b128 v[90:93], v186 offset:32768
    ds_read_b64_tr_b16 v[6:7], v3 offset:55296
    ds_read_b64_tr_b16 v[8:9], v3 offset:55808
    ds_read_b64_tr_b16 v[10:11], v4 offset:55296
    ds_read_b64_tr_b16 v[12:13], v4 offset:55808
    v_mfma_f32_32x32x16_bf16 v[238:253], v[18:21], v[86:89], v[238:253]
    s_waitcnt lgkmcnt(5)
    v_mfma_f32_32x32x16_bf16 v[190:205], v[22:25], v[86:89], v[190:205]
    ds_read_b64_tr_b16 v[14:15], v3 offset:63488
    ds_read_b64_tr_b16 v[16:17], v3 offset:64000
    ds_read_b64_tr_b16 v[18:19], v4 offset:63488
    ds_read_b64_tr_b16 v[20:21], v4 offset:64000
    v_mfma_f32_32x32x16_bf16 v[206:221], v[26:29], v[86:89], v[206:221]
    s_waitcnt lgkmcnt(4)
    v_mfma_f32_32x32x16_bf16 v[222:237], v[6:9], v[90:93], v[222:237]
    s_mov_b32 s42, 0x05040100
    s_mov_b32 s43, 0x07060302
    v_mfma_f32_32x32x16_bf16 v[238:253], v[10:13], v[90:93], v[238:253]
    s_waitcnt vmcnt(0)
    v_permlane32_swap_b32 v158, v160
    v_permlane32_swap_b32 v159, v161
    v_permlane32_swap_b32 v162, v164
    v_permlane32_swap_b32 v163, v165
    v_permlane32_swap_b32 v166, v168
    s_barrier
    v_add_u32 v174, 65536, v174
    v_add_u32 v178, 65536, v178
    v_add_u32 v182, 65536, v182
    v_add_u32 v186, 65536, v186
    ds_read_b128 v[94:97], v174 offset:0
    v_add_u32 v3, 65536, v3
    v_add_u32 v4, 65536, v4
    ds_read_b64_tr_b16 v[22:23], v3 offset:16384
    ds_read_b64_tr_b16 v[24:25], v3 offset:16896
    ds_read_b64_tr_b16 v[26:27], v4 offset:16384
    ds_read_b64_tr_b16 v[28:29], v4 offset:16896
    s_waitcnt lgkmcnt(5)
    v_mfma_f32_32x32x16_bf16 v[190:205], v[14:17], v[90:93], v[190:205]
    ds_read_b64_tr_b16 v[6:7], v3 offset:24576
    ds_read_b64_tr_b16 v[8:9], v3 offset:25088
    ds_read_b64_tr_b16 v[10:11], v4 offset:24576
    ds_read_b64_tr_b16 v[12:13], v4 offset:25088
    v_permlane32_swap_b32 v167, v169
    v_permlane32_swap_b32 v170, v172
    v_permlane32_swap_b32 v171, v173
    v_permlane16_swap_b32 v158, v159
    v_permlane16_swap_b32 v160, v161
    v_permlane16_swap_b32 v162, v163
    v_mfma_f32_32x32x16_bf16 v[206:221], v[18:21], v[90:93], v[206:221]
    v_permlane16_swap_b32 v164, v165
    v_permlane16_swap_b32 v166, v167
    v_permlane16_swap_b32 v168, v169
    v_permlane16_swap_b32 v170, v171
    v_permlane16_swap_b32 v172, v173
    s_nop 1
    v_perm_b32 v142, v159, v158, s42
    s_waitcnt lgkmcnt(4)
    v_mfma_f32_32x32x16_bf16 v[222:237], v[22:25], v[94:97], v[222:237]
    ds_read_b128 v[98:101], v178 offset:0
    ds_read_b64_tr_b16 v[14:15], v3 offset:18432
    ds_read_b64_tr_b16 v[16:17], v3 offset:18944
    ds_read_b64_tr_b16 v[18:19], v4 offset:18432
    ds_read_b64_tr_b16 v[20:21], v4 offset:18944
    v_perm_b32 v146, v159, v158, s43
    v_perm_b32 v158, v159, v158, v135
    v_perm_b32 v143, v161, v160, s42
    v_perm_b32 v147, v161, v160, s43
    v_perm_b32 v160, v161, v160, v135
    v_perm_b32 v144, v167, v166, s42
    v_mfma_f32_32x32x16_bf16 v[238:253], v[26:29], v[94:97], v[238:253]
    v_perm_b32 v148, v167, v166, s43
    v_perm_b32 v166, v167, v166, v135
    v_perm_b32 v145, v169, v168, s42
    v_perm_b32 v149, v169, v168, s43
    v_perm_b32 v168, v169, v168, v135
    s_nop 1
    v_mov_b32_dpp v142, v158 row_ror:8 row_mask:0xf bank_mask:0xc
    s_waitcnt lgkmcnt(5)
    v_mfma_f32_32x32x16_bf16 v[190:205], v[6:9], v[94:97], v[190:205]
    ds_read_b64_tr_b16 v[22:23], v3 offset:26624
    ds_read_b64_tr_b16 v[24:25], v3 offset:27136
    ds_read_b64_tr_b16 v[26:27], v4 offset:26624
    ds_read_b64_tr_b16 v[28:29], v4 offset:27136
    v_mov_b32_dpp v146, v158 row_ror:8 row_mask:0xf bank_mask:0x3
    v_mov_b32_dpp v143, v160 row_ror:8 row_mask:0xf bank_mask:0xc
    v_mov_b32_dpp v147, v160 row_ror:8 row_mask:0xf bank_mask:0x3
    v_mov_b32_dpp v144, v166 row_ror:8 row_mask:0xf bank_mask:0xc
    v_mov_b32_dpp v148, v166 row_ror:8 row_mask:0xf bank_mask:0x3
    v_mov_b32_dpp v145, v168 row_ror:8 row_mask:0xf bank_mask:0xc
    v_mfma_f32_32x32x16_bf16 v[206:221], v[10:13], v[94:97], v[206:221]
    v_mov_b32_dpp v149, v168 row_ror:8 row_mask:0xf bank_mask:0x3
    buffer_store_dwordx4 v[142:145], v134, s[68:71], 0 offen offset:0 sc1
    buffer_store_dwordx4 v[146:149], v134, s[68:71], 0 offen offset:2048 sc1
    v_perm_b32 v150, v163, v162, s42
    s_waitcnt lgkmcnt(4)
    v_mfma_f32_32x32x16_bf16 v[222:237], v[14:17], v[98:101], v[222:237]
    ds_read_b128 v[102:105], v182 offset:0
    ds_read_b64_tr_b16 v[6:7], v3 offset:20480
    ds_read_b64_tr_b16 v[8:9], v3 offset:20992
    ds_read_b64_tr_b16 v[10:11], v4 offset:20480
    ds_read_b64_tr_b16 v[12:13], v4 offset:20992
    v_perm_b32 v154, v163, v162, s43
    v_perm_b32 v162, v163, v162, v135
    v_perm_b32 v151, v165, v164, s42
    v_perm_b32 v155, v165, v164, s43
    v_perm_b32 v164, v165, v164, v135
    v_perm_b32 v152, v171, v170, s42
    v_mfma_f32_32x32x16_bf16 v[238:253], v[18:21], v[98:101], v[238:253]
    v_perm_b32 v156, v171, v170, s43
    v_perm_b32 v170, v171, v170, v135
    v_perm_b32 v153, v173, v172, s42
    v_perm_b32 v157, v173, v172, s43
    v_perm_b32 v172, v173, v172, v135
    s_nop 1
    v_mov_b32_dpp v150, v162 row_ror:8 row_mask:0xf bank_mask:0xc
    s_waitcnt lgkmcnt(5)
    v_mfma_f32_32x32x16_bf16 v[190:205], v[22:25], v[98:101], v[190:205]
    ds_read_b64_tr_b16 v[14:15], v3 offset:28672
    ds_read_b64_tr_b16 v[16:17], v3 offset:29184
    ds_read_b64_tr_b16 v[18:19], v4 offset:28672
    ds_read_b64_tr_b16 v[20:21], v4 offset:29184
    v_mov_b32_dpp v154, v162 row_ror:8 row_mask:0xf bank_mask:0x3
    v_mov_b32_dpp v151, v164 row_ror:8 row_mask:0xf bank_mask:0xc
    v_mov_b32_dpp v155, v164 row_ror:8 row_mask:0xf bank_mask:0x3
    v_mov_b32_dpp v152, v170 row_ror:8 row_mask:0xf bank_mask:0xc
    v_mov_b32_dpp v156, v170 row_ror:8 row_mask:0xf bank_mask:0x3
    v_mov_b32_dpp v153, v172 row_ror:8 row_mask:0xf bank_mask:0xc
    v_mfma_f32_32x32x16_bf16 v[206:221], v[26:29], v[98:101], v[206:221]
    v_mov_b32_dpp v157, v172 row_ror:8 row_mask:0xf bank_mask:0x3
    buffer_store_dwordx4 v[150:153], v134, s[68:71], 0 offen offset:512 sc1
    buffer_store_dwordx4 v[154:157], v134, s[68:71], 0 offen offset:2560 sc1
    s_waitcnt lgkmcnt(4)
    v_mfma_f32_32x32x16_bf16 v[222:237], v[6:9], v[102:105], v[222:237]
    ds_read_b128 v[106:109], v186 offset:0
    ds_read_b64_tr_b16 v[22:23], v3 offset:22528
    ds_read_b64_tr_b16 v[24:25], v3 offset:23040
    ds_read_b64_tr_b16 v[26:27], v4 offset:22528
    ds_read_b64_tr_b16 v[28:29], v4 offset:23040
    v_mfma_f32_32x32x16_bf16 v[238:253], v[10:13], v[102:105], v[238:253]
    s_waitcnt lgkmcnt(5)
    v_mfma_f32_32x32x16_bf16 v[190:205], v[14:17], v[102:105], v[190:205]
    ds_read_b64_tr_b16 v[6:7], v3 offset:30720
    ds_read_b64_tr_b16 v[8:9], v3 offset:31232
    ds_read_b64_tr_b16 v[10:11], v4 offset:30720
    ds_read_b64_tr_b16 v[12:13], v4 offset:31232
    v_mfma_f32_32x32x16_bf16 v[206:221], v[18:21], v[102:105], v[206:221]
    s_waitcnt lgkmcnt(4)
    v_mfma_f32_32x32x16_bf16 v[222:237], v[22:25], v[106:109], v[222:237]
    v_mfma_f32_32x32x16_bf16 v[238:253], v[26:29], v[106:109], v[238:253]
    s_barrier
    v_add_u32 v174, -131072, v174
    v_add_u32 v178, -131072, v178
    v_add_u32 v182, -131072, v182
    v_add_u32 v186, -131072, v186
    ds_read_b128 v[110:113], v174 offset:0
    v_add_u32 v3, -131072, v3
    v_add_u32 v4, -131072, v4
    ds_read_b64_tr_b16 v[14:15], v3 offset:16384
    ds_read_b64_tr_b16 v[16:17], v3 offset:16896
    ds_read_b64_tr_b16 v[18:19], v4 offset:16384
    ds_read_b64_tr_b16 v[20:21], v4 offset:16896
    s_waitcnt lgkmcnt(5)
    v_mfma_f32_32x32x16_bf16 v[190:205], v[6:9], v[106:109], v[190:205]
    ds_read_b64_tr_b16 v[22:23], v3 offset:24576
    ds_read_b64_tr_b16 v[24:25], v3 offset:25088
    ds_read_b64_tr_b16 v[26:27], v4 offset:24576
    ds_read_b64_tr_b16 v[28:29], v4 offset:25088
    v_mfma_f32_32x32x16_bf16 v[206:221], v[10:13], v[106:109], v[206:221]
    s_waitcnt lgkmcnt(4)
    v_mfma_f32_32x32x16_bf16 v[222:237], v[14:17], v[110:113], v[222:237]
    ds_read_b128 v[114:117], v178 offset:0
    ds_read_b64_tr_b16 v[6:7], v3 offset:18432
    ds_read_b64_tr_b16 v[8:9], v3 offset:18944
    ds_read_b64_tr_b16 v[10:11], v4 offset:18432
    ds_read_b64_tr_b16 v[12:13], v4 offset:18944
    v_mfma_f32_32x32x16_bf16 v[238:253], v[18:21], v[110:113], v[238:253]
    s_waitcnt lgkmcnt(5)
    v_mfma_f32_32x32x16_bf16 v[190:205], v[22:25], v[110:113], v[190:205]
    ds_read_b64_tr_b16 v[14:15], v3 offset:26624
    ds_read_b64_tr_b16 v[16:17], v3 offset:27136
    ds_read_b64_tr_b16 v[18:19], v4 offset:26624
    ds_read_b64_tr_b16 v[20:21], v4 offset:27136
    v_mfma_f32_32x32x16_bf16 v[206:221], v[26:29], v[110:113], v[206:221]
    s_waitcnt lgkmcnt(4)
    v_mfma_f32_32x32x16_bf16 v[222:237], v[6:9], v[114:117], v[222:237]
    ds_read_b128 v[118:121], v182 offset:0
    ds_read_b64_tr_b16 v[22:23], v3 offset:20480
    ds_read_b64_tr_b16 v[24:25], v3 offset:20992
    ds_read_b64_tr_b16 v[26:27], v4 offset:20480
    ds_read_b64_tr_b16 v[28:29], v4 offset:20992
    v_mfma_f32_32x32x16_bf16 v[238:253], v[10:13], v[114:117], v[238:253]
    s_waitcnt lgkmcnt(5)
    v_mfma_f32_32x32x16_bf16 v[190:205], v[14:17], v[114:117], v[190:205]
    ds_read_b64_tr_b16 v[6:7], v3 offset:28672
    ds_read_b64_tr_b16 v[8:9], v3 offset:29184
    ds_read_b64_tr_b16 v[10:11], v4 offset:28672
    ds_read_b64_tr_b16 v[12:13], v4 offset:29184
    v_mfma_f32_32x32x16_bf16 v[206:221], v[18:21], v[114:117], v[206:221]
    s_waitcnt lgkmcnt(4)
    v_mfma_f32_32x32x16_bf16 v[222:237], v[22:25], v[118:121], v[222:237]
    ds_read_b128 v[122:125], v186 offset:0
    ds_read_b64_tr_b16 v[14:15], v3 offset:22528
    ds_read_b64_tr_b16 v[16:17], v3 offset:23040
    ds_read_b64_tr_b16 v[18:19], v4 offset:22528
    ds_read_b64_tr_b16 v[20:21], v4 offset:23040
    v_mfma_f32_32x32x16_bf16 v[238:253], v[26:29], v[118:121], v[238:253]
    s_waitcnt lgkmcnt(5)
    v_mfma_f32_32x32x16_bf16 v[190:205], v[6:9], v[118:121], v[190:205]
    ds_read_b64_tr_b16 v[22:23], v3 offset:30720
    ds_read_b64_tr_b16 v[24:25], v3 offset:31232
    ds_read_b64_tr_b16 v[26:27], v4 offset:30720
    ds_read_b64_tr_b16 v[28:29], v4 offset:31232
    v_mfma_f32_32x32x16_bf16 v[206:221], v[10:13], v[118:121], v[206:221]
    s_waitcnt lgkmcnt(4)
    v_mfma_f32_32x32x16_bf16 v[222:237], v[14:17], v[122:125], v[222:237]
    v_mfma_f32_32x32x16_bf16 v[238:253], v[18:21], v[122:125], v[238:253]
    s_waitcnt vmcnt(0)
    s_barrier
    ds_read_b128 v[126:129], v174 offset:32768
    ds_read_b64_tr_b16 v[6:7], v3 offset:49152
    ds_read_b64_tr_b16 v[8:9], v3 offset:49664
    ds_read_b64_tr_b16 v[10:11], v4 offset:49152
    ds_read_b64_tr_b16 v[12:13], v4 offset:49664
    s_cmp_lg_u32 s3, 0
    s_cbranch_scc1 g_naqa
    s_and_b32 s43, s2, 3
    s_lshl_b32 s43, s43, 6
    v_mov_b32_e64 v187, 1
    s_mov_b64 exec, 1
    buffer_atomic_add v187, off, s[52:55], s43 offset:0 sc1
    s_mov_b64 exec, -1
g_naqa:
    s_waitcnt lgkmcnt(5)
    v_mfma_f32_32x32x16_bf16 v[190:205], v[22:25], v[122:125], v[190:205]
    ds_read_b64_tr_b16 v[14:15], v3 offset:57344
    ds_read_b64_tr_b16 v[16:17], v3 offset:57856
    ds_read_b64_tr_b16 v[18:19], v4 offset:57344
    ds_read_b64_tr_b16 v[20:21], v4 offset:57856
    v_mfma_f32_32x32x16_bf16 v[206:221], v[26:29], v[122:125], v[206:221]
    s_waitcnt lgkmcnt(4)
    v_mfma_f32_32x32x16_bf16 v[222:237], v[6:9], v[126:129], v[222:237]
    ds_read_b128 v[130:133], v178 offset:32768
    ds_read_b64_tr_b16 v[22:23], v3 offset:51200
    ds_read_b64_tr_b16 v[24:25], v3 offset:51712
    ds_read_b64_tr_b16 v[26:27], v4 offset:51200
    ds_read_b64_tr_b16 v[28:29], v4 offset:51712
    v_mfma_f32_32x32x16_bf16 v[238:253], v[10:13], v[126:129], v[238:253]
    s_waitcnt lgkmcnt(5)
    v_mfma_f32_32x32x16_bf16 v[190:205], v[14:17], v[126:129], v[190:205]
    ds_read_b64_tr_b16 v[6:7], v3 offset:59392
    ds_read_b64_tr_b16 v[8:9], v3 offset:59904
    ds_read_b64_tr_b16 v[10:11], v4 offset:59392
    ds_read_b64_tr_b16 v[12:13], v4 offset:59904
    v_mfma_f32_32x32x16_bf16 v[206:221], v[18:21], v[126:129], v[206:221]
    s_waitcnt lgkmcnt(4)
    v_mfma_f32_32x32x16_bf16 v[222:237], v[22:25], v[130:133], v[222:237]
    ds_read_b128 v[134:137], v182 offset:32768
    ds_read_b64_tr_b16 v[14:15], v3 offset:53248
    ds_read_b64_tr_b16 v[16:17], v3 offset:53760
    ds_read_b64_tr_b16 v[18:19], v4 offset:53248
    ds_read_b64_tr_b16 v[20:21], v4 offset:53760
    v_mfma_f32_32x32x16_bf16 v[238:253], v[26:29], v[130:133], v[238:253]
    s_waitcnt lgkmcnt(5)
    v_mfma_f32_32x32x16_bf16 v[190:205], v[6:9], v[130:133], v[190:205]
    ds_read_b64_tr_b16 v[22:23], v3 offset:61440
    ds_read_b64_tr_b16 v[24:25], v3 offset:61952
    ds_read_b64_tr_b16 v[26:27], v4 offset:61440
    ds_read_b64_tr_b16 v[28:29], v4 offset:61952
    v_mfma_f32_32x32x16_bf16 v[206:221], v[10:13], v[130:133], v[206:221]
    s_waitcnt lgkmcnt(4)
    v_mfma_f32_32x32x16_bf16 v[222:237], v[14:17], v[134:137], v[222:237]
    ds_read_b128 v[138:141], v186 offset:32768
    ds_read_b64_tr_b16 v[6:7], v3 offset:55296
    ds_read_b64_tr_b16 v[8:9], v3 offset:55808
    ds_read_b64_tr_b16 v[10:11], v4 offset:55296
    ds_read_b64_tr_b16 v[12:13], v4 offset:55808
    v_mfma_f32_32x32x16_bf16 v[238:253], v[18:21], v[134:137], v[238:253]
    s_waitcnt lgkmcnt(5)
    v_mfma_f32_32x32x16_bf16 v[190:205], v[22:25], v[134:137], v[190:205]
    ds_read_b64_tr_b16 v[14:15], v3 offset:63488
    ds_read_b64_tr_b16 v[16:17], v3 offset:64000
    ds_read_b64_tr_b16 v[18:19], v4 offset:63488
    ds_read_b64_tr_b16 v[20:21], v4 offset:64000
    v_mfma_f32_32x32x16_bf16 v[206:221], v[26:29], v[134:137], v[206:221]
    s_waitcnt lgkmcnt(4)
    v_mfma_f32_32x32x16_bf16 v[222:237], v[6:9], v[138:141], v[222:237]
    v_mfma_f32_32x32x16_bf16 v[238:253], v[10:13], v[138:141], v[238:253]
    s_barrier
    v_add_u32 v174, 65536, v174
    v_add_u32 v178, 65536, v178
    v_add_u32 v182, 65536, v182
    v_add_u32 v186, 65536, v186
    ds_read_b128 v[142:145], v174 offset:0
    v_add_u32 v3, 65536, v3
    v_add_u32 v4, 65536, v4
    ds_read_b64_tr_b16 v[22:23], v3 offset:16384
    ds_read_b64_tr_b16 v[24:25], v3 offset:16896
    ds_read_b64_tr_b16 v[26:27], v4 offset:16384
    ds_read_b64_tr_b16 v[28:29], v4 offset:16896
    s_waitcnt lgkmcnt(5)
    v_mfma_f32_32x32x16_bf16 v[190:205], v[14:17], v[138:141], v[190:205]
    ds_read_b64_tr_b16 v[6:7], v3 offset:24576
    ds_read_b64_tr_b16 v[8:9], v3 offset:25088
    ds_read_b64_tr_b16 v[10:11], v4 offset:24576
    ds_read_b64_tr_b16 v[12:13], v4 offset:25088
    v_mfma_f32_32x32x16_bf16 v[206:221], v[18:21], v[138:141], v[206:221]
    s_waitcnt lgkmcnt(4)
    v_mfma_f32_32x32x16_bf16 v[222:237], v[22:25], v[142:145], v[222:237]
    ds_read_b128 v[146:149], v178 offset:0
    ds_read_b64_tr_b16 v[14:15], v3 offset:18432
    ds_read_b64_tr_b16 v[16:17], v3 offset:18944
    ds_read_b64_tr_b16 v[18:19], v4 offset:18432
    ds_read_b64_tr_b16 v[20:21], v4 offset:18944
    v_mfma_f32_32x32x16_bf16 v[238:253], v[26:29], v[142:145], v[238:253]
    s_waitcnt lgkmcnt(5)
    v_mfma_f32_32x32x16_bf16 v[190:205], v[6:9], v[142:145], v[190:205]
    ds_read_b64_tr_b16 v[22:23], v3 offset:26624
    ds_read_b64_tr_b16 v[24:25], v3 offset:27136
    ds_read_b64_tr_b16 v[26:27], v4 offset:26624
    ds_read_b64_tr_b16 v[28:29], v4 offset:27136
    v_mfma_f32_32x32x16_bf16 v[206:221], v[10:13], v[142:145], v[206:221]
    s_waitcnt lgkmcnt(4)
    v_mfma_f32_32x32x16_bf16 v[222:237], v[14:17], v[146:149], v[222:237]
    ds_read_b128 v[150:153], v182 offset:0
    ds_read_b64_tr_b16 v[6:7], v3 offset:20480
    ds_read_b64_tr_b16 v[8:9], v3 offset:20992
    ds_read_b64_tr_b16 v[10:11], v4 offset:20480
    ds_read_b64_tr_b16 v[12:13], v4 offset:20992
    v_mfma_f32_32x32x16_bf16 v[238:253], v[18:21], v[146:149], v[238:253]
    s_waitcnt lgkmcnt(5)
    v_mfma_f32_32x32x16_bf16 v[190:205], v[22:25], v[146:149], v[190:205]
    ds_read_b64_tr_b16 v[14:15], v3 offset:28672
    ds_read_b64_tr_b16 v[16:17], v3 offset:29184
    ds_read_b64_tr_b16 v[18:19], v4 offset:28672
    ds_read_b64_tr_b16 v[20:21], v4 offset:29184
    v_mfma_f32_32x32x16_bf16 v[206:221], v[26:29], v[146:149], v[206:221]
    s_waitcnt lgkmcnt(4)
    v_mfma_f32_32x32x16_bf16 v[222:237], v[6:9], v[150:153], v[222:237]
    ds_read_b128 v[154:157], v186 offset:0
    ds_read_b64_tr_b16 v[22:23], v3 offset:22528
    ds_read_b64_tr_b16 v[24:25], v3 offset:23040
    ds_read_b64_tr_b16 v[26:27], v4 offset:22528
    ds_read_b64_tr_b16 v[28:29], v4 offset:23040
    v_mfma_f32_32x32x16_bf16 v[238:253], v[10:13], v[150:153], v[238:253]
    s_waitcnt lgkmcnt(5)
    v_mfma_f32_32x32x16_bf16 v[190:205], v[14:17], v[150:153], v[190:205]
    ds_read_b64_tr_b16 v[6:7], v3 offset:30720
    ds_read_b64_tr_b16 v[8:9], v3 offset:31232
    ds_read_b64_tr_b16 v[10:11], v4 offset:30720
    ds_read_b64_tr_b16 v[12:13], v4 offset:31232
    v_mfma_f32_32x32x16_bf16 v[206:221], v[18:21], v[150:153], v[206:221]
    s_waitcnt lgkmcnt(4)
    v_mfma_f32_32x32x16_bf16 v[222:237], v[22:25], v[154:157], v[222:237]
    v_mfma_f32_32x32x16_bf16 v[238:253], v[26:29], v[154:157], v[238:253]
    s_barrier
    ds_read_b128 v[158:161], v174 offset:32768
    ds_read_b64_tr_b16 v[14:15], v3 offset:49152
    ds_read_b64_tr_b16 v[16:17], v3 offset:49664
    ds_read_b64_tr_b16 v[18:19], v4 offset:49152
    ds_read_b64_tr_b16 v[20:21], v4 offset:49664
    s_waitcnt lgkmcnt(5)
    v_mfma_f32_32x32x16_bf16 v[190:205], v[6:9], v[154:157], v[190:205]
    ds_read_b64_tr_b16 v[22:23], v3 offset:57344
    ds_read_b64_tr_b16 v[24:25], v3 offset:57856
    ds_read_b64_tr_b16 v[26:27], v4 offset:57344
    ds_read_b64_tr_b16 v[28:29], v4 offset:57856
    v_mfma_f32_32x32x16_bf16 v[206:221], v[10:13], v[154:157], v[206:221]
    s_waitcnt lgkmcnt(4)
    v_mfma_f32_32x32x16_bf16 v[222:237], v[14:17], v[158:161], v[222:237]
    ds_read_b128 v[162:165], v178 offset:32768
    ds_read_b64_tr_b16 v[6:7], v3 offset:51200
    ds_read_b64_tr_b16 v[8:9], v3 offset:51712
    ds_read_b64_tr_b16 v[10:11], v4 offset:51200
    ds_read_b64_tr_b16 v[12:13], v4 offset:51712
    v_mfma_f32_32x32x16_bf16 v[238:253], v[18:21], v[158:161], v[238:253]
    s_waitcnt lgkmcnt(5)
    v_mfma_f32_32x32x16_bf16 v[190:205], v[22:25], v[158:161], v[190:205]
    ds_read_b64_tr_b16 v[14:15], v3 offset:59392
    ds_read_b64_tr_b16 v[16:17], v3 offset:59904
    ds_read_b64_tr_b16 v[18:19], v4 offset:59392
    ds_read_b64_tr_b16 v[20:21], v4 offset:59904
    v_mfma_f32_32x32x16_bf16 v[206:221], v[26:29], v[158:161], v[206:221]
    s_waitcnt lgkmcnt(4)
    v_mfma_f32_32x32x16_bf16 v[222:237], v[6:9], v[162:165], v[222:237]
    ds_read_b128 v[166:169], v182 offset:32768
    ds_read_b64_tr_b16 v[22:23], v3 offset:53248
    ds_read_b64_tr_b16 v[24:25], v3 offset:53760
    ds_read_b64_tr_b16 v[26:27], v4 offset:53248
    ds_read_b64_tr_b16 v[28:29], v4 offset:53760
    v_mfma_f32_32x32x16_bf16 v[238:253], v[10:13], v[162:165], v[238:253]
    s_waitcnt lgkmcnt(5)
    v_mfma_f32_32x32x16_bf16 v[190:205], v[14:17], v[162:165], v[190:205]
    ds_read_b64_tr_b16 v[6:7], v3 offset:61440
    ds_read_b64_tr_b16 v[8:9], v3 offset:61952
    ds_read_b64_tr_b16 v[10:11], v4 offset:61440
    ds_read_b64_tr_b16 v[12:13], v4 offset:61952
    v_mfma_f32_32x32x16_bf16 v[206:221], v[18:21], v[162:165], v[206:221]
    s_waitcnt lgkmcnt(4)
    v_mfma_f32_32x32x16_bf16 v[222:237], v[22:25], v[166:169], v[222:237]
    ds_read_b128 v[170:173], v186 offset:32768
    ds_read_b64_tr_b16 v[14:15], v3 offset:55296
    ds_read_b64_tr_b16 v[16:17], v3 offset:55808
    ds_read_b64_tr_b16 v[18:19], v4 offset:55296
    ds_read_b64_tr_b16 v[20:21], v4 offset:55808
    v_mfma_f32_32x32x16_bf16 v[238:253], v[26:29], v[166:169], v[238:253]
    s_waitcnt lgkmcnt(5)
    v_mfma_f32_32x32x16_bf16 v[190:205], v[6:9], v[166:169], v[190:205]
    ds_read_b64_tr_b16 v[22:23], v3 offset:63488
    ds_read_b64_tr_b16 v[24:25], v3 offset:64000
    ds_read_b64_tr_b16 v[26:27], v4 offset:63488
    ds_read_b64_tr_b16 v[28:29], v4 offset:64000
    v_mfma_f32_32x32x16_bf16 v[206:221], v[10:13], v[166:169], v[206:221]
    s_waitcnt lgkmcnt(4)
    v_mfma_f32_32x32x16_bf16 v[222:237], v[14:17], v[170:173], v[222:237]
    v_mfma_f32_32x32x16_bf16 v[238:253], v[18:21], v[170:173], v[238:253]
    s_barrier
    v_add_u32 v174, 65536, v174
    v_add_u32 v178, 65536, v178
    v_add_u32 v182, 65536, v182
    v_add_u32 v186, 65536, v186
    ds_read_b128 v[174:177], v174 offset:0
    v_add_u32 v3, 65536, v3
    v_add_u32 v4, 65536, v4
    ds_read_b64_tr_b16 v[6:7], v3 offset:16384
    ds_read_b64_tr_b16 v[8:9], v3 offset:16896
    ds_read_b64_tr_b16 v[10:11], v4 offset:16384
    ds_read_b64_tr_b16 v[12:13], v4 offset:16896
    s_waitcnt lgkmcnt(5)
    v_mfma_f32_32x32x16_bf16 v[190:205], v[22:25], v[170:173], v[190:205]
    ds_read_b128 v[178:181], v178 offset:0
    ds_read_b64_tr_b16 v[14:15], v3 offset:18432
    ds_read_b64_tr_b16 v[16:17], v3 offset:18944
    ds_read_b64_tr_b16 v[18:19], v4 offset:18432
    ds_read_b64_tr_b16 v[20:21], v4 offset:18944
    v_mfma_f32_32x32x16_bf16 v[206:221], v[26:29], v[170:173], v[206:221]
    s_cmp_eq_u32 s61, 15
    s_cbranch_scc1 g_ch
    s_cmp_eq_u32 s57, 1
    s_cbranch_scc1 g_cq1
    s_cmp_eq_u32 s57, 2
    s_cbranch_scc1 g_cq2
    s_cmp_eq_u32 s57, 3
    s_cbranch_scc1 g_cq3
    s_cmp_eq_u32 s57, 4
    s_cbranch_scc1 g_cq4
g_cq0:
    s_waitcnt lgkmcnt(5)
    v_mfma_f32_32x32x16_bf16 v[222:237], v[6:9], v[174:177], v[222:237]
    ds_read_b128 v[182:185], v182 offset:0
    ds_read_b64_tr_b16 v[22:23], v3 offset:20480
    ds_read_b64_tr_b16 v[24:25], v3 offset:20992
    ds_read_b64_tr_b16 v[26:27], v4 offset:20480
    ds_read_b64_tr_b16 v[28:29], v4 offset:20992
    v_mfma_f32_32x32x16_bf16 v[238:253], v[10:13], v[174:177], v[238:253]
    s_waitcnt lgkmcnt(5)
    v_mfma_f32_32x32x16_bf16 v[222:237], v[14:17], v[178:181], v[222:237]
    ds_read_b128 v[186:189], v186 offset:0
    ds_read_b64_tr_b16 v[6:7], v3 offset:22528
    ds_read_b64_tr_b16 v[8:9], v3 offset:23040
    ds_read_b64_tr_b16 v[10:11], v4 offset:22528
    ds_read_b64_tr_b16 v[12:13], v4 offset:23040
    v_mfma_f32_32x32x16_bf16 v[238:253], v[18:21], v[178:181], v[238:253]
    s_waitcnt lgkmcnt(5)
    v_mfma_f32_32x32x16_bf16 v[222:237], v[22:25], v[182:185], v[222:237]
    ds_read_b64_tr_b16 v[14:15], v3 offset:24576
    ds_read_b64_tr_b16 v[16:17], v3 offset:25088
    ds_read_b64_tr_b16 v[18:19], v4 offset:24576
    ds_read_b64_tr_b16 v[20:21], v4 offset:25088
    v_mfma_f32_32x32x16_bf16 v[238:253], v[26:29], v[182:185], v[238:253]
    s_waitcnt lgkmcnt(4)
    v_mfma_f32_32x32x16_bf16 v[222:237], v[6:9], v[186:189], v[222:237]
    ds_read_b64_tr_b16 v[22:23], v3 offset:26624
    ds_read_b64_tr_b16 v[24:25], v3 offset:27136
    ds_read_b64_tr_b16 v[26:27], v4 offset:26624
    ds_read_b64_tr_b16 v[28:29], v4 offset:27136
    v_mfma_f32_32x32x16_bf16 v[238:253], v[10:13], v[186:189], v[238:253]
    s_waitcnt lgkmcnt(4)
    v_mfma_f32_32x32x16_bf16 v[190:205], v[14:17], v[174:177], v[190:205]
    ds_read_b64_tr_b16 v[6:7], v3 offset:28672
    ds_read_b64_tr_b16 v[8:9], v3 offset:29184
    ds_read_b64_tr_b16 v[10:11], v4 offset:28672
    ds_read_b64_tr_b16 v[12:13], v4 offset:29184
    v_mfma_f32_32x32x16_bf16 v[206:221], v[18:21], v[174:177], v[206:221]
    s_waitcnt lgkmcnt(4)
    v_mfma_f32_32x32x16_bf16 v[190:205], v[22:25], v[178:181], v[190:205]
    ds_read_b64_tr_b16 v[14:15], v3 offset:30720
    ds_read_b64_tr_b16 v[16:17], v3 offset:31232
    ds_read_b64_tr_b16 v[18:19], v4 offset:30720
    ds_read_b64_tr_b16 v[20:21], v4 offset:31232
    v_pk_mul_f32 v[222:223], v[222:223], s[96:97]
    v_pk_mul_f32 v[224:225], v[224:225], s[96:97]
    v_cvt_pk_bf16_f32 v222, v222, v223
    v_cvt_pk_bf16_f32 v223, v224, v225
    s_nop 1
    v_mfma_f32_32x32x16_bf16 v[206:221], v[26:29], v[178:181], v[206:221]
    v_pk_mul_f32 v[226:227], v[226:227], s[96:97]
    v_pk_mul_f32 v[228:229], v[228:229], s[96:97]
    v_cvt_pk_bf16_f32 v224, v226, v227
    v_cvt_pk_bf16_f32 v225, v228, v229
    s_mul_i32 s42, s93, 0
    s_add_u32 s42, s42, s92
    s_nop 1
    v_permlane32_swap_b32 v222, v224
    v_permlane32_swap_b32 v223, v225
    buffer_store_dwordx4 v[222:225], v2, s[88:91], s42 offen sc1
    s_waitcnt lgkmcnt(4)
    v_mfma_f32_32x32x16_bf16 v[190:205], v[6:9], v[182:185], v[190:205]
    v_pk_mul_f32 v[230:231], v[230:231], s[96:97]
    v_pk_mul_f32 v[232:233], v[232:233], s[96:97]
    v_cvt_pk_bf16_f32 v230, v230, v231
    v_cvt_pk_bf16_f32 v231, v232, v233
    s_mul_i32 s42, s93, 0
    s_add_u32 s42, s42, s92
    s_nop 1
    v_mfma_f32_32x32x16_bf16 v[206:221], v[10:13], v[182:185], v[206:221]
    v_mov_b32_dpp v232, v230 quad_perm:[1,1,3,3] row_mask:0xf bank_mask:0xf
    v_mov_b32_dpp v233, v231 quad_perm:[1,1,3,3] row_mask:0xf bank_mask:0xf
    s_mov_b64 exec, s[58:59]
    buffer_store_dwordx4 v[230:233], v254, s[88:91], s42 offen offset:1024 sc1
    s_mov_b64 exec, -1
    s_nop 1
    s_barrier
    v_add_u32 v3, -131072, v3
    v_add_u32 v4, -131072, v4
    ds_read_b64_tr_b16 v[22:23], v3 offset:0
    ds_read_b64_tr_b16 v[24:25], v3 offset:512
    ds_read_b64_tr_b16 v[26:27], v4 offset:0
    ds_read_b64_tr_b16 v[28:29], v4 offset:512
    v_pk_mul_f32 v[234:235], v[234:235], s[96:97]
    v_pk_mul_f32 v[236:237], v[236:237], s[96:97]
    v_cvt_pk_bf16_f32 v234, v234, v235
    v_cvt_pk_bf16_f32 v235, v236, v237
    s_waitcnt lgkmcnt(4)
    v_mfma_f32_32x32x16_bf16 v[190:205], v[14:17], v[186:189], v[190:205]
    ds_read_b64_tr_b16 v[6:7], v3 offset:2048
    ds_read_b64_tr_b16 v[8:9], v3 offset:2560
    ds_read_b64_tr_b16 v[10:11], v4 offset:2048
    ds_read_b64_tr_b16 v[12:13], v4 offset:2560
    v_pk_mul_f32 v[238:239], v[238:239], s[96:97]
    v_pk_mul_f32 v[240:241], v[240:241], s[96:97]
    v_cvt_pk_bf16_f32 v236, v238, v239
    v_cvt_pk_bf16_f32 v237, v240, v241
    s_mul_i32 s42, s93, 1
    s_add_u32 s42, s42, s92
    s_nop 1
    v_mfma_f32_32x32x16_bf16 v[206:221], v[18:21], v[186:189], v[206:221]
    v_permlane32_swap_b32 v234, v236
    v_permlane32_swap_b32 v235, v237
    buffer_store_dwordx4 v[234:237], v2, s[88:91], s42 offen sc1
    s_nop 1
    v_pk_mul_f32 v[242:243], v[242:243], s[96:97]
    v_pk_mul_f32 v[244:245], v[244:245], s[96:97]
    v_cvt_pk_bf16_f32 v242, v242, v243
    v_cvt_pk_bf16_f32 v243, v244, v245
    s_nop 1
    v_pk_mul_f32 v[246:247], v[246:247], s[96:97]
    v_pk_mul_f32 v[248:249], v[248:249], s[96:97]
    v_cvt_pk_bf16_f32 v244, v246, v247
    v_cvt_pk_bf16_f32 v245, v248, v249
    s_mul_i32 s42, s93, 2
    s_add_u32 s42, s42, s92
    s_nop 1
    v_permlane32_swap_b32 v242, v244
    v_permlane32_swap_b32 v243, v245
    buffer_store_dwordx4 v[242:245], v2, s[88:91], s42 offen sc1
    s_nop 1
    v_pk_mul_f32 v[250:251], v[250:251], s[96:97]
    v_pk_mul_f32 v[252:253], v[252:253], s[96:97]
    v_cvt_pk_bf16_f32 v250, v250, v251
    v_cvt_pk_bf16_f32 v251, v252, v253
    s_mul_i32 s42, s93, 2
    s_add_u32 s42, s42, s92
    s_nop 1
    v_mov_b32_dpp v252, v250 quad_perm:[1,1,3,3] row_mask:0xf bank_mask:0xf
    v_mov_b32_dpp v253, v251 quad_perm:[1,1,3,3] row_mask:0xf bank_mask:0xf
    s_mov_b64 exec, s[58:59]
    buffer_store_dwordx4 v[250:253], v254, s[88:91], s42 offen offset:1024 sc1
    s_mov_b64 exec, -1
    s_waitcnt lgkmcnt(4)
    v_mfma_f32_32x32x16_bf16 v[222:237], v[22:25], v[30:33], 0
    ds_read_b64_tr_b16 v[14:15], v3 offset:4096
    ds_read_b64_tr_b16 v[16:17], v3 offset:4608
    ds_read_b64_tr_b16 v[18:19], v4 offset:4096
    ds_read_b64_tr_b16 v[20:21], v4 offset:4608
    v_mfma_f32_32x32x16_bf16 v[238:253], v[26:29], v[30:33], 0
    s_waitcnt lgkmcnt(4)
    v_mfma_f32_32x32x16_bf16 v[222:237], v[6:9], v[34:37], v[222:237]
    ds_read_b64_tr_b16 v[22:23], v3 offset:6144
    ds_read_b64_tr_b16 v[24:25], v3 offset:6656
    ds_read_b64_tr_b16 v[26:27], v4 offset:6144
    ds_read_b64_tr_b16 v[28:29], v4 offset:6656
    v_pk_mul_f32 v[190:191], v[190:191], s[96:97]
    v_pk_mul_f32 v[192:193], v[192:193], s[96:97]
    v_cvt_pk_bf16_f32 v190, v190, v191
    v_cvt_pk_bf16_f32 v191, v192, v193
    s_nop 1
    v_mfma_f32_32x32x16_bf16 v[238:253], v[10:13], v[34:37], v[238:253]
    v_pk_mul_f32 v[194:195], v[194:195], s[96:97]
    v_pk_mul_f32 v[196:197], v[196:197], s[96:97]
    v_cvt_pk_bf16_f32 v192, v194, v195
    v_cvt_pk_bf16_f32 v193, v196, v197
    s_mul_i32 s42, s93, 3
    s_add_u32 s42, s42, s92
    s_waitcnt lgkmcnt(4)
    v_mfma_f32_32x32x16_bf16 v[222:237], v[14:17], v[38:41], v[222:237]
    ds_read_b64_tr_b16 v[6:7], v3 offset:8192
    ds_read_b64_tr_b16 v[8:9], v3 offset:8704
    ds_read_b64_tr_b16 v[10:11], v4 offset:8192
    ds_read_b64_tr_b16 v[12:13], v4 offset:8704
    v_permlane32_swap_b32 v190, v192
    v_permlane32_swap_b32 v191, v193
    buffer_store_dwordx4 v[190:193], v2, s[88:91], s42 offen sc1
    s_nop 1
    v_mfma_f32_32x32x16_bf16 v[238:253], v[18:21], v[38:41], v[238:253]
    v_pk_mul_f32 v[198:199], v[198:199], s[96:97]
    v_pk_mul_f32 v[200:201], v[200:201], s[96:97]
    v_cvt_pk_bf16_f32 v198, v198, v199
    v_cvt_pk_bf16_f32 v199, v200, v201
    s_waitcnt lgkmcnt(4)
    v_mfma_f32_32x32x16_bf16 v[222:237], v[22:25], v[42:45], v[222:237]
    ds_read_b64_tr_b16 v[14:15], v3 offset:10240
    ds_read_b64_tr_b16 v[16:17], v3 offset:10752
    ds_read_b64_tr_b16 v[18:19], v4 offset:10240
    ds_read_b64_tr_b16 v[20:21], v4 offset:10752
    v_pk_mul_f32 v[202:203], v[202:203], s[96:97]
    v_pk_mul_f32 v[204:205], v[204:205], s[96:97]
    v_cvt_pk_bf16_f32 v200, v202, v203
    v_cvt_pk_bf16_f32 v201, v204, v205
    s_mul_i32 s42, s93, 4
    s_add_u32 s42, s42, s92
    s_nop 1
    v_mfma_f32_32x32x16_bf16 v[238:253], v[26:29], v[42:45], v[238:253]
    v_permlane32_swap_b32 v198, v200
    v_permlane32_swap_b32 v199, v201
    buffer_store_dwordx4 v[198:201], v2, s[88:91], s42 offen sc1
    s_waitcnt lgkmcnt(4)
    v_mfma_f32_32x32x16_bf16 v[222:237], v[6:9], v[46:49], v[222:237]
    ds_read_b64_tr_b16 v[22:23], v3 offset:12288
    ds_read_b64_tr_b16 v[24:25], v3 offset:12800
    ds_read_b64_tr_b16 v[26:27], v4 offset:12288
    ds_read_b64_tr_b16 v[28:29], v4 offset:12800
    v_pk_mul_f32 v[206:207], v[206:207], s[96:97]
    v_pk_mul_f32 v[208:209], v[208:209], s[96:97]
    v_cvt_pk_bf16_f32 v206, v206, v207
    v_cvt_pk_bf16_f32 v207, v208, v209
    s_mul_i32 s42, s93, 4
    s_add_u32 s42, s42, s92
    s_nop 1
    v_mfma_f32_32x32x16_bf16 v[238:253], v[10:13], v[46:49], v[238:253]
    v_mov_b32_dpp v208, v206 quad_perm:[1,1,3,3] row_mask:0xf bank_mask:0xf
    v_mov_b32_dpp v209, v207 quad_perm:[1,1,3,3] row_mask:0xf bank_mask:0xf
    s_mov_b64 exec, s[58:59]
    buffer_store_dwordx4 v[206:209], v254, s[88:91], s42 offen offset:1024 sc1
    s_mov_b64 exec, -1
    s_waitcnt lgkmcnt(4)
    v_mfma_f32_32x32x16_bf16 v[222:237], v[14:17], v[50:53], v[222:237]
    ds_read_b64_tr_b16 v[6:7], v3 offset:14336
    ds_read_b64_tr_b16 v[8:9], v3 offset:14848
    ds_read_b64_tr_b16 v[10:11], v4 offset:14336
    ds_read_b64_tr_b16 v[12:13], v4 offset:14848
    v_pk_mul_f32 v[210:211], v[210:211], s[96:97]
    v_pk_mul_f32 v[212:213], v[212:213], s[96:97]
    v_cvt_pk_bf16_f32 v210, v210, v211
    v_cvt_pk_bf16_f32 v211, v212, v213
    s_nop 1
    v_mfma_f32_32x32x16_bf16 v[238:253], v[18:21], v[50:53], v[238:253]
    v_pk_mul_f32 v[214:215], v[214:215], s[96:97]
    v_pk_mul_f32 v[216:217], v[216:217], s[96:97]
    v_cvt_pk_bf16_f32 v212, v214, v215
    v_cvt_pk_bf16_f32 v213, v216, v217
    s_mul_i32 s42, s93, 5
    s_add_u32 s42, s42, s92
    s_waitcnt lgkmcnt(4)
    v_mfma_f32_32x32x16_bf16 v[222:237], v[22:25], v[54:57], v[222:237]
    ds_read_b64_tr_b16 v[14:15], v3 offset:16384
    ds_read_b64_tr_b16 v[16:17], v3 offset:16896
    ds_read_b64_tr_b16 v[18:19], v4 offset:16384
    ds_read_b64_tr_b16 v[20:21], v4 offset:16896
    v_permlane32_swap_b32 v210, v212
    v_permlane32_swap_b32 v211, v213
    buffer_store_dwordx4 v[210:213], v2, s[88:91], s42 offen sc1
    s_nop 1
    v_mfma_f32_32x32x16_bf16 v[238:253], v[26:29], v[54:57], v[238:253]
    v_pk_mul_f32 v[218:219], v[218:219], s[96:97]
    v_pk_mul_f32 v[220:221], v[220:221], s[96:97]
    v_cvt_pk_bf16_f32 v218, v218, v219
    v_cvt_pk_bf16_f32 v219, v220, v221
    s_mul_i32 s42, s93, 6
    s_add_u32 s42, s42, s92
    s_waitcnt lgkmcnt(4)
    v_mfma_f32_32x32x16_bf16 v[222:237], v[6:9], v[58:61], v[222:237]
    ds_read_b64_tr_b16 v[22:23], v3 offset:18432
    ds_read_b64_tr_b16 v[24:25], v3 offset:18944
    ds_read_b64_tr_b16 v[26:27], v4 offset:18432
    ds_read_b64_tr_b16 v[28:29], v4 offset:18944
    v_permlane32_swap_b32 v218, v220
    v_permlane32_swap_b32 v219, v221
    s_mov_b32 exec_hi, 0
    buffer_store_dwordx4 v[218:221], v2, s[88:91], s42 offen offset:0 sc1
    s_mov_b32 exec_hi, -1
    s_nop 1
    v_mfma_f32_32x32x16_bf16 v[238:253], v[10:13], v[58:61], v[238:253]
    s_waitcnt lgkmcnt(4)
    v_mfma_f32_32x32x16_bf16 v[222:237], v[14:17], v[62:65], v[222:237]
    v_mfma_f32_32x32x16_bf16 v[238:253], v[18:21], v[62:65], v[238:253]
    s_barrier
    ds_read_b64_tr_b16 v[6:7], v3 offset:20480
    ds_read_b64_tr_b16 v[8:9], v3 offset:20992
    ds_read_b64_tr_b16 v[10:11], v4 offset:20480
    ds_read_b64_tr_b16 v[12:13], v4 offset:20992
    s_waitcnt lgkmcnt(4)
    v_mfma_f32_32x32x16_bf16 v[222:237], v[22:25], v[66:69], v[222:237]
    ds_read_b64_tr_b16 v[14:15], v3 offset:22528
    ds_read_b64_tr_b16 v[16:17], v3 offset:23040
    ds_read_b64_tr_b16 v[18:19], v4 offset:22528
    ds_read_b64_tr_b16 v[20:21], v4 offset:23040
    v_mfma_f32_32x32x16_bf16 v[238:253], v[26:29], v[66:69], v[238:253]
    s_waitcnt lgkmcnt(4)
    v_mfma_f32_32x32x16_bf16 v[222:237], v[6:9], v[70:73], v[222:237]
    ds_read_b64_tr_b16 v[22:23], v3 offset:24576
    ds_read_b64_tr_b16 v[24:25], v3 offset:25088
    ds_read_b64_tr_b16 v[26:27], v4 offset:24576
    ds_read_b64_tr_b16 v[28:29], v4 offset:25088
    v_mfma_f32_32x32x16_bf16 v[238:253], v[10:13], v[70:73], v[238:253]
    s_waitcnt lgkmcnt(4)
    v_mfma_f32_32x32x16_bf16 v[222:237], v[14:17], v[74:77], v[222:237]
    ds_read_b64_tr_b16 v[6:7], v3 offset:26624
    ds_read_b64_tr_b16 v[8:9], v3 offset:27136
    ds_read_b64_tr_b16 v[10:11], v4 offset:26624
    ds_read_b64_tr_b16 v[12:13], v4 offset:27136
    v_mfma_f32_32x32x16_bf16 v[238:253], v[18:21], v[74:77], v[238:253]
    s_waitcnt lgkmcnt(4)
    v_mfma_f32_32x32x16_bf16 v[222:237], v[22:25], v[78:81], v[222:237]
    ds_read_b64_tr_b16 v[14:15], v3 offset:28672
    ds_read_b64_tr_b16 v[16:17], v3 offset:29184
    ds_read_b64_tr_b16 v[18:19], v4 offset:28672
    ds_read_b64_tr_b16 v[20:21], v4 offset:29184
    v_mfma_f32_32x32x16_bf16 v[238:253], v[26:29], v[78:81], v[238:253]
    s_waitcnt lgkmcnt(4)
    v_mfma_f32_32x32x16_bf16 v[222:237], v[6:9], v[82:85], v[222:237]
    ds_read_b64_tr_b16 v[22:23], v3 offset:30720
    ds_read_b64_tr_b16 v[24:25], v3 offset:31232
    ds_read_b64_tr_b16 v[26:27], v4 offset:30720
    ds_read_b64_tr_b16 v[28:29], v4 offset:31232
    v_mfma_f32_32x32x16_bf16 v[238:253], v[10:13], v[82:85], v[238:253]
    s_waitcnt lgkmcnt(4)
    v_mfma_f32_32x32x16_bf16 v[222:237], v[14:17], v[86:89], v[222:237]
    ds_read_b64_tr_b16 v[6:7], v3 offset:32768
    ds_read_b64_tr_b16 v[8:9], v3 offset:33280
    ds_read_b64_tr_b16 v[10:11], v4 offset:32768
    ds_read_b64_tr_b16 v[12:13], v4 offset:33280
    v_mfma_f32_32x32x16_bf16 v[238:253], v[18:21], v[86:89], v[238:253]
    s_waitcnt lgkmcnt(4)
    v_mfma_f32_32x32x16_bf16 v[222:237], v[22:25], v[90:93], v[222:237]
    ds_read_b64_tr_b16 v[14:15], v3 offset:34816
    ds_read_b64_tr_b16 v[16:17], v3 offset:35328
    ds_read_b64_tr_b16 v[18:19], v4 offset:34816
    ds_read_b64_tr_b16 v[20:21], v4 offset:35328
    v_mfma_f32_32x32x16_bf16 v[238:253], v[26:29], v[90:93], v[238:253]
    s_waitcnt lgkmcnt(4)
    v_mfma_f32_32x32x16_bf16 v[222:237], v[6:9], v[94:97], v[222:237]
    ds_read_b64_tr_b16 v[22:23], v3 offset:36864
    ds_read_b64_tr_b16 v[24:25], v3 offset:37376
    ds_read_b64_tr_b16 v[26:27], v4 offset:36864
    ds_read_b64_tr_b16 v[28:29], v4 offset:37376
    v_mfma_f32_32x32x16_bf16 v[238:253], v[10:13], v[94:97], v[238:253]
    s_waitcnt lgkmcnt(4)
    v_mfma_f32_32x32x16_bf16 v[222:237], v[14:17], v[98:101], v[222:237]
    ds_read_b64_tr_b16 v[6:7], v3 offset:38912
    ds_read_b64_tr_b16 v[8:9], v3 offset:39424
    ds_read_b64_tr_b16 v[10:11], v4 offset:38912
    ds_read_b64_tr_b16 v[12:13], v4 offset:39424
    v_mfma_f32_32x32x16_bf16 v[238:253], v[18:21], v[98:101], v[238:253]
    s_waitcnt lgkmcnt(4)
    v_mfma_f32_32x32x16_bf16 v[222:237], v[22:25], v[102:105], v[222:237]
    v_mfma_f32_32x32x16_bf16 v[238:253], v[26:29], v[102:105], v[238:253]
    s_waitcnt vmcnt(0)
    s_barrier
    v_mov_b32 v254, 1
    buffer_store_dword v254, v255, s[48:51], s98 offen sc1
    ds_read_b64_tr_b16 v[14:15], v3 offset:40960
    ds_read_b64_tr_b16 v[16:17], v3 offset:41472
    ds_read_b64_tr_b16 v[18:19], v4 offset:40960
    ds_read_b64_tr_b16 v[20:21], v4 offset:41472
    s_waitcnt lgkmcnt(4)
    v_mfma_f32_32x32x16_bf16 v[222:237], v[6:9], v[106:109], v[222:237]
    ds_read_b64_tr_b16 v[22:23], v3 offset:43008
    ds_read_b64_tr_b16 v[24:25], v3 offset:43520
    ds_read_b64_tr_b16 v[26:27], v4 offset:43008
    ds_read_b64_tr_b16 v[28:29], v4 offset:43520
    v_mfma_f32_32x32x16_bf16 v[238:253], v[10:13], v[106:109], v[238:253]
    s_waitcnt lgkmcnt(4)
    v_mfma_f32_32x32x16_bf16 v[222:237], v[14:17], v[110:113], v[222:237]
    ds_read_b64_tr_b16 v[6:7], v3 offset:45056
    ds_read_b64_tr_b16 v[8:9], v3 offset:45568
    ds_read_b64_tr_b16 v[10:11], v4 offset:45056
    ds_read_b64_tr_b16 v[12:13], v4 offset:45568
    v_mfma_f32_32x32x16_bf16 v[238:253], v[18:21], v[110:113], v[238:253]
    s_waitcnt lgkmcnt(4)
    v_mfma_f32_32x32x16_bf16 v[222:237], v[22:25], v[114:117], v[222:237]
    ds_read_b64_tr_b16 v[14:15], v3 offset:47104
    ds_read_b64_tr_b16 v[16:17], v3 offset:47616
    ds_read_b64_tr_b16 v[18:19], v4 offset:47104
    ds_read_b64_tr_b16 v[20:21], v4 offset:47616
    v_mfma_f32_32x32x16_bf16 v[238:253], v[26:29], v[114:117], v[238:253]
    s_waitcnt lgkmcnt(4)
    v_mfma_f32_32x32x16_bf16 v[222:237], v[6:9], v[118:121], v[222:237]
    ds_read_b64_tr_b16 v[22:23], v3 offset:49152
    ds_read_b64_tr_b16 v[24:25], v3 offset:49664
    ds_read_b64_tr_b16 v[26:27], v4 offset:49152
    ds_read_b64_tr_b16 v[28:29], v4 offset:49664
    v_mfma_f32_32x32x16_bf16 v[238:253], v[10:13], v[118:121], v[238:253]
    s_waitcnt lgkmcnt(4)
    v_mfma_f32_32x32x16_bf16 v[222:237], v[14:17], v[122:125], v[222:237]
    ds_read_b64_tr_b16 v[6:7], v3 offset:51200
    ds_read_b64_tr_b16 v[8:9], v3 offset:51712
    ds_read_b64_tr_b16 v[10:11], v4 offset:51200
    ds_read_b64_tr_b16 v[12:13], v4 offset:51712
    v_mfma_f32_32x32x16_bf16 v[238:253], v[18:21], v[122:125], v[238:253]
    s_waitcnt lgkmcnt(4)
    v_mfma_f32_32x32x16_bf16 v[222:237], v[22:25], v[126:129], v[222:237]
    ds_read_b64_tr_b16 v[14:15], v3 offset:53248
    ds_read_b64_tr_b16 v[16:17], v3 offset:53760
    ds_read_b64_tr_b16 v[18:19], v4 offset:53248
    ds_read_b64_tr_b16 v[20:21], v4 offset:53760
    v_mfma_f32_32x32x16_bf16 v[238:253], v[26:29], v[126:129], v[238:253]
    s_waitcnt lgkmcnt(4)
    v_mfma_f32_32x32x16_bf16 v[222:237], v[6:9], v[130:133], v[222:237]
    ds_read_b64_tr_b16 v[22:23], v3 offset:55296
    ds_read_b64_tr_b16 v[24:25], v3 offset:55808
    ds_read_b64_tr_b16 v[26:27], v4 offset:55296
    ds_read_b64_tr_b16 v[28:29], v4 offset:55808
    v_mfma_f32_32x32x16_bf16 v[238:253], v[10:13], v[130:133], v[238:253]
    s_waitcnt lgkmcnt(4)
    v_mfma_f32_32x32x16_bf16 v[222:237], v[14:17], v[134:137], v[222:237]
    ds_read_b64_tr_b16 v[6:7], v3 offset:57344
    ds_read_b64_tr_b16 v[8:9], v3 offset:57856
    ds_read_b64_tr_b16 v[10:11], v4 offset:57344
    ds_read_b64_tr_b16 v[12:13], v4 offset:57856
    v_mfma_f32_32x32x16_bf16 v[238:253], v[18:21], v[134:137], v[238:253]
    s_waitcnt lgkmcnt(4)
    v_mfma_f32_32x32x16_bf16 v[222:237], v[22:25], v[138:141], v[222:237]
    ds_read_b64_tr_b16 v[14:15], v3 offset:59392
    ds_read_b64_tr_b16 v[16:17], v3 offset:59904
    ds_read_b64_tr_b16 v[18:19], v4 offset:59392
    ds_read_b64_tr_b16 v[20:21], v4 offset:59904
    v_mfma_f32_32x32x16_bf16 v[238:253], v[26:29], v[138:141], v[238:253]
    s_waitcnt lgkmcnt(4)
    v_mfma_f32_32x32x16_bf16 v[222:237], v[6:9], v[142:145], v[222:237]
    v_mfma_f32_32x32x16_bf16 v[238:253], v[10:13], v[142:145], v[238:253]
    s_barrier
    v_add_u32 v3, 61440, v3
    v_add_u32 v4, 61440, v4
    ds_read_b64_tr_b16 v[22:23], v3 offset:0
    ds_read_b64_tr_b16 v[24:25], v3 offset:512
    ds_read_b64_tr_b16 v[26:27], v4 offset:0
    ds_read_b64_tr_b16 v[28:29], v4 offset:512
    s_waitcnt lgkmcnt(4)
    v_mfma_f32_32x32x16_bf16 v[222:237], v[14:17], v[146:149], v[222:237]
    ds_read_b64_tr_b16 v[6:7], v3 offset:2048
    ds_read_b64_tr_b16 v[8:9], v3 offset:2560
    ds_read_b64_tr_b16 v[10:11], v4 offset:2048
    ds_read_b64_tr_b16 v[12:13], v4 offset:2560
    v_mfma_f32_32x32x16_bf16 v[238:253], v[18:21], v[146:149], v[238:253]
    s_waitcnt lgkmcnt(4)
    v_mfma_f32_32x32x16_bf16 v[222:237], v[22:25], v[150:153], v[222:237]
    ds_read_b64_tr_b16 v[14:15], v3 offset:4096
    ds_read_b64_tr_b16 v[16:17], v3 offset:4608
    ds_read_b64_tr_b16 v[18:19], v4 offset:4096
    ds_read_b64_tr_b16 v[20:21], v4 offset:4608
    v_mfma_f32_32x32x16_bf16 v[238:253], v[26:29], v[150:153], v[238:253]
    s_waitcnt lgkmcnt(4)
    v_mfma_f32_32x32x16_bf16 v[222:237], v[6:9], v[154:157], v[222:237]
    ds_read_b64_tr_b16 v[22:23], v3 offset:6144
    ds_read_b64_tr_b16 v[24:25], v3 offset:6656
    ds_read_b64_tr_b16 v[26:27], v4 offset:6144
    ds_read_b64_tr_b16 v[28:29], v4 offset:6656
    v_mfma_f32_32x32x16_bf16 v[238:253], v[10:13], v[154:157], v[238:253]
    s_waitcnt lgkmcnt(4)
    v_mfma_f32_32x32x16_bf16 v[222:237], v[14:17], v[158:161], v[222:237]
    ds_read_b64_tr_b16 v[6:7], v3 offset:8192
    ds_read_b64_tr_b16 v[8:9], v3 offset:8704
    ds_read_b64_tr_b16 v[10:11], v4 offset:8192
    ds_read_b64_tr_b16 v[12:13], v4 offset:8704
    v_mfma_f32_32x32x16_bf16 v[238:253], v[18:21], v[158:161], v[238:253]
    s_waitcnt lgkmcnt(4)
    v_mfma_f32_32x32x16_bf16 v[222:237], v[22:25], v[162:165], v[222:237]
    ds_read_b64_tr_b16 v[14:15], v3 offset:10240
    ds_read_b64_tr_b16 v[16:17], v3 offset:10752
    ds_read_b64_tr_b16 v[18:19], v4 offset:10240
    ds_read_b64_tr_b16 v[20:21], v4 offset:10752
    v_mfma_f32_32x32x16_bf16 v[238:253], v[26:29], v[162:165], v[238:253]
    s_waitcnt lgkmcnt(4)
    v_mfma_f32_32x32x16_bf16 v[222:237], v[6:9], v[166:169], v[222:237]
    ds_read_b64_tr_b16 v[22:23], v3 offset:12288
    ds_read_b64_tr_b16 v[24:25], v3 offset:12800
    ds_read_b64_tr_b16 v[26:27], v4 offset:12288
    ds_read_b64_tr_b16 v[28:29], v4 offset:12800
    v_mfma_f32_32x32x16_bf16 v[238:253], v[10:13], v[166:169], v[238:253]
    s_waitcnt lgkmcnt(4)
    v_mfma_f32_32x32x16_bf16 v[222:237], v[14:17], v[170:173], v[222:237]
    ds_read_b64_tr_b16 v[6:7], v3 offset:14336
    ds_read_b64_tr_b16 v[8:9], v3 offset:14848
    ds_read_b64_tr_b16 v[10:11], v4 offset:14336
    ds_read_b64_tr_b16 v[12:13], v4 offset:14848
    v_mfma_f32_32x32x16_bf16 v[238:253], v[18:21], v[170:173], v[238:253]
    s_waitcnt lgkmcnt(4)
    v_mfma_f32_32x32x16_bf16 v[222:237], v[22:25], v[174:177], v[222:237]
    ds_read_b64_tr_b16 v[14:15], v3 offset:16384
    ds_read_b64_tr_b16 v[16:17], v3 offset:16896
    ds_read_b64_tr_b16 v[18:19], v4 offset:16384
    ds_read_b64_tr_b16 v[20:21], v4 offset:16896
    v_mfma_f32_32x32x16_bf16 v[238:253], v[26:29], v[174:177], v[238:253]
    s_waitcnt lgkmcnt(4)
    v_mfma_f32_32x32x16_bf16 v[222:237], v[6:9], v[178:181], v[222:237]
    ds_read_b64_tr_b16 v[22:23], v3 offset:18432
    ds_read_b64_tr_b16 v[24:25], v3 offset:18944
    ds_read_b64_tr_b16 v[26:27], v4 offset:18432
    ds_read_b64_tr_b16 v[28:29], v4 offset:18944
    v_mfma_f32_32x32x16_bf16 v[238:253], v[10:13], v[178:181], v[238:253]
    s_waitcnt lgkmcnt(4)
    v_mfma_f32_32x32x16_bf16 v[222:237], v[14:17], v[182:185], v[222:237]
    v_mfma_f32_32x32x16_bf16 v[238:253], v[18:21], v[182:185], v[238:253]
    s_waitcnt lgkmcnt(0)
    s_barrier
    ds_read_b64_tr_b16 v[6:7], v5 offset:0
    ds_read_b64_tr_b16 v[8:9], v5 offset:256
    s_waitcnt lgkmcnt(2)
    v_mfma_f32_32x32x16_bf16 v[222:237], v[22:25], v[186:189], v[222:237]
    ds_read_b64_tr_b16 v[14:15], v5 offset:1024
    ds_read_b64_tr_b16 v[16:17], v5 offset:1280
    v_mfma_f32_32x32x16_bf16 v[238:253], v[26:29], v[186:189], v[238:253]
    s_waitcnt lgkmcnt(2)
    v_mfma_f32_32x32x16_bf16 v[190:205], v[6:9], v[30:33], 0
    ds_read_b64_tr_b16 v[22:23], v5 offset:2048
    ds_read_b64_tr_b16 v[24:25], v5 offset:2304
    s_waitcnt lgkmcnt(2)
    v_mfma_f32_32x32x16_bf16 v[190:205], v[14:17], v[34:37], v[190:205]
    ds_read_b64_tr_b16 v[6:7], v5 offset:3072
    ds_read_b64_tr_b16 v[8:9], v5 offset:3328
    s_waitcnt lgkmcnt(2)
    v_mfma_f32_32x32x16_bf16 v[190:205], v[22:25], v[38:41], v[190:205]
    ds_read_b64_tr_b16 v[14:15], v5 offset:4096
    ds_read_b64_tr_b16 v[16:17], v5 offset:4352
    v_cvt_pk_bf16_f32 v222, v222, v223
    v_cvt_pk_bf16_f32 v223, v224, v225
    v_cvt_pk_bf16_f32 v224, v226, v227
    v_cvt_pk_bf16_f32 v225, v228, v229
    s_waitcnt lgkmcnt(2)
    v_mfma_f32_32x32x16_bf16 v[190:205], v[6:9], v[42:45], v[190:205]
    ds_read_b64_tr_b16 v[22:23], v5 offset:5120
    ds_read_b64_tr_b16 v[24:25], v5 offset:5376
    v_pk_max_i16 v222, v222, 0
    v_pk_max_i16 v223, v223, 0
    v_pk_max_i16 v224, v224, 0
    v_pk_max_i16 v225, v225, 0
    s_waitcnt lgkmcnt(2)
    v_mfma_f32_32x32x16_bf16 v[190:205], v[14:17], v[46:49], v[190:205]
    ds_read_b64_tr_b16 v[6:7], v5 offset:6144
    ds_read_b64_tr_b16 v[8:9], v5 offset:6400
    v_cvt_pk_bf16_f32 v230, v230, v231
    v_cvt_pk_bf16_f32 v231, v232, v233
    v_cvt_pk_bf16_f32 v232, v234, v235
    v_cvt_pk_bf16_f32 v233, v236, v237
    s_waitcnt lgkmcnt(2)
    v_mfma_f32_32x32x16_bf16 v[190:205], v[22:25], v[50:53], v[190:205]
    ds_read_b64_tr_b16 v[14:15], v5 offset:7168
    ds_read_b64_tr_b16 v[16:17], v5 offset:7424
    v_pk_max_i16 v230, v230, 0
    v_pk_max_i16 v231, v231, 0
    v_pk_max_i16 v232, v232, 0
    v_pk_max_i16 v233, v233, 0
    s_waitcnt lgkmcnt(2)
    v_mfma_f32_32x32x16_bf16 v[190:205], v[6:9], v[54:57], v[190:205]
    ds_read_b64_tr_b16 v[22:23], v5 offset:8192
    ds_read_b64_tr_b16 v[24:25], v5 offset:8448
    v_cvt_pk_bf16_f32 v238, v238, v239
    v_cvt_pk_bf16_f32 v239, v240, v241
    v_cvt_pk_bf16_f32 v240, v242, v243
    v_cvt_pk_bf16_f32 v241, v244, v245
    s_waitcnt lgkmcnt(2)
    v_mfma_f32_32x32x16_bf16 v[190:205], v[14:17], v[58:61], v[190:205]
    ds_read_b64_tr_b16 v[6:7], v5 offset:9216
    ds_read_b64_tr_b16 v[8:9], v5 offset:9472
    v_pk_max_i16 v238, v238, 0
    v_pk_max_i16 v239, v239, 0
    v_pk_max_i16 v240, v240, 0
    v_pk_max_i16 v241, v241, 0
    s_waitcnt lgkmcnt(2)
    v_mfma_f32_32x32x16_bf16 v[190:205], v[22:25], v[62:65], v[190:205]
    ds_read_b64_tr_b16 v[14:15], v5 offset:10240
    ds_read_b64_tr_b16 v[16:17], v5 offset:10496
    v_cvt_pk_bf16_f32 v246, v246, v247
    v_cvt_pk_bf16_f32 v247, v248, v249
    v_cvt_pk_bf16_f32 v248, v250, v251
    v_cvt_pk_bf16_f32 v249, v252, v253
    s_waitcnt lgkmcnt(2)
    v_mfma_f32_32x32x16_bf16 v[190:205], v[6:9], v[66:69], v[190:205]
    ds_read_b64_tr_b16 v[22:23], v5 offset:11264
    ds_read_b64_tr_b16 v[24:25], v5 offset:11520
    v_pk_max_i16 v246, v246, 0
    v_pk_max_i16 v247, v247, 0
    v_pk_max_i16 v248, v248, 0
    v_pk_max_i16 v249, v249, 0
    s_waitcnt lgkmcnt(2)
    v_mfma_f32_32x32x16_bf16 v[190:205], v[14:17], v[70:73], v[190:205]
    ds_read_b64_tr_b16 v[6:7], v5 offset:12288
    ds_read_b64_tr_b16 v[8:9], v5 offset:12544
    s_waitcnt lgkmcnt(2)
    v_mfma_f32_32x32x16_bf16 v[190:205], v[22:25], v[74:77], v[190:205]
    ds_read_b64_tr_b16 v[14:15], v5 offset:13312
    ds_read_b64_tr_b16 v[16:17], v5 offset:13568
    s_waitcnt lgkmcnt(2)
    v_mfma_f32_32x32x16_bf16 v[190:205], v[6:9], v[78:81], v[190:205]
    ds_read_b64_tr_b16 v[22:23], v5 offset:14336
    ds_read_b64_tr_b16 v[24:25], v5 offset:14592
    s_waitcnt lgkmcnt(2)
    v_mfma_f32_32x32x16_bf16 v[190:205], v[14:17], v[82:85], v[190:205]
    ds_read_b64_tr_b16 v[6:7], v5 offset:15360
    ds_read_b64_tr_b16 v[8:9], v5 offset:15616
    s_waitcnt lgkmcnt(2)
    v_mfma_f32_32x32x16_bf16 v[190:205], v[22:25], v[86:89], v[190:205]
    ds_read_b64_tr_b16 v[14:15], v5 offset:16384
    ds_read_b64_tr_b16 v[16:17], v5 offset:16640
    s_waitcnt lgkmcnt(2)
    v_mfma_f32_32x32x16_bf16 v[190:205], v[6:9], v[90:93], v[190:205]
    ds_read_b64_tr_b16 v[22:23], v5 offset:17408
    ds_read_b64_tr_b16 v[24:25], v5 offset:17664
    s_waitcnt lgkmcnt(2)
    v_mfma_f32_32x32x16_bf16 v[190:205], v[14:17], v[94:97], v[190:205]
    ds_read_b64_tr_b16 v[6:7], v5 offset:18432
    ds_read_b64_tr_b16 v[8:9], v5 offset:18688
    s_waitcnt lgkmcnt(2)
    v_mfma_f32_32x32x16_bf16 v[190:205], v[22:25], v[98:101], v[190:205]
    ds_read_b64_tr_b16 v[14:15], v5 offset:19456
    ds_read_b64_tr_b16 v[16:17], v5 offset:19712
    s_waitcnt lgkmcnt(2)
    v_mfma_f32_32x32x16_bf16 v[190:205], v[6:9], v[102:105], v[190:205]
    ds_read_b64_tr_b16 v[22:23], v5 offset:20480
    ds_read_b64_tr_b16 v[24:25], v5 offset:20736
    s_waitcnt lgkmcnt(2)
    v_mfma_f32_32x32x16_bf16 v[190:205], v[14:17], v[106:109], v[190:205]
    ds_read_b64_tr_b16 v[6:7], v5 offset:21504
    ds_read_b64_tr_b16 v[8:9], v5 offset:21760
    s_waitcnt lgkmcnt(2)
    v_mfma_f32_32x32x16_bf16 v[190:205], v[22:25], v[110:113], v[190:205]
    ds_read_b64_tr_b16 v[14:15], v5 offset:22528
    ds_read_b64_tr_b16 v[16:17], v5 offset:22784
    s_waitcnt lgkmcnt(2)
    v_mfma_f32_32x32x16_bf16 v[190:205], v[6:9], v[114:117], v[190:205]
    ds_read_b64_tr_b16 v[22:23], v5 offset:23552
    ds_read_b64_tr_b16 v[24:25], v5 offset:23808
    s_waitcnt lgkmcnt(2)
    v_mfma_f32_32x32x16_bf16 v[190:205], v[14:17], v[118:121], v[190:205]
    ds_read_b64_tr_b16 v[6:7], v5 offset:24576
    ds_read_b64_tr_b16 v[8:9], v5 offset:24832
    s_waitcnt lgkmcnt(2)
    v_mfma_f32_32x32x16_bf16 v[190:205], v[22:25], v[122:125], v[190:205]
    ds_read_b64_tr_b16 v[14:15], v5 offset:25600
    ds_read_b64_tr_b16 v[16:17], v5 offset:25856
    s_waitcnt lgkmcnt(2)
    v_mfma_f32_32x32x16_bf16 v[190:205], v[6:9], v[126:129], v[190:205]
    ds_read_b64_tr_b16 v[22:23], v5 offset:26624
    ds_read_b64_tr_b16 v[24:25], v5 offset:26880
    s_waitcnt lgkmcnt(2)
    v_mfma_f32_32x32x16_bf16 v[190:205], v[14:17], v[130:133], v[190:205]
    ds_read_b64_tr_b16 v[6:7], v5 offset:27648
    ds_read_b64_tr_b16 v[8:9], v5 offset:27904
    s_waitcnt lgkmcnt(2)
    v_mfma_f32_32x32x16_bf16 v[190:205], v[22:25], v[134:137], v[190:205]
    ds_read_b64_tr_b16 v[14:15], v5 offset:28672
    ds_read_b64_tr_b16 v[16:17], v5 offset:28928
    s_waitcnt lgkmcnt(2)
    v_mfma_f32_32x32x16_bf16 v[190:205], v[6:9], v[138:141], v[190:205]
    ds_read_b64_tr_b16 v[22:23], v5 offset:29696
    ds_read_b64_tr_b16 v[24:25], v5 offset:29952
    s_waitcnt lgkmcnt(2)
    v_mfma_f32_32x32x16_bf16 v[190:205], v[14:17], v[142:145], v[190:205]
    ds_read_b64_tr_b16 v[6:7], v5 offset:30720
    ds_read_b64_tr_b16 v[8:9], v5 offset:30976
    s_waitcnt lgkmcnt(2)
    v_mfma_f32_32x32x16_bf16 v[190:205], v[22:25], v[146:149], v[190:205]
    ds_read_b64_tr_b16 v[14:15], v5 offset:31744
    ds_read_b64_tr_b16 v[16:17], v5 offset:32000
    s_waitcnt lgkmcnt(2)
    v_mfma_f32_32x32x16_bf16 v[190:205], v[6:9], v[150:153], v[190:205]
    ds_read_b64_tr_b16 v[22:23], v5 offset:32768
    ds_read_b64_tr_b16 v[24:25], v5 offset:33024
    s_waitcnt lgkmcnt(2)
    v_mfma_f32_32x32x16_bf16 v[190:205], v[14:17], v[154:157], v[190:205]
    ds_read_b64_tr_b16 v[6:7], v5 offset:33792
    ds_read_b64_tr_b16 v[8:9], v5 offset:34048
    s_waitcnt lgkmcnt(2)
    v_mfma_f32_32x32x16_bf16 v[190:205], v[22:25], v[158:161], v[190:205]
    ds_read_b64_tr_b16 v[14:15], v5 offset:34816
    ds_read_b64_tr_b16 v[16:17], v5 offset:35072
    s_waitcnt lgkmcnt(2)
    v_mfma_f32_32x32x16_bf16 v[190:205], v[6:9], v[162:165], v[190:205]
    ds_read_b64_tr_b16 v[22:23], v5 offset:35840
    ds_read_b64_tr_b16 v[24:25], v5 offset:36096
    s_waitcnt lgkmcnt(2)
    v_mfma_f32_32x32x16_bf16 v[190:205], v[14:17], v[166:169], v[190:205]
    ds_read_b64_tr_b16 v[6:7], v5 offset:36864
    ds_read_b64_tr_b16 v[8:9], v5 offset:37120
    s_waitcnt lgkmcnt(2)
    v_mfma_f32_32x32x16_bf16 v[190:205], v[22:25], v[170:173], v[190:205]
    ds_read_b64_tr_b16 v[14:15], v5 offset:37888
    ds_read_b64_tr_b16 v[16:17], v5 offset:38144
    s_waitcnt lgkmcnt(2)
    v_mfma_f32_32x32x16_bf16 v[190:205], v[6:9], v[174:177], v[190:205]
    ds_read_b64_tr_b16 v[22:23], v5 offset:38912
    ds_read_b64_tr_b16 v[24:25], v5 offset:39168
    s_waitcnt lgkmcnt(2)
    v_mfma_f32_32x32x16_bf16 v[190:205], v[14:17], v[178:181], v[190:205]
    ds_read_b64_tr_b16 v[6:7], v5 offset:39936
    ds_read_b64_tr_b16 v[8:9], v5 offset:40192
    s_waitcnt lgkmcnt(2)
    v_mfma_f32_32x32x16_bf16 v[190:205], v[22:25], v[182:185], v[190:205]
    s_waitcnt lgkmcnt(0)
    v_mfma_f32_32x32x16_bf16 v[190:205], v[6:9], v[186:189], v[190:205]
    s_nop 3
    s_movk_i32 s44, 0x400
    v_lshlrev_b32 v2, 4, v1
    v_mov_b32 v5, v2
    v_and_b32 v8, 31, v1
    v_lshrrev_b32 v9, 5, v1
    v_lshlrev_b32_e64 v11, 3, v8
    v_mul_u32_u24 v3, 2560, v9
    v_add3_u32 v3, v3, v11, s44
    v_mov_b32 v20, 0
    v_mov_b32 v21, 0
    v_mov_b32 v22, 0
    v_mov_b32 v23, 0
    v_mov_b32 v6, 0
    v_mov_b32 v7, 0
    v_mov_b32 v254, 0
    v_mov_b32 v255, 0
    v_lshrrev_b32 v4, 3, v8
    v_xor_b32 v4, v4, v9
    v_and_b32 v4, 1, v4
    v_lshlrev_b32 v4, 6, v4
    v_lshrrev_b32_e64 v10, 2, v8
    v_lshl_add_u32 v4, v10, 7, v4
    v_and_b32_e64 v10, 3, v8
    v_lshl_add_u32 v4, v10, 4, v4
    v_add_u32 v4, 1280, v4
    v_cmp_eq_u32_e64 vcc, 20, v8
    v_cmp_eq_u32 s[58:59], 24, v8
    s_mul_i32 s42, s74, 2560
    s_add_u32 s42, s42, 71680
    s_or_b64 vcc, vcc, s[58:59]
    v_mov_b32 v10, 0x3f803f80
    s_nop 1
    v_cndmask_b32 v10, 0, v10, vcc
    v_mov_b32 v30, v10
    v_mov_b32 v31, v10
    v_mov_b32 v32, v10
    v_mov_b32 v33, v10
    v_mov_b32 v34, v10
    v_mov_b32 v35, v10
    v_mov_b32 v36, v10
    v_mov_b32 v37, v10
    v_add_u32 v10, s42, v2
    v_add_u32_e64 v11, s42, v11
    s_nop 1
    s_add_u32 s101, s94, s101
    v_cvt_pk_bf16_f32 v190, v190, v191
    v_cvt_pk_bf16_f32 v191, v192, v193
    v_cvt_pk_bf16_f32 v192, v194, v195
    v_cvt_pk_bf16_f32 v193, v196, v197
    s_nop 1
    v_pk_max_i16 v190, v190, 0
    v_pk_max_i16 v191, v191, 0
    v_pk_max_i16 v192, v192, 0
    v_pk_max_i16 v193, v193, 0
    s_nop 1
    v_cvt_pk_bf16_f32 v198, v198, v199
    v_cvt_pk_bf16_f32 v199, v200, v201
    v_cvt_pk_bf16_f32 v200, v202, v203
    v_cvt_pk_bf16_f32 v201, v204, v205
    s_nop 1
    v_pk_max_i16 v198, v198, 0
    v_pk_max_i16 v199, v199, 0
    v_pk_max_i16 v200, v200, 0
    v_pk_max_i16 v201, v201, 0
    s_branch g_att1
g_cq1:
    s_waitcnt lgkmcnt(5)
    v_mfma_f32_32x32x16_bf16 v[222:237], v[6:9], v[174:177], v[222:237]
    ds_read_b128 v[182:185], v182 offset:0
    ds_read_b64_tr_b16 v[22:23], v3 offset:20480
    ds_read_b64_tr_b16 v[24:25], v3 offset:20992
    ds_read_b64_tr_b16 v[26:27], v4 offset:20480
    ds_read_b64_tr_b16 v[28:29], v4 offset:20992
    v_mfma_f32_32x32x16_bf16 v[238:253], v[10:13], v[174:177], v[238:253]
    s_waitcnt lgkmcnt(5)
    v_mfma_f32_32x32x16_bf16 v[222:237], v[14:17], v[178:181], v[222:237]
    ds_read_b128 v[186:189], v186 offset:0
    ds_read_b64_tr_b16 v[6:7], v3 offset:22528
    ds_read_b64_tr_b16 v[8:9], v3 offset:23040
    ds_read_b64_tr_b16 v[10:11], v4 offset:22528
    ds_read_b64_tr_b16 v[12:13], v4 offset:23040
    v_mfma_f32_32x32x16_bf16 v[238:253], v[18:21], v[178:181], v[238:253]
    s_waitcnt lgkmcnt(5)
    v_mfma_f32_32x32x16_bf16 v[222:237], v[22:25], v[182:185], v[222:237]
    ds_read_b64_tr_b16 v[14:15], v3 offset:24576
    ds_read_b64_tr_b16 v[16:17], v3 offset:25088
    ds_read_b64_tr_b16 v[18:19], v4 offset:24576
    ds_read_b64_tr_b16 v[20:21], v4 offset:25088
    v_mfma_f32_32x32x16_bf16 v[238:253], v[26:29], v[182:185], v[238:253]
    s_waitcnt lgkmcnt(4)
    v_mfma_f32_32x32x16_bf16 v[222:237], v[6:9], v[186:189], v[222:237]
    ds_read_b64_tr_b16 v[22:23], v3 offset:26624
    ds_read_b64_tr_b16 v[24:25], v3 offset:27136
    ds_read_b64_tr_b16 v[26:27], v4 offset:26624
    ds_read_b64_tr_b16 v[28:29], v4 offset:27136
    v_mfma_f32_32x32x16_bf16 v[238:253], v[10:13], v[186:189], v[238:253]
    s_waitcnt lgkmcnt(4)
    v_mfma_f32_32x32x16_bf16 v[190:205], v[14:17], v[174:177], v[190:205]
    ds_read_b64_tr_b16 v[6:7], v3 offset:28672
    ds_read_b64_tr_b16 v[8:9], v3 offset:29184
    ds_read_b64_tr_b16 v[10:11], v4 offset:28672
    ds_read_b64_tr_b16 v[12:13], v4 offset:29184
    v_mfma_f32_32x32x16_bf16 v[206:221], v[18:21], v[174:177], v[206:221]
    s_waitcnt lgkmcnt(4)
    v_mfma_f32_32x32x16_bf16 v[190:205], v[22:25], v[178:181], v[190:205]
    ds_read_b64_tr_b16 v[14:15], v3 offset:30720
    ds_read_b64_tr_b16 v[16:17], v3 offset:31232
    ds_read_b64_tr_b16 v[18:19], v4 offset:30720
    ds_read_b64_tr_b16 v[20:21], v4 offset:31232
    v_pk_mul_f32 v[222:223], v[222:223], s[96:97]
    v_pk_mul_f32 v[224:225], v[224:225], s[96:97]
    v_cvt_pk_bf16_f32 v222, v222, v223
    v_cvt_pk_bf16_f32 v223, v224, v225
    s_mul_i32 s42, s93, 6
    s_add_u32 s42, s42, s92
    s_nop 1
    v_mfma_f32_32x32x16_bf16 v[206:221], v[26:29], v[178:181], v[206:221]
    v_permlane32_swap_b32 v222, v224
    v_permlane32_swap_b32 v223, v225
    s_mov_b32 exec_hi, 0
    buffer_store_dwordx4 v[222:225], v2, s[88:91], s42 offen offset:512 sc1
    s_mov_b32 exec_hi, -1
    s_nop 1
    v_pk_mul_f32 v[226:227], v[226:227], s[96:97]
    v_pk_mul_f32 v[228:229], v[228:229], s[96:97]
    v_cvt_pk_bf16_f32 v226, v226, v227
    v_cvt_pk_bf16_f32 v227, v228, v229
    s_mul_i32 s42, s93, 6
    s_add_u32 s42, s42, s92
    s_waitcnt lgkmcnt(4)
    v_mfma_f32_32x32x16_bf16 v[190:205], v[6:9], v[182:185], v[190:205]
    v_mov_b32_dpp v228, v226 quad_perm:[1,1,3,3] row_mask:0xf bank_mask:0xf
    v_mov_b32_dpp v229, v227 quad_perm:[1,1,3,3] row_mask:0xf bank_mask:0xf
    s_mov_b64 exec, s[58:59]
    buffer_store_dwordx4 v[226:229], v254, s[88:91], s42 offen offset:1024 sc1
    s_mov_b64 exec, -1
    s_nop 1
    v_mfma_f32_32x32x16_bf16 v[206:221], v[10:13], v[182:185], v[206:221]
    v_pk_mul_f32 v[230:231], v[230:231], s[96:97]
    v_pk_mul_f32 v[232:233], v[232:233], s[96:97]
    v_cvt_pk_bf16_f32 v230, v230, v231
    v_cvt_pk_bf16_f32 v231, v232, v233
    s_nop 1
    s_barrier
    v_add_u32 v3, -131072, v3
    v_add_u32 v4, -131072, v4
    ds_read_b64_tr_b16 v[22:23], v3 offset:0
    ds_read_b64_tr_b16 v[24:25], v3 offset:512
    ds_read_b64_tr_b16 v[26:27], v4 offset:0
    ds_read_b64_tr_b16 v[28:29], v4 offset:512
    v_pk_mul_f32 v[234:235], v[234:235], s[96:97]
    v_pk_mul_f32 v[236:237], v[236:237], s[96:97]
    v_cvt_pk_bf16_f32 v232, v234, v235
    v_cvt_pk_bf16_f32 v233, v236, v237
    s_mul_i32 s42, s93, 7
    s_add_u32 s42, s42, s92
    s_waitcnt lgkmcnt(4)
    v_mfma_f32_32x32x16_bf16 v[190:205], v[14:17], v[186:189], v[190:205]
    ds_read_b64_tr_b16 v[6:7], v3 offset:2048
    ds_read_b64_tr_b16 v[8:9], v3 offset:2560
    ds_read_b64_tr_b16 v[10:11], v4 offset:2048
    ds_read_b64_tr_b16 v[12:13], v4 offset:2560
    v_permlane32_swap_b32 v230, v232
    v_permlane32_swap_b32 v231, v233
    buffer_store_dwordx4 v[230:233], v2, s[88:91], s42 offen sc1
    s_nop 1
    v_mfma_f32_32x32x16_bf16 v[206:221], v[18:21], v[186:189], v[206:221]
    v_pk_mul_f32 v[238:239], v[238:239], s[96:97]
    v_pk_mul_f32 v[240:241], v[240:241], s[96:97]
    v_cvt_pk_bf16_f32 v238, v238, v239
    v_cvt_pk_bf16_f32 v239, v240, v241
    s_nop 1
    v_pk_mul_f32 v[242:243], v[242:243], s[96:97]
    v_pk_mul_f32 v[244:245], v[244:245], s[96:97]
    v_cvt_pk_bf16_f32 v240, v242, v243
    v_cvt_pk_bf16_f32 v241, v244, v245
    s_mul_i32 s42, s93, 8
    s_add_u32 s42, s42, s92
    s_nop 1
    v_permlane32_swap_b32 v238, v240
    v_permlane32_swap_b32 v239, v241
    buffer_store_dwordx4 v[238:241], v2, s[88:91], s42 offen sc1
    s_nop 1
    v_pk_mul_f32 v[246:247], v[246:247], s[96:97]
    v_pk_mul_f32 v[248:249], v[248:249], s[96:97]
    v_cvt_pk_bf16_f32 v246, v246, v247
    v_cvt_pk_bf16_f32 v247, v248, v249
    s_mul_i32 s42, s93, 8
    s_add_u32 s42, s42, s92
    s_nop 1
    v_mov_b32_dpp v248, v246 quad_perm:[1,1,3,3] row_mask:0xf bank_mask:0xf
    v_mov_b32_dpp v249, v247 quad_perm:[1,1,3,3] row_mask:0xf bank_mask:0xf
    s_mov_b64 exec, s[58:59]
    buffer_store_dwordx4 v[246:249], v254, s[88:91], s42 offen offset:1024 sc1
    s_mov_b64 exec, -1
    s_nop 1
    v_pk_mul_f32 v[250:251], v[250:251], s[96:97]
    v_pk_mul_f32 v[252:253], v[252:253], s[96:97]
    v_cvt_pk_bf16_f32 v250, v250, v251
    v_cvt_pk_bf16_f32 v251, v252, v253
    s_mul_i32 s42, s93, 9
    s_add_u32 s42, s42, s92
    s_nop 1
    v_permlane32_swap_b32 v250, v252
    v_permlane32_swap_b32 v251, v253
    s_mov_b32 exec_hi, 0
    buffer_store_dwordx4 v[250:253], v2, s[88:91], s42 offen offset:0 sc1
    s_mov_b32 exec_hi, -1
    s_waitcnt lgkmcnt(4)
    v_mfma_f32_32x32x16_bf16 v[222:237], v[22:25], v[30:33], 0
    ds_read_b64_tr_b16 v[14:15], v3 offset:4096
    ds_read_b64_tr_b16 v[16:17], v3 offset:4608
    ds_read_b64_tr_b16 v[18:19], v4 offset:4096
    ds_read_b64_tr_b16 v[20:21], v4 offset:4608
    v_mfma_f32_32x32x16_bf16 v[238:253], v[26:29], v[30:33], 0
    s_waitcnt lgkmcnt(4)
    v_mfma_f32_32x32x16_bf16 v[222:237], v[6:9], v[34:37], v[222:237]
    ds_read_b64_tr_b16 v[22:23], v3 offset:6144
    ds_read_b64_tr_b16 v[24:25], v3 offset:6656
    ds_read_b64_tr_b16 v[26:27], v4 offset:6144
    ds_read_b64_tr_b16 v[28:29], v4 offset:6656
    v_pk_mul_f32 v[190:191], v[190:191], s[96:97]
    v_pk_mul_f32 v[192:193], v[192:193], s[96:97]
    v_cvt_pk_bf16_f32 v190, v190, v191
    v_cvt_pk_bf16_f32 v191, v192, v193
    s_mul_i32 s42, s93, 9
    s_add_u32 s42, s42, s92
    s_nop 1
    v_mfma_f32_32x32x16_bf16 v[238:253], v[10:13], v[34:37], v[238:253]
    v_permlane32_swap_b32 v190, v192
    v_permlane32_swap_b32 v191, v193
    s_mov_b32 exec_hi, 0
    buffer_store_dwordx4 v[190:193], v2, s[88:91], s42 offen offset:512 sc1
    s_mov_b32 exec_hi, -1
    s_waitcnt lgkmcnt(4)
    v_mfma_f32_32x32x16_bf16 v[222:237], v[14:17], v[38:41], v[222:237]
    ds_read_b64_tr_b16 v[6:7], v3 offset:8192
    ds_read_b64_tr_b16 v[8:9], v3 offset:8704
    ds_read_b64_tr_b16 v[10:11], v4 offset:8192
    ds_read_b64_tr_b16 v[12:13], v4 offset:8704
    v_pk_mul_f32 v[194:195], v[194:195], s[96:97]
    v_pk_mul_f32 v[196:197], v[196:197], s[96:97]
    v_cvt_pk_bf16_f32 v194, v194, v195
    v_cvt_pk_bf16_f32 v195, v196, v197
    s_nop 1
    v_mfma_f32_32x32x16_bf16 v[238:253], v[18:21], v[38:41], v[238:253]
    v_pk_mul_f32 v[198:199], v[198:199], s[96:97]
    v_pk_mul_f32 v[200:201], v[200:201], s[96:97]
    v_cvt_pk_bf16_f32 v196, v198, v199
    v_cvt_pk_bf16_f32 v197, v200, v201
    s_mul_i32 s42, s93, 10
    s_add_u32 s42, s42, s92
    s_waitcnt lgkmcnt(4)
    v_mfma_f32_32x32x16_bf16 v[222:237], v[22:25], v[42:45], v[222:237]
    ds_read_b64_tr_b16 v[14:15], v3 offset:10240
    ds_read_b64_tr_b16 v[16:17], v3 offset:10752
    ds_read_b64_tr_b16 v[18:19], v4 offset:10240
    ds_read_b64_tr_b16 v[20:21], v4 offset:10752
    v_permlane32_swap_b32 v194, v196
    v_permlane32_swap_b32 v195, v197
    buffer_store_dwordx4 v[194:197], v2, s[88:91], s42 offen sc1
    s_nop 1
    v_mfma_f32_32x32x16_bf16 v[238:253], v[26:29], v[42:45], v[238:253]
    v_pk_mul_f32 v[202:203], v[202:203], s[96:97]
    v_pk_mul_f32 v[204:205], v[204:205], s[96:97]
    v_cvt_pk_bf16_f32 v202, v202, v203
    v_cvt_pk_bf16_f32 v203, v204, v205
    s_mul_i32 s42, s93, 10
    s_add_u32 s42, s42, s92
    s_waitcnt lgkmcnt(4)
    v_mfma_f32_32x32x16_bf16 v[222:237], v[6:9], v[46:49], v[222:237]
    ds_read_b64_tr_b16 v[22:23], v3 offset:12288
    ds_read_b64_tr_b16 v[24:25], v3 offset:12800
    ds_read_b64_tr_b16 v[26:27], v4 offset:12288
    ds_read_b64_tr_b16 v[28:29], v4 offset:12800
    v_mov_b32_dpp v204, v202 quad_perm:[1,1,3,3] row_mask:0xf bank_mask:0xf
    v_mov_b32_dpp v205, v203 quad_perm:[1,1,3,3] row_mask:0xf bank_mask:0xf
    s_mov_b64 exec, s[58:59]
    buffer_store_dwordx4 v[202:205], v254, s[88:91], s42 offen offset:1024 sc1
    s_mov_b64 exec, -1
    s_nop 1
    v_mfma_f32_32x32x16_bf16 v[238:253], v[10:13], v[46:49], v[238:253]
    v_pk_mul_f32 v[206:207], v[206:207], s[96:97]
    v_pk_mul_f32 v[208:209], v[208:209], s[96:97]
    v_cvt_pk_bf16_f32 v206, v206, v207
    v_cvt_pk_bf16_f32 v207, v208, v209
    s_waitcnt lgkmcnt(4)
    v_mfma_f32_32x32x16_bf16 v[222:237], v[14:17], v[50:53], v[222:237]
    ds_read_b64_tr_b16 v[6:7], v3 offset:14336
    ds_read_b64_tr_b16 v[8:9], v3 offset:14848
    ds_read_b64_tr_b16 v[10:11], v4 offset:14336
    ds_read_b64_tr_b16 v[12:13], v4 offset:14848
    v_pk_mul_f32 v[210:211], v[210:211], s[96:97]
    v_pk_mul_f32 v[212:213], v[212:213], s[96:97]
    v_cvt_pk_bf16_f32 v208, v210, v211
    v_cvt_pk_bf16_f32 v209, v212, v213
    s_mul_i32 s42, s93, 11
    s_add_u32 s42, s42, s92
    s_nop 1
    v_mfma_f32_32x32x16_bf16 v[238:253], v[18:21], v[50:53], v[238:253]
    v_permlane32_swap_b32 v206, v208
    v_permlane32_swap_b32 v207, v209
    buffer_store_dwordx4 v[206:209], v2, s[88:91], s42 offen sc1
    s_waitcnt lgkmcnt(4)
    v_mfma_f32_32x32x16_bf16 v[222:237], v[22:25], v[54:57], v[222:237]
    ds_read_b64_tr_b16 v[14:15], v3 offset:16384
    ds_read_b64_tr_b16 v[16:17], v3 offset:16896
    ds_read_b64_tr_b16 v[18:19], v4 offset:16384
    ds_read_b64_tr_b16 v[20:21], v4 offset:16896
    v_pk_mul_f32 v[214:215], v[214:215], s[96:97]
    v_pk_mul_f32 v[216:217], v[216:217], s[96:97]
    v_cvt_pk_bf16_f32 v214, v214, v215
    v_cvt_pk_bf16_f32 v215, v216, v217
    s_nop 1
    v_mfma_f32_32x32x16_bf16 v[238:253], v[26:29], v[54:57], v[238:253]
    v_pk_mul_f32 v[218:219], v[218:219], s[96:97]
    v_pk_mul_f32 v[220:221], v[220:221], s[96:97]
    v_cvt_pk_bf16_f32 v216, v218, v219
    v_cvt_pk_bf16_f32 v217, v220, v221
    s_mul_i32 s42, s93, 12
    s_add_u32 s42, s42, s92
    s_waitcnt lgkmcnt(4)
    v_mfma_f32_32x32x16_bf16 v[222:237], v[6:9], v[58:61], v[222:237]
    ds_read_b64_tr_b16 v[22:23], v3 offset:18432
    ds_read_b64_tr_b16 v[24:25], v3 offset:18944
    ds_read_b64_tr_b16 v[26:27], v4 offset:18432
    ds_read_b64_tr_b16 v[28:29], v4 offset:18944
    v_permlane32_swap_b32 v214, v216
    v_permlane32_swap_b32 v215, v217
    buffer_store_dwordx4 v[214:217], v2, s[88:91], s42 offen sc1
    s_nop 1
    v_mfma_f32_32x32x16_bf16 v[238:253], v[10:13], v[58:61], v[238:253]
    s_waitcnt lgkmcnt(4)
    v_mfma_f32_32x32x16_bf16 v[222:237], v[14:17], v[62:65], v[222:237]
    v_mfma_f32_32x32x16_bf16 v[238:253], v[18:21], v[62:65], v[238:253]
    s_barrier
    ds_read_b64_tr_b16 v[6:7], v3 offset:20480
    ds_read_b64_tr_b16 v[8:9], v3 offset:20992
    ds_read_b64_tr_b16 v[10:11], v4 offset:20480
    ds_read_b64_tr_b16 v[12:13], v4 offset:20992
    s_waitcnt lgkmcnt(4)
    v_mfma_f32_32x32x16_bf16 v[222:237], v[22:25], v[66:69], v[222:237]
    ds_read_b64_tr_b16 v[14:15], v3 offset:22528
    ds_read_b64_tr_b16 v[16:17], v3 offset:23040
    ds_read_b64_tr_b16 v[18:19], v4 offset:22528
    ds_read_b64_tr_b16 v[20:21], v4 offset:23040
    v_mfma_f32_32x32x16_bf16 v[238:253], v[26:29], v[66:69], v[238:253]
    s_waitcnt lgkmcnt(4)
    v_mfma_f32_32x32x16_bf16 v[222:237], v[6:9], v[70:73], v[222:237]
    ds_read_b64_tr_b16 v[22:23], v3 offset:24576
    ds_read_b64_tr_b16 v[24:25], v3 offset:25088
    ds_read_b64_tr_b16 v[26:27], v4 offset:24576
    ds_read_b64_tr_b16 v[28:29], v4 offset:25088
    v_mfma_f32_32x32x16_bf16 v[238:253], v[10:13], v[70:73], v[238:253]
    s_waitcnt lgkmcnt(4)
    v_mfma_f32_32x32x16_bf16 v[222:237], v[14:17], v[74:77], v[222:237]
    ds_read_b64_tr_b16 v[6:7], v3 offset:26624
    ds_read_b64_tr_b16 v[8:9], v3 offset:27136
    ds_read_b64_tr_b16 v[10:11], v4 offset:26624
    ds_read_b64_tr_b16 v[12:13], v4 offset:27136
    v_mfma_f32_32x32x16_bf16 v[238:253], v[18:21], v[74:77], v[238:253]
    s_waitcnt lgkmcnt(4)
    v_mfma_f32_32x32x16_bf16 v[222:237], v[22:25], v[78:81], v[222:237]
    ds_read_b64_tr_b16 v[14:15], v3 offset:28672
    ds_read_b64_tr_b16 v[16:17], v3 offset:29184
    ds_read_b64_tr_b16 v[18:19], v4 offset:28672
    ds_read_b64_tr_b16 v[20:21], v4 offset:29184
    v_mfma_f32_32x32x16_bf16 v[238:253], v[26:29], v[78:81], v[238:253]
    s_waitcnt lgkmcnt(4)
    v_mfma_f32_32x32x16_bf16 v[222:237], v[6:9], v[82:85], v[222:237]
    ds_read_b64_tr_b16 v[22:23], v3 offset:30720
    ds_read_b64_tr_b16 v[24:25], v3 offset:31232
    ds_read_b64_tr_b16 v[26:27], v4 offset:30720
    ds_read_b64_tr_b16 v[28:29], v4 offset:31232
    v_mfma_f32_32x32x16_bf16 v[238:253], v[10:13], v[82:85], v[238:253]
    s_waitcnt lgkmcnt(4)
    v_mfma_f32_32x32x16_bf16 v[222:237], v[14:17], v[86:89], v[222:237]
    ds_read_b64_tr_b16 v[6:7], v3 offset:32768
    ds_read_b64_tr_b16 v[8:9], v3 offset:33280
    ds_read_b64_tr_b16 v[10:11], v4 offset:32768
    ds_read_b64_tr_b16 v[12:13], v4 offset:33280
    v_mfma_f32_32x32x16_bf16 v[238:253], v[18:21], v[86:89], v[238:253]
    s_waitcnt lgkmcnt(4)
    v_mfma_f32_32x32x16_bf16 v[222:237], v[22:25], v[90:93], v[222:237]
    ds_read_b64_tr_b16 v[14:15], v3 offset:34816
    ds_read_b64_tr_b16 v[16:17], v3 offset:35328
    ds_read_b64_tr_b16 v[18:19], v4 offset:34816
    ds_read_b64_tr_b16 v[20:21], v4 offset:35328
    v_mfma_f32_32x32x16_bf16 v[238:253], v[26:29], v[90:93], v[238:253]
    s_waitcnt lgkmcnt(4)
    v_mfma_f32_32x32x16_bf16 v[222:237], v[6:9], v[94:97], v[222:237]
    ds_read_b64_tr_b16 v[22:23], v3 offset:36864
    ds_read_b64_tr_b16 v[24:25], v3 offset:37376
    ds_read_b64_tr_b16 v[26:27], v4 offset:36864
    ds_read_b64_tr_b16 v[28:29], v4 offset:37376
    v_mfma_f32_32x32x16_bf16 v[238:253], v[10:13], v[94:97], v[238:253]
    s_waitcnt lgkmcnt(4)
    v_mfma_f32_32x32x16_bf16 v[222:237], v[14:17], v[98:101], v[222:237]
    ds_read_b64_tr_b16 v[6:7], v3 offset:38912
    ds_read_b64_tr_b16 v[8:9], v3 offset:39424
    ds_read_b64_tr_b16 v[10:11], v4 offset:38912
    ds_read_b64_tr_b16 v[12:13], v4 offset:39424
    v_mfma_f32_32x32x16_bf16 v[238:253], v[18:21], v[98:101], v[238:253]
    s_waitcnt lgkmcnt(4)
    v_mfma_f32_32x32x16_bf16 v[222:237], v[22:25], v[102:105], v[222:237]
    v_mfma_f32_32x32x16_bf16 v[238:253], v[26:29], v[102:105], v[238:253]
    s_waitcnt vmcnt(0)
    s_barrier
    v_mov_b32 v254, 1
    buffer_store_dword v254, v255, s[48:51], s98 offen sc1
    ds_read_b64_tr_b16 v[14:15], v3 offset:40960
    ds_read_b64_tr_b16 v[16:17], v3 offset:41472
    ds_read_b64_tr_b16 v[18:19], v4 offset:40960
    ds_read_b64_tr_b16 v[20:21], v4 offset:41472
    s_waitcnt lgkmcnt(4)
    v_mfma_f32_32x32x16_bf16 v[222:237], v[6:9], v[106:109], v[222:237]
    ds_read_b64_tr_b16 v[22:23], v3 offset:43008
    ds_read_b64_tr_b16 v[24:25], v3 offset:43520
    ds_read_b64_tr_b16 v[26:27], v4 offset:43008
    ds_read_b64_tr_b16 v[28:29], v4 offset:43520
    v_mfma_f32_32x32x16_bf16 v[238:253], v[10:13], v[106:109], v[238:253]
    s_waitcnt lgkmcnt(4)
    v_mfma_f32_32x32x16_bf16 v[222:237], v[14:17], v[110:113], v[222:237]
    ds_read_b64_tr_b16 v[6:7], v3 offset:45056
    ds_read_b64_tr_b16 v[8:9], v3 offset:45568
    ds_read_b64_tr_b16 v[10:11], v4 offset:45056
    ds_read_b64_tr_b16 v[12:13], v4 offset:45568
    v_mfma_f32_32x32x16_bf16 v[238:253], v[18:21], v[110:113], v[238:253]
    s_waitcnt lgkmcnt(4)
    v_mfma_f32_32x32x16_bf16 v[222:237], v[22:25], v[114:117], v[222:237]
    ds_read_b64_tr_b16 v[14:15], v3 offset:47104
    ds_read_b64_tr_b16 v[16:17], v3 offset:47616
    ds_read_b64_tr_b16 v[18:19], v4 offset:47104
    ds_read_b64_tr_b16 v[20:21], v4 offset:47616
    v_mfma_f32_32x32x16_bf16 v[238:253], v[26:29], v[114:117], v[238:253]
    s_waitcnt lgkmcnt(4)
    v_mfma_f32_32x32x16_bf16 v[222:237], v[6:9], v[118:121], v[222:237]
    ds_read_b64_tr_b16 v[22:23], v3 offset:49152
    ds_read_b64_tr_b16 v[24:25], v3 offset:49664
    ds_read_b64_tr_b16 v[26:27], v4 offset:49152
    ds_read_b64_tr_b16 v[28:29], v4 offset:49664
    v_mfma_f32_32x32x16_bf16 v[238:253], v[10:13], v[118:121], v[238:253]
    s_waitcnt lgkmcnt(4)
    v_mfma_f32_32x32x16_bf16 v[222:237], v[14:17], v[122:125], v[222:237]
    ds_read_b64_tr_b16 v[6:7], v3 offset:51200
    ds_read_b64_tr_b16 v[8:9], v3 offset:51712
    ds_read_b64_tr_b16 v[10:11], v4 offset:51200
    ds_read_b64_tr_b16 v[12:13], v4 offset:51712
    v_mfma_f32_32x32x16_bf16 v[238:253], v[18:21], v[122:125], v[238:253]
    s_waitcnt lgkmcnt(4)
    v_mfma_f32_32x32x16_bf16 v[222:237], v[22:25], v[126:129], v[222:237]
    ds_read_b64_tr_b16 v[14:15], v3 offset:53248
    ds_read_b64_tr_b16 v[16:17], v3 offset:53760
    ds_read_b64_tr_b16 v[18:19], v4 offset:53248
    ds_read_b64_tr_b16 v[20:21], v4 offset:53760
    v_mfma_f32_32x32x16_bf16 v[238:253], v[26:29], v[126:129], v[238:253]
    s_waitcnt lgkmcnt(4)
    v_mfma_f32_32x32x16_bf16 v[222:237], v[6:9], v[130:133], v[222:237]
    ds_read_b64_tr_b16 v[22:23], v3 offset:55296
    ds_read_b64_tr_b16 v[24:25], v3 offset:55808
    ds_read_b64_tr_b16 v[26:27], v4 offset:55296
    ds_read_b64_tr_b16 v[28:29], v4 offset:55808
    v_mfma_f32_32x32x16_bf16 v[238:253], v[10:13], v[130:133], v[238:253]
    s_waitcnt lgkmcnt(4)
    v_mfma_f32_32x32x16_bf16 v[222:237], v[14:17], v[134:137], v[222:237]
    ds_read_b64_tr_b16 v[6:7], v3 offset:57344
    ds_read_b64_tr_b16 v[8:9], v3 offset:57856
    ds_read_b64_tr_b16 v[10:11], v4 offset:57344
    ds_read_b64_tr_b16 v[12:13], v4 offset:57856
    v_mfma_f32_32x32x16_bf16 v[238:253], v[18:21], v[134:137], v[238:253]
    s_waitcnt lgkmcnt(4)
    v_mfma_f32_32x32x16_bf16 v[222:237], v[22:25], v[138:141], v[222:237]
    ds_read_b64_tr_b16 v[14:15], v3 offset:59392
    ds_read_b64_tr_b16 v[16:17], v3 offset:59904
    ds_read_b64_tr_b16 v[18:19], v4 offset:59392
    ds_read_b64_tr_b16 v[20:21], v4 offset:59904
    v_mfma_f32_32x32x16_bf16 v[238:253], v[26:29], v[138:141], v[238:253]
    s_waitcnt lgkmcnt(4)
    v_mfma_f32_32x32x16_bf16 v[222:237], v[6:9], v[142:145], v[222:237]
    v_mfma_f32_32x32x16_bf16 v[238:253], v[10:13], v[142:145], v[238:253]
    s_barrier
    v_add_u32 v3, 61440, v3
    v_add_u32 v4, 61440, v4
    ds_read_b64_tr_b16 v[22:23], v3 offset:0
    ds_read_b64_tr_b16 v[24:25], v3 offset:512
    ds_read_b64_tr_b16 v[26:27], v4 offset:0
    ds_read_b64_tr_b16 v[28:29], v4 offset:512
    s_waitcnt lgkmcnt(4)
    v_mfma_f32_32x32x16_bf16 v[222:237], v[14:17], v[146:149], v[222:237]
    ds_read_b64_tr_b16 v[6:7], v3 offset:2048
    ds_read_b64_tr_b16 v[8:9], v3 offset:2560
    ds_read_b64_tr_b16 v[10:11], v4 offset:2048
    ds_read_b64_tr_b16 v[12:13], v4 offset:2560
    v_mfma_f32_32x32x16_bf16 v[238:253], v[18:21], v[146:149], v[238:253]
    s_waitcnt lgkmcnt(4)
    v_mfma_f32_32x32x16_bf16 v[222:237], v[22:25], v[150:153], v[222:237]
    ds_read_b64_tr_b16 v[14:15], v3 offset:4096
    ds_read_b64_tr_b16 v[16:17], v3 offset:4608
    ds_read_b64_tr_b16 v[18:19], v4 offset:4096
    ds_read_b64_tr_b16 v[20:21], v4 offset:4608
    v_mfma_f32_32x32x16_bf16 v[238:253], v[26:29], v[150:153], v[238:253]
    s_waitcnt lgkmcnt(4)
    v_mfma_f32_32x32x16_bf16 v[222:237], v[6:9], v[154:157], v[222:237]
    ds_read_b64_tr_b16 v[22:23], v3 offset:6144
    ds_read_b64_tr_b16 v[24:25], v3 offset:6656
    ds_read_b64_tr_b16 v[26:27], v4 offset:6144
    ds_read_b64_tr_b16 v[28:29], v4 offset:6656
    v_mfma_f32_32x32x16_bf16 v[238:253], v[10:13], v[154:157], v[238:253]
    s_waitcnt lgkmcnt(4)
    v_mfma_f32_32x32x16_bf16 v[222:237], v[14:17], v[158:161], v[222:237]
    ds_read_b64_tr_b16 v[6:7], v3 offset:8192
    ds_read_b64_tr_b16 v[8:9], v3 offset:8704
    ds_read_b64_tr_b16 v[10:11], v4 offset:8192
    ds_read_b64_tr_b16 v[12:13], v4 offset:8704
    v_mfma_f32_32x32x16_bf16 v[238:253], v[18:21], v[158:161], v[238:253]
    s_waitcnt lgkmcnt(4)
    v_mfma_f32_32x32x16_bf16 v[222:237], v[22:25], v[162:165], v[222:237]
    ds_read_b64_tr_b16 v[14:15], v3 offset:10240
    ds_read_b64_tr_b16 v[16:17], v3 offset:10752
    ds_read_b64_tr_b16 v[18:19], v4 offset:10240
    ds_read_b64_tr_b16 v[20:21], v4 offset:10752
    v_mfma_f32_32x32x16_bf16 v[238:253], v[26:29], v[162:165], v[238:253]
    s_waitcnt lgkmcnt(4)
    v_mfma_f32_32x32x16_bf16 v[222:237], v[6:9], v[166:169], v[222:237]
    ds_read_b64_tr_b16 v[22:23], v3 offset:12288
    ds_read_b64_tr_b16 v[24:25], v3 offset:12800
    ds_read_b64_tr_b16 v[26:27], v4 offset:12288
    ds_read_b64_tr_b16 v[28:29], v4 offset:12800
    v_mfma_f32_32x32x16_bf16 v[238:253], v[10:13], v[166:169], v[238:253]
    s_waitcnt lgkmcnt(4)
    v_mfma_f32_32x32x16_bf16 v[222:237], v[14:17], v[170:173], v[222:237]
    ds_read_b64_tr_b16 v[6:7], v3 offset:14336
    ds_read_b64_tr_b16 v[8:9], v3 offset:14848
    ds_read_b64_tr_b16 v[10:11], v4 offset:14336
    ds_read_b64_tr_b16 v[12:13], v4 offset:14848
    v_mfma_f32_32x32x16_bf16 v[238:253], v[18:21], v[170:173], v[238:253]
    s_waitcnt lgkmcnt(4)
    v_mfma_f32_32x32x16_bf16 v[222:237], v[22:25], v[174:177], v[222:237]
    ds_read_b64_tr_b16 v[14:15], v3 offset:16384
    ds_read_b64_tr_b16 v[16:17], v3 offset:16896
    ds_read_b64_tr_b16 v[18:19], v4 offset:16384
    ds_read_b64_tr_b16 v[20:21], v4 offset:16896
    v_mfma_f32_32x32x16_bf16 v[238:253], v[26:29], v[174:177], v[238:253]
    s_waitcnt lgkmcnt(4)
    v_mfma_f32_32x32x16_bf16 v[222:237], v[6:9], v[178:181], v[222:237]
    ds_read_b64_tr_b16 v[22:23], v3 offset:18432
    ds_read_b64_tr_b16 v[24:25], v3 offset:18944
    ds_read_b64_tr_b16 v[26:27], v4 offset:18432
    ds_read_b64_tr_b16 v[28:29], v4 offset:18944
    v_mfma_f32_32x32x16_bf16 v[238:253], v[10:13], v[178:181], v[238:253]
    s_waitcnt lgkmcnt(4)
    v_mfma_f32_32x32x16_bf16 v[222:237], v[14:17], v[182:185], v[222:237]
    v_mfma_f32_32x32x16_bf16 v[238:253], v[18:21], v[182:185], v[238:253]
    s_waitcnt lgkmcnt(0)
    s_barrier
    ds_read_b64_tr_b16 v[6:7], v5 offset:0
    ds_read_b64_tr_b16 v[8:9], v5 offset:256
    s_waitcnt lgkmcnt(2)
    v_mfma_f32_32x32x16_bf16 v[222:237], v[22:25], v[186:189], v[222:237]
    ds_read_b64_tr_b16 v[14:15], v5 offset:1024
    ds_read_b64_tr_b16 v[16:17], v5 offset:1280
    v_mfma_f32_32x32x16_bf16 v[238:253], v[26:29], v[186:189], v[238:253]
    s_waitcnt lgkmcnt(2)
    v_mfma_f32_32x32x16_bf16 v[190:205], v[6:9], v[30:33], 0
    ds_read_b64_tr_b16 v[22:23], v5 offset:2048
    ds_read_b64_tr_b16 v[24:25], v5 offset:2304
    s_waitcnt lgkmcnt(2)
    v_mfma_f32_32x32x16_bf16 v[190:205], v[14:17], v[34:37], v[190:205]
    ds_read_b64_tr_b16 v[6:7], v5 offset:3072
    ds_read_b64_tr_b16 v[8:9], v5 offset:3328
    s_waitcnt lgkmcnt(2)
    v_mfma_f32_32x32x16_bf16 v[190:205], v[22:25], v[38:41], v[190:205]
    ds_read_b64_tr_b16 v[14:15], v5 offset:4096
    ds_read_b64_tr_b16 v[16:17], v5 offset:4352
    v_cvt_pk_bf16_f32 v222, v222, v223
    v_cvt_pk_bf16_f32 v223, v224, v225
    v_cvt_pk_bf16_f32 v224, v226, v227
    v_cvt_pk_bf16_f32 v225, v228, v229
    s_waitcnt lgkmcnt(2)
    v_mfma_f32_32x32x16_bf16 v[190:205], v[6:9], v[42:45], v[190:205]
    ds_read_b64_tr_b16 v[22:23], v5 offset:5120
    ds_read_b64_tr_b16 v[24:25], v5 offset:5376
    v_pk_max_i16 v222, v222, 0
    v_pk_max_i16 v223, v223, 0
    v_pk_max_i16 v224, v224, 0
    v_pk_max_i16 v225, v225, 0
    s_waitcnt lgkmcnt(2)
    v_mfma_f32_32x32x16_bf16 v[190:205], v[14:17], v[46:49], v[190:205]
    ds_read_b64_tr_b16 v[6:7], v5 offset:6144
    ds_read_b64_tr_b16 v[8:9], v5 offset:6400
    v_cvt_pk_bf16_f32 v230, v230, v231
    v_cvt_pk_bf16_f32 v231, v232, v233
    v_cvt_pk_bf16_f32 v232, v234, v235
    v_cvt_pk_bf16_f32 v233, v236, v237
    s_waitcnt lgkmcnt(2)
    v_mfma_f32_32x32x16_bf16 v[190:205], v[22:25], v[50:53], v[190:205]
    ds_read_b64_tr_b16 v[14:15], v5 offset:7168
    ds_read_b64_tr_b16 v[16:17], v5 offset:7424
    v_pk_max_i16 v230, v230, 0
    v_pk_max_i16 v231, v231, 0
    v_pk_max_i16 v232, v232, 0
    v_pk_max_i16 v233, v233, 0
    s_waitcnt lgkmcnt(2)
    v_mfma_f32_32x32x16_bf16 v[190:205], v[6:9], v[54:57], v[190:205]
    ds_read_b64_tr_b16 v[22:23], v5 offset:8192
    ds_read_b64_tr_b16 v[24:25], v5 offset:8448
    v_cvt_pk_bf16_f32 v238, v238, v239
    v_cvt_pk_bf16_f32 v239, v240, v241
    v_cvt_pk_bf16_f32 v240, v242, v243
    v_cvt_pk_bf16_f32 v241, v244, v245
    s_waitcnt lgkmcnt(2)
    v_mfma_f32_32x32x16_bf16 v[190:205], v[14:17], v[58:61], v[190:205]
    ds_read_b64_tr_b16 v[6:7], v5 offset:9216
    ds_read_b64_tr_b16 v[8:9], v5 offset:9472
    v_pk_max_i16 v238, v238, 0
    v_pk_max_i16 v239, v239, 0
    v_pk_max_i16 v240, v240, 0
    v_pk_max_i16 v241, v241, 0
    s_waitcnt lgkmcnt(2)
    v_mfma_f32_32x32x16_bf16 v[190:205], v[22:25], v[62:65], v[190:205]
    ds_read_b64_tr_b16 v[14:15], v5 offset:10240
    ds_read_b64_tr_b16 v[16:17], v5 offset:10496
    v_cvt_pk_bf16_f32 v246, v246, v247
    v_cvt_pk_bf16_f32 v247, v248, v249
    v_cvt_pk_bf16_f32 v248, v250, v251
    v_cvt_pk_bf16_f32 v249, v252, v253
    s_waitcnt lgkmcnt(2)
    v_mfma_f32_32x32x16_bf16 v[190:205], v[6:9], v[66:69], v[190:205]
    ds_read_b64_tr_b16 v[22:23], v5 offset:11264
    ds_read_b64_tr_b16 v[24:25], v5 offset:11520
    v_pk_max_i16 v246, v246, 0
    v_pk_max_i16 v247, v247, 0
    v_pk_max_i16 v248, v248, 0
    v_pk_max_i16 v249, v249, 0
    s_waitcnt lgkmcnt(2)
    v_mfma_f32_32x32x16_bf16 v[190:205], v[14:17], v[70:73], v[190:205]
    ds_read_b64_tr_b16 v[6:7], v5 offset:12288
    ds_read_b64_tr_b16 v[8:9], v5 offset:12544
    s_waitcnt lgkmcnt(2)
    v_mfma_f32_32x32x16_bf16 v[190:205], v[22:25], v[74:77], v[190:205]
    ds_read_b64_tr_b16 v[14:15], v5 offset:13312
    ds_read_b64_tr_b16 v[16:17], v5 offset:13568
    s_waitcnt lgkmcnt(2)
    v_mfma_f32_32x32x16_bf16 v[190:205], v[6:9], v[78:81], v[190:205]
    ds_read_b64_tr_b16 v[22:23], v5 offset:14336
    ds_read_b64_tr_b16 v[24:25], v5 offset:14592
    s_waitcnt lgkmcnt(2)
    v_mfma_f32_32x32x16_bf16 v[190:205], v[14:17], v[82:85], v[190:205]
    ds_read_b64_tr_b16 v[6:7], v5 offset:15360
    ds_read_b64_tr_b16 v[8:9], v5 offset:15616
    s_waitcnt lgkmcnt(2)
    v_mfma_f32_32x32x16_bf16 v[190:205], v[22:25], v[86:89], v[190:205]
    ds_read_b64_tr_b16 v[14:15], v5 offset:16384
    ds_read_b64_tr_b16 v[16:17], v5 offset:16640
    s_waitcnt lgkmcnt(2)
    v_mfma_f32_32x32x16_bf16 v[190:205], v[6:9], v[90:93], v[190:205]
    ds_read_b64_tr_b16 v[22:23], v5 offset:17408
    ds_read_b64_tr_b16 v[24:25], v5 offset:17664
    s_waitcnt lgkmcnt(2)
    v_mfma_f32_32x32x16_bf16 v[190:205], v[14:17], v[94:97], v[190:205]
    ds_read_b64_tr_b16 v[6:7], v5 offset:18432
    ds_read_b64_tr_b16 v[8:9], v5 offset:18688
    s_waitcnt lgkmcnt(2)
    v_mfma_f32_32x32x16_bf16 v[190:205], v[22:25], v[98:101], v[190:205]
    ds_read_b64_tr_b16 v[14:15], v5 offset:19456
    ds_read_b64_tr_b16 v[16:17], v5 offset:19712
    s_waitcnt lgkmcnt(2)
    v_mfma_f32_32x32x16_bf16 v[190:205], v[6:9], v[102:105], v[190:205]
    ds_read_b64_tr_b16 v[22:23], v5 offset:20480
    ds_read_b64_tr_b16 v[24:25], v5 offset:20736
    s_waitcnt lgkmcnt(2)
    v_mfma_f32_32x32x16_bf16 v[190:205], v[14:17], v[106:109], v[190:205]
    ds_read_b64_tr_b16 v[6:7], v5 offset:21504
    ds_read_b64_tr_b16 v[8:9], v5 offset:21760
    s_waitcnt lgkmcnt(2)
    v_mfma_f32_32x32x16_bf16 v[190:205], v[22:25], v[110:113], v[190:205]
    ds_read_b64_tr_b16 v[14:15], v5 offset:22528
    ds_read_b64_tr_b16 v[16:17], v5 offset:22784
    s_waitcnt lgkmcnt(2)
    v_mfma_f32_32x32x16_bf16 v[190:205], v[6:9], v[114:117], v[190:205]
    ds_read_b64_tr_b16 v[22:23], v5 offset:23552
    ds_read_b64_tr_b16 v[24:25], v5 offset:23808
    s_waitcnt lgkmcnt(2)
    v_mfma_f32_32x32x16_bf16 v[190:205], v[14:17], v[118:121], v[190:205]
    ds_read_b64_tr_b16 v[6:7], v5 offset:24576
    ds_read_b64_tr_b16 v[8:9], v5 offset:24832
    s_waitcnt lgkmcnt(2)
    v_mfma_f32_32x32x16_bf16 v[190:205], v[22:25], v[122:125], v[190:205]
    ds_read_b64_tr_b16 v[14:15], v5 offset:25600
    ds_read_b64_tr_b16 v[16:17], v5 offset:25856
    s_waitcnt lgkmcnt(2)
    v_mfma_f32_32x32x16_bf16 v[190:205], v[6:9], v[126:129], v[190:205]
    ds_read_b64_tr_b16 v[22:23], v5 offset:26624
    ds_read_b64_tr_b16 v[24:25], v5 offset:26880
    s_waitcnt lgkmcnt(2)
    v_mfma_f32_32x32x16_bf16 v[190:205], v[14:17], v[130:133], v[190:205]
    ds_read_b64_tr_b16 v[6:7], v5 offset:27648
    ds_read_b64_tr_b16 v[8:9], v5 offset:27904
    s_waitcnt lgkmcnt(2)
    v_mfma_f32_32x32x16_bf16 v[190:205], v[22:25], v[134:137], v[190:205]
    ds_read_b64_tr_b16 v[14:15], v5 offset:28672
    ds_read_b64_tr_b16 v[16:17], v5 offset:28928
    s_waitcnt lgkmcnt(2)
    v_mfma_f32_32x32x16_bf16 v[190:205], v[6:9], v[138:141], v[190:205]
    ds_read_b64_tr_b16 v[22:23], v5 offset:29696
    ds_read_b64_tr_b16 v[24:25], v5 offset:29952
    s_waitcnt lgkmcnt(2)
    v_mfma_f32_32x32x16_bf16 v[190:205], v[14:17], v[142:145], v[190:205]
    ds_read_b64_tr_b16 v[6:7], v5 offset:30720
    ds_read_b64_tr_b16 v[8:9], v5 offset:30976
    s_waitcnt lgkmcnt(2)
    v_mfma_f32_32x32x16_bf16 v[190:205], v[22:25], v[146:149], v[190:205]
    ds_read_b64_tr_b16 v[14:15], v5 offset:31744
    ds_read_b64_tr_b16 v[16:17], v5 offset:32000
    s_waitcnt lgkmcnt(2)
    v_mfma_f32_32x32x16_bf16 v[190:205], v[6:9], v[150:153], v[190:205]
    ds_read_b64_tr_b16 v[22:23], v5 offset:32768
    ds_read_b64_tr_b16 v[24:25], v5 offset:33024
    s_waitcnt lgkmcnt(2)
    v_mfma_f32_32x32x16_bf16 v[190:205], v[14:17], v[154:157], v[190:205]
    ds_read_b64_tr_b16 v[6:7], v5 offset:33792
    ds_read_b64_tr_b16 v[8:9], v5 offset:34048
    s_waitcnt lgkmcnt(2)
    v_mfma_f32_32x32x16_bf16 v[190:205], v[22:25], v[158:161], v[190:205]
    ds_read_b64_tr_b16 v[14:15], v5 offset:34816
    ds_read_b64_tr_b16 v[16:17], v5 offset:35072
    s_waitcnt lgkmcnt(2)
    v_mfma_f32_32x32x16_bf16 v[190:205], v[6:9], v[162:165], v[190:205]
    ds_read_b64_tr_b16 v[22:23], v5 offset:35840
    ds_read_b64_tr_b16 v[24:25], v5 offset:36096
    s_waitcnt lgkmcnt(2)
    v_mfma_f32_32x32x16_bf16 v[190:205], v[14:17], v[166:169], v[190:205]
    ds_read_b64_tr_b16 v[6:7], v5 offset:36864
    ds_read_b64_tr_b16 v[8:9], v5 offset:37120
    s_waitcnt lgkmcnt(2)
    v_mfma_f32_32x32x16_bf16 v[190:205], v[22:25], v[170:173], v[190:205]
    ds_read_b64_tr_b16 v[14:15], v5 offset:37888
    ds_read_b64_tr_b16 v[16:17], v5 offset:38144
    s_waitcnt lgkmcnt(2)
    v_mfma_f32_32x32x16_bf16 v[190:205], v[6:9], v[174:177], v[190:205]
    ds_read_b64_tr_b16 v[22:23], v5 offset:38912
    ds_read_b64_tr_b16 v[24:25], v5 offset:39168
    s_waitcnt lgkmcnt(2)
    v_mfma_f32_32x32x16_bf16 v[190:205], v[14:17], v[178:181], v[190:205]
    ds_read_b64_tr_b16 v[6:7], v5 offset:39936
    ds_read_b64_tr_b16 v[8:9], v5 offset:40192
    s_waitcnt lgkmcnt(2)
    v_mfma_f32_32x32x16_bf16 v[190:205], v[22:25], v[182:185], v[190:205]
    s_waitcnt lgkmcnt(0)
    v_mfma_f32_32x32x16_bf16 v[190:205], v[6:9], v[186:189], v[190:205]
    s_nop 3
    s_movk_i32 s44, 0x400
    v_lshlrev_b32 v2, 4, v1
    v_mov_b32 v5, v2
    v_and_b32 v8, 31, v1
    v_lshrrev_b32 v9, 5, v1
    v_lshlrev_b32_e64 v11, 3, v8
    v_mul_u32_u24 v3, 2560, v9
    v_add3_u32 v3, v3, v11, s44
    v_mov_b32 v20, 0
    v_mov_b32 v21, 0
    v_mov_b32 v22, 0
    v_mov_b32 v23, 0
    v_mov_b32 v6, 0
    v_mov_b32 v7, 0
    v_mov_b32 v254, 0
    v_mov_b32 v255, 0
    v_lshrrev_b32 v4, 3, v8
    v_xor_b32 v4, v4, v9
    v_and_b32 v4, 1, v4
    v_lshlrev_b32 v4, 6, v4
    v_lshrrev_b32_e64 v10, 2, v8
    v_lshl_add_u32 v4, v10, 7, v4
    v_and_b32_e64 v10, 3, v8
    v_lshl_add_u32 v4, v10, 4, v4
    v_add_u32 v4, 1280, v4
    v_cmp_eq_u32_e64 vcc, 20, v8
    v_cmp_eq_u32 s[58:59], 24, v8
    s_mul_i32 s42, s74, 2560
    s_add_u32 s42, s42, 71680
    s_or_b64 vcc, vcc, s[58:59]
    v_mov_b32 v10, 0x3f803f80
    s_nop 1
    v_cndmask_b32 v10, 0, v10, vcc
    v_mov_b32 v30, v10
    v_mov_b32 v31, v10
    v_mov_b32 v32, v10
    v_mov_b32 v33, v10
    v_mov_b32 v34, v10
    v_mov_b32 v35, v10
    v_mov_b32 v36, v10
    v_mov_b32 v37, v10
    v_add_u32 v10, s42, v2
    v_add_u32_e64 v11, s42, v11
    s_nop 1
    s_add_u32 s101, s94, s101
    v_cvt_pk_bf16_f32 v190, v190, v191
    v_cvt_pk_bf16_f32 v191, v192, v193
    v_cvt_pk_bf16_f32 v192, v194, v195
    v_cvt_pk_bf16_f32 v193, v196, v197
    s_nop 1
    v_pk_max_i16 v190, v190, 0
    v_pk_max_i16 v191, v191, 0
    v_pk_max_i16 v192, v192, 0
    v_pk_max_i16 v193, v193, 0
    s_nop 1
    v_cvt_pk_bf16_f32 v198, v198, v199
    v_cvt_pk_bf16_f32 v199, v200, v201
    v_cvt_pk_bf16_f32 v200, v202, v203
    v_cvt_pk_bf16_f32 v201, v204, v205
    s_nop 1
    v_pk_max_i16 v198, v198, 0
    v_pk_max_i16 v199, v199, 0
    v_pk_max_i16 v200, v200, 0
    v_pk_max_i16 v201, v201, 0
    s_branch g_att1
g_cq2:
    s_waitcnt lgkmcnt(5)
    v_mfma_f32_32x32x16_bf16 v[222:237], v[6:9], v[174:177], v[222:237]
    ds_read_b128 v[182:185], v182 offset:0
    ds_read_b64_tr_b16 v[22:23], v3 offset:20480
    ds_read_b64_tr_b16 v[24:25], v3 offset:20992
    ds_read_b64_tr_b16 v[26:27], v4 offset:20480
    ds_read_b64_tr_b16 v[28:29], v4 offset:20992
    v_mfma_f32_32x32x16_bf16 v[238:253], v[10:13], v[174:177], v[238:253]
    s_waitcnt lgkmcnt(5)
    v_mfma_f32_32x32x16_bf16 v[222:237], v[14:17], v[178:181], v[222:237]
    ds_read_b128 v[186:189], v186 offset:0
    ds_read_b64_tr_b16 v[6:7], v3 offset:22528
    ds_read_b64_tr_b16 v[8:9], v3 offset:23040
    ds_read_b64_tr_b16 v[10:11], v4 offset:22528
    ds_read_b64_tr_b16 v[12:13], v4 offset:23040
    v_mfma_f32_32x32x16_bf16 v[238:253], v[18:21], v[178:181], v[238:253]
    s_waitcnt lgkmcnt(5)
    v_mfma_f32_32x32x16_bf16 v[222:237], v[22:25], v[182:185], v[222:237]
    ds_read_b64_tr_b16 v[14:15], v3 offset:24576
    ds_read_b64_tr_b16 v[16:17], v3 offset:25088
    ds_read_b64_tr_b16 v[18:19], v4 offset:24576
    ds_read_b64_tr_b16 v[20:21], v4 offset:25088
    v_mfma_f32_32x32x16_bf16 v[238:253], v[26:29], v[182:185], v[238:253]
    s_waitcnt lgkmcnt(4)
    v_mfma_f32_32x32x16_bf16 v[222:237], v[6:9], v[186:189], v[222:237]
    ds_read_b64_tr_b16 v[22:23], v3 offset:26624
    ds_read_b64_tr_b16 v[24:25], v3 offset:27136
    ds_read_b64_tr_b16 v[26:27], v4 offset:26624
    ds_read_b64_tr_b16 v[28:29], v4 offset:27136
    v_mfma_f32_32x32x16_bf16 v[238:253], v[10:13], v[186:189], v[238:253]
    s_waitcnt lgkmcnt(4)
    v_mfma_f32_32x32x16_bf16 v[190:205], v[14:17], v[174:177], v[190:205]
    ds_read_b64_tr_b16 v[6:7], v3 offset:28672
    ds_read_b64_tr_b16 v[8:9], v3 offset:29184
    ds_read_b64_tr_b16 v[10:11], v4 offset:28672
    ds_read_b64_tr_b16 v[12:13], v4 offset:29184
    v_mfma_f32_32x32x16_bf16 v[206:221], v[18:21], v[174:177], v[206:221]
    s_waitcnt lgkmcnt(4)
    v_mfma_f32_32x32x16_bf16 v[190:205], v[22:25], v[178:181], v[190:205]
    ds_read_b64_tr_b16 v[14:15], v3 offset:30720
    ds_read_b64_tr_b16 v[16:17], v3 offset:31232
    ds_read_b64_tr_b16 v[18:19], v4 offset:30720
    ds_read_b64_tr_b16 v[20:21], v4 offset:31232
    v_pk_mul_f32 v[222:223], v[222:223], s[96:97]
    v_pk_mul_f32 v[224:225], v[224:225], s[96:97]
    v_cvt_pk_bf16_f32 v222, v222, v223
    v_cvt_pk_bf16_f32 v223, v224, v225
    s_mul_i32 s42, s93, 12
    s_add_u32 s42, s42, s92
    s_nop 1
    v_mfma_f32_32x32x16_bf16 v[206:221], v[26:29], v[178:181], v[206:221]
    v_mov_b32_dpp v224, v222 quad_perm:[1,1,3,3] row_mask:0xf bank_mask:0xf
    v_mov_b32_dpp v225, v223 quad_perm:[1,1,3,3] row_mask:0xf bank_mask:0xf
    s_mov_b64 exec, s[58:59]
    buffer_store_dwordx4 v[222:225], v254, s[88:91], s42 offen offset:1024 sc1
    s_mov_b64 exec, -1
    s_nop 1
    v_pk_mul_f32 v[226:227], v[226:227], s[96:97]
    v_pk_mul_f32 v[228:229], v[228:229], s[96:97]
    v_cvt_pk_bf16_f32 v226, v226, v227
    v_cvt_pk_bf16_f32 v227, v228, v229
    s_waitcnt lgkmcnt(4)
    v_mfma_f32_32x32x16_bf16 v[190:205], v[6:9], v[182:185], v[190:205]
    v_pk_mul_f32 v[230:231], v[230:231], s[96:97]
    v_pk_mul_f32 v[232:233], v[232:233], s[96:97]
    v_cvt_pk_bf16_f32 v228, v230, v231
    v_cvt_pk_bf16_f32 v229, v232, v233
    s_mul_i32 s42, s93, 13
    s_add_u32 s42, s42, s92
    s_nop 1
    v_mfma_f32_32x32x16_bf16 v[206:221], v[10:13], v[182:185], v[206:221]
    v_permlane32_swap_b32 v226, v228
    v_permlane32_swap_b32 v227, v229
    buffer_store_dwordx4 v[226:229], v2, s[88:91], s42 offen sc1
    s_nop 1
    s_barrier
    v_add_u32 v3, -131072, v3
    v_add_u32 v4, -131072, v4
    ds_read_b64_tr_b16 v[22:23], v3 offset:0
    ds_read_b64_tr_b16 v[24:25], v3 offset:512
    ds_read_b64_tr_b16 v[26:27], v4 offset:0
    ds_read_b64_tr_b16 v[28:29], v4 offset:512
    v_pk_mul_f32 v[234:235], v[234:235], s[96:97]
    v_pk_mul_f32 v[236:237], v[236:237], s[96:97]
    v_cvt_pk_bf16_f32 v234, v234, v235
    v_cvt_pk_bf16_f32 v235, v236, v237
    s_waitcnt lgkmcnt(4)
    v_mfma_f32_32x32x16_bf16 v[190:205], v[14:17], v[186:189], v[190:205]
    ds_read_b64_tr_b16 v[6:7], v3 offset:2048
    ds_read_b64_tr_b16 v[8:9], v3 offset:2560
    ds_read_b64_tr_b16 v[10:11], v4 offset:2048
    ds_read_b64_tr_b16 v[12:13], v4 offset:2560
    v_pk_mul_f32 v[238:239], v[238:239], s[96:97]
    v_pk_mul_f32 v[240:241], v[240:241], s[96:97]
    v_cvt_pk_bf16_f32 v236, v238, v239
    v_cvt_pk_bf16_f32 v237, v240, v241
    s_mul_i32 s42, s93, 14
    s_add_u32 s42, s42, s92
    s_nop 1
    v_mfma_f32_32x32x16_bf16 v[206:221], v[18:21], v[186:189], v[206:221]
    v_permlane32_swap_b32 v234, v236
    v_permlane32_swap_b32 v235, v237
    buffer_store_dwordx4 v[234:237], v2, s[88:91], s42 offen sc1
    s_nop 1
    v_pk_mul_f32 v[242:243], v[242:243], s[96:97]
    v_pk_mul_f32 v[244:245], v[244:245], s[96:97]
    v_cvt_pk_bf16_f32 v242, v242, v243
    v_cvt_pk_bf16_f32 v243, v244, v245
    s_mul_i32 s42, s93, 14
    s_add_u32 s42, s42, s92
    s_nop 1
    v_mov_b32_dpp v244, v242 quad_perm:[1,1,3,3] row_mask:0xf bank_mask:0xf
    v_mov_b32_dpp v245, v243 quad_perm:[1,1,3,3] row_mask:0xf bank_mask:0xf
    s_mov_b64 exec, s[58:59]
    buffer_store_dwordx4 v[242:245], v254, s[88:91], s42 offen offset:1024 sc1
    s_mov_b64 exec, -1
    s_nop 1
    v_pk_mul_f32 v[246:247], v[246:247], s[96:97]
    v_pk_mul_f32 v[248:249], v[248:249], s[96:97]
    v_cvt_pk_bf16_f32 v246, v246, v247
    v_cvt_pk_bf16_f32 v247, v248, v249
    s_nop 1
    v_pk_mul_f32 v[250:251], v[250:251], s[96:97]
    v_pk_mul_f32 v[252:253], v[252:253], s[96:97]
    v_cvt_pk_bf16_f32 v248, v250, v251
    v_cvt_pk_bf16_f32 v249, v252, v253
    s_mul_i32 s42, s93, 15
    s_add_u32 s42, s42, s92
    s_nop 1
    v_permlane32_swap_b32 v246, v248
    v_permlane32_swap_b32 v247, v249
    buffer_store_dwordx4 v[246:249], v2, s[88:91], s42 offen sc1
    s_waitcnt lgkmcnt(4)
    v_mfma_f32_32x32x16_bf16 v[222:237], v[22:25], v[30:33], 0
    ds_read_b64_tr_b16 v[14:15], v3 offset:4096
    ds_read_b64_tr_b16 v[16:17], v3 offset:4608
    ds_read_b64_tr_b16 v[18:19], v4 offset:4096
    ds_read_b64_tr_b16 v[20:21], v4 offset:4608
    v_mfma_f32_32x32x16_bf16 v[238:253], v[26:29], v[30:33], 0
    s_waitcnt lgkmcnt(4)
    v_mfma_f32_32x32x16_bf16 v[222:237], v[6:9], v[34:37], v[222:237]
    ds_read_b64_tr_b16 v[22:23], v3 offset:6144
    ds_read_b64_tr_b16 v[24:25], v3 offset:6656
    ds_read_b64_tr_b16 v[26:27], v4 offset:6144
    ds_read_b64_tr_b16 v[28:29], v4 offset:6656
    v_pk_mul_f32 v[190:191], v[190:191], s[96:97]
    v_pk_mul_f32 v[192:193], v[192:193], s[96:97]
    v_cvt_pk_bf16_f32 v190, v190, v191
    v_cvt_pk_bf16_f32 v191, v192, v193
    s_nop 1
    v_mfma_f32_32x32x16_bf16 v[238:253], v[10:13], v[34:37], v[238:253]
    v_pk_mul_f32 v[194:195], v[194:195], s[96:97]
    v_pk_mul_f32 v[196:197], v[196:197], s[96:97]
    v_cvt_pk_bf16_f32 v192, v194, v195
    v_cvt_pk_bf16_f32 v193, v196, v197
    s_mul_i32 s42, s93, 16
    s_add_u32 s42, s42, s92
    s_waitcnt lgkmcnt(4)
    v_mfma_f32_32x32x16_bf16 v[222:237], v[14:17], v[38:41], v[222:237]
    ds_read_b64_tr_b16 v[6:7], v3 offset:8192
    ds_read_b64_tr_b16 v[8:9], v3 offset:8704
    ds_read_b64_tr_b16 v[10:11], v4 offset:8192
    ds_read_b64_tr_b16 v[12:13], v4 offset:8704
    v_permlane32_swap_b32 v190, v192
    v_permlane32_swap_b32 v191, v193
    buffer_store_dwordx4 v[190:193], v2, s[88:91], s42 offen sc1
    s_nop 1
    v_mfma_f32_32x32x16_bf16 v[238:253], v[18:21], v[38:41], v[238:253]
    v_pk_mul_f32 v[198:199], v[198:199], s[96:97]
    v_pk_mul_f32 v[200:201], v[200:201], s[96:97]
    v_cvt_pk_bf16_f32 v198, v198, v199
    v_cvt_pk_bf16_f32 v199, v200, v201
    s_mul_i32 s42, s93, 16
    s_add_u32 s42, s42, s92
    s_waitcnt lgkmcnt(4)
    v_mfma_f32_32x32x16_bf16 v[222:237], v[22:25], v[42:45], v[222:237]
    ds_read_b64_tr_b16 v[14:15], v3 offset:10240
    ds_read_b64_tr_b16 v[16:17], v3 offset:10752
    ds_read_b64_tr_b16 v[18:19], v4 offset:10240
    ds_read_b64_tr_b16 v[20:21], v4 offset:10752
    v_mov_b32_dpp v200, v198 quad_perm:[1,1,3,3] row_mask:0xf bank_mask:0xf
    v_mov_b32_dpp v201, v199 quad_perm:[1,1,3,3] row_mask:0xf bank_mask:0xf
    s_mov_b64 exec, s[58:59]
    buffer_store_dwordx4 v[198:201], v254, s[88:91], s42 offen offset:1024 sc1
    s_mov_b64 exec, -1
    s_nop 1
    v_mfma_f32_32x32x16_bf16 v[238:253], v[26:29], v[42:45], v[238:253]
    v_pk_mul_f32 v[202:203], v[202:203], s[96:97]
    v_pk_mul_f32 v[204:205], v[204:205], s[96:97]
    v_cvt_pk_bf16_f32 v202, v202, v203
    v_cvt_pk_bf16_f32 v203, v204, v205
    s_waitcnt lgkmcnt(4)
    v_mfma_f32_32x32x16_bf16 v[222:237], v[6:9], v[46:49], v[222:237]
    ds_read_b64_tr_b16 v[22:23], v3 offset:12288
    ds_read_b64_tr_b16 v[24:25], v3 offset:12800
    ds_read_b64_tr_b16 v[26:27], v4 offset:12288
    ds_read_b64_tr_b16 v[28:29], v4 offset:12800
    v_pk_mul_f32 v[206:207], v[206:207], s[96:97]
    v_pk_mul_f32 v[208:209], v[208:209], s[96:97]
    v_cvt_pk_bf16_f32 v204, v206, v207
    v_cvt_pk_bf16_f32 v205, v208, v209
    s_mul_i32 s42, s93, 17
    s_add_u32 s42, s42, s92
    s_nop 1
    v_mfma_f32_32x32x16_bf16 v[238:253], v[10:13], v[46:49], v[238:253]
    v_permlane32_swap_b32 v202, v204
    v_permlane32_swap_b32 v203, v205
    buffer_store_dwordx4 v[202:205], v2, s[88:91], s42 offen sc1
    s_waitcnt lgkmcnt(4)
    v_mfma_f32_32x32x16_bf16 v[222:237], v[14:17], v[50:53], v[222:237]
    ds_read_b64_tr_b16 v[6:7], v3 offset:14336
    ds_read_b64_tr_b16 v[8:9], v3 offset:14848
    ds_read_b64_tr_b16 v[10:11], v4 offset:14336
    ds_read_b64_tr_b16 v[12:13], v4 offset:14848
    v_pk_mul_f32 v[210:211], v[210:211], s[96:97]
    v_pk_mul_f32 v[212:213], v[212:213], s[96:97]
    v_cvt_pk_bf16_f32 v210, v210, v211
    v_cvt_pk_bf16_f32 v211, v212, v213
    s_nop 1
    v_mfma_f32_32x32x16_bf16 v[238:253], v[18:21], v[50:53], v[238:253]
    v_pk_mul_f32 v[214:215], v[214:215], s[96:97]
    v_pk_mul_f32 v[216:217], v[216:217], s[96:97]
    v_cvt_pk_bf16_f32 v212, v214, v215
    v_cvt_pk_bf16_f32 v213, v216, v217
    s_mul_i32 s42, s93, 18
    s_add_u32 s42, s42, s92
    s_waitcnt lgkmcnt(4)
    v_mfma_f32_32x32x16_bf16 v[222:237], v[22:25], v[54:57], v[222:237]
    ds_read_b64_tr_b16 v[14:15], v3 offset:16384
    ds_read_b64_tr_b16 v[16:17], v3 offset:16896
    ds_read_b64_tr_b16 v[18:19], v4 offset:16384
    ds_read_b64_tr_b16 v[20:21], v4 offset:16896
    v_permlane32_swap_b32 v210, v212
    v_permlane32_swap_b32 v211, v213
    buffer_store_dwordx4 v[210:213], v2, s[88:91], s42 offen sc1
    s_nop 1
    v_mfma_f32_32x32x16_bf16 v[238:253], v[26:29], v[54:57], v[238:253]
    v_pk_mul_f32 v[218:219], v[218:219], s[96:97]
    v_pk_mul_f32 v[220:221], v[220:221], s[96:97]
    v_cvt_pk_bf16_f32 v218, v218, v219
    v_cvt_pk_bf16_f32 v219, v220, v221
    s_mul_i32 s42, s93, 18
    s_add_u32 s42, s42, s92
    s_waitcnt lgkmcnt(4)
    v_mfma_f32_32x32x16_bf16 v[222:237], v[6:9], v[58:61], v[222:237]
    ds_read_b64_tr_b16 v[22:23], v3 offset:18432
    ds_read_b64_tr_b16 v[24:25], v3 offset:18944
    ds_read_b64_tr_b16 v[26:27], v4 offset:18432
    ds_read_b64_tr_b16 v[28:29], v4 offset:18944
    v_mov_b32_dpp v220, v218 quad_perm:[1,1,3,3] row_mask:0xf bank_mask:0xf
    v_mov_b32_dpp v221, v219 quad_perm:[1,1,3,3] row_mask:0xf bank_mask:0xf
    s_mov_b64 exec, s[58:59]
    buffer_store_dwordx4 v[218:221], v254, s[88:91], s42 offen offset:1024 sc1
    s_mov_b64 exec, -1
    s_nop 1
    v_mfma_f32_32x32x16_bf16 v[238:253], v[10:13], v[58:61], v[238:253]
    s_waitcnt lgkmcnt(4)
    v_mfma_f32_32x32x16_bf16 v[222:237], v[14:17], v[62:65], v[222:237]
    v_mfma_f32_32x32x16_bf16 v[238:253], v[18:21], v[62:65], v[238:253]
    s_barrier
    ds_read_b64_tr_b16 v[6:7], v3 offset:20480
    ds_read_b64_tr_b16 v[8:9], v3 offset:20992
    ds_read_b64_tr_b16 v[10:11], v4 offset:20480
    ds_read_b64_tr_b16 v[12:13], v4 offset:20992
    s_waitcnt lgkmcnt(4)
    v_mfma_f32_32x32x16_bf16 v[222:237], v[22:25], v[66:69], v[222:237]
    ds_read_b64_tr_b16 v[14:15], v3 offset:22528
    ds_read_b64_tr_b16 v[16:17], v3 offset:23040
    ds_read_b64_tr_b16 v[18:19], v4 offset:22528
    ds_read_b64_tr_b16 v[20:21], v4 offset:23040
    v_mfma_f32_32x32x16_bf16 v[238:253], v[26:29], v[66:69], v[238:253]
    s_waitcnt lgkmcnt(4)
    v_mfma_f32_32x32x16_bf16 v[222:237], v[6:9], v[70:73], v[222:237]
    ds_read_b64_tr_b16 v[22:23], v3 offset:24576
    ds_read_b64_tr_b16 v[24:25], v3 offset:25088
    ds_read_b64_tr_b16 v[26:27], v4 offset:24576
    ds_read_b64_tr_b16 v[28:29], v4 offset:25088
    v_mfma_f32_32x32x16_bf16 v[238:253], v[10:13], v[70:73], v[238:253]
    s_waitcnt lgkmcnt(4)
    v_mfma_f32_32x32x16_bf16 v[222:237], v[14:17], v[74:77], v[222:237]
    ds_read_b64_tr_b16 v[6:7], v3 offset:26624
    ds_read_b64_tr_b16 v[8:9], v3 offset:27136
    ds_read_b64_tr_b16 v[10:11], v4 offset:26624
    ds_read_b64_tr_b16 v[12:13], v4 offset:27136
    v_mfma_f32_32x32x16_bf16 v[238:253], v[18:21], v[74:77], v[238:253]
    s_waitcnt lgkmcnt(4)
    v_mfma_f32_32x32x16_bf16 v[222:237], v[22:25], v[78:81], v[222:237]
    ds_read_b64_tr_b16 v[14:15], v3 offset:28672
    ds_read_b64_tr_b16 v[16:17], v3 offset:29184
    ds_read_b64_tr_b16 v[18:19], v4 offset:28672
    ds_read_b64_tr_b16 v[20:21], v4 offset:29184
    v_mfma_f32_32x32x16_bf16 v[238:253], v[26:29], v[78:81], v[238:253]
    s_waitcnt lgkmcnt(4)
    v_mfma_f32_32x32x16_bf16 v[222:237], v[6:9], v[82:85], v[222:237]
    ds_read_b64_tr_b16 v[22:23], v3 offset:30720
    ds_read_b64_tr_b16 v[24:25], v3 offset:31232
    ds_read_b64_tr_b16 v[26:27], v4 offset:30720
    ds_read_b64_tr_b16 v[28:29], v4 offset:31232
    v_mfma_f32_32x32x16_bf16 v[238:253], v[10:13], v[82:85], v[238:253]
    s_waitcnt lgkmcnt(4)
    v_mfma_f32_32x32x16_bf16 v[222:237], v[14:17], v[86:89], v[222:237]
    ds_read_b64_tr_b16 v[6:7], v3 offset:32768
    ds_read_b64_tr_b16 v[8:9], v3 offset:33280
    ds_read_b64_tr_b16 v[10:11], v4 offset:32768
    ds_read_b64_tr_b16 v[12:13], v4 offset:33280
    v_mfma_f32_32x32x16_bf16 v[238:253], v[18:21], v[86:89], v[238:253]
    s_waitcnt lgkmcnt(4)
    v_mfma_f32_32x32x16_bf16 v[222:237], v[22:25], v[90:93], v[222:237]
    ds_read_b64_tr_b16 v[14:15], v3 offset:34816
    ds_read_b64_tr_b16 v[16:17], v3 offset:35328
    ds_read_b64_tr_b16 v[18:19], v4 offset:34816
    ds_read_b64_tr_b16 v[20:21], v4 offset:35328
    v_mfma_f32_32x32x16_bf16 v[238:253], v[26:29], v[90:93], v[238:253]
    s_waitcnt lgkmcnt(4)
    v_mfma_f32_32x32x16_bf16 v[222:237], v[6:9], v[94:97], v[222:237]
    ds_read_b64_tr_b16 v[22:23], v3 offset:36864
    ds_read_b64_tr_b16 v[24:25], v3 offset:37376
    ds_read_b64_tr_b16 v[26:27], v4 offset:36864
    ds_read_b64_tr_b16 v[28:29], v4 offset:37376
    v_mfma_f32_32x32x16_bf16 v[238:253], v[10:13], v[94:97], v[238:253]
    s_waitcnt lgkmcnt(4)
    v_mfma_f32_32x32x16_bf16 v[222:237], v[14:17], v[98:101], v[222:237]
    ds_read_b64_tr_b16 v[6:7], v3 offset:38912
    ds_read_b64_tr_b16 v[8:9], v3 offset:39424
    ds_read_b64_tr_b16 v[10:11], v4 offset:38912
    ds_read_b64_tr_b16 v[12:13], v4 offset:39424
    v_mfma_f32_32x32x16_bf16 v[238:253], v[18:21], v[98:101], v[238:253]
    s_waitcnt lgkmcnt(4)
    v_mfma_f32_32x32x16_bf16 v[222:237], v[22:25], v[102:105], v[222:237]
    v_mfma_f32_32x32x16_bf16 v[238:253], v[26:29], v[102:105], v[238:253]
    s_waitcnt vmcnt(0)
    s_barrier
    v_mov_b32_e64 v254, 1
    buffer_store_dword v254, v255, s[48:51], s98 offen sc1
    ds_read_b64_tr_b16 v[14:15], v3 offset:40960
    ds_read_b64_tr_b16 v[16:17], v3 offset:41472
    ds_read_b64_tr_b16 v[18:19], v4 offset:40960
    ds_read_b64_tr_b16 v[20:21], v4 offset:41472
    s_waitcnt lgkmcnt(4)
    v_mfma_f32_32x32x16_bf16 v[222:237], v[6:9], v[106:109], v[222:237]
    ds_read_b64_tr_b16 v[22:23], v3 offset:43008
    ds_read_b64_tr_b16 v[24:25], v3 offset:43520
    ds_read_b64_tr_b16 v[26:27], v4 offset:43008
    ds_read_b64_tr_b16 v[28:29], v4 offset:43520
    v_mfma_f32_32x32x16_bf16 v[238:253], v[10:13], v[106:109], v[238:253]
    s_waitcnt lgkmcnt(4)
    v_mfma_f32_32x32x16_bf16 v[222:237], v[14:17], v[110:113], v[222:237]
    ds_read_b64_tr_b16 v[6:7], v3 offset:45056
    ds_read_b64_tr_b16 v[8:9], v3 offset:45568
    ds_read_b64_tr_b16 v[10:11], v4 offset:45056
    ds_read_b64_tr_b16 v[12:13], v4 offset:45568
    v_mfma_f32_32x32x16_bf16 v[238:253], v[18:21], v[110:113], v[238:253]
    s_waitcnt lgkmcnt(4)
    v_mfma_f32_32x32x16_bf16 v[222:237], v[22:25], v[114:117], v[222:237]
    ds_read_b64_tr_b16 v[14:15], v3 offset:47104
    ds_read_b64_tr_b16 v[16:17], v3 offset:47616
    ds_read_b64_tr_b16 v[18:19], v4 offset:47104
    ds_read_b64_tr_b16 v[20:21], v4 offset:47616
    v_mfma_f32_32x32x16_bf16 v[238:253], v[26:29], v[114:117], v[238:253]
    s_waitcnt lgkmcnt(4)
    v_mfma_f32_32x32x16_bf16 v[222:237], v[6:9], v[118:121], v[222:237]
    ds_read_b64_tr_b16 v[22:23], v3 offset:49152
    ds_read_b64_tr_b16 v[24:25], v3 offset:49664
    ds_read_b64_tr_b16 v[26:27], v4 offset:49152
    ds_read_b64_tr_b16 v[28:29], v4 offset:49664
    v_mfma_f32_32x32x16_bf16 v[238:253], v[10:13], v[118:121], v[238:253]
    s_waitcnt lgkmcnt(4)
    v_mfma_f32_32x32x16_bf16 v[222:237], v[14:17], v[122:125], v[222:237]
    ds_read_b64_tr_b16 v[6:7], v3 offset:51200
    ds_read_b64_tr_b16 v[8:9], v3 offset:51712
    ds_read_b64_tr_b16 v[10:11], v4 offset:51200
    ds_read_b64_tr_b16 v[12:13], v4 offset:51712
    v_mfma_f32_32x32x16_bf16 v[238:253], v[18:21], v[122:125], v[238:253]
    s_waitcnt lgkmcnt(4)
    v_mfma_f32_32x32x16_bf16 v[222:237], v[22:25], v[126:129], v[222:237]
    ds_read_b64_tr_b16 v[14:15], v3 offset:53248
    ds_read_b64_tr_b16 v[16:17], v3 offset:53760
    ds_read_b64_tr_b16 v[18:19], v4 offset:53248
    ds_read_b64_tr_b16 v[20:21], v4 offset:53760
    v_mfma_f32_32x32x16_bf16 v[238:253], v[26:29], v[126:129], v[238:253]
    s_waitcnt lgkmcnt(4)
    v_mfma_f32_32x32x16_bf16 v[222:237], v[6:9], v[130:133], v[222:237]
    ds_read_b64_tr_b16 v[22:23], v3 offset:55296
    ds_read_b64_tr_b16 v[24:25], v3 offset:55808
    ds_read_b64_tr_b16 v[26:27], v4 offset:55296
    ds_read_b64_tr_b16 v[28:29], v4 offset:55808
    v_mfma_f32_32x32x16_bf16 v[238:253], v[10:13], v[130:133], v[238:253]
    s_waitcnt lgkmcnt(4)
    v_mfma_f32_32x32x16_bf16 v[222:237], v[14:17], v[134:137], v[222:237]
    ds_read_b64_tr_b16 v[6:7], v3 offset:57344
    ds_read_b64_tr_b16 v[8:9], v3 offset:57856
    ds_read_b64_tr_b16 v[10:11], v4 offset:57344
    ds_read_b64_tr_b16 v[12:13], v4 offset:57856
    v_mfma_f32_32x32x16_bf16 v[238:253], v[18:21], v[134:137], v[238:253]
    s_waitcnt lgkmcnt(4)
    v_mfma_f32_32x32x16_bf16 v[222:237], v[22:25], v[138:141], v[222:237]
    ds_read_b64_tr_b16 v[14:15], v3 offset:59392
    ds_read_b64_tr_b16 v[16:17], v3 offset:59904
    ds_read_b64_tr_b16 v[18:19], v4 offset:59392
    ds_read_b64_tr_b16 v[20:21], v4 offset:59904
    v_mfma_f32_32x32x16_bf16 v[238:253], v[26:29], v[138:141], v[238:253]
    s_waitcnt lgkmcnt(4)
    v_mfma_f32_32x32x16_bf16 v[222:237], v[6:9], v[142:145], v[222:237]
    v_mfma_f32_32x32x16_bf16 v[238:253], v[10:13], v[142:145], v[238:253]
    s_barrier
    v_add_u32 v3, 61440, v3
    v_add_u32 v4, 61440, v4
    ds_read_b64_tr_b16 v[22:23], v3 offset:0
    ds_read_b64_tr_b16 v[24:25], v3 offset:512
    ds_read_b64_tr_b16 v[26:27], v4 offset:0
    ds_read_b64_tr_b16 v[28:29], v4 offset:512
    s_waitcnt lgkmcnt(4)
    v_mfma_f32_32x32x16_bf16 v[222:237], v[14:17], v[146:149], v[222:237]
    ds_read_b64_tr_b16 v[6:7], v3 offset:2048
    ds_read_b64_tr_b16 v[8:9], v3 offset:2560
    ds_read_b64_tr_b16 v[10:11], v4 offset:2048
    ds_read_b64_tr_b16 v[12:13], v4 offset:2560
    v_mfma_f32_32x32x16_bf16 v[238:253], v[18:21], v[146:149], v[238:253]
    s_waitcnt lgkmcnt(4)
    v_mfma_f32_32x32x16_bf16 v[222:237], v[22:25], v[150:153], v[222:237]
    ds_read_b64_tr_b16 v[14:15], v3 offset:4096
    ds_read_b64_tr_b16 v[16:17], v3 offset:4608
    ds_read_b64_tr_b16 v[18:19], v4 offset:4096
    ds_read_b64_tr_b16 v[20:21], v4 offset:4608
    v_mfma_f32_32x32x16_bf16 v[238:253], v[26:29], v[150:153], v[238:253]
    s_waitcnt lgkmcnt(4)
    v_mfma_f32_32x32x16_bf16 v[222:237], v[6:9], v[154:157], v[222:237]
    ds_read_b64_tr_b16 v[22:23], v3 offset:6144
    ds_read_b64_tr_b16 v[24:25], v3 offset:6656
    ds_read_b64_tr_b16 v[26:27], v4 offset:6144
    ds_read_b64_tr_b16 v[28:29], v4 offset:6656
    v_mfma_f32_32x32x16_bf16 v[238:253], v[10:13], v[154:157], v[238:253]
    s_waitcnt lgkmcnt(4)
    v_mfma_f32_32x32x16_bf16 v[222:237], v[14:17], v[158:161], v[222:237]
    ds_read_b64_tr_b16 v[6:7], v3 offset:8192
    ds_read_b64_tr_b16 v[8:9], v3 offset:8704
    ds_read_b64_tr_b16 v[10:11], v4 offset:8192
    ds_read_b64_tr_b16 v[12:13], v4 offset:8704
    v_mfma_f32_32x32x16_bf16 v[238:253], v[18:21], v[158:161], v[238:253]
    s_waitcnt lgkmcnt(4)
    v_mfma_f32_32x32x16_bf16 v[222:237], v[22:25], v[162:165], v[222:237]
    ds_read_b64_tr_b16 v[14:15], v3 offset:10240
    ds_read_b64_tr_b16 v[16:17], v3 offset:10752
    ds_read_b64_tr_b16 v[18:19], v4 offset:10240
    ds_read_b64_tr_b16 v[20:21], v4 offset:10752
    v_mfma_f32_32x32x16_bf16 v[238:253], v[26:29], v[162:165], v[238:253]
    s_waitcnt lgkmcnt(4)
    v_mfma_f32_32x32x16_bf16 v[222:237], v[6:9], v[166:169], v[222:237]
    ds_read_b64_tr_b16 v[22:23], v3 offset:12288
    ds_read_b64_tr_b16 v[24:25], v3 offset:12800
    ds_read_b64_tr_b16 v[26:27], v4 offset:12288
    ds_read_b64_tr_b16 v[28:29], v4 offset:12800
    v_mfma_f32_32x32x16_bf16 v[238:253], v[10:13], v[166:169], v[238:253]
    s_waitcnt lgkmcnt(4)
    v_mfma_f32_32x32x16_bf16 v[222:237], v[14:17], v[170:173], v[222:237]
    ds_read_b64_tr_b16 v[6:7], v3 offset:14336
    ds_read_b64_tr_b16 v[8:9], v3 offset:14848
    ds_read_b64_tr_b16 v[10:11], v4 offset:14336
    ds_read_b64_tr_b16 v[12:13], v4 offset:14848
    v_mfma_f32_32x32x16_bf16 v[238:253], v[18:21], v[170:173], v[238:253]
    s_waitcnt lgkmcnt(4)
    v_mfma_f32_32x32x16_bf16 v[222:237], v[22:25], v[174:177], v[222:237]
    ds_read_b64_tr_b16 v[14:15], v3 offset:16384
    ds_read_b64_tr_b16 v[16:17], v3 offset:16896
    ds_read_b64_tr_b16 v[18:19], v4 offset:16384
    ds_read_b64_tr_b16 v[20:21], v4 offset:16896
    v_mfma_f32_32x32x16_bf16 v[238:253], v[26:29], v[174:177], v[238:253]
    s_waitcnt lgkmcnt(4)
    v_mfma_f32_32x32x16_bf16 v[222:237], v[6:9], v[178:181], v[222:237]
    ds_read_b64_tr_b16 v[22:23], v3 offset:18432
    ds_read_b64_tr_b16 v[24:25], v3 offset:18944
    ds_read_b64_tr_b16 v[26:27], v4 offset:18432
    ds_read_b64_tr_b16 v[28:29], v4 offset:18944
    v_mfma_f32_32x32x16_bf16 v[238:253], v[10:13], v[178:181], v[238:253]
    s_waitcnt lgkmcnt(4)
    v_mfma_f32_32x32x16_bf16 v[222:237], v[14:17], v[182:185], v[222:237]
    v_mfma_f32_32x32x16_bf16 v[238:253], v[18:21], v[182:185], v[238:253]
    s_waitcnt lgkmcnt(0)
    s_barrier
    ds_read_b64_tr_b16 v[6:7], v5 offset:0
    ds_read_b64_tr_b16 v[8:9], v5 offset:256
    s_waitcnt lgkmcnt(2)
    v_mfma_f32_32x32x16_bf16 v[222:237], v[22:25], v[186:189], v[222:237]
    ds_read_b64_tr_b16 v[14:15], v5 offset:1024
    ds_read_b64_tr_b16 v[16:17], v5 offset:1280
    v_mfma_f32_32x32x16_bf16 v[238:253], v[26:29], v[186:189], v[238:253]
    s_waitcnt lgkmcnt(2)
    v_mfma_f32_32x32x16_bf16 v[190:205], v[6:9], v[30:33], 0
    ds_read_b64_tr_b16 v[22:23], v5 offset:2048
    ds_read_b64_tr_b16 v[24:25], v5 offset:2304
    s_waitcnt lgkmcnt(2)
    v_mfma_f32_32x32x16_bf16 v[190:205], v[14:17], v[34:37], v[190:205]
    ds_read_b64_tr_b16 v[6:7], v5 offset:3072
    ds_read_b64_tr_b16 v[8:9], v5 offset:3328
    s_waitcnt lgkmcnt(2)
    v_mfma_f32_32x32x16_bf16 v[190:205], v[22:25], v[38:41], v[190:205]
    ds_read_b64_tr_b16 v[14:15], v5 offset:4096
    ds_read_b64_tr_b16 v[16:17], v5 offset:4352
    v_cvt_pk_bf16_f32 v222, v222, v223
    v_cvt_pk_bf16_f32 v223, v224, v225
    v_cvt_pk_bf16_f32 v224, v226, v227
    v_cvt_pk_bf16_f32 v225, v228, v229
    s_waitcnt lgkmcnt(2)
    v_mfma_f32_32x32x16_bf16 v[190:205], v[6:9], v[42:45], v[190:205]
    ds_read_b64_tr_b16 v[22:23], v5 offset:5120
    ds_read_b64_tr_b16 v[24:25], v5 offset:5376
    v_pk_max_i16 v222, v222, 0
    v_pk_max_i16 v223, v223, 0
    v_pk_max_i16 v224, v224, 0
    v_pk_max_i16 v225, v225, 0
    s_waitcnt lgkmcnt(2)
    v_mfma_f32_32x32x16_bf16 v[190:205], v[14:17], v[46:49], v[190:205]
    ds_read_b64_tr_b16 v[6:7], v5 offset:6144
    ds_read_b64_tr_b16 v[8:9], v5 offset:6400
    v_cvt_pk_bf16_f32 v230, v230, v231
    v_cvt_pk_bf16_f32 v231, v232, v233
    v_cvt_pk_bf16_f32 v232, v234, v235
    v_cvt_pk_bf16_f32 v233, v236, v237
    s_waitcnt lgkmcnt(2)
    v_mfma_f32_32x32x16_bf16 v[190:205], v[22:25], v[50:53], v[190:205]
    ds_read_b64_tr_b16 v[14:15], v5 offset:7168
    ds_read_b64_tr_b16 v[16:17], v5 offset:7424
    v_pk_max_i16 v230, v230, 0
    v_pk_max_i16 v231, v231, 0
    v_pk_max_i16 v232, v232, 0
    v_pk_max_i16 v233, v233, 0
    s_waitcnt lgkmcnt(2)
    v_mfma_f32_32x32x16_bf16 v[190:205], v[6:9], v[54:57], v[190:205]
    ds_read_b64_tr_b16 v[22:23], v5 offset:8192
    ds_read_b64_tr_b16 v[24:25], v5 offset:8448
    v_cvt_pk_bf16_f32 v238, v238, v239
    v_cvt_pk_bf16_f32 v239, v240, v241
    v_cvt_pk_bf16_f32 v240, v242, v243
    v_cvt_pk_bf16_f32 v241, v244, v245
    s_waitcnt lgkmcnt(2)
    v_mfma_f32_32x32x16_bf16 v[190:205], v[14:17], v[58:61], v[190:205]
    ds_read_b64_tr_b16 v[6:7], v5 offset:9216
    ds_read_b64_tr_b16 v[8:9], v5 offset:9472
    v_pk_max_i16 v238, v238, 0
    v_pk_max_i16 v239, v239, 0
    v_pk_max_i16 v240, v240, 0
    v_pk_max_i16 v241, v241, 0
    s_waitcnt lgkmcnt(2)
    v_mfma_f32_32x32x16_bf16 v[190:205], v[22:25], v[62:65], v[190:205]
    ds_read_b64_tr_b16 v[14:15], v5 offset:10240
    ds_read_b64_tr_b16 v[16:17], v5 offset:10496
    v_cvt_pk_bf16_f32 v246, v246, v247
    v_cvt_pk_bf16_f32 v247, v248, v249
    v_cvt_pk_bf16_f32 v248, v250, v251
    v_cvt_pk_bf16_f32 v249, v252, v253
    s_waitcnt lgkmcnt(2)
    v_mfma_f32_32x32x16_bf16 v[190:205], v[6:9], v[66:69], v[190:205]
    ds_read_b64_tr_b16 v[22:23], v5 offset:11264
    ds_read_b64_tr_b16 v[24:25], v5 offset:11520
    v_pk_max_i16 v246, v246, 0
    v_pk_max_i16 v247, v247, 0
    v_pk_max_i16 v248, v248, 0
    v_pk_max_i16 v249, v249, 0
    s_waitcnt lgkmcnt(2)
    v_mfma_f32_32x32x16_bf16 v[190:205], v[14:17], v[70:73], v[190:205]
    ds_read_b64_tr_b16 v[6:7], v5 offset:12288
    ds_read_b64_tr_b16 v[8:9], v5 offset:12544
    s_waitcnt lgkmcnt(2)
    v_mfma_f32_32x32x16_bf16 v[190:205], v[22:25], v[74:77], v[190:205]
    ds_read_b64_tr_b16 v[14:15], v5 offset:13312
    ds_read_b64_tr_b16 v[16:17], v5 offset:13568
    s_waitcnt lgkmcnt(2)
    v_mfma_f32_32x32x16_bf16 v[190:205], v[6:9], v[78:81], v[190:205]
    ds_read_b64_tr_b16 v[22:23], v5 offset:14336
    ds_read_b64_tr_b16 v[24:25], v5 offset:14592
    s_waitcnt lgkmcnt(2)
    v_mfma_f32_32x32x16_bf16 v[190:205], v[14:17], v[82:85], v[190:205]
    ds_read_b64_tr_b16 v[6:7], v5 offset:15360
    ds_read_b64_tr_b16 v[8:9], v5 offset:15616
    s_waitcnt lgkmcnt(2)
    v_mfma_f32_32x32x16_bf16 v[190:205], v[22:25], v[86:89], v[190:205]
    ds_read_b64_tr_b16 v[14:15], v5 offset:16384
    ds_read_b64_tr_b16 v[16:17], v5 offset:16640
    s_waitcnt lgkmcnt(2)
    v_mfma_f32_32x32x16_bf16 v[190:205], v[6:9], v[90:93], v[190:205]
    ds_read_b64_tr_b16 v[22:23], v5 offset:17408
    ds_read_b64_tr_b16 v[24:25], v5 offset:17664
    s_waitcnt lgkmcnt(2)
    v_mfma_f32_32x32x16_bf16 v[190:205], v[14:17], v[94:97], v[190:205]
    ds_read_b64_tr_b16 v[6:7], v5 offset:18432
    ds_read_b64_tr_b16 v[8:9], v5 offset:18688
    s_waitcnt lgkmcnt(2)
    v_mfma_f32_32x32x16_bf16 v[190:205], v[22:25], v[98:101], v[190:205]
    ds_read_b64_tr_b16 v[14:15], v5 offset:19456
    ds_read_b64_tr_b16 v[16:17], v5 offset:19712
    s_waitcnt lgkmcnt(2)
    v_mfma_f32_32x32x16_bf16 v[190:205], v[6:9], v[102:105], v[190:205]
    ds_read_b64_tr_b16 v[22:23], v5 offset:20480
    ds_read_b64_tr_b16 v[24:25], v5 offset:20736
    s_waitcnt lgkmcnt(2)
    v_mfma_f32_32x32x16_bf16 v[190:205], v[14:17], v[106:109], v[190:205]
    ds_read_b64_tr_b16 v[6:7], v5 offset:21504
    ds_read_b64_tr_b16 v[8:9], v5 offset:21760
    s_waitcnt lgkmcnt(2)
    v_mfma_f32_32x32x16_bf16 v[190:205], v[22:25], v[110:113], v[190:205]
    ds_read_b64_tr_b16 v[14:15], v5 offset:22528
    ds_read_b64_tr_b16 v[16:17], v5 offset:22784
    s_waitcnt lgkmcnt(2)
    v_mfma_f32_32x32x16_bf16 v[190:205], v[6:9], v[114:117], v[190:205]
    ds_read_b64_tr_b16 v[22:23], v5 offset:23552
    ds_read_b64_tr_b16 v[24:25], v5 offset:23808
    s_waitcnt lgkmcnt(2)
    v_mfma_f32_32x32x16_bf16 v[190:205], v[14:17], v[118:121], v[190:205]
    ds_read_b64_tr_b16 v[6:7], v5 offset:24576
    ds_read_b64_tr_b16 v[8:9], v5 offset:24832
    s_waitcnt lgkmcnt(2)
    v_mfma_f32_32x32x16_bf16 v[190:205], v[22:25], v[122:125], v[190:205]
    ds_read_b64_tr_b16 v[14:15], v5 offset:25600
    ds_read_b64_tr_b16 v[16:17], v5 offset:25856
    s_waitcnt lgkmcnt(2)
    v_mfma_f32_32x32x16_bf16 v[190:205], v[6:9], v[126:129], v[190:205]
    ds_read_b64_tr_b16 v[22:23], v5 offset:26624
    ds_read_b64_tr_b16 v[24:25], v5 offset:26880
    s_waitcnt lgkmcnt(2)
    v_mfma_f32_32x32x16_bf16 v[190:205], v[14:17], v[130:133], v[190:205]
    ds_read_b64_tr_b16 v[6:7], v5 offset:27648
    ds_read_b64_tr_b16 v[8:9], v5 offset:27904
    s_waitcnt lgkmcnt(2)
    v_mfma_f32_32x32x16_bf16 v[190:205], v[22:25], v[134:137], v[190:205]
    ds_read_b64_tr_b16 v[14:15], v5 offset:28672
    ds_read_b64_tr_b16 v[16:17], v5 offset:28928
    s_waitcnt lgkmcnt(2)
    v_mfma_f32_32x32x16_bf16 v[190:205], v[6:9], v[138:141], v[190:205]
    ds_read_b64_tr_b16 v[22:23], v5 offset:29696
    ds_read_b64_tr_b16 v[24:25], v5 offset:29952
    s_waitcnt lgkmcnt(2)
    v_mfma_f32_32x32x16_bf16 v[190:205], v[14:17], v[142:145], v[190:205]
    ds_read_b64_tr_b16 v[6:7], v5 offset:30720
    ds_read_b64_tr_b16 v[8:9], v5 offset:30976
    s_waitcnt lgkmcnt(2)
    v_mfma_f32_32x32x16_bf16 v[190:205], v[22:25], v[146:149], v[190:205]
    ds_read_b64_tr_b16 v[14:15], v5 offset:31744
    ds_read_b64_tr_b16 v[16:17], v5 offset:32000
    s_waitcnt lgkmcnt(2)
    v_mfma_f32_32x32x16_bf16 v[190:205], v[6:9], v[150:153], v[190:205]
    ds_read_b64_tr_b16 v[22:23], v5 offset:32768
    ds_read_b64_tr_b16 v[24:25], v5 offset:33024
    s_waitcnt lgkmcnt(2)
    v_mfma_f32_32x32x16_bf16 v[190:205], v[14:17], v[154:157], v[190:205]
    ds_read_b64_tr_b16 v[6:7], v5 offset:33792
    ds_read_b64_tr_b16 v[8:9], v5 offset:34048
    s_waitcnt lgkmcnt(2)
    v_mfma_f32_32x32x16_bf16 v[190:205], v[22:25], v[158:161], v[190:205]
    ds_read_b64_tr_b16 v[14:15], v5 offset:34816
    ds_read_b64_tr_b16 v[16:17], v5 offset:35072
    s_waitcnt lgkmcnt(2)
    v_mfma_f32_32x32x16_bf16 v[190:205], v[6:9], v[162:165], v[190:205]
    ds_read_b64_tr_b16 v[22:23], v5 offset:35840
    ds_read_b64_tr_b16 v[24:25], v5 offset:36096
    s_waitcnt lgkmcnt(2)
    v_mfma_f32_32x32x16_bf16 v[190:205], v[14:17], v[166:169], v[190:205]
    ds_read_b64_tr_b16 v[6:7], v5 offset:36864
    ds_read_b64_tr_b16 v[8:9], v5 offset:37120
    s_waitcnt lgkmcnt(2)
    v_mfma_f32_32x32x16_bf16 v[190:205], v[22:25], v[170:173], v[190:205]
    ds_read_b64_tr_b16 v[14:15], v5 offset:37888
    ds_read_b64_tr_b16 v[16:17], v5 offset:38144
    s_waitcnt lgkmcnt(2)
    v_mfma_f32_32x32x16_bf16 v[190:205], v[6:9], v[174:177], v[190:205]
    ds_read_b64_tr_b16 v[22:23], v5 offset:38912
    ds_read_b64_tr_b16 v[24:25], v5 offset:39168
    s_waitcnt lgkmcnt(2)
    v_mfma_f32_32x32x16_bf16 v[190:205], v[14:17], v[178:181], v[190:205]
    ds_read_b64_tr_b16 v[6:7], v5 offset:39936
    ds_read_b64_tr_b16 v[8:9], v5 offset:40192
    s_waitcnt lgkmcnt(2)
    v_mfma_f32_32x32x16_bf16 v[190:205], v[22:25], v[182:185], v[190:205]
    s_waitcnt lgkmcnt(0)
    v_mfma_f32_32x32x16_bf16 v[190:205], v[6:9], v[186:189], v[190:205]
    s_nop 3
    s_movk_i32 s44, 0x400
    v_lshlrev_b32 v2, 4, v1
    v_mov_b32 v5, v2
    v_and_b32 v8, 31, v1
    v_lshrrev_b32 v9, 5, v1
    v_lshlrev_b32_e64 v11, 3, v8
    v_mul_u32_u24 v3, 2560, v9
    v_add3_u32 v3, v3, v11, s44
    v_mov_b32 v20, 0
    v_mov_b32 v21, 0
    v_mov_b32 v22, 0
    v_mov_b32 v23, 0
    v_mov_b32 v6, 0
    v_mov_b32 v7, 0
    v_mov_b32 v254, 0
    v_mov_b32 v255, 0
    v_lshrrev_b32 v4, 3, v8
    v_xor_b32 v4, v4, v9
    v_and_b32 v4, 1, v4
    v_lshlrev_b32 v4, 6, v4
    v_lshrrev_b32_e64 v10, 2, v8
    v_lshl_add_u32 v4, v10, 7, v4
    v_and_b32_e64 v10, 3, v8
    v_lshl_add_u32 v4, v10, 4, v4
    v_add_u32 v4, 1280, v4
    v_cmp_eq_u32_e64 vcc, 20, v8
    v_cmp_eq_u32 s[58:59], 24, v8
    s_mul_i32 s42, s74, 2560
    s_add_u32 s42, s42, 71680
    s_or_b64 vcc, vcc, s[58:59]
    v_mov_b32 v10, 0x3f803f80
    s_nop 1
    v_cndmask_b32 v10, 0, v10, vcc
    v_mov_b32 v30, v10
    v_mov_b32 v31, v10
    v_mov_b32 v32, v10
    v_mov_b32 v33, v10
    v_mov_b32 v34, v10
    v_mov_b32 v35, v10
    v_mov_b32 v36, v10
    v_mov_b32 v37, v10
    v_add_u32 v10, s42, v2
    v_add_u32_e64 v11, s42, v11
    s_nop 1
    s_add_u32 s101, s94, s101
    v_cvt_pk_bf16_f32 v190, v190, v191
    v_cvt_pk_bf16_f32 v191, v192, v193
    v_cvt_pk_bf16_f32 v192, v194, v195
    v_cvt_pk_bf16_f32 v193, v196, v197
    s_nop 1
    v_pk_max_i16 v190, v190, 0
    v_pk_max_i16 v191, v191, 0
    v_pk_max_i16 v192, v192, 0
    v_pk_max_i16 v193, v193, 0
    s_nop 1
    v_cvt_pk_bf16_f32 v198, v198, v199
    v_cvt_pk_bf16_f32 v199, v200, v201
    v_cvt_pk_bf16_f32 v200, v202, v203
    v_cvt_pk_bf16_f32 v201, v204, v205
    s_nop 1
    v_pk_max_i16 v198, v198, 0
    v_pk_max_i16 v199, v199, 0
    v_pk_max_i16 v200, v200, 0
    v_pk_max_i16 v201, v201, 0
    s_branch g_att1
g_cq3:
    s_waitcnt lgkmcnt(5)
    v_mfma_f32_32x32x16_bf16 v[222:237], v[6:9], v[174:177], v[222:237]
    ds_read_b128 v[182:185], v182 offset:0
    ds_read_b64_tr_b16 v[22:23], v3 offset:20480
    ds_read_b64_tr_b16 v[24:25], v3 offset:20992
    ds_read_b64_tr_b16 v[26:27], v4 offset:20480
    ds_read_b64_tr_b16 v[28:29], v4 offset:20992
    v_mfma_f32_32x32x16_bf16 v[238:253], v[10:13], v[174:177], v[238:253]
    s_waitcnt lgkmcnt(5)
    v_mfma_f32_32x32x16_bf16 v[222:237], v[14:17], v[178:181], v[222:237]
    ds_read_b128 v[186:189], v186 offset:0
    ds_read_b64_tr_b16 v[6:7], v3 offset:22528
    ds_read_b64_tr_b16 v[8:9], v3 offset:23040
    ds_read_b64_tr_b16 v[10:11], v4 offset:22528
    ds_read_b64_tr_b16 v[12:13], v4 offset:23040
    v_mfma_f32_32x32x16_bf16 v[238:253], v[18:21], v[178:181], v[238:253]
    s_waitcnt lgkmcnt(5)
    v_mfma_f32_32x32x16_bf16 v[222:237], v[22:25], v[182:185], v[222:237]
    ds_read_b64_tr_b16 v[14:15], v3 offset:24576
    ds_read_b64_tr_b16 v[16:17], v3 offset:25088
    ds_read_b64_tr_b16 v[18:19], v4 offset:24576
    ds_read_b64_tr_b16 v[20:21], v4 offset:25088
    v_mfma_f32_32x32x16_bf16 v[238:253], v[26:29], v[182:185], v[238:253]
    s_waitcnt lgkmcnt(4)
    v_mfma_f32_32x32x16_bf16 v[222:237], v[6:9], v[186:189], v[222:237]
    ds_read_b64_tr_b16 v[22:23], v3 offset:26624
    ds_read_b64_tr_b16 v[24:25], v3 offset:27136
    ds_read_b64_tr_b16 v[26:27], v4 offset:26624
    ds_read_b64_tr_b16 v[28:29], v4 offset:27136
    v_mfma_f32_32x32x16_bf16 v[238:253], v[10:13], v[186:189], v[238:253]
    s_waitcnt lgkmcnt(4)
    v_mfma_f32_32x32x16_bf16 v[190:205], v[14:17], v[174:177], v[190:205]
    ds_read_b64_tr_b16 v[6:7], v3 offset:28672
    ds_read_b64_tr_b16 v[8:9], v3 offset:29184
    ds_read_b64_tr_b16 v[10:11], v4 offset:28672
    ds_read_b64_tr_b16 v[12:13], v4 offset:29184
    v_mfma_f32_32x32x16_bf16 v[206:221], v[18:21], v[174:177], v[206:221]
    s_waitcnt lgkmcnt(4)
    v_mfma_f32_32x32x16_bf16 v[190:205], v[22:25], v[178:181], v[190:205]
    ds_read_b64_tr_b16 v[14:15], v3 offset:30720
    ds_read_b64_tr_b16 v[16:17], v3 offset:31232
    ds_read_b64_tr_b16 v[18:19], v4 offset:30720
    ds_read_b64_tr_b16 v[20:21], v4 offset:31232
    v_pk_mul_f32 v[222:223], v[222:223], s[96:97]
    v_pk_mul_f32 v[224:225], v[224:225], s[96:97]
    v_cvt_pk_bf16_f32 v222, v222, v223
    v_cvt_pk_bf16_f32 v223, v224, v225
    s_nop 1
    v_mfma_f32_32x32x16_bf16 v[206:221], v[26:29], v[178:181], v[206:221]
    v_pk_mul_f32 v[226:227], v[226:227], s[96:97]
    v_pk_mul_f32 v[228:229], v[228:229], s[96:97]
    v_cvt_pk_bf16_f32 v224, v226, v227
    v_cvt_pk_bf16_f32 v225, v228, v229
    s_mul_i32 s42, s93, 19
    s_add_u32 s42, s42, s92
    s_nop 1
    v_permlane32_swap_b32 v222, v224
    v_permlane32_swap_b32 v223, v225
    buffer_store_dwordx4 v[222:225], v2, s[88:91], s42 offen sc1
    s_waitcnt lgkmcnt(4)
    v_mfma_f32_32x32x16_bf16 v[190:205], v[6:9], v[182:185], v[190:205]
    v_pk_mul_f32 v[230:231], v[230:231], s[96:97]
    v_pk_mul_f32 v[232:233], v[232:233], s[96:97]
    v_cvt_pk_bf16_f32 v230, v230, v231
    v_cvt_pk_bf16_f32 v231, v232, v233
    s_nop 1
    v_mfma_f32_32x32x16_bf16 v[206:221], v[10:13], v[182:185], v[206:221]
    v_pk_mul_f32 v[234:235], v[234:235], s[96:97]
    v_pk_mul_f32 v[236:237], v[236:237], s[96:97]
    v_cvt_pk_bf16_f32 v232, v234, v235
    v_cvt_pk_bf16_f32 v233, v236, v237
    s_mul_i32 s42, s93, 20
    s_add_u32 s42, s42, s92
    s_nop 1
    s_barrier
    v_add_u32 v3, -131072, v3
    v_add_u32 v4, -131072, v4
    ds_read_b64_tr_b16 v[22:23], v3 offset:0
    ds_read_b64_tr_b16 v[24:25], v3 offset:512
    ds_read_b64_tr_b16 v[26:27], v4 offset:0
    ds_read_b64_tr_b16 v[28:29], v4 offset:512
    v_permlane32_swap_b32 v230, v232
    v_permlane32_swap_b32 v231, v233
    buffer_store_dwordx4 v[230:233], v2, s[88:91], s42 offen sc1
    s_waitcnt lgkmcnt(4)
    v_mfma_f32_32x32x16_bf16 v[190:205], v[14:17], v[186:189], v[190:205]
    ds_read_b64_tr_b16 v[6:7], v3 offset:2048
    ds_read_b64_tr_b16 v[8:9], v3 offset:2560
    ds_read_b64_tr_b16 v[10:11], v4 offset:2048
    ds_read_b64_tr_b16 v[12:13], v4 offset:2560
    v_pk_mul_f32 v[238:239], v[238:239], s[96:97]
    v_pk_mul_f32 v[240:241], v[240:241], s[96:97]
    v_cvt_pk_bf16_f32 v238, v238, v239
    v_cvt_pk_bf16_f32 v239, v240, v241
    s_mul_i32 s42, s93, 20
    s_add_u32 s42, s42, s92
    s_nop 1
    v_mfma_f32_32x32x16_bf16 v[206:221], v[18:21], v[186:189], v[206:221]
    v_mov_b32_dpp v240, v238 quad_perm:[1,1,3,3] row_mask:0xf bank_mask:0xf
    v_mov_b32_dpp v241, v239 quad_perm:[1,1,3,3] row_mask:0xf bank_mask:0xf
    s_mov_b64 exec, s[58:59]
    buffer_store_dwordx4 v[238:241], v254, s[88:91], s42 offen offset:1024 sc1
    s_mov_b64 exec, -1
    s_nop 1
    v_pk_mul_f32 v[242:243], v[242:243], s[96:97]
    v_pk_mul_f32 v[244:245], v[244:245], s[96:97]
    v_cvt_pk_bf16_f32 v242, v242, v243
    v_cvt_pk_bf16_f32 v243, v244, v245
    s_nop 1
    v_pk_mul_f32 v[246:247], v[246:247], s[96:97]
    v_pk_mul_f32 v[248:249], v[248:249], s[96:97]
    v_cvt_pk_bf16_f32 v244, v246, v247
    v_cvt_pk_bf16_f32 v245, v248, v249
    s_mul_i32 s42, s93, 21
    s_add_u32 s42, s42, s92
    s_nop 1
    v_permlane32_swap_b32 v242, v244
    v_permlane32_swap_b32 v243, v245
    buffer_store_dwordx4 v[242:245], v2, s[88:91], s42 offen sc1
    s_nop 1
    v_pk_mul_f32 v[250:251], v[250:251], s[96:97]
    v_pk_mul_f32 v[252:253], v[252:253], s[96:97]
    v_cvt_pk_bf16_f32 v250, v250, v251
    v_cvt_pk_bf16_f32 v251, v252, v253
    s_mul_i32 s42, s93, 22
    s_add_u32 s42, s42, s92
    s_nop 1
    v_permlane32_swap_b32 v250, v252
    v_permlane32_swap_b32 v251, v253
    s_mov_b32 exec_hi, 0
    buffer_store_dwordx4 v[250:253], v2, s[88:91], s42 offen offset:0 sc1
    s_mov_b32 exec_hi, -1
    s_waitcnt lgkmcnt(4)
    v_mfma_f32_32x32x16_bf16 v[222:237], v[22:25], v[30:33], 0
    ds_read_b64_tr_b16 v[14:15], v3 offset:4096
    ds_read_b64_tr_b16 v[16:17], v3 offset:4608
    ds_read_b64_tr_b16 v[18:19], v4 offset:4096
    ds_read_b64_tr_b16 v[20:21], v4 offset:4608
    v_mfma_f32_32x32x16_bf16 v[238:253], v[26:29], v[30:33], 0
    s_waitcnt lgkmcnt(4)
    v_mfma_f32_32x32x16_bf16 v[222:237], v[6:9], v[34:37], v[222:237]
    ds_read_b64_tr_b16 v[22:23], v3 offset:6144
    ds_read_b64_tr_b16 v[24:25], v3 offset:6656
    ds_read_b64_tr_b16 v[26:27], v4 offset:6144
    ds_read_b64_tr_b16 v[28:29], v4 offset:6656
    v_pk_mul_f32 v[190:191], v[190:191], s[96:97]
    v_pk_mul_f32 v[192:193], v[192:193], s[96:97]
    v_cvt_pk_bf16_f32 v190, v190, v191
    v_cvt_pk_bf16_f32 v191, v192, v193
    s_mul_i32 s42, s93, 22
    s_add_u32 s42, s42, s92
    s_nop 1
    v_mfma_f32_32x32x16_bf16 v[238:253], v[10:13], v[34:37], v[238:253]
    v_permlane32_swap_b32 v190, v192
    v_permlane32_swap_b32 v191, v193
    s_mov_b32 exec_hi, 0
    buffer_store_dwordx4 v[190:193], v2, s[88:91], s42 offen offset:512 sc1
    s_mov_b32 exec_hi, -1
    s_waitcnt lgkmcnt(4)
    v_mfma_f32_32x32x16_bf16 v[222:237], v[14:17], v[38:41], v[222:237]
    ds_read_b64_tr_b16 v[6:7], v3 offset:8192
    ds_read_b64_tr_b16 v[8:9], v3 offset:8704
    ds_read_b64_tr_b16 v[10:11], v4 offset:8192
    ds_read_b64_tr_b16 v[12:13], v4 offset:8704
    v_pk_mul_f32 v[194:195], v[194:195], s[96:97]
    v_pk_mul_f32 v[196:197], v[196:197], s[96:97]
    v_cvt_pk_bf16_f32 v194, v194, v195
    v_cvt_pk_bf16_f32 v195, v196, v197
    s_mul_i32 s42, s93, 22
    s_add_u32 s42, s42, s92
    s_nop 1
    v_mfma_f32_32x32x16_bf16 v[238:253], v[18:21], v[38:41], v[238:253]
    v_mov_b32_dpp v196, v194 quad_perm:[1,1,3,3] row_mask:0xf bank_mask:0xf
    v_mov_b32_dpp v197, v195 quad_perm:[1,1,3,3] row_mask:0xf bank_mask:0xf
    s_mov_b64 exec, s[58:59]
    buffer_store_dwordx4 v[194:197], v254, s[88:91], s42 offen offset:1024 sc1
    s_mov_b64 exec, -1
    s_waitcnt lgkmcnt(4)
    v_mfma_f32_32x32x16_bf16 v[222:237], v[22:25], v[42:45], v[222:237]
    ds_read_b64_tr_b16 v[14:15], v3 offset:10240
    ds_read_b64_tr_b16 v[16:17], v3 offset:10752
    ds_read_b64_tr_b16 v[18:19], v4 offset:10240
    ds_read_b64_tr_b16 v[20:21], v4 offset:10752
    v_pk_mul_f32 v[198:199], v[198:199], s[96:97]
    v_pk_mul_f32 v[200:201], v[200:201], s[96:97]
    v_cvt_pk_bf16_f32 v198, v198, v199
    v_cvt_pk_bf16_f32 v199, v200, v201
    s_nop 1
    v_mfma_f32_32x32x16_bf16 v[238:253], v[26:29], v[42:45], v[238:253]
    v_pk_mul_f32 v[202:203], v[202:203], s[96:97]
    v_pk_mul_f32 v[204:205], v[204:205], s[96:97]
    v_cvt_pk_bf16_f32 v200, v202, v203
    v_cvt_pk_bf16_f32 v201, v204, v205
    s_mul_i32 s42, s93, 23
    s_add_u32 s42, s42, s92
    s_waitcnt lgkmcnt(4)
    v_mfma_f32_32x32x16_bf16 v[222:237], v[6:9], v[46:49], v[222:237]
    ds_read_b64_tr_b16 v[22:23], v3 offset:12288
    ds_read_b64_tr_b16 v[24:25], v3 offset:12800
    ds_read_b64_tr_b16 v[26:27], v4 offset:12288
    ds_read_b64_tr_b16 v[28:29], v4 offset:12800
    v_permlane32_swap_b32 v198, v200
    v_permlane32_swap_b32 v199, v201
    buffer_store_dwordx4 v[198:201], v2, s[88:91], s42 offen sc1
    s_nop 1
    v_mfma_f32_32x32x16_bf16 v[238:253], v[10:13], v[46:49], v[238:253]
    v_pk_mul_f32 v[206:207], v[206:207], s[96:97]
    v_pk_mul_f32 v[208:209], v[208:209], s[96:97]
    v_cvt_pk_bf16_f32 v206, v206, v207
    v_cvt_pk_bf16_f32 v207, v208, v209
    s_waitcnt lgkmcnt(4)
    v_mfma_f32_32x32x16_bf16 v[222:237], v[14:17], v[50:53], v[222:237]
    ds_read_b64_tr_b16 v[6:7], v3 offset:14336
    ds_read_b64_tr_b16 v[8:9], v3 offset:14848
    ds_read_b64_tr_b16 v[10:11], v4 offset:14336
    ds_read_b64_tr_b16 v[12:13], v4 offset:14848
    v_pk_mul_f32 v[210:211], v[210:211], s[96:97]
    v_pk_mul_f32 v[212:213], v[212:213], s[96:97]
    v_cvt_pk_bf16_f32 v208, v210, v211
    v_cvt_pk_bf16_f32 v209, v212, v213
    s_mul_i32 s42, s93, 24
    s_add_u32 s42, s42, s92
    s_nop 1
    v_mfma_f32_32x32x16_bf16 v[238:253], v[18:21], v[50:53], v[238:253]
    v_permlane32_swap_b32 v206, v208
    v_permlane32_swap_b32 v207, v209
    buffer_store_dwordx4 v[206:209], v2, s[88:91], s42 offen sc1
    s_waitcnt lgkmcnt(4)
    v_mfma_f32_32x32x16_bf16 v[222:237], v[22:25], v[54:57], v[222:237]
    ds_read_b64_tr_b16 v[14:15], v3 offset:16384
    ds_read_b64_tr_b16 v[16:17], v3 offset:16896
    ds_read_b64_tr_b16 v[18:19], v4 offset:16384
    ds_read_b64_tr_b16 v[20:21], v4 offset:16896
    v_pk_mul_f32 v[214:215], v[214:215], s[96:97]
    v_pk_mul_f32 v[216:217], v[216:217], s[96:97]
    v_cvt_pk_bf16_f32 v214, v214, v215
    v_cvt_pk_bf16_f32 v215, v216, v217
    s_mul_i32 s42, s93, 24
    s_add_u32 s42, s42, s92
    s_nop 1
    v_mfma_f32_32x32x16_bf16 v[238:253], v[26:29], v[54:57], v[238:253]
    v_mov_b32_dpp v216, v214 quad_perm:[1,1,3,3] row_mask:0xf bank_mask:0xf
    v_mov_b32_dpp v217, v215 quad_perm:[1,1,3,3] row_mask:0xf bank_mask:0xf
    s_mov_b64 exec, s[58:59]
    buffer_store_dwordx4 v[214:217], v254, s[88:91], s42 offen offset:1024 sc1
    s_mov_b64 exec, -1
    s_waitcnt lgkmcnt(4)
    v_mfma_f32_32x32x16_bf16 v[222:237], v[6:9], v[58:61], v[222:237]
    ds_read_b64_tr_b16 v[22:23], v3 offset:18432
    ds_read_b64_tr_b16 v[24:25], v3 offset:18944
    ds_read_b64_tr_b16 v[26:27], v4 offset:18432
    ds_read_b64_tr_b16 v[28:29], v4 offset:18944
    v_pk_mul_f32 v[218:219], v[218:219], s[96:97]
    v_pk_mul_f32 v[220:221], v[220:221], s[96:97]
    v_cvt_pk_bf16_f32 v218, v218, v219
    v_cvt_pk_bf16_f32 v219, v220, v221
    s_mul_i32 s42, s93, 25
    s_add_u32 s42, s42, s92
    s_nop 1
    v_mfma_f32_32x32x16_bf16 v[238:253], v[10:13], v[58:61], v[238:253]
    v_permlane32_swap_b32 v218, v220
    v_permlane32_swap_b32 v219, v221
    s_mov_b32 exec_hi, 0
    buffer_store_dwordx4 v[218:221], v2, s[88:91], s42 offen offset:0 sc1
    s_mov_b32 exec_hi, -1
    s_waitcnt lgkmcnt(4)
    v_mfma_f32_32x32x16_bf16 v[222:237], v[14:17], v[62:65], v[222:237]
    v_mfma_f32_32x32x16_bf16 v[238:253], v[18:21], v[62:65], v[238:253]
    s_barrier
    ds_read_b64_tr_b16 v[6:7], v3 offset:20480
    ds_read_b64_tr_b16 v[8:9], v3 offset:20992
    ds_read_b64_tr_b16 v[10:11], v4 offset:20480
    ds_read_b64_tr_b16 v[12:13], v4 offset:20992
    s_waitcnt lgkmcnt(4)
    v_mfma_f32_32x32x16_bf16 v[222:237], v[22:25], v[66:69], v[222:237]
    ds_read_b64_tr_b16 v[14:15], v3 offset:22528
    ds_read_b64_tr_b16 v[16:17], v3 offset:23040
    ds_read_b64_tr_b16 v[18:19], v4 offset:22528
    ds_read_b64_tr_b16 v[20:21], v4 offset:23040
    v_mfma_f32_32x32x16_bf16 v[238:253], v[26:29], v[66:69], v[238:253]
    s_waitcnt lgkmcnt(4)
    v_mfma_f32_32x32x16_bf16 v[222:237], v[6:9], v[70:73], v[222:237]
    ds_read_b64_tr_b16 v[22:23], v3 offset:24576
    ds_read_b64_tr_b16 v[24:25], v3 offset:25088
    ds_read_b64_tr_b16 v[26:27], v4 offset:24576
    ds_read_b64_tr_b16 v[28:29], v4 offset:25088
    v_mfma_f32_32x32x16_bf16 v[238:253], v[10:13], v[70:73], v[238:253]
    s_waitcnt lgkmcnt(4)
    v_mfma_f32_32x32x16_bf16 v[222:237], v[14:17], v[74:77], v[222:237]
    ds_read_b64_tr_b16 v[6:7], v3 offset:26624
    ds_read_b64_tr_b16 v[8:9], v3 offset:27136
    ds_read_b64_tr_b16 v[10:11], v4 offset:26624
    ds_read_b64_tr_b16 v[12:13], v4 offset:27136
    v_mfma_f32_32x32x16_bf16 v[238:253], v[18:21], v[74:77], v[238:253]
    s_waitcnt lgkmcnt(4)
    v_mfma_f32_32x32x16_bf16 v[222:237], v[22:25], v[78:81], v[222:237]
    ds_read_b64_tr_b16 v[14:15], v3 offset:28672
    ds_read_b64_tr_b16 v[16:17], v3 offset:29184
    ds_read_b64_tr_b16 v[18:19], v4 offset:28672
    ds_read_b64_tr_b16 v[20:21], v4 offset:29184
    v_mfma_f32_32x32x16_bf16 v[238:253], v[26:29], v[78:81], v[238:253]
    s_waitcnt lgkmcnt(4)
    v_mfma_f32_32x32x16_bf16 v[222:237], v[6:9], v[82:85], v[222:237]
    ds_read_b64_tr_b16 v[22:23], v3 offset:30720
    ds_read_b64_tr_b16 v[24:25], v3 offset:31232
    ds_read_b64_tr_b16 v[26:27], v4 offset:30720
    ds_read_b64_tr_b16 v[28:29], v4 offset:31232
    v_mfma_f32_32x32x16_bf16 v[238:253], v[10:13], v[82:85], v[238:253]
    s_waitcnt lgkmcnt(4)
    v_mfma_f32_32x32x16_bf16 v[222:237], v[14:17], v[86:89], v[222:237]
    ds_read_b64_tr_b16 v[6:7], v3 offset:32768
    ds_read_b64_tr_b16 v[8:9], v3 offset:33280
    ds_read_b64_tr_b16 v[10:11], v4 offset:32768
    ds_read_b64_tr_b16 v[12:13], v4 offset:33280
    v_mfma_f32_32x32x16_bf16 v[238:253], v[18:21], v[86:89], v[238:253]
    s_waitcnt lgkmcnt(4)
    v_mfma_f32_32x32x16_bf16 v[222:237], v[22:25], v[90:93], v[222:237]
    ds_read_b64_tr_b16 v[14:15], v3 offset:34816
    ds_read_b64_tr_b16 v[16:17], v3 offset:35328
    ds_read_b64_tr_b16 v[18:19], v4 offset:34816
    ds_read_b64_tr_b16 v[20:21], v4 offset:35328
    v_mfma_f32_32x32x16_bf16 v[238:253], v[26:29], v[90:93], v[238:253]
    s_waitcnt lgkmcnt(4)
    v_mfma_f32_32x32x16_bf16 v[222:237], v[6:9], v[94:97], v[222:237]
    ds_read_b64_tr_b16 v[22:23], v3 offset:36864
    ds_read_b64_tr_b16 v[24:25], v3 offset:37376
    ds_read_b64_tr_b16 v[26:27], v4 offset:36864
    ds_read_b64_tr_b16 v[28:29], v4 offset:37376
    v_mfma_f32_32x32x16_bf16 v[238:253], v[10:13], v[94:97], v[238:253]
    s_waitcnt lgkmcnt(4)
    v_mfma_f32_32x32x16_bf16 v[222:237], v[14:17], v[98:101], v[222:237]
    ds_read_b64_tr_b16 v[6:7], v3 offset:38912
    ds_read_b64_tr_b16 v[8:9], v3 offset:39424
    ds_read_b64_tr_b16 v[10:11], v4 offset:38912
    ds_read_b64_tr_b16 v[12:13], v4 offset:39424
    v_mfma_f32_32x32x16_bf16 v[238:253], v[18:21], v[98:101], v[238:253]
    s_waitcnt lgkmcnt(4)
    v_mfma_f32_32x32x16_bf16 v[222:237], v[22:25], v[102:105], v[222:237]
    v_mfma_f32_32x32x16_bf16 v[238:253], v[26:29], v[102:105], v[238:253]
    s_waitcnt vmcnt(0)
    s_barrier
    v_mov_b32_e64 v254, 1
    buffer_store_dword v254, v255, s[48:51], s98 offen sc1
    ds_read_b64_tr_b16 v[14:15], v3 offset:40960
    ds_read_b64_tr_b16 v[16:17], v3 offset:41472
    ds_read_b64_tr_b16 v[18:19], v4 offset:40960
    ds_read_b64_tr_b16 v[20:21], v4 offset:41472
    s_waitcnt lgkmcnt(4)
    v_mfma_f32_32x32x16_bf16 v[222:237], v[6:9], v[106:109], v[222:237]
    ds_read_b64_tr_b16 v[22:23], v3 offset:43008
    ds_read_b64_tr_b16 v[24:25], v3 offset:43520
    ds_read_b64_tr_b16 v[26:27], v4 offset:43008
    ds_read_b64_tr_b16 v[28:29], v4 offset:43520
    v_mfma_f32_32x32x16_bf16 v[238:253], v[10:13], v[106:109], v[238:253]
    s_waitcnt lgkmcnt(4)
    v_mfma_f32_32x32x16_bf16 v[222:237], v[14:17], v[110:113], v[222:237]
    ds_read_b64_tr_b16 v[6:7], v3 offset:45056
    ds_read_b64_tr_b16 v[8:9], v3 offset:45568
    ds_read_b64_tr_b16 v[10:11], v4 offset:45056
    ds_read_b64_tr_b16 v[12:13], v4 offset:45568
    v_mfma_f32_32x32x16_bf16 v[238:253], v[18:21], v[110:113], v[238:253]
    s_waitcnt lgkmcnt(4)
    v_mfma_f32_32x32x16_bf16 v[222:237], v[22:25], v[114:117], v[222:237]
    ds_read_b64_tr_b16 v[14:15], v3 offset:47104
    ds_read_b64_tr_b16 v[16:17], v3 offset:47616
    ds_read_b64_tr_b16 v[18:19], v4 offset:47104
    ds_read_b64_tr_b16 v[20:21], v4 offset:47616
    v_mfma_f32_32x32x16_bf16 v[238:253], v[26:29], v[114:117], v[238:253]
    s_waitcnt lgkmcnt(4)
    v_mfma_f32_32x32x16_bf16 v[222:237], v[6:9], v[118:121], v[222:237]
    ds_read_b64_tr_b16 v[22:23], v3 offset:49152
    ds_read_b64_tr_b16 v[24:25], v3 offset:49664
    ds_read_b64_tr_b16 v[26:27], v4 offset:49152
    ds_read_b64_tr_b16 v[28:29], v4 offset:49664
    v_mfma_f32_32x32x16_bf16 v[238:253], v[10:13], v[118:121], v[238:253]
    s_waitcnt lgkmcnt(4)
    v_mfma_f32_32x32x16_bf16 v[222:237], v[14:17], v[122:125], v[222:237]
    ds_read_b64_tr_b16 v[6:7], v3 offset:51200
    ds_read_b64_tr_b16 v[8:9], v3 offset:51712
    ds_read_b64_tr_b16 v[10:11], v4 offset:51200
    ds_read_b64_tr_b16 v[12:13], v4 offset:51712
    v_mfma_f32_32x32x16_bf16 v[238:253], v[18:21], v[122:125], v[238:253]
    s_waitcnt lgkmcnt(4)
    v_mfma_f32_32x32x16_bf16 v[222:237], v[22:25], v[126:129], v[222:237]
    ds_read_b64_tr_b16 v[14:15], v3 offset:53248
    ds_read_b64_tr_b16 v[16:17], v3 offset:53760
    ds_read_b64_tr_b16 v[18:19], v4 offset:53248
    ds_read_b64_tr_b16 v[20:21], v4 offset:53760
    v_mfma_f32_32x32x16_bf16 v[238:253], v[26:29], v[126:129], v[238:253]
    s_waitcnt lgkmcnt(4)
    v_mfma_f32_32x32x16_bf16 v[222:237], v[6:9], v[130:133], v[222:237]
    ds_read_b64_tr_b16 v[22:23], v3 offset:55296
    ds_read_b64_tr_b16 v[24:25], v3 offset:55808
    ds_read_b64_tr_b16 v[26:27], v4 offset:55296
    ds_read_b64_tr_b16 v[28:29], v4 offset:55808
    v_mfma_f32_32x32x16_bf16 v[238:253], v[10:13], v[130:133], v[238:253]
    s_waitcnt lgkmcnt(4)
    v_mfma_f32_32x32x16_bf16 v[222:237], v[14:17], v[134:137], v[222:237]
    ds_read_b64_tr_b16 v[6:7], v3 offset:57344
    ds_read_b64_tr_b16 v[8:9], v3 offset:57856
    ds_read_b64_tr_b16 v[10:11], v4 offset:57344
    ds_read_b64_tr_b16 v[12:13], v4 offset:57856
    v_mfma_f32_32x32x16_bf16 v[238:253], v[18:21], v[134:137], v[238:253]
    s_waitcnt lgkmcnt(4)
    v_mfma_f32_32x32x16_bf16 v[222:237], v[22:25], v[138:141], v[222:237]
    ds_read_b64_tr_b16 v[14:15], v3 offset:59392
    ds_read_b64_tr_b16 v[16:17], v3 offset:59904
    ds_read_b64_tr_b16 v[18:19], v4 offset:59392
    ds_read_b64_tr_b16 v[20:21], v4 offset:59904
    v_mfma_f32_32x32x16_bf16 v[238:253], v[26:29], v[138:141], v[238:253]
    s_waitcnt lgkmcnt(4)
    v_mfma_f32_32x32x16_bf16 v[222:237], v[6:9], v[142:145], v[222:237]
    v_mfma_f32_32x32x16_bf16 v[238:253], v[10:13], v[142:145], v[238:253]
    s_barrier
    v_add_u32 v3, 61440, v3
    v_add_u32 v4, 61440, v4
    ds_read_b64_tr_b16 v[22:23], v3 offset:0
    ds_read_b64_tr_b16 v[24:25], v3 offset:512
    ds_read_b64_tr_b16 v[26:27], v4 offset:0
    ds_read_b64_tr_b16 v[28:29], v4 offset:512
    s_waitcnt lgkmcnt(4)
    v_mfma_f32_32x32x16_bf16 v[222:237], v[14:17], v[146:149], v[222:237]
    ds_read_b64_tr_b16 v[6:7], v3 offset:2048
    ds_read_b64_tr_b16 v[8:9], v3 offset:2560
    ds_read_b64_tr_b16 v[10:11], v4 offset:2048
    ds_read_b64_tr_b16 v[12:13], v4 offset:2560
    v_mfma_f32_32x32x16_bf16 v[238:253], v[18:21], v[146:149], v[238:253]
    s_waitcnt lgkmcnt(4)
    v_mfma_f32_32x32x16_bf16 v[222:237], v[22:25], v[150:153], v[222:237]
    ds_read_b64_tr_b16 v[14:15], v3 offset:4096
    ds_read_b64_tr_b16 v[16:17], v3 offset:4608
    ds_read_b64_tr_b16 v[18:19], v4 offset:4096
    ds_read_b64_tr_b16 v[20:21], v4 offset:4608
    v_mfma_f32_32x32x16_bf16 v[238:253], v[26:29], v[150:153], v[238:253]
    s_waitcnt lgkmcnt(4)
    v_mfma_f32_32x32x16_bf16 v[222:237], v[6:9], v[154:157], v[222:237]
    ds_read_b64_tr_b16 v[22:23], v3 offset:6144
    ds_read_b64_tr_b16 v[24:25], v3 offset:6656
    ds_read_b64_tr_b16 v[26:27], v4 offset:6144
    ds_read_b64_tr_b16 v[28:29], v4 offset:6656
    v_mfma_f32_32x32x16_bf16 v[238:253], v[10:13], v[154:157], v[238:253]
    s_waitcnt lgkmcnt(4)
    v_mfma_f32_32x32x16_bf16 v[222:237], v[14:17], v[158:161], v[222:237]
    ds_read_b64_tr_b16 v[6:7], v3 offset:8192
    ds_read_b64_tr_b16 v[8:9], v3 offset:8704
    ds_read_b64_tr_b16 v[10:11], v4 offset:8192
    ds_read_b64_tr_b16 v[12:13], v4 offset:8704
    v_mfma_f32_32x32x16_bf16 v[238:253], v[18:21], v[158:161], v[238:253]
    s_waitcnt lgkmcnt(4)
    v_mfma_f32_32x32x16_bf16 v[222:237], v[22:25], v[162:165], v[222:237]
    ds_read_b64_tr_b16 v[14:15], v3 offset:10240
    ds_read_b64_tr_b16 v[16:17], v3 offset:10752
    ds_read_b64_tr_b16 v[18:19], v4 offset:10240
    ds_read_b64_tr_b16 v[20:21], v4 offset:10752
    v_mfma_f32_32x32x16_bf16 v[238:253], v[26:29], v[162:165], v[238:253]
    s_waitcnt lgkmcnt(4)
    v_mfma_f32_32x32x16_bf16 v[222:237], v[6:9], v[166:169], v[222:237]
    ds_read_b64_tr_b16 v[22:23], v3 offset:12288
    ds_read_b64_tr_b16 v[24:25], v3 offset:12800
    ds_read_b64_tr_b16 v[26:27], v4 offset:12288
    ds_read_b64_tr_b16 v[28:29], v4 offset:12800
    v_mfma_f32_32x32x16_bf16 v[238:253], v[10:13], v[166:169], v[238:253]
    s_waitcnt lgkmcnt(4)
    v_mfma_f32_32x32x16_bf16 v[222:237], v[14:17], v[170:173], v[222:237]
    ds_read_b64_tr_b16 v[6:7], v3 offset:14336
    ds_read_b64_tr_b16 v[8:9], v3 offset:14848
    ds_read_b64_tr_b16 v[10:11], v4 offset:14336
    ds_read_b64_tr_b16 v[12:13], v4 offset:14848
    v_mfma_f32_32x32x16_bf16 v[238:253], v[18:21], v[170:173], v[238:253]
    s_waitcnt lgkmcnt(4)
    v_mfma_f32_32x32x16_bf16 v[222:237], v[22:25], v[174:177], v[222:237]
    ds_read_b64_tr_b16 v[14:15], v3 offset:16384
    ds_read_b64_tr_b16 v[16:17], v3 offset:16896
    ds_read_b64_tr_b16 v[18:19], v4 offset:16384
    ds_read_b64_tr_b16 v[20:21], v4 offset:16896
    v_mfma_f32_32x32x16_bf16 v[238:253], v[26:29], v[174:177], v[238:253]
    s_waitcnt lgkmcnt(4)
    v_mfma_f32_32x32x16_bf16 v[222:237], v[6:9], v[178:181], v[222:237]
    ds_read_b64_tr_b16 v[22:23], v3 offset:18432
    ds_read_b64_tr_b16 v[24:25], v3 offset:18944
    ds_read_b64_tr_b16 v[26:27], v4 offset:18432
    ds_read_b64_tr_b16 v[28:29], v4 offset:18944
    v_mfma_f32_32x32x16_bf16 v[238:253], v[10:13], v[178:181], v[238:253]
    s_waitcnt lgkmcnt(4)
    v_mfma_f32_32x32x16_bf16 v[222:237], v[14:17], v[182:185], v[222:237]
    v_mfma_f32_32x32x16_bf16 v[238:253], v[18:21], v[182:185], v[238:253]
    s_waitcnt lgkmcnt(0)
    s_barrier
    ds_read_b64_tr_b16 v[6:7], v5 offset:0
    ds_read_b64_tr_b16 v[8:9], v5 offset:256
    s_waitcnt lgkmcnt(2)
    v_mfma_f32_32x32x16_bf16 v[222:237], v[22:25], v[186:189], v[222:237]
    ds_read_b64_tr_b16 v[14:15], v5 offset:1024
    ds_read_b64_tr_b16 v[16:17], v5 offset:1280
    v_mfma_f32_32x32x16_bf16 v[238:253], v[26:29], v[186:189], v[238:253]
    s_waitcnt lgkmcnt(2)
    v_mfma_f32_32x32x16_bf16 v[190:205], v[6:9], v[30:33], 0
    ds_read_b64_tr_b16 v[22:23], v5 offset:2048
    ds_read_b64_tr_b16 v[24:25], v5 offset:2304
    s_waitcnt lgkmcnt(2)
    v_mfma_f32_32x32x16_bf16 v[190:205], v[14:17], v[34:37], v[190:205]
    ds_read_b64_tr_b16 v[6:7], v5 offset:3072
    ds_read_b64_tr_b16 v[8:9], v5 offset:3328
    s_waitcnt lgkmcnt(2)
    v_mfma_f32_32x32x16_bf16 v[190:205], v[22:25], v[38:41], v[190:205]
    ds_read_b64_tr_b16 v[14:15], v5 offset:4096
    ds_read_b64_tr_b16 v[16:17], v5 offset:4352
    v_cvt_pk_bf16_f32 v222, v222, v223
    v_cvt_pk_bf16_f32 v223, v224, v225
    v_cvt_pk_bf16_f32 v224, v226, v227
    v_cvt_pk_bf16_f32 v225, v228, v229
    s_waitcnt lgkmcnt(2)
    v_mfma_f32_32x32x16_bf16 v[190:205], v[6:9], v[42:45], v[190:205]
    ds_read_b64_tr_b16 v[22:23], v5 offset:5120
    ds_read_b64_tr_b16 v[24:25], v5 offset:5376
    v_pk_max_i16 v222, v222, 0
    v_pk_max_i16 v223, v223, 0
    v_pk_max_i16 v224, v224, 0
    v_pk_max_i16 v225, v225, 0
    s_waitcnt lgkmcnt(2)
    v_mfma_f32_32x32x16_bf16 v[190:205], v[14:17], v[46:49], v[190:205]
    ds_read_b64_tr_b16 v[6:7], v5 offset:6144
    ds_read_b64_tr_b16 v[8:9], v5 offset:6400
    v_cvt_pk_bf16_f32 v230, v230, v231
    v_cvt_pk_bf16_f32 v231, v232, v233
    v_cvt_pk_bf16_f32 v232, v234, v235
    v_cvt_pk_bf16_f32 v233, v236, v237
    s_waitcnt lgkmcnt(2)
    v_mfma_f32_32x32x16_bf16 v[190:205], v[22:25], v[50:53], v[190:205]
    ds_read_b64_tr_b16 v[14:15], v5 offset:7168
    ds_read_b64_tr_b16 v[16:17], v5 offset:7424
    v_pk_max_i16 v230, v230, 0
    v_pk_max_i16 v231, v231, 0
    v_pk_max_i16 v232, v232, 0
    v_pk_max_i16 v233, v233, 0
    s_waitcnt lgkmcnt(2)
    v_mfma_f32_32x32x16_bf16 v[190:205], v[6:9], v[54:57], v[190:205]
    ds_read_b64_tr_b16 v[22:23], v5 offset:8192
    ds_read_b64_tr_b16 v[24:25], v5 offset:8448
    v_cvt_pk_bf16_f32 v238, v238, v239
    v_cvt_pk_bf16_f32 v239, v240, v241
    v_cvt_pk_bf16_f32 v240, v242, v243
    v_cvt_pk_bf16_f32 v241, v244, v245
    s_waitcnt lgkmcnt(2)
    v_mfma_f32_32x32x16_bf16 v[190:205], v[14:17], v[58:61], v[190:205]
    ds_read_b64_tr_b16 v[6:7], v5 offset:9216
    ds_read_b64_tr_b16 v[8:9], v5 offset:9472
    v_pk_max_i16 v238, v238, 0
    v_pk_max_i16 v239, v239, 0
    v_pk_max_i16 v240, v240, 0
    v_pk_max_i16 v241, v241, 0
    s_waitcnt lgkmcnt(2)
    v_mfma_f32_32x32x16_bf16 v[190:205], v[22:25], v[62:65], v[190:205]
    ds_read_b64_tr_b16 v[14:15], v5 offset:10240
    ds_read_b64_tr_b16 v[16:17], v5 offset:10496
    v_cvt_pk_bf16_f32 v246, v246, v247
    v_cvt_pk_bf16_f32 v247, v248, v249
    v_cvt_pk_bf16_f32 v248, v250, v251
    v_cvt_pk_bf16_f32 v249, v252, v253
    s_waitcnt lgkmcnt(2)
    v_mfma_f32_32x32x16_bf16 v[190:205], v[6:9], v[66:69], v[190:205]
    ds_read_b64_tr_b16 v[22:23], v5 offset:11264
    ds_read_b64_tr_b16 v[24:25], v5 offset:11520
    v_pk_max_i16 v246, v246, 0
    v_pk_max_i16 v247, v247, 0
    v_pk_max_i16 v248, v248, 0
    v_pk_max_i16 v249, v249, 0
    s_waitcnt lgkmcnt(2)
    v_mfma_f32_32x32x16_bf16 v[190:205], v[14:17], v[70:73], v[190:205]
    ds_read_b64_tr_b16 v[6:7], v5 offset:12288
    ds_read_b64_tr_b16 v[8:9], v5 offset:12544
    s_waitcnt lgkmcnt(2)
    v_mfma_f32_32x32x16_bf16 v[190:205], v[22:25], v[74:77], v[190:205]
    ds_read_b64_tr_b16 v[14:15], v5 offset:13312
    ds_read_b64_tr_b16 v[16:17], v5 offset:13568
    s_waitcnt lgkmcnt(2)
    v_mfma_f32_32x32x16_bf16 v[190:205], v[6:9], v[78:81], v[190:205]
    ds_read_b64_tr_b16 v[22:23], v5 offset:14336
    ds_read_b64_tr_b16 v[24:25], v5 offset:14592
    s_waitcnt lgkmcnt(2)
    v_mfma_f32_32x32x16_bf16 v[190:205], v[14:17], v[82:85], v[190:205]
    ds_read_b64_tr_b16 v[6:7], v5 offset:15360
    ds_read_b64_tr_b16 v[8:9], v5 offset:15616
    s_waitcnt lgkmcnt(2)
    v_mfma_f32_32x32x16_bf16 v[190:205], v[22:25], v[86:89], v[190:205]
    ds_read_b64_tr_b16 v[14:15], v5 offset:16384
    ds_read_b64_tr_b16 v[16:17], v5 offset:16640
    s_waitcnt lgkmcnt(2)
    v_mfma_f32_32x32x16_bf16 v[190:205], v[6:9], v[90:93], v[190:205]
    ds_read_b64_tr_b16 v[22:23], v5 offset:17408
    ds_read_b64_tr_b16 v[24:25], v5 offset:17664
    s_waitcnt lgkmcnt(2)
    v_mfma_f32_32x32x16_bf16 v[190:205], v[14:17], v[94:97], v[190:205]
    ds_read_b64_tr_b16 v[6:7], v5 offset:18432
    ds_read_b64_tr_b16 v[8:9], v5 offset:18688
    s_waitcnt lgkmcnt(2)
    v_mfma_f32_32x32x16_bf16 v[190:205], v[22:25], v[98:101], v[190:205]
    ds_read_b64_tr_b16 v[14:15], v5 offset:19456
    ds_read_b64_tr_b16 v[16:17], v5 offset:19712
    s_waitcnt lgkmcnt(2)
    v_mfma_f32_32x32x16_bf16 v[190:205], v[6:9], v[102:105], v[190:205]
    ds_read_b64_tr_b16 v[22:23], v5 offset:20480
    ds_read_b64_tr_b16 v[24:25], v5 offset:20736
    s_waitcnt lgkmcnt(2)
    v_mfma_f32_32x32x16_bf16 v[190:205], v[14:17], v[106:109], v[190:205]
    ds_read_b64_tr_b16 v[6:7], v5 offset:21504
    ds_read_b64_tr_b16 v[8:9], v5 offset:21760
    s_waitcnt lgkmcnt(2)
    v_mfma_f32_32x32x16_bf16 v[190:205], v[22:25], v[110:113], v[190:205]
    ds_read_b64_tr_b16 v[14:15], v5 offset:22528
    ds_read_b64_tr_b16 v[16:17], v5 offset:22784
    s_waitcnt lgkmcnt(2)
    v_mfma_f32_32x32x16_bf16 v[190:205], v[6:9], v[114:117], v[190:205]
    ds_read_b64_tr_b16 v[22:23], v5 offset:23552
    ds_read_b64_tr_b16 v[24:25], v5 offset:23808
    s_waitcnt lgkmcnt(2)
    v_mfma_f32_32x32x16_bf16 v[190:205], v[14:17], v[118:121], v[190:205]
    ds_read_b64_tr_b16 v[6:7], v5 offset:24576
    ds_read_b64_tr_b16 v[8:9], v5 offset:24832
    s_waitcnt lgkmcnt(2)
    v_mfma_f32_32x32x16_bf16 v[190:205], v[22:25], v[122:125], v[190:205]
    ds_read_b64_tr_b16 v[14:15], v5 offset:25600
    ds_read_b64_tr_b16 v[16:17], v5 offset:25856
    s_waitcnt lgkmcnt(2)
    v_mfma_f32_32x32x16_bf16 v[190:205], v[6:9], v[126:129], v[190:205]
    ds_read_b64_tr_b16 v[22:23], v5 offset:26624
    ds_read_b64_tr_b16 v[24:25], v5 offset:26880
    s_waitcnt lgkmcnt(2)
    v_mfma_f32_32x32x16_bf16 v[190:205], v[14:17], v[130:133], v[190:205]
    ds_read_b64_tr_b16 v[6:7], v5 offset:27648
    ds_read_b64_tr_b16 v[8:9], v5 offset:27904
    s_waitcnt lgkmcnt(2)
    v_mfma_f32_32x32x16_bf16 v[190:205], v[22:25], v[134:137], v[190:205]
    ds_read_b64_tr_b16 v[14:15], v5 offset:28672
    ds_read_b64_tr_b16 v[16:17], v5 offset:28928
    s_waitcnt lgkmcnt(2)
    v_mfma_f32_32x32x16_bf16 v[190:205], v[6:9], v[138:141], v[190:205]
    ds_read_b64_tr_b16 v[22:23], v5 offset:29696
    ds_read_b64_tr_b16 v[24:25], v5 offset:29952
    s_waitcnt lgkmcnt(2)
    v_mfma_f32_32x32x16_bf16 v[190:205], v[14:17], v[142:145], v[190:205]
    ds_read_b64_tr_b16 v[6:7], v5 offset:30720
    ds_read_b64_tr_b16 v[8:9], v5 offset:30976
    s_waitcnt lgkmcnt(2)
    v_mfma_f32_32x32x16_bf16 v[190:205], v[22:25], v[146:149], v[190:205]
    ds_read_b64_tr_b16 v[14:15], v5 offset:31744
    ds_read_b64_tr_b16 v[16:17], v5 offset:32000
    s_waitcnt lgkmcnt(2)
    v_mfma_f32_32x32x16_bf16 v[190:205], v[6:9], v[150:153], v[190:205]
    ds_read_b64_tr_b16 v[22:23], v5 offset:32768
    ds_read_b64_tr_b16 v[24:25], v5 offset:33024
    s_waitcnt lgkmcnt(2)
    v_mfma_f32_32x32x16_bf16 v[190:205], v[14:17], v[154:157], v[190:205]
    ds_read_b64_tr_b16 v[6:7], v5 offset:33792
    ds_read_b64_tr_b16 v[8:9], v5 offset:34048
    s_waitcnt lgkmcnt(2)
    v_mfma_f32_32x32x16_bf16 v[190:205], v[22:25], v[158:161], v[190:205]
    ds_read_b64_tr_b16 v[14:15], v5 offset:34816
    ds_read_b64_tr_b16 v[16:17], v5 offset:35072
    s_waitcnt lgkmcnt(2)
    v_mfma_f32_32x32x16_bf16 v[190:205], v[6:9], v[162:165], v[190:205]
    ds_read_b64_tr_b16 v[22:23], v5 offset:35840
    ds_read_b64_tr_b16 v[24:25], v5 offset:36096
    s_waitcnt lgkmcnt(2)
    v_mfma_f32_32x32x16_bf16 v[190:205], v[14:17], v[166:169], v[190:205]
    ds_read_b64_tr_b16 v[6:7], v5 offset:36864
    ds_read_b64_tr_b16 v[8:9], v5 offset:37120
    s_waitcnt lgkmcnt(2)
    v_mfma_f32_32x32x16_bf16 v[190:205], v[22:25], v[170:173], v[190:205]
    ds_read_b64_tr_b16 v[14:15], v5 offset:37888
    ds_read_b64_tr_b16 v[16:17], v5 offset:38144
    s_waitcnt lgkmcnt(2)
    v_mfma_f32_32x32x16_bf16 v[190:205], v[6:9], v[174:177], v[190:205]
    ds_read_b64_tr_b16 v[22:23], v5 offset:38912
    ds_read_b64_tr_b16 v[24:25], v5 offset:39168
    s_waitcnt lgkmcnt(2)
    v_mfma_f32_32x32x16_bf16 v[190:205], v[14:17], v[178:181], v[190:205]
    ds_read_b64_tr_b16 v[6:7], v5 offset:39936
    ds_read_b64_tr_b16 v[8:9], v5 offset:40192
    s_waitcnt lgkmcnt(2)
    v_mfma_f32_32x32x16_bf16 v[190:205], v[22:25], v[182:185], v[190:205]
    s_waitcnt lgkmcnt(0)
    v_mfma_f32_32x32x16_bf16 v[190:205], v[6:9], v[186:189], v[190:205]
    s_nop 3
    s_movk_i32 s44, 0x400
    v_lshlrev_b32 v2, 4, v1
    v_mov_b32 v5, v2
    v_and_b32 v8, 31, v1
    v_lshrrev_b32 v9, 5, v1
    v_lshlrev_b32_e64 v11, 3, v8
    v_mul_u32_u24 v3, 2560, v9
    v_add3_u32 v3, v3, v11, s44
    v_mov_b32 v20, 0
    v_mov_b32 v21, 0
    v_mov_b32 v22, 0
    v_mov_b32 v23, 0
    v_mov_b32 v6, 0
    v_mov_b32 v7, 0
    v_mov_b32 v254, 0
    v_mov_b32 v255, 0
    v_lshrrev_b32 v4, 3, v8
    v_xor_b32 v4, v4, v9
    v_and_b32 v4, 1, v4
    v_lshlrev_b32 v4, 6, v4
    v_lshrrev_b32_e64 v10, 2, v8
    v_lshl_add_u32 v4, v10, 7, v4
    v_and_b32_e64 v10, 3, v8
    v_lshl_add_u32 v4, v10, 4, v4
    v_add_u32 v4, 1280, v4
    v_cmp_eq_u32_e64 vcc, 20, v8
    v_cmp_eq_u32 s[58:59], 24, v8
    s_mul_i32 s42, s74, 2560
    s_add_u32 s42, s42, 71680
    s_or_b64 vcc, vcc, s[58:59]
    v_mov_b32 v10, 0x3f803f80
    s_nop 1
    v_cndmask_b32 v10, 0, v10, vcc
    v_mov_b32 v30, v10
    v_mov_b32 v31, v10
    v_mov_b32 v32, v10
    v_mov_b32 v33, v10
    v_mov_b32 v34, v10
    v_mov_b32 v35, v10
    v_mov_b32 v36, v10
    v_mov_b32 v37, v10
    v_add_u32 v10, s42, v2
    v_add_u32_e64 v11, s42, v11
    s_nop 1
    s_add_u32 s101, s94, s101
    v_cvt_pk_bf16_f32 v190, v190, v191
    v_cvt_pk_bf16_f32 v191, v192, v193
    v_cvt_pk_bf16_f32 v192, v194, v195
    v_cvt_pk_bf16_f32 v193, v196, v197
    s_nop 1
    v_pk_max_i16 v190, v190, 0
    v_pk_max_i16 v191, v191, 0
    v_pk_max_i16 v192, v192, 0
    v_pk_max_i16 v193, v193, 0
    s_nop 1
    v_cvt_pk_bf16_f32 v198, v198, v199
    v_cvt_pk_bf16_f32 v199, v200, v201
    v_cvt_pk_bf16_f32 v200, v202, v203
    v_cvt_pk_bf16_f32 v201, v204, v205
    s_nop 1
    v_pk_max_i16 v198, v198, 0
    v_pk_max_i16 v199, v199, 0
    v_pk_max_i16 v200, v200, 0
    v_pk_max_i16 v201, v201, 0
    s_branch g_att1
g_cq4:
    s_waitcnt lgkmcnt(5)
    v_mfma_f32_32x32x16_bf16 v[222:237], v[6:9], v[174:177], v[222:237]
    ds_read_b128 v[182:185], v182 offset:0
    ds_read_b64_tr_b16 v[22:23], v3 offset:20480
    ds_read_b64_tr_b16 v[24:25], v3 offset:20992
    ds_read_b64_tr_b16 v[26:27], v4 offset:20480
    ds_read_b64_tr_b16 v[28:29], v4 offset:20992
    v_mfma_f32_32x32x16_bf16 v[238:253], v[10:13], v[174:177], v[238:253]
    s_waitcnt lgkmcnt(5)
    v_mfma_f32_32x32x16_bf16 v[222:237], v[14:17], v[178:181], v[222:237]
    ds_read_b128 v[186:189], v186 offset:0
    ds_read_b64_tr_b16 v[6:7], v3 offset:22528
    ds_read_b64_tr_b16 v[8:9], v3 offset:23040
    ds_read_b64_tr_b16 v[10:11], v4 offset:22528
    ds_read_b64_tr_b16 v[12:13], v4 offset:23040
    v_mfma_f32_32x32x16_bf16 v[238:253], v[18:21], v[178:181], v[238:253]
    s_waitcnt lgkmcnt(5)
    v_mfma_f32_32x32x16_bf16 v[222:237], v[22:25], v[182:185], v[222:237]
    ds_read_b64_tr_b16 v[14:15], v3 offset:24576
    ds_read_b64_tr_b16 v[16:17], v3 offset:25088
    ds_read_b64_tr_b16 v[18:19], v4 offset:24576
    ds_read_b64_tr_b16 v[20:21], v4 offset:25088
    v_mfma_f32_32x32x16_bf16 v[238:253], v[26:29], v[182:185], v[238:253]
    s_waitcnt lgkmcnt(4)
    v_mfma_f32_32x32x16_bf16 v[222:237], v[6:9], v[186:189], v[222:237]
    ds_read_b64_tr_b16 v[22:23], v3 offset:26624
    ds_read_b64_tr_b16 v[24:25], v3 offset:27136
    ds_read_b64_tr_b16 v[26:27], v4 offset:26624
    ds_read_b64_tr_b16 v[28:29], v4 offset:27136
    v_mfma_f32_32x32x16_bf16 v[238:253], v[10:13], v[186:189], v[238:253]
    s_waitcnt lgkmcnt(4)
    v_mfma_f32_32x32x16_bf16 v[190:205], v[14:17], v[174:177], v[190:205]
    ds_read_b64_tr_b16 v[6:7], v3 offset:28672
    ds_read_b64_tr_b16 v[8:9], v3 offset:29184
    ds_read_b64_tr_b16 v[10:11], v4 offset:28672
    ds_read_b64_tr_b16 v[12:13], v4 offset:29184
    v_mfma_f32_32x32x16_bf16 v[206:221], v[18:21], v[174:177], v[206:221]
    s_waitcnt lgkmcnt(4)
    v_mfma_f32_32x32x16_bf16 v[190:205], v[22:25], v[178:181], v[190:205]
    ds_read_b64_tr_b16 v[14:15], v3 offset:30720
    ds_read_b64_tr_b16 v[16:17], v3 offset:31232
    ds_read_b64_tr_b16 v[18:19], v4 offset:30720
    ds_read_b64_tr_b16 v[20:21], v4 offset:31232
    v_pk_mul_f32 v[222:223], v[222:223], s[96:97]
    v_pk_mul_f32 v[224:225], v[224:225], s[96:97]
    v_cvt_pk_bf16_f32 v222, v222, v223
    v_cvt_pk_bf16_f32 v223, v224, v225
    s_mul_i32 s42, s93, 25
    s_add_u32 s42, s42, s92
    s_nop 1
    v_mfma_f32_32x32x16_bf16 v[206:221], v[26:29], v[178:181], v[206:221]
    v_permlane32_swap_b32 v222, v224
    v_permlane32_swap_b32 v223, v225
    s_mov_b32 exec_hi, 0
    buffer_store_dwordx4 v[222:225], v2, s[88:91], s42 offen offset:512 sc1
    s_mov_b32 exec_hi, -1
    s_nop 1
    v_pk_mul_f32 v[226:227], v[226:227], s[96:97]
    v_pk_mul_f32 v[228:229], v[228:229], s[96:97]
    v_cvt_pk_bf16_f32 v226, v226, v227
    v_cvt_pk_bf16_f32 v227, v228, v229
    s_waitcnt lgkmcnt(4)
    v_mfma_f32_32x32x16_bf16 v[190:205], v[6:9], v[182:185], v[190:205]
    v_pk_mul_f32 v[230:231], v[230:231], s[96:97]
    v_pk_mul_f32 v[232:233], v[232:233], s[96:97]
    v_cvt_pk_bf16_f32 v228, v230, v231
    v_cvt_pk_bf16_f32 v229, v232, v233
    s_mul_i32 s42, s93, 26
    s_add_u32 s42, s42, s92
    s_nop 1
    v_mfma_f32_32x32x16_bf16 v[206:221], v[10:13], v[182:185], v[206:221]
    v_permlane32_swap_b32 v226, v228
    v_permlane32_swap_b32 v227, v229
    buffer_store_dwordx4 v[226:229], v2, s[88:91], s42 offen sc1
    s_nop 1
    s_barrier
    v_add_u32 v3, -131072, v3
    v_add_u32 v4, -131072, v4
    ds_read_b64_tr_b16 v[22:23], v3 offset:0
    ds_read_b64_tr_b16 v[24:25], v3 offset:512
    ds_read_b64_tr_b16 v[26:27], v4 offset:0
    ds_read_b64_tr_b16 v[28:29], v4 offset:512
    v_pk_mul_f32 v[234:235], v[234:235], s[96:97]
    v_pk_mul_f32 v[236:237], v[236:237], s[96:97]
    v_cvt_pk_bf16_f32 v234, v234, v235
    v_cvt_pk_bf16_f32 v235, v236, v237
    s_mul_i32 s42, s93, 26
    s_add_u32 s42, s42, s92
    s_waitcnt lgkmcnt(4)
    v_mfma_f32_32x32x16_bf16 v[190:205], v[14:17], v[186:189], v[190:205]
    ds_read_b64_tr_b16 v[6:7], v3 offset:2048
    ds_read_b64_tr_b16 v[8:9], v3 offset:2560
    ds_read_b64_tr_b16 v[10:11], v4 offset:2048
    ds_read_b64_tr_b16 v[12:13], v4 offset:2560
    v_mov_b32_dpp v236, v234 quad_perm:[1,1,3,3] row_mask:0xf bank_mask:0xf
    v_mov_b32_dpp v237, v235 quad_perm:[1,1,3,3] row_mask:0xf bank_mask:0xf
    s_mov_b64 exec, s[58:59]
    buffer_store_dwordx4 v[234:237], v254, s[88:91], s42 offen offset:1024 sc1
    s_mov_b64 exec, -1
    s_nop 1
    v_mfma_f32_32x32x16_bf16 v[206:221], v[18:21], v[186:189], v[206:221]
    v_pk_mul_f32 v[238:239], v[238:239], s[96:97]
    v_pk_mul_f32 v[240:241], v[240:241], s[96:97]
    v_cvt_pk_bf16_f32 v238, v238, v239
    v_cvt_pk_bf16_f32 v239, v240, v241
    s_nop 1
    v_pk_mul_f32 v[242:243], v[242:243], s[96:97]
    v_pk_mul_f32 v[244:245], v[244:245], s[96:97]
    v_cvt_pk_bf16_f32 v240, v242, v243
    v_cvt_pk_bf16_f32 v241, v244, v245
    s_mul_i32 s42, s93, 27
    s_add_u32 s42, s42, s92
    s_nop 1
    v_permlane32_swap_b32 v238, v240
    v_permlane32_swap_b32 v239, v241
    buffer_store_dwordx4 v[238:241], v2, s[88:91], s42 offen sc1
    s_nop 1
    v_pk_mul_f32 v[246:247], v[246:247], s[96:97]
    v_pk_mul_f32 v[248:249], v[248:249], s[96:97]
    v_cvt_pk_bf16_f32 v246, v246, v247
    v_cvt_pk_bf16_f32 v247, v248, v249
    s_nop 1
    v_pk_mul_f32 v[250:251], v[250:251], s[96:97]
    v_pk_mul_f32 v[252:253], v[252:253], s[96:97]
    v_cvt_pk_bf16_f32 v248, v250, v251
    v_cvt_pk_bf16_f32 v249, v252, v253
    s_mul_i32 s42, s93, 28
    s_add_u32 s42, s42, s92
    s_nop 1
    v_permlane32_swap_b32 v246, v248
    v_permlane32_swap_b32 v247, v249
    buffer_store_dwordx4 v[246:249], v2, s[88:91], s42 offen sc1
    s_waitcnt lgkmcnt(4)
    v_mfma_f32_32x32x16_bf16 v[222:237], v[22:25], v[30:33], 0
    ds_read_b64_tr_b16 v[14:15], v3 offset:4096
    ds_read_b64_tr_b16 v[16:17], v3 offset:4608
    ds_read_b64_tr_b16 v[18:19], v4 offset:4096
    ds_read_b64_tr_b16 v[20:21], v4 offset:4608
    v_mfma_f32_32x32x16_bf16 v[238:253], v[26:29], v[30:33], 0
    s_waitcnt lgkmcnt(4)
    v_mfma_f32_32x32x16_bf16 v[222:237], v[6:9], v[34:37], v[222:237]
    ds_read_b64_tr_b16 v[22:23], v3 offset:6144
    ds_read_b64_tr_b16 v[24:25], v3 offset:6656
    ds_read_b64_tr_b16 v[26:27], v4 offset:6144
    ds_read_b64_tr_b16 v[28:29], v4 offset:6656
    v_pk_mul_f32 v[190:191], v[190:191], s[96:97]
    v_pk_mul_f32 v[192:193], v[192:193], s[96:97]
    v_cvt_pk_bf16_f32 v190, v190, v191
    v_cvt_pk_bf16_f32 v191, v192, v193
    s_mul_i32 s42, s93, 28
    s_add_u32 s42, s42, s92
    s_nop 1
    v_mfma_f32_32x32x16_bf16 v[238:253], v[10:13], v[34:37], v[238:253]
    v_mov_b32_dpp v192, v190 quad_perm:[1,1,3,3] row_mask:0xf bank_mask:0xf
    v_mov_b32_dpp v193, v191 quad_perm:[1,1,3,3] row_mask:0xf bank_mask:0xf
    s_mov_b64 exec, s[58:59]
    buffer_store_dwordx4 v[190:193], v254, s[88:91], s42 offen offset:1024 sc1
    s_mov_b64 exec, -1
    s_waitcnt lgkmcnt(4)
    v_mfma_f32_32x32x16_bf16 v[222:237], v[14:17], v[38:41], v[222:237]
    ds_read_b64_tr_b16 v[6:7], v3 offset:8192
    ds_read_b64_tr_b16 v[8:9], v3 offset:8704
    ds_read_b64_tr_b16 v[10:11], v4 offset:8192
    ds_read_b64_tr_b16 v[12:13], v4 offset:8704
    v_pk_mul_f32 v[194:195], v[194:195], s[96:97]
    v_pk_mul_f32 v[196:197], v[196:197], s[96:97]
    v_cvt_pk_bf16_f32 v194, v194, v195
    v_cvt_pk_bf16_f32 v195, v196, v197
    s_nop 1
    v_mfma_f32_32x32x16_bf16 v[238:253], v[18:21], v[38:41], v[238:253]
    v_pk_mul_f32 v[198:199], v[198:199], s[96:97]
    v_pk_mul_f32 v[200:201], v[200:201], s[96:97]
    v_cvt_pk_bf16_f32 v196, v198, v199
    v_cvt_pk_bf16_f32 v197, v200, v201
    s_mul_i32 s42, s93, 29
    s_add_u32 s42, s42, s92
    s_waitcnt lgkmcnt(4)
    v_mfma_f32_32x32x16_bf16 v[222:237], v[22:25], v[42:45], v[222:237]
    ds_read_b64_tr_b16 v[14:15], v3 offset:10240
    ds_read_b64_tr_b16 v[16:17], v3 offset:10752
    ds_read_b64_tr_b16 v[18:19], v4 offset:10240
    ds_read_b64_tr_b16 v[20:21], v4 offset:10752
    v_permlane32_swap_b32 v194, v196
    v_permlane32_swap_b32 v195, v197
    buffer_store_dwordx4 v[194:197], v2, s[88:91], s42 offen sc1
    s_nop 1
    v_mfma_f32_32x32x16_bf16 v[238:253], v[26:29], v[42:45], v[238:253]
    v_pk_mul_f32 v[202:203], v[202:203], s[96:97]
    v_pk_mul_f32 v[204:205], v[204:205], s[96:97]
    v_cvt_pk_bf16_f32 v202, v202, v203
    v_cvt_pk_bf16_f32 v203, v204, v205
    s_waitcnt lgkmcnt(4)
    v_mfma_f32_32x32x16_bf16 v[222:237], v[6:9], v[46:49], v[222:237]
    ds_read_b64_tr_b16 v[22:23], v3 offset:12288
    ds_read_b64_tr_b16 v[24:25], v3 offset:12800
    ds_read_b64_tr_b16 v[26:27], v4 offset:12288
    ds_read_b64_tr_b16 v[28:29], v4 offset:12800
    v_pk_mul_f32 v[206:207], v[206:207], s[96:97]
    v_pk_mul_f32 v[208:209], v[208:209], s[96:97]
    v_cvt_pk_bf16_f32 v204, v206, v207
    v_cvt_pk_bf16_f32 v205, v208, v209
    s_mul_i32 s42, s93, 30
    s_add_u32 s42, s42, s92
    s_nop 1
    v_mfma_f32_32x32x16_bf16 v[238:253], v[10:13], v[46:49], v[238:253]
    v_permlane32_swap_b32 v202, v204
    v_permlane32_swap_b32 v203, v205
    buffer_store_dwordx4 v[202:205], v2, s[88:91], s42 offen sc1
    s_waitcnt lgkmcnt(4)
    v_mfma_f32_32x32x16_bf16 v[222:237], v[14:17], v[50:53], v[222:237]
    ds_read_b64_tr_b16 v[6:7], v3 offset:14336
    ds_read_b64_tr_b16 v[8:9], v3 offset:14848
    ds_read_b64_tr_b16 v[10:11], v4 offset:14336
    ds_read_b64_tr_b16 v[12:13], v4 offset:14848
    v_pk_mul_f32 v[210:211], v[210:211], s[96:97]
    v_pk_mul_f32 v[212:213], v[212:213], s[96:97]
    v_cvt_pk_bf16_f32 v210, v210, v211
    v_cvt_pk_bf16_f32 v211, v212, v213
    s_mul_i32 s42, s93, 30
    s_add_u32 s42, s42, s92
    s_nop 1
    v_mfma_f32_32x32x16_bf16 v[238:253], v[18:21], v[50:53], v[238:253]
    v_mov_b32_dpp v212, v210 quad_perm:[1,1,3,3] row_mask:0xf bank_mask:0xf
    v_mov_b32_dpp v213, v211 quad_perm:[1,1,3,3] row_mask:0xf bank_mask:0xf
    s_mov_b64 exec, s[58:59]
    buffer_store_dwordx4 v[210:213], v254, s[88:91], s42 offen offset:1024 sc1
    s_mov_b64 exec, -1
    s_waitcnt lgkmcnt(4)
    v_mfma_f32_32x32x16_bf16 v[222:237], v[22:25], v[54:57], v[222:237]
    ds_read_b64_tr_b16 v[14:15], v3 offset:16384
    ds_read_b64_tr_b16 v[16:17], v3 offset:16896
    ds_read_b64_tr_b16 v[18:19], v4 offset:16384
    ds_read_b64_tr_b16 v[20:21], v4 offset:16896
    v_pk_mul_f32 v[214:215], v[214:215], s[96:97]
    v_pk_mul_f32 v[216:217], v[216:217], s[96:97]
    v_cvt_pk_bf16_f32 v214, v214, v215
    v_cvt_pk_bf16_f32 v215, v216, v217
    s_nop 1
    v_mfma_f32_32x32x16_bf16 v[238:253], v[26:29], v[54:57], v[238:253]
    v_pk_mul_f32 v[218:219], v[218:219], s[96:97]
    v_pk_mul_f32 v[220:221], v[220:221], s[96:97]
    v_cvt_pk_bf16_f32 v216, v218, v219
    v_cvt_pk_bf16_f32 v217, v220, v221
    s_mul_i32 s42, s93, 31
    s_add_u32 s42, s42, s92
    s_waitcnt lgkmcnt(4)
    v_mfma_f32_32x32x16_bf16 v[222:237], v[6:9], v[58:61], v[222:237]
    ds_read_b64_tr_b16 v[22:23], v3 offset:18432
    ds_read_b64_tr_b16 v[24:25], v3 offset:18944
    ds_read_b64_tr_b16 v[26:27], v4 offset:18432
    ds_read_b64_tr_b16 v[28:29], v4 offset:18944
    v_permlane32_swap_b32 v214, v216
    v_permlane32_swap_b32 v215, v217
    buffer_store_dwordx4 v[214:217], v2, s[88:91], s42 offen sc1
    s_nop 1
    v_mfma_f32_32x32x16_bf16 v[238:253], v[10:13], v[58:61], v[238:253]
    s_waitcnt lgkmcnt(4)
    v_mfma_f32_32x32x16_bf16 v[222:237], v[14:17], v[62:65], v[222:237]
    v_mfma_f32_32x32x16_bf16 v[238:253], v[18:21], v[62:65], v[238:253]
    s_barrier
    ds_read_b64_tr_b16 v[6:7], v3 offset:20480
    ds_read_b64_tr_b16 v[8:9], v3 offset:20992
    ds_read_b64_tr_b16 v[10:11], v4 offset:20480
    ds_read_b64_tr_b16 v[12:13], v4 offset:20992
    s_waitcnt lgkmcnt(4)
    v_mfma_f32_32x32x16_bf16 v[222:237], v[22:25], v[66:69], v[222:237]
    ds_read_b64_tr_b16 v[14:15], v3 offset:22528
    ds_read_b64_tr_b16 v[16:17], v3 offset:23040
    ds_read_b64_tr_b16 v[18:19], v4 offset:22528
    ds_read_b64_tr_b16 v[20:21], v4 offset:23040
    v_mfma_f32_32x32x16_bf16 v[238:253], v[26:29], v[66:69], v[238:253]
    s_waitcnt lgkmcnt(4)
    v_mfma_f32_32x32x16_bf16 v[222:237], v[6:9], v[70:73], v[222:237]
    ds_read_b64_tr_b16 v[22:23], v3 offset:24576
    ds_read_b64_tr_b16 v[24:25], v3 offset:25088
    ds_read_b64_tr_b16 v[26:27], v4 offset:24576
    ds_read_b64_tr_b16 v[28:29], v4 offset:25088
    v_mfma_f32_32x32x16_bf16 v[238:253], v[10:13], v[70:73], v[238:253]
    s_waitcnt lgkmcnt(4)
    v_mfma_f32_32x32x16_bf16 v[222:237], v[14:17], v[74:77], v[222:237]
    ds_read_b64_tr_b16 v[6:7], v3 offset:26624
    ds_read_b64_tr_b16 v[8:9], v3 offset:27136
    ds_read_b64_tr_b16 v[10:11], v4 offset:26624
    ds_read_b64_tr_b16 v[12:13], v4 offset:27136
    v_mfma_f32_32x32x16_bf16 v[238:253], v[18:21], v[74:77], v[238:253]
    s_waitcnt lgkmcnt(4)
    v_mfma_f32_32x32x16_bf16 v[222:237], v[22:25], v[78:81], v[222:237]
    ds_read_b64_tr_b16 v[14:15], v3 offset:28672
    ds_read_b64_tr_b16 v[16:17], v3 offset:29184
    ds_read_b64_tr_b16 v[18:19], v4 offset:28672
    ds_read_b64_tr_b16 v[20:21], v4 offset:29184
    v_mfma_f32_32x32x16_bf16 v[238:253], v[26:29], v[78:81], v[238:253]
    s_waitcnt lgkmcnt(4)
    v_mfma_f32_32x32x16_bf16 v[222:237], v[6:9], v[82:85], v[222:237]
    ds_read_b64_tr_b16 v[22:23], v3 offset:30720
    ds_read_b64_tr_b16 v[24:25], v3 offset:31232
    ds_read_b64_tr_b16 v[26:27], v4 offset:30720
    ds_read_b64_tr_b16 v[28:29], v4 offset:31232
    v_mfma_f32_32x32x16_bf16 v[238:253], v[10:13], v[82:85], v[238:253]
    s_waitcnt lgkmcnt(4)
    v_mfma_f32_32x32x16_bf16 v[222:237], v[14:17], v[86:89], v[222:237]
    ds_read_b64_tr_b16 v[6:7], v3 offset:32768
    ds_read_b64_tr_b16 v[8:9], v3 offset:33280
    ds_read_b64_tr_b16 v[10:11], v4 offset:32768
    ds_read_b64_tr_b16 v[12:13], v4 offset:33280
    v_mfma_f32_32x32x16_bf16 v[238:253], v[18:21], v[86:89], v[238:253]
    s_waitcnt lgkmcnt(4)
    v_mfma_f32_32x32x16_bf16 v[222:237], v[22:25], v[90:93], v[222:237]
    ds_read_b64_tr_b16 v[14:15], v3 offset:34816
    ds_read_b64_tr_b16 v[16:17], v3 offset:35328
    ds_read_b64_tr_b16 v[18:19], v4 offset:34816
    ds_read_b64_tr_b16 v[20:21], v4 offset:35328
    v_mfma_f32_32x32x16_bf16 v[238:253], v[26:29], v[90:93], v[238:253]
    s_waitcnt lgkmcnt(4)
    v_mfma_f32_32x32x16_bf16 v[222:237], v[6:9], v[94:97], v[222:237]
    ds_read_b64_tr_b16 v[22:23], v3 offset:36864
    ds_read_b64_tr_b16 v[24:25], v3 offset:37376
    ds_read_b64_tr_b16 v[26:27], v4 offset:36864
    ds_read_b64_tr_b16 v[28:29], v4 offset:37376
    v_mfma_f32_32x32x16_bf16 v[238:253], v[10:13], v[94:97], v[238:253]
    s_waitcnt lgkmcnt(4)
    v_mfma_f32_32x32x16_bf16 v[222:237], v[14:17], v[98:101], v[222:237]
    ds_read_b64_tr_b16 v[6:7], v3 offset:38912
    ds_read_b64_tr_b16 v[8:9], v3 offset:39424
    ds_read_b64_tr_b16 v[10:11], v4 offset:38912
    ds_read_b64_tr_b16 v[12:13], v4 offset:39424
    v_mfma_f32_32x32x16_bf16 v[238:253], v[18:21], v[98:101], v[238:253]
    s_waitcnt lgkmcnt(4)
    v_mfma_f32_32x32x16_bf16 v[222:237], v[22:25], v[102:105], v[222:237]
    v_mfma_f32_32x32x16_bf16 v[238:253], v[26:29], v[102:105], v[238:253]
    s_waitcnt vmcnt(0)
    s_barrier
    v_mov_b32_e64 v254, 1
    buffer_store_dword v254, v255, s[48:51], s98 offen sc1
    ds_read_b64_tr_b16 v[14:15], v3 offset:40960
    ds_read_b64_tr_b16 v[16:17], v3 offset:41472
    ds_read_b64_tr_b16 v[18:19], v4 offset:40960
    ds_read_b64_tr_b16 v[20:21], v4 offset:41472
    s_waitcnt lgkmcnt(4)
    v_mfma_f32_32x32x16_bf16 v[222:237], v[6:9], v[106:109], v[222:237]
    ds_read_b64_tr_b16 v[22:23], v3 offset:43008
    ds_read_b64_tr_b16 v[24:25], v3 offset:43520
    ds_read_b64_tr_b16 v[26:27], v4 offset:43008
    ds_read_b64_tr_b16 v[28:29], v4 offset:43520
    v_mfma_f32_32x32x16_bf16 v[238:253], v[10:13], v[106:109], v[238:253]
    s_waitcnt lgkmcnt(4)
    v_mfma_f32_32x32x16_bf16 v[222:237], v[14:17], v[110:113], v[222:237]
    ds_read_b64_tr_b16 v[6:7], v3 offset:45056
    ds_read_b64_tr_b16 v[8:9], v3 offset:45568
    ds_read_b64_tr_b16 v[10:11], v4 offset:45056
    ds_read_b64_tr_b16 v[12:13], v4 offset:45568
    v_mfma_f32_32x32x16_bf16 v[238:253], v[18:21], v[110:113], v[238:253]
    s_waitcnt lgkmcnt(4)
    v_mfma_f32_32x32x16_bf16 v[222:237], v[22:25], v[114:117], v[222:237]
    ds_read_b64_tr_b16 v[14:15], v3 offset:47104
    ds_read_b64_tr_b16 v[16:17], v3 offset:47616
    ds_read_b64_tr_b16 v[18:19], v4 offset:47104
    ds_read_b64_tr_b16 v[20:21], v4 offset:47616
    v_mfma_f32_32x32x16_bf16 v[238:253], v[26:29], v[114:117], v[238:253]
    s_waitcnt lgkmcnt(4)
    v_mfma_f32_32x32x16_bf16 v[222:237], v[6:9], v[118:121], v[222:237]
    ds_read_b64_tr_b16 v[22:23], v3 offset:49152
    ds_read_b64_tr_b16 v[24:25], v3 offset:49664
    ds_read_b64_tr_b16 v[26:27], v4 offset:49152
    ds_read_b64_tr_b16 v[28:29], v4 offset:49664
    v_mfma_f32_32x32x16_bf16 v[238:253], v[10:13], v[118:121], v[238:253]
    s_waitcnt lgkmcnt(4)
    v_mfma_f32_32x32x16_bf16 v[222:237], v[14:17], v[122:125], v[222:237]
    ds_read_b64_tr_b16 v[6:7], v3 offset:51200
    ds_read_b64_tr_b16 v[8:9], v3 offset:51712
    ds_read_b64_tr_b16 v[10:11], v4 offset:51200
    ds_read_b64_tr_b16 v[12:13], v4 offset:51712
    v_mfma_f32_32x32x16_bf16 v[238:253], v[18:21], v[122:125], v[238:253]
    s_waitcnt lgkmcnt(4)
    v_mfma_f32_32x32x16_bf16 v[222:237], v[22:25], v[126:129], v[222:237]
    ds_read_b64_tr_b16 v[14:15], v3 offset:53248
    ds_read_b64_tr_b16 v[16:17], v3 offset:53760
    ds_read_b64_tr_b16 v[18:19], v4 offset:53248
    ds_read_b64_tr_b16 v[20:21], v4 offset:53760
    v_mfma_f32_32x32x16_bf16 v[238:253], v[26:29], v[126:129], v[238:253]
    s_waitcnt lgkmcnt(4)
    v_mfma_f32_32x32x16_bf16 v[222:237], v[6:9], v[130:133], v[222:237]
    ds_read_b64_tr_b16 v[22:23], v3 offset:55296
    ds_read_b64_tr_b16 v[24:25], v3 offset:55808
    ds_read_b64_tr_b16 v[26:27], v4 offset:55296
    ds_read_b64_tr_b16 v[28:29], v4 offset:55808
    v_mfma_f32_32x32x16_bf16 v[238:253], v[10:13], v[130:133], v[238:253]
    s_waitcnt lgkmcnt(4)
    v_mfma_f32_32x32x16_bf16 v[222:237], v[14:17], v[134:137], v[222:237]
    ds_read_b64_tr_b16 v[6:7], v3 offset:57344
    ds_read_b64_tr_b16 v[8:9], v3 offset:57856
    ds_read_b64_tr_b16 v[10:11], v4 offset:57344
    ds_read_b64_tr_b16 v[12:13], v4 offset:57856
    v_mfma_f32_32x32x16_bf16 v[238:253], v[18:21], v[134:137], v[238:253]
    s_waitcnt lgkmcnt(4)
    v_mfma_f32_32x32x16_bf16 v[222:237], v[22:25], v[138:141], v[222:237]
    ds_read_b64_tr_b16 v[14:15], v3 offset:59392
    ds_read_b64_tr_b16 v[16:17], v3 offset:59904
    ds_read_b64_tr_b16 v[18:19], v4 offset:59392
    ds_read_b64_tr_b16 v[20:21], v4 offset:59904
    v_mfma_f32_32x32x16_bf16 v[238:253], v[26:29], v[138:141], v[238:253]
    s_waitcnt lgkmcnt(4)
    v_mfma_f32_32x32x16_bf16 v[222:237], v[6:9], v[142:145], v[222:237]
    v_mfma_f32_32x32x16_bf16 v[238:253], v[10:13], v[142:145], v[238:253]
    s_barrier
    v_add_u32 v3, 61440, v3
    v_add_u32 v4, 61440, v4
    ds_read_b64_tr_b16 v[22:23], v3 offset:0
    ds_read_b64_tr_b16 v[24:25], v3 offset:512
    ds_read_b64_tr_b16 v[26:27], v4 offset:0
    ds_read_b64_tr_b16 v[28:29], v4 offset:512
    s_waitcnt lgkmcnt(4)
    v_mfma_f32_32x32x16_bf16 v[222:237], v[14:17], v[146:149], v[222:237]
    ds_read_b64_tr_b16 v[6:7], v3 offset:2048
    ds_read_b64_tr_b16 v[8:9], v3 offset:2560
    ds_read_b64_tr_b16 v[10:11], v4 offset:2048
    ds_read_b64_tr_b16 v[12:13], v4 offset:2560
    v_mfma_f32_32x32x16_bf16 v[238:253], v[18:21], v[146:149], v[238:253]
    s_waitcnt lgkmcnt(4)
    v_mfma_f32_32x32x16_bf16 v[222:237], v[22:25], v[150:153], v[222:237]
    ds_read_b64_tr_b16 v[14:15], v3 offset:4096
    ds_read_b64_tr_b16 v[16:17], v3 offset:4608
    ds_read_b64_tr_b16 v[18:19], v4 offset:4096
    ds_read_b64_tr_b16 v[20:21], v4 offset:4608
    v_mfma_f32_32x32x16_bf16 v[238:253], v[26:29], v[150:153], v[238:253]
    s_waitcnt lgkmcnt(4)
    v_mfma_f32_32x32x16_bf16 v[222:237], v[6:9], v[154:157], v[222:237]
    ds_read_b64_tr_b16 v[22:23], v3 offset:6144
    ds_read_b64_tr_b16 v[24:25], v3 offset:6656
    ds_read_b64_tr_b16 v[26:27], v4 offset:6144
    ds_read_b64_tr_b16 v[28:29], v4 offset:6656
    v_mfma_f32_32x32x16_bf16 v[238:253], v[10:13], v[154:157], v[238:253]
    s_waitcnt lgkmcnt(4)
    v_mfma_f32_32x32x16_bf16 v[222:237], v[14:17], v[158:161], v[222:237]
    ds_read_b64_tr_b16 v[6:7], v3 offset:8192
    ds_read_b64_tr_b16 v[8:9], v3 offset:8704
    ds_read_b64_tr_b16 v[10:11], v4 offset:8192
    ds_read_b64_tr_b16 v[12:13], v4 offset:8704
    v_mfma_f32_32x32x16_bf16 v[238:253], v[18:21], v[158:161], v[238:253]
    s_waitcnt lgkmcnt(4)
    v_mfma_f32_32x32x16_bf16 v[222:237], v[22:25], v[162:165], v[222:237]
    ds_read_b64_tr_b16 v[14:15], v3 offset:10240
    ds_read_b64_tr_b16 v[16:17], v3 offset:10752
    ds_read_b64_tr_b16 v[18:19], v4 offset:10240
    ds_read_b64_tr_b16 v[20:21], v4 offset:10752
    v_mfma_f32_32x32x16_bf16 v[238:253], v[26:29], v[162:165], v[238:253]
    s_waitcnt lgkmcnt(4)
    v_mfma_f32_32x32x16_bf16 v[222:237], v[6:9], v[166:169], v[222:237]
    ds_read_b64_tr_b16 v[22:23], v3 offset:12288
    ds_read_b64_tr_b16 v[24:25], v3 offset:12800
    ds_read_b64_tr_b16 v[26:27], v4 offset:12288
    ds_read_b64_tr_b16 v[28:29], v4 offset:12800
    v_mfma_f32_32x32x16_bf16 v[238:253], v[10:13], v[166:169], v[238:253]
    s_waitcnt lgkmcnt(4)
    v_mfma_f32_32x32x16_bf16 v[222:237], v[14:17], v[170:173], v[222:237]
    ds_read_b64_tr_b16 v[6:7], v3 offset:14336
    ds_read_b64_tr_b16 v[8:9], v3 offset:14848
    ds_read_b64_tr_b16 v[10:11], v4 offset:14336
    ds_read_b64_tr_b16 v[12:13], v4 offset:14848
    v_mfma_f32_32x32x16_bf16 v[238:253], v[18:21], v[170:173], v[238:253]
    s_waitcnt lgkmcnt(4)
    v_mfma_f32_32x32x16_bf16 v[222:237], v[22:25], v[174:177], v[222:237]
    ds_read_b64_tr_b16 v[14:15], v3 offset:16384
    ds_read_b64_tr_b16 v[16:17], v3 offset:16896
    ds_read_b64_tr_b16 v[18:19], v4 offset:16384
    ds_read_b64_tr_b16 v[20:21], v4 offset:16896
    v_mfma_f32_32x32x16_bf16 v[238:253], v[26:29], v[174:177], v[238:253]
    s_waitcnt lgkmcnt(4)
    v_mfma_f32_32x32x16_bf16 v[222:237], v[6:9], v[178:181], v[222:237]
    ds_read_b64_tr_b16 v[22:23], v3 offset:18432
    ds_read_b64_tr_b16 v[24:25], v3 offset:18944
    ds_read_b64_tr_b16 v[26:27], v4 offset:18432
    ds_read_b64_tr_b16 v[28:29], v4 offset:18944
    v_mfma_f32_32x32x16_bf16 v[238:253], v[10:13], v[178:181], v[238:253]
    s_waitcnt lgkmcnt(4)
    v_mfma_f32_32x32x16_bf16 v[222:237], v[14:17], v[182:185], v[222:237]
    v_mfma_f32_32x32x16_bf16 v[238:253], v[18:21], v[182:185], v[238:253]
    s_waitcnt lgkmcnt(0)
    s_barrier
    ds_read_b64_tr_b16 v[6:7], v5 offset:0
    ds_read_b64_tr_b16 v[8:9], v5 offset:256
    s_waitcnt lgkmcnt(2)
    v_mfma_f32_32x32x16_bf16 v[222:237], v[22:25], v[186:189], v[222:237]
    ds_read_b64_tr_b16 v[14:15], v5 offset:1024
    ds_read_b64_tr_b16 v[16:17], v5 offset:1280
    v_mfma_f32_32x32x16_bf16 v[238:253], v[26:29], v[186:189], v[238:253]
    s_waitcnt lgkmcnt(2)
    v_mfma_f32_32x32x16_bf16 v[190:205], v[6:9], v[30:33], 0
    ds_read_b64_tr_b16 v[22:23], v5 offset:2048
    ds_read_b64_tr_b16 v[24:25], v5 offset:2304
    s_waitcnt lgkmcnt(2)
    v_mfma_f32_32x32x16_bf16 v[190:205], v[14:17], v[34:37], v[190:205]
    ds_read_b64_tr_b16 v[6:7], v5 offset:3072
    ds_read_b64_tr_b16 v[8:9], v5 offset:3328
    s_waitcnt lgkmcnt(2)
    v_mfma_f32_32x32x16_bf16 v[190:205], v[22:25], v[38:41], v[190:205]
    ds_read_b64_tr_b16 v[14:15], v5 offset:4096
    ds_read_b64_tr_b16 v[16:17], v5 offset:4352
    v_cvt_pk_bf16_f32 v222, v222, v223
    v_cvt_pk_bf16_f32 v223, v224, v225
    v_cvt_pk_bf16_f32 v224, v226, v227
    v_cvt_pk_bf16_f32 v225, v228, v229
    s_waitcnt lgkmcnt(2)
    v_mfma_f32_32x32x16_bf16 v[190:205], v[6:9], v[42:45], v[190:205]
    ds_read_b64_tr_b16 v[22:23], v5 offset:5120
    ds_read_b64_tr_b16 v[24:25], v5 offset:5376
    v_pk_max_i16 v222, v222, 0
    v_pk_max_i16 v223, v223, 0
    v_pk_max_i16 v224, v224, 0
    v_pk_max_i16 v225, v225, 0
    s_waitcnt lgkmcnt(2)
    v_mfma_f32_32x32x16_bf16 v[190:205], v[14:17], v[46:49], v[190:205]
    ds_read_b64_tr_b16 v[6:7], v5 offset:6144
    ds_read_b64_tr_b16 v[8:9], v5 offset:6400
    v_cvt_pk_bf16_f32 v230, v230, v231
    v_cvt_pk_bf16_f32 v231, v232, v233
    v_cvt_pk_bf16_f32 v232, v234, v235
    v_cvt_pk_bf16_f32 v233, v236, v237
    s_waitcnt lgkmcnt(2)
    v_mfma_f32_32x32x16_bf16 v[190:205], v[22:25], v[50:53], v[190:205]
    ds_read_b64_tr_b16 v[14:15], v5 offset:7168
    ds_read_b64_tr_b16 v[16:17], v5 offset:7424
    v_pk_max_i16 v230, v230, 0
    v_pk_max_i16 v231, v231, 0
    v_pk_max_i16 v232, v232, 0
    v_pk_max_i16 v233, v233, 0
    s_waitcnt lgkmcnt(2)
    v_mfma_f32_32x32x16_bf16 v[190:205], v[6:9], v[54:57], v[190:205]
    ds_read_b64_tr_b16 v[22:23], v5 offset:8192
    ds_read_b64_tr_b16 v[24:25], v5 offset:8448
    v_cvt_pk_bf16_f32 v238, v238, v239
    v_cvt_pk_bf16_f32 v239, v240, v241
    v_cvt_pk_bf16_f32 v240, v242, v243
    v_cvt_pk_bf16_f32 v241, v244, v245
    s_waitcnt lgkmcnt(2)
    v_mfma_f32_32x32x16_bf16 v[190:205], v[14:17], v[58:61], v[190:205]
    ds_read_b64_tr_b16 v[6:7], v5 offset:9216
    ds_read_b64_tr_b16 v[8:9], v5 offset:9472
    v_pk_max_i16 v238, v238, 0
    v_pk_max_i16 v239, v239, 0
    v_pk_max_i16 v240, v240, 0
    v_pk_max_i16 v241, v241, 0
    s_waitcnt lgkmcnt(2)
    v_mfma_f32_32x32x16_bf16 v[190:205], v[22:25], v[62:65], v[190:205]
    ds_read_b64_tr_b16 v[14:15], v5 offset:10240
    ds_read_b64_tr_b16 v[16:17], v5 offset:10496
    v_cvt_pk_bf16_f32 v246, v246, v247
    v_cvt_pk_bf16_f32 v247, v248, v249
    v_cvt_pk_bf16_f32 v248, v250, v251
    v_cvt_pk_bf16_f32 v249, v252, v253
    s_waitcnt lgkmcnt(2)
    v_mfma_f32_32x32x16_bf16 v[190:205], v[6:9], v[66:69], v[190:205]
    ds_read_b64_tr_b16 v[22:23], v5 offset:11264
    ds_read_b64_tr_b16 v[24:25], v5 offset:11520
    v_pk_max_i16 v246, v246, 0
    v_pk_max_i16 v247, v247, 0
    v_pk_max_i16 v248, v248, 0
    v_pk_max_i16 v249, v249, 0
    s_waitcnt lgkmcnt(2)
    v_mfma_f32_32x32x16_bf16 v[190:205], v[14:17], v[70:73], v[190:205]
    ds_read_b64_tr_b16 v[6:7], v5 offset:12288
    ds_read_b64_tr_b16 v[8:9], v5 offset:12544
    s_waitcnt lgkmcnt(2)
    v_mfma_f32_32x32x16_bf16 v[190:205], v[22:25], v[74:77], v[190:205]
    ds_read_b64_tr_b16 v[14:15], v5 offset:13312
    ds_read_b64_tr_b16 v[16:17], v5 offset:13568
    s_waitcnt lgkmcnt(2)
    v_mfma_f32_32x32x16_bf16 v[190:205], v[6:9], v[78:81], v[190:205]
    ds_read_b64_tr_b16 v[22:23], v5 offset:14336
    ds_read_b64_tr_b16 v[24:25], v5 offset:14592
    s_waitcnt lgkmcnt(2)
    v_mfma_f32_32x32x16_bf16 v[190:205], v[14:17], v[82:85], v[190:205]
    ds_read_b64_tr_b16 v[6:7], v5 offset:15360
    ds_read_b64_tr_b16 v[8:9], v5 offset:15616
    s_waitcnt lgkmcnt(2)
    v_mfma_f32_32x32x16_bf16 v[190:205], v[22:25], v[86:89], v[190:205]
    ds_read_b64_tr_b16 v[14:15], v5 offset:16384
    ds_read_b64_tr_b16 v[16:17], v5 offset:16640
    s_waitcnt lgkmcnt(2)
    v_mfma_f32_32x32x16_bf16 v[190:205], v[6:9], v[90:93], v[190:205]
    ds_read_b64_tr_b16 v[22:23], v5 offset:17408
    ds_read_b64_tr_b16 v[24:25], v5 offset:17664
    s_waitcnt lgkmcnt(2)
    v_mfma_f32_32x32x16_bf16 v[190:205], v[14:17], v[94:97], v[190:205]
    ds_read_b64_tr_b16 v[6:7], v5 offset:18432
    ds_read_b64_tr_b16 v[8:9], v5 offset:18688
    s_waitcnt lgkmcnt(2)
    v_mfma_f32_32x32x16_bf16 v[190:205], v[22:25], v[98:101], v[190:205]
    ds_read_b64_tr_b16 v[14:15], v5 offset:19456
    ds_read_b64_tr_b16 v[16:17], v5 offset:19712
    s_waitcnt lgkmcnt(2)
    v_mfma_f32_32x32x16_bf16 v[190:205], v[6:9], v[102:105], v[190:205]
    ds_read_b64_tr_b16 v[22:23], v5 offset:20480
    ds_read_b64_tr_b16 v[24:25], v5 offset:20736
    s_waitcnt lgkmcnt(2)
    v_mfma_f32_32x32x16_bf16 v[190:205], v[14:17], v[106:109], v[190:205]
    ds_read_b64_tr_b16 v[6:7], v5 offset:21504
    ds_read_b64_tr_b16 v[8:9], v5 offset:21760
    s_waitcnt lgkmcnt(2)
    v_mfma_f32_32x32x16_bf16 v[190:205], v[22:25], v[110:113], v[190:205]
    ds_read_b64_tr_b16 v[14:15], v5 offset:22528
    ds_read_b64_tr_b16 v[16:17], v5 offset:22784
    s_waitcnt lgkmcnt(2)
    v_mfma_f32_32x32x16_bf16 v[190:205], v[6:9], v[114:117], v[190:205]
    ds_read_b64_tr_b16 v[22:23], v5 offset:23552
    ds_read_b64_tr_b16 v[24:25], v5 offset:23808
    s_waitcnt lgkmcnt(2)
    v_mfma_f32_32x32x16_bf16 v[190:205], v[14:17], v[118:121], v[190:205]
    ds_read_b64_tr_b16 v[6:7], v5 offset:24576
    ds_read_b64_tr_b16 v[8:9], v5 offset:24832
    s_waitcnt lgkmcnt(2)
    v_mfma_f32_32x32x16_bf16 v[190:205], v[22:25], v[122:125], v[190:205]
    ds_read_b64_tr_b16 v[14:15], v5 offset:25600
    ds_read_b64_tr_b16 v[16:17], v5 offset:25856
    s_waitcnt lgkmcnt(2)
    v_mfma_f32_32x32x16_bf16 v[190:205], v[6:9], v[126:129], v[190:205]
    ds_read_b64_tr_b16 v[22:23], v5 offset:26624
    ds_read_b64_tr_b16 v[24:25], v5 offset:26880
    s_waitcnt lgkmcnt(2)
    v_mfma_f32_32x32x16_bf16 v[190:205], v[14:17], v[130:133], v[190:205]
    ds_read_b64_tr_b16 v[6:7], v5 offset:27648
    ds_read_b64_tr_b16 v[8:9], v5 offset:27904
    s_waitcnt lgkmcnt(2)
    v_mfma_f32_32x32x16_bf16 v[190:205], v[22:25], v[134:137], v[190:205]
    ds_read_b64_tr_b16 v[14:15], v5 offset:28672
    ds_read_b64_tr_b16 v[16:17], v5 offset:28928
    s_waitcnt lgkmcnt(2)
    v_mfma_f32_32x32x16_bf16 v[190:205], v[6:9], v[138:141], v[190:205]
    ds_read_b64_tr_b16 v[22:23], v5 offset:29696
    ds_read_b64_tr_b16 v[24:25], v5 offset:29952
    s_waitcnt lgkmcnt(2)
    v_mfma_f32_32x32x16_bf16 v[190:205], v[14:17], v[142:145], v[190:205]
    ds_read_b64_tr_b16 v[6:7], v5 offset:30720
    ds_read_b64_tr_b16 v[8:9], v5 offset:30976
    s_waitcnt lgkmcnt(2)
    v_mfma_f32_32x32x16_bf16 v[190:205], v[22:25], v[146:149], v[190:205]
    ds_read_b64_tr_b16 v[14:15], v5 offset:31744
    ds_read_b64_tr_b16 v[16:17], v5 offset:32000
    s_waitcnt lgkmcnt(2)
    v_mfma_f32_32x32x16_bf16 v[190:205], v[6:9], v[150:153], v[190:205]
    ds_read_b64_tr_b16 v[22:23], v5 offset:32768
    ds_read_b64_tr_b16 v[24:25], v5 offset:33024
    s_waitcnt lgkmcnt(2)
    v_mfma_f32_32x32x16_bf16 v[190:205], v[14:17], v[154:157], v[190:205]
    ds_read_b64_tr_b16 v[6:7], v5 offset:33792
    ds_read_b64_tr_b16 v[8:9], v5 offset:34048
    s_waitcnt lgkmcnt(2)
    v_mfma_f32_32x32x16_bf16 v[190:205], v[22:25], v[158:161], v[190:205]
    ds_read_b64_tr_b16 v[14:15], v5 offset:34816
    ds_read_b64_tr_b16 v[16:17], v5 offset:35072
    s_waitcnt lgkmcnt(2)
    v_mfma_f32_32x32x16_bf16 v[190:205], v[6:9], v[162:165], v[190:205]
    ds_read_b64_tr_b16 v[22:23], v5 offset:35840
    ds_read_b64_tr_b16 v[24:25], v5 offset:36096
    s_waitcnt lgkmcnt(2)
    v_mfma_f32_32x32x16_bf16 v[190:205], v[14:17], v[166:169], v[190:205]
    ds_read_b64_tr_b16 v[6:7], v5 offset:36864
    ds_read_b64_tr_b16 v[8:9], v5 offset:37120
    s_waitcnt lgkmcnt(2)
    v_mfma_f32_32x32x16_bf16 v[190:205], v[22:25], v[170:173], v[190:205]
    ds_read_b64_tr_b16 v[14:15], v5 offset:37888
    ds_read_b64_tr_b16 v[16:17], v5 offset:38144
    s_waitcnt lgkmcnt(2)
    v_mfma_f32_32x32x16_bf16 v[190:205], v[6:9], v[174:177], v[190:205]
    ds_read_b64_tr_b16 v[22:23], v5 offset:38912
    ds_read_b64_tr_b16 v[24:25], v5 offset:39168
    s_waitcnt lgkmcnt(2)
    v_mfma_f32_32x32x16_bf16 v[190:205], v[14:17], v[178:181], v[190:205]
    ds_read_b64_tr_b16 v[6:7], v5 offset:39936
    ds_read_b64_tr_b16 v[8:9], v5 offset:40192
    s_waitcnt lgkmcnt(2)
    v_mfma_f32_32x32x16_bf16 v[190:205], v[22:25], v[182:185], v[190:205]
    s_waitcnt lgkmcnt(0)
    v_mfma_f32_32x32x16_bf16 v[190:205], v[6:9], v[186:189], v[190:205]
    s_nop 3
    s_movk_i32 s44, 0x400
    v_lshlrev_b32 v2, 4, v1
    v_mov_b32 v5, v2
    v_and_b32 v8, 31, v1
    v_lshrrev_b32 v9, 5, v1
    v_lshlrev_b32_e64 v11, 3, v8
    v_mul_u32_u24 v3, 2560, v9
    v_add3_u32 v3, v3, v11, s44
    v_mov_b32 v20, 0
    v_mov_b32 v21, 0
    v_mov_b32 v22, 0
    v_mov_b32 v23, 0
    v_mov_b32 v6, 0
    v_mov_b32 v7, 0
    v_mov_b32 v254, 0
    v_mov_b32 v255, 0
    v_lshrrev_b32 v4, 3, v8
    v_xor_b32 v4, v4, v9
    v_and_b32 v4, 1, v4
    v_lshlrev_b32 v4, 6, v4
    v_lshrrev_b32_e64 v10, 2, v8
    v_lshl_add_u32 v4, v10, 7, v4
    v_and_b32_e64 v10, 3, v8
    v_lshl_add_u32 v4, v10, 4, v4
    v_add_u32 v4, 1280, v4
    v_cmp_eq_u32_e64 vcc, 20, v8
    v_cmp_eq_u32 s[58:59], 24, v8
    s_mul_i32 s42, s74, 2560
    s_add_u32 s42, s42, 71680
    s_or_b64 vcc, vcc, s[58:59]
    v_mov_b32 v10, 0x3f803f80
    s_nop 1
    v_cndmask_b32 v10, 0, v10, vcc
    v_mov_b32 v30, v10
    v_mov_b32 v31, v10
    v_mov_b32 v32, v10
    v_mov_b32 v33, v10
    v_mov_b32 v34, v10
    v_mov_b32 v35, v10
    v_mov_b32 v36, v10
    v_mov_b32 v37, v10
    v_add_u32 v10, s42, v2
    v_add_u32_e64 v11, s42, v11
    s_nop 1
    s_add_u32 s101, s94, s101
    v_cvt_pk_bf16_f32 v190, v190, v191
    v_cvt_pk_bf16_f32 v191, v192, v193
    v_cvt_pk_bf16_f32 v192, v194, v195
    v_cvt_pk_bf16_f32 v193, v196, v197
    s_nop 1
    v_pk_max_i16 v190, v190, 0
    v_pk_max_i16 v191, v191, 0
    v_pk_max_i16 v192, v192, 0
    v_pk_max_i16 v193, v193, 0
    s_nop 1
    v_cvt_pk_bf16_f32 v198, v198, v199
    v_cvt_pk_bf16_f32 v199, v200, v201
    v_cvt_pk_bf16_f32 v200, v202, v203
    v_cvt_pk_bf16_f32 v201, v204, v205
    s_nop 1
    v_pk_max_i16 v198, v198, 0
    v_pk_max_i16 v199, v199, 0
    v_pk_max_i16 v200, v200, 0
    v_pk_max_i16 v201, v201, 0
    s_branch g_att1
g_ch:
    s_waitcnt lgkmcnt(5)
    v_mfma_f32_32x32x16_bf16 v[222:237], v[6:9], v[174:177], v[222:237]
    ds_read_b128 v[182:185], v182 offset:0
    ds_read_b64_tr_b16 v[22:23], v3 offset:20480
    ds_read_b64_tr_b16 v[24:25], v3 offset:20992
    ds_read_b64_tr_b16 v[26:27], v4 offset:20480
    ds_read_b64_tr_b16 v[28:29], v4 offset:20992
    v_mfma_f32_32x32x16_bf16 v[238:253], v[10:13], v[174:177], v[238:253]
    s_waitcnt lgkmcnt(5)
    v_mfma_f32_32x32x16_bf16 v[222:237], v[14:17], v[178:181], v[222:237]
    ds_read_b128 v[186:189], v186 offset:0
    ds_read_b64_tr_b16 v[6:7], v3 offset:22528
    ds_read_b64_tr_b16 v[8:9], v3 offset:23040
    ds_read_b64_tr_b16 v[10:11], v4 offset:22528
    ds_read_b64_tr_b16 v[12:13], v4 offset:23040
    v_mfma_f32_32x32x16_bf16 v[238:253], v[18:21], v[178:181], v[238:253]
    s_waitcnt lgkmcnt(5)
    v_mfma_f32_32x32x16_bf16 v[222:237], v[22:25], v[182:185], v[222:237]
    ds_read_b64_tr_b16 v[14:15], v3 offset:24576
    ds_read_b64_tr_b16 v[16:17], v3 offset:25088
    ds_read_b64_tr_b16 v[18:19], v4 offset:24576
    ds_read_b64_tr_b16 v[20:21], v4 offset:25088
    v_mfma_f32_32x32x16_bf16 v[238:253], v[26:29], v[182:185], v[238:253]
    s_waitcnt lgkmcnt(4)
    v_mfma_f32_32x32x16_bf16 v[222:237], v[6:9], v[186:189], v[222:237]
    ds_read_b64_tr_b16 v[22:23], v3 offset:26624
    ds_read_b64_tr_b16 v[24:25], v3 offset:27136
    ds_read_b64_tr_b16 v[26:27], v4 offset:26624
    ds_read_b64_tr_b16 v[28:29], v4 offset:27136
    v_mfma_f32_32x32x16_bf16 v[238:253], v[10:13], v[186:189], v[238:253]
    s_waitcnt lgkmcnt(4)
    v_mfma_f32_32x32x16_bf16 v[190:205], v[14:17], v[174:177], v[190:205]
    ds_read_b64_tr_b16 v[6:7], v3 offset:28672
    ds_read_b64_tr_b16 v[8:9], v3 offset:29184
    ds_read_b64_tr_b16 v[10:11], v4 offset:28672
    ds_read_b64_tr_b16 v[12:13], v4 offset:29184
    v_mfma_f32_32x32x16_bf16 v[206:221], v[18:21], v[174:177], v[206:221]
    s_waitcnt lgkmcnt(4)
    v_mfma_f32_32x32x16_bf16 v[190:205], v[22:25], v[178:181], v[190:205]
    ds_read_b64_tr_b16 v[14:15], v3 offset:30720
    ds_read_b64_tr_b16 v[16:17], v3 offset:31232
    ds_read_b64_tr_b16 v[18:19], v4 offset:30720
    ds_read_b64_tr_b16 v[20:21], v4 offset:31232
    v_cvt_pk_bf16_f32 v222, v222, v223
    v_cvt_pk_bf16_f32 v223, v224, v225
    v_cvt_pk_bf16_f32 v224, v226, v227
    v_cvt_pk_bf16_f32 v225, v228, v229
    s_nop 1
    v_mfma_f32_32x32x16_bf16 v[206:221], v[26:29], v[178:181], v[206:221]
    v_pk_max_i16 v222, v222, 0
    v_pk_max_i16 v223, v223, 0
    v_pk_max_i16 v224, v224, 0
    v_pk_max_i16 v225, v225, 0
    buffer_store_dwordx4 v[222:225], v2, s[64:67], s94 offen offset:0 sc1
    s_nop 1
    v_cvt_pk_bf16_f32 v230, v230, v231
    v_cvt_pk_bf16_f32 v231, v232, v233
    v_cvt_pk_bf16_f32 v232, v234, v235
    v_cvt_pk_bf16_f32 v233, v236, v237
    s_waitcnt lgkmcnt(4)
    v_mfma_f32_32x32x16_bf16 v[190:205], v[6:9], v[182:185], v[190:205]
    v_pk_max_i16 v230, v230, 0
    v_pk_max_i16 v231, v231, 0
    v_pk_max_i16 v232, v232, 0
    v_pk_max_i16 v233, v233, 0
    buffer_store_dwordx4 v[230:233], v2, s[64:67], s94 offen offset:1024 sc1
    s_nop 1
    v_mfma_f32_32x32x16_bf16 v[206:221], v[10:13], v[182:185], v[206:221]
    v_cvt_pk_bf16_f32 v238, v238, v239
    v_cvt_pk_bf16_f32 v239, v240, v241
    v_cvt_pk_bf16_f32 v240, v242, v243
    v_cvt_pk_bf16_f32 v241, v244, v245
    s_nop 1
    s_barrier
    v_add_u32 v3, -131072, v3
    v_add_u32 v4, -131072, v4
    ds_read_b64_tr_b16 v[22:23], v3 offset:0
    ds_read_b64_tr_b16 v[24:25], v3 offset:512
    ds_read_b64_tr_b16 v[26:27], v4 offset:0
    ds_read_b64_tr_b16 v[28:29], v4 offset:512
    v_pk_max_i16 v238, v238, 0
    v_pk_max_i16 v239, v239, 0
    v_pk_max_i16 v240, v240, 0
    v_pk_max_i16 v241, v241, 0
    buffer_store_dwordx4 v[238:241], v2, s[64:67], s94 offen offset:2048 sc1
    s_waitcnt lgkmcnt(4)
    v_mfma_f32_32x32x16_bf16 v[190:205], v[14:17], v[186:189], v[190:205]
    ds_read_b64_tr_b16 v[6:7], v3 offset:2048
    ds_read_b64_tr_b16 v[8:9], v3 offset:2560
    ds_read_b64_tr_b16 v[10:11], v4 offset:2048
    ds_read_b64_tr_b16 v[12:13], v4 offset:2560
    v_cvt_pk_bf16_f32 v246, v246, v247
    v_cvt_pk_bf16_f32 v247, v248, v249
    v_cvt_pk_bf16_f32 v248, v250, v251
    v_cvt_pk_bf16_f32 v249, v252, v253
    s_nop 1
    v_mfma_f32_32x32x16_bf16 v[206:221], v[18:21], v[186:189], v[206:221]
    v_pk_max_i16 v246, v246, 0
    v_pk_max_i16 v247, v247, 0
    v_pk_max_i16 v248, v248, 0
    v_pk_max_i16 v249, v249, 0
    buffer_store_dwordx4 v[246:249], v2, s[64:67], s94 offen offset:3072 sc1
    s_nop 1
    s_waitcnt lgkmcnt(4)
    v_mfma_f32_32x32x16_bf16 v[222:237], v[22:25], v[30:33], 0
    ds_read_b64_tr_b16 v[14:15], v3 offset:4096
    ds_read_b64_tr_b16 v[16:17], v3 offset:4608
    ds_read_b64_tr_b16 v[18:19], v4 offset:4096
    ds_read_b64_tr_b16 v[20:21], v4 offset:4608
    v_mfma_f32_32x32x16_bf16 v[238:253], v[26:29], v[30:33], 0
    s_waitcnt lgkmcnt(4)
    v_mfma_f32_32x32x16_bf16 v[222:237], v[6:9], v[34:37], v[222:237]
    ds_read_b64_tr_b16 v[22:23], v3 offset:6144
    ds_read_b64_tr_b16 v[24:25], v3 offset:6656
    ds_read_b64_tr_b16 v[26:27], v4 offset:6144
    ds_read_b64_tr_b16 v[28:29], v4 offset:6656
    s_add_u32 s94, s94, 4096
    v_cvt_pk_bf16_f32 v190, v190, v191
    v_cvt_pk_bf16_f32 v191, v192, v193
    v_cvt_pk_bf16_f32 v192, v194, v195
    v_cvt_pk_bf16_f32 v193, v196, v197
    s_nop 1
    v_mfma_f32_32x32x16_bf16 v[238:253], v[10:13], v[34:37], v[238:253]
    v_pk_max_i16 v190, v190, 0
    v_pk_max_i16 v191, v191, 0
    v_pk_max_i16 v192, v192, 0
    v_pk_max_i16 v193, v193, 0
    buffer_store_dwordx4 v[190:193], v2, s[64:67], s94 offen offset:0 sc1
    s_waitcnt lgkmcnt(4)
    v_mfma_f32_32x32x16_bf16 v[222:237], v[14:17], v[38:41], v[222:237]
    ds_read_b64_tr_b16 v[6:7], v3 offset:8192
    ds_read_b64_tr_b16 v[8:9], v3 offset:8704
    ds_read_b64_tr_b16 v[10:11], v4 offset:8192
    ds_read_b64_tr_b16 v[12:13], v4 offset:8704
    v_cvt_pk_bf16_f32 v198, v198, v199
    v_cvt_pk_bf16_f32 v199, v200, v201
    v_cvt_pk_bf16_f32 v200, v202, v203
    v_cvt_pk_bf16_f32 v201, v204, v205
    s_nop 1
    v_mfma_f32_32x32x16_bf16 v[238:253], v[18:21], v[38:41], v[238:253]
    v_pk_max_i16 v198, v198, 0
    v_pk_max_i16 v199, v199, 0
    v_pk_max_i16 v200, v200, 0
    v_pk_max_i16 v201, v201, 0
    buffer_store_dwordx4 v[198:201], v2, s[64:67], s94 offen offset:1024 sc1
    s_waitcnt lgkmcnt(4)
    v_mfma_f32_32x32x16_bf16 v[222:237], v[22:25], v[42:45], v[222:237]
    ds_read_b64_tr_b16 v[14:15], v3 offset:10240
    ds_read_b64_tr_b16 v[16:17], v3 offset:10752
    ds_read_b64_tr_b16 v[18:19], v4 offset:10240
    ds_read_b64_tr_b16 v[20:21], v4 offset:10752
    v_cvt_pk_bf16_f32 v206, v206, v207
    v_cvt_pk_bf16_f32 v207, v208, v209
    v_cvt_pk_bf16_f32 v208, v210, v211
    v_cvt_pk_bf16_f32 v209, v212, v213
    s_nop 1
    v_mfma_f32_32x32x16_bf16 v[238:253], v[26:29], v[42:45], v[238:253]
    v_pk_max_i16 v206, v206, 0
    v_pk_max_i16 v207, v207, 0
    v_pk_max_i16 v208, v208, 0
    v_pk_max_i16 v209, v209, 0
    buffer_store_dwordx4 v[206:209], v2, s[64:67], s94 offen offset:2048 sc1
    s_waitcnt lgkmcnt(4)
    v_mfma_f32_32x32x16_bf16 v[222:237], v[6:9], v[46:49], v[222:237]
    ds_read_b64_tr_b16 v[22:23], v3 offset:12288
    ds_read_b64_tr_b16 v[24:25], v3 offset:12800
    ds_read_b64_tr_b16 v[26:27], v4 offset:12288
    ds_read_b64_tr_b16 v[28:29], v4 offset:12800
    v_cvt_pk_bf16_f32 v214, v214, v215
    v_cvt_pk_bf16_f32 v215, v216, v217
    v_cvt_pk_bf16_f32 v216, v218, v219
    v_cvt_pk_bf16_f32 v217, v220, v221
    s_nop 1
    v_mfma_f32_32x32x16_bf16 v[238:253], v[10:13], v[46:49], v[238:253]
    v_pk_max_i16 v214, v214, 0
    v_pk_max_i16 v215, v215, 0
    v_pk_max_i16 v216, v216, 0
    v_pk_max_i16 v217, v217, 0
    buffer_store_dwordx4 v[214:217], v2, s[64:67], s94 offen offset:3072 sc1
    s_waitcnt lgkmcnt(4)
    v_mfma_f32_32x32x16_bf16 v[222:237], v[14:17], v[50:53], v[222:237]
    ds_read_b64_tr_b16 v[6:7], v3 offset:14336
    ds_read_b64_tr_b16 v[8:9], v3 offset:14848
    ds_read_b64_tr_b16 v[10:11], v4 offset:14336
    ds_read_b64_tr_b16 v[12:13], v4 offset:14848
    v_mfma_f32_32x32x16_bf16 v[238:253], v[18:21], v[50:53], v[238:253]
    s_waitcnt lgkmcnt(4)
    v_mfma_f32_32x32x16_bf16 v[222:237], v[22:25], v[54:57], v[222:237]
    ds_read_b64_tr_b16 v[14:15], v3 offset:16384
    ds_read_b64_tr_b16 v[16:17], v3 offset:16896
    ds_read_b64_tr_b16 v[18:19], v4 offset:16384
    ds_read_b64_tr_b16 v[20:21], v4 offset:16896
    v_mfma_f32_32x32x16_bf16 v[238:253], v[26:29], v[54:57], v[238:253]
    s_waitcnt lgkmcnt(4)
    v_mfma_f32_32x32x16_bf16 v[222:237], v[6:9], v[58:61], v[222:237]
    ds_read_b64_tr_b16 v[22:23], v3 offset:18432
    ds_read_b64_tr_b16 v[24:25], v3 offset:18944
    ds_read_b64_tr_b16 v[26:27], v4 offset:18432
    ds_read_b64_tr_b16 v[28:29], v4 offset:18944
    v_mfma_f32_32x32x16_bf16 v[238:253], v[10:13], v[58:61], v[238:253]
    s_waitcnt lgkmcnt(4)
    v_mfma_f32_32x32x16_bf16 v[222:237], v[14:17], v[62:65], v[222:237]
    v_mfma_f32_32x32x16_bf16 v[238:253], v[18:21], v[62:65], v[238:253]
    s_barrier
    ds_read_b64_tr_b16 v[6:7], v3 offset:20480
    ds_read_b64_tr_b16 v[8:9], v3 offset:20992
    ds_read_b64_tr_b16 v[10:11], v4 offset:20480
    ds_read_b64_tr_b16 v[12:13], v4 offset:20992
    s_waitcnt lgkmcnt(4)
    v_mfma_f32_32x32x16_bf16 v[222:237], v[22:25], v[66:69], v[222:237]
    ds_read_b64_tr_b16 v[14:15], v3 offset:22528
    ds_read_b64_tr_b16 v[16:17], v3 offset:23040
    ds_read_b64_tr_b16 v[18:19], v4 offset:22528
    ds_read_b64_tr_b16 v[20:21], v4 offset:23040
    v_mfma_f32_32x32x16_bf16 v[238:253], v[26:29], v[66:69], v[238:253]
    s_waitcnt lgkmcnt(4)
    v_mfma_f32_32x32x16_bf16 v[222:237], v[6:9], v[70:73], v[222:237]
    ds_read_b64_tr_b16 v[22:23], v3 offset:24576
    ds_read_b64_tr_b16 v[24:25], v3 offset:25088
    ds_read_b64_tr_b16 v[26:27], v4 offset:24576
    ds_read_b64_tr_b16 v[28:29], v4 offset:25088
    v_mfma_f32_32x32x16_bf16 v[238:253], v[10:13], v[70:73], v[238:253]
    s_waitcnt lgkmcnt(4)
    v_mfma_f32_32x32x16_bf16 v[222:237], v[14:17], v[74:77], v[222:237]
    ds_read_b64_tr_b16 v[6:7], v3 offset:26624
    ds_read_b64_tr_b16 v[8:9], v3 offset:27136
    ds_read_b64_tr_b16 v[10:11], v4 offset:26624
    ds_read_b64_tr_b16 v[12:13], v4 offset:27136
    v_mfma_f32_32x32x16_bf16 v[238:253], v[18:21], v[74:77], v[238:253]
    s_waitcnt lgkmcnt(4)
    v_mfma_f32_32x32x16_bf16 v[222:237], v[22:25], v[78:81], v[222:237]
    ds_read_b64_tr_b16 v[14:15], v3 offset:28672
    ds_read_b64_tr_b16 v[16:17], v3 offset:29184
    ds_read_b64_tr_b16 v[18:19], v4 offset:28672
    ds_read_b64_tr_b16 v[20:21], v4 offset:29184
    v_mfma_f32_32x32x16_bf16 v[238:253], v[26:29], v[78:81], v[238:253]
    s_waitcnt lgkmcnt(4)
    v_mfma_f32_32x32x16_bf16 v[222:237], v[6:9], v[82:85], v[222:237]
    ds_read_b64_tr_b16 v[22:23], v3 offset:30720
    ds_read_b64_tr_b16 v[24:25], v3 offset:31232
    ds_read_b64_tr_b16 v[26:27], v4 offset:30720
    ds_read_b64_tr_b16 v[28:29], v4 offset:31232
    v_mfma_f32_32x32x16_bf16 v[238:253], v[10:13], v[82:85], v[238:253]
    s_waitcnt lgkmcnt(4)
    v_mfma_f32_32x32x16_bf16 v[222:237], v[14:17], v[86:89], v[222:237]
    ds_read_b64_tr_b16 v[6:7], v3 offset:32768
    ds_read_b64_tr_b16 v[8:9], v3 offset:33280
    ds_read_b64_tr_b16 v[10:11], v4 offset:32768
    ds_read_b64_tr_b16 v[12:13], v4 offset:33280
    v_mfma_f32_32x32x16_bf16 v[238:253], v[18:21], v[86:89], v[238:253]
    s_waitcnt lgkmcnt(4)
    v_mfma_f32_32x32x16_bf16 v[222:237], v[22:25], v[90:93], v[222:237]
    ds_read_b64_tr_b16 v[14:15], v3 offset:34816
    ds_read_b64_tr_b16 v[16:17], v3 offset:35328
    ds_read_b64_tr_b16 v[18:19], v4 offset:34816
    ds_read_b64_tr_b16 v[20:21], v4 offset:35328
    v_mfma_f32_32x32x16_bf16 v[238:253], v[26:29], v[90:93], v[238:253]
    s_waitcnt lgkmcnt(4)
    v_mfma_f32_32x32x16_bf16 v[222:237], v[6:9], v[94:97], v[222:237]
    ds_read_b64_tr_b16 v[22:23], v3 offset:36864
    ds_read_b64_tr_b16 v[24:25], v3 offset:37376
    ds_read_b64_tr_b16 v[26:27], v4 offset:36864
    ds_read_b64_tr_b16 v[28:29], v4 offset:37376
    v_mfma_f32_32x32x16_bf16 v[238:253], v[10:13], v[94:97], v[238:253]
    s_waitcnt lgkmcnt(4)
    v_mfma_f32_32x32x16_bf16 v[222:237], v[14:17], v[98:101], v[222:237]
    ds_read_b64_tr_b16 v[6:7], v3 offset:38912
    ds_read_b64_tr_b16 v[8:9], v3 offset:39424
    ds_read_b64_tr_b16 v[10:11], v4 offset:38912
    ds_read_b64_tr_b16 v[12:13], v4 offset:39424
    v_mfma_f32_32x32x16_bf16 v[238:253], v[18:21], v[98:101], v[238:253]
    s_waitcnt lgkmcnt(4)
    v_mfma_f32_32x32x16_bf16 v[222:237], v[22:25], v[102:105], v[222:237]
    v_mfma_f32_32x32x16_bf16 v[238:253], v[26:29], v[102:105], v[238:253]
    s_waitcnt vmcnt(0)
    s_barrier
    v_mov_b32 v254, 1
    buffer_store_dword v254, v255, s[48:51], s98 offen sc1
    ds_read_b64_tr_b16 v[14:15], v3 offset:40960
    ds_read_b64_tr_b16 v[16:17], v3 offset:41472
    ds_read_b64_tr_b16 v[18:19], v4 offset:40960
    ds_read_b64_tr_b16 v[20:21], v4 offset:41472
    s_waitcnt lgkmcnt(4)
    v_mfma_f32_32x32x16_bf16 v[222:237], v[6:9], v[106:109], v[222:237]
    ds_read_b64_tr_b16 v[22:23], v3 offset:43008
    ds_read_b64_tr_b16 v[24:25], v3 offset:43520
    ds_read_b64_tr_b16 v[26:27], v4 offset:43008
    ds_read_b64_tr_b16 v[28:29], v4 offset:43520
    v_mfma_f32_32x32x16_bf16 v[238:253], v[10:13], v[106:109], v[238:253]
    s_waitcnt lgkmcnt(4)
    v_mfma_f32_32x32x16_bf16 v[222:237], v[14:17], v[110:113], v[222:237]
    ds_read_b64_tr_b16 v[6:7], v3 offset:45056
    ds_read_b64_tr_b16 v[8:9], v3 offset:45568
    ds_read_b64_tr_b16 v[10:11], v4 offset:45056
    ds_read_b64_tr_b16 v[12:13], v4 offset:45568
    v_mfma_f32_32x32x16_bf16 v[238:253], v[18:21], v[110:113], v[238:253]
    s_waitcnt lgkmcnt(4)
    v_mfma_f32_32x32x16_bf16 v[222:237], v[22:25], v[114:117], v[222:237]
    ds_read_b64_tr_b16 v[14:15], v3 offset:47104
    ds_read_b64_tr_b16 v[16:17], v3 offset:47616
    ds_read_b64_tr_b16 v[18:19], v4 offset:47104
    ds_read_b64_tr_b16 v[20:21], v4 offset:47616
    v_mfma_f32_32x32x16_bf16 v[238:253], v[26:29], v[114:117], v[238:253]
    s_waitcnt lgkmcnt(4)
    v_mfma_f32_32x32x16_bf16 v[222:237], v[6:9], v[118:121], v[222:237]
    ds_read_b64_tr_b16 v[22:23], v3 offset:49152
    ds_read_b64_tr_b16 v[24:25], v3 offset:49664
    ds_read_b64_tr_b16 v[26:27], v4 offset:49152
    ds_read_b64_tr_b16 v[28:29], v4 offset:49664
    v_mfma_f32_32x32x16_bf16 v[238:253], v[10:13], v[118:121], v[238:253]
    s_waitcnt lgkmcnt(4)
    v_mfma_f32_32x32x16_bf16 v[222:237], v[14:17], v[122:125], v[222:237]
    ds_read_b64_tr_b16 v[6:7], v3 offset:51200
    ds_read_b64_tr_b16 v[8:9], v3 offset:51712
    ds_read_b64_tr_b16 v[10:11], v4 offset:51200
    ds_read_b64_tr_b16 v[12:13], v4 offset:51712
    v_mfma_f32_32x32x16_bf16 v[238:253], v[18:21], v[122:125], v[238:253]
    s_waitcnt lgkmcnt(4)
    v_mfma_f32_32x32x16_bf16 v[222:237], v[22:25], v[126:129], v[222:237]
    ds_read_b64_tr_b16 v[14:15], v3 offset:53248
    ds_read_b64_tr_b16 v[16:17], v3 offset:53760
    ds_read_b64_tr_b16 v[18:19], v4 offset:53248
    ds_read_b64_tr_b16 v[20:21], v4 offset:53760
    v_mfma_f32_32x32x16_bf16 v[238:253], v[26:29], v[126:129], v[238:253]
    s_waitcnt lgkmcnt(4)
    v_mfma_f32_32x32x16_bf16 v[222:237], v[6:9], v[130:133], v[222:237]
    ds_read_b64_tr_b16 v[22:23], v3 offset:55296
    ds_read_b64_tr_b16 v[24:25], v3 offset:55808
    ds_read_b64_tr_b16 v[26:27], v4 offset:55296
    ds_read_b64_tr_b16 v[28:29], v4 offset:55808
    v_mfma_f32_32x32x16_bf16 v[238:253], v[10:13], v[130:133], v[238:253]
    s_waitcnt lgkmcnt(4)
    v_mfma_f32_32x32x16_bf16 v[222:237], v[14:17], v[134:137], v[222:237]
    ds_read_b64_tr_b16 v[6:7], v3 offset:57344
    ds_read_b64_tr_b16 v[8:9], v3 offset:57856
    ds_read_b64_tr_b16 v[10:11], v4 offset:57344
    ds_read_b64_tr_b16 v[12:13], v4 offset:57856
    v_mfma_f32_32x32x16_bf16 v[238:253], v[18:21], v[134:137], v[238:253]
    s_waitcnt lgkmcnt(4)
    v_mfma_f32_32x32x16_bf16 v[222:237], v[22:25], v[138:141], v[222:237]
    ds_read_b64_tr_b16 v[14:15], v3 offset:59392
    ds_read_b64_tr_b16 v[16:17], v3 offset:59904
    ds_read_b64_tr_b16 v[18:19], v4 offset:59392
    ds_read_b64_tr_b16 v[20:21], v4 offset:59904
    v_mfma_f32_32x32x16_bf16 v[238:253], v[26:29], v[138:141], v[238:253]
    s_waitcnt lgkmcnt(4)
    v_mfma_f32_32x32x16_bf16 v[222:237], v[6:9], v[142:145], v[222:237]
    v_mfma_f32_32x32x16_bf16 v[238:253], v[10:13], v[142:145], v[238:253]
    s_barrier
    v_add_u32 v3, 61440, v3
    v_add_u32 v4, 61440, v4
    ds_read_b64_tr_b16 v[22:23], v3 offset:0
    ds_read_b64_tr_b16 v[24:25], v3 offset:512
    ds_read_b64_tr_b16 v[26:27], v4 offset:0
    ds_read_b64_tr_b16 v[28:29], v4 offset:512
    s_waitcnt lgkmcnt(4)
    v_mfma_f32_32x32x16_bf16 v[222:237], v[14:17], v[146:149], v[222:237]
    ds_read_b64_tr_b16 v[6:7], v3 offset:2048
    ds_read_b64_tr_b16 v[8:9], v3 offset:2560
    ds_read_b64_tr_b16 v[10:11], v4 offset:2048
    ds_read_b64_tr_b16 v[12:13], v4 offset:2560
    v_mfma_f32_32x32x16_bf16 v[238:253], v[18:21], v[146:149], v[238:253]
    s_waitcnt lgkmcnt(4)
    v_mfma_f32_32x32x16_bf16 v[222:237], v[22:25], v[150:153], v[222:237]
    ds_read_b64_tr_b16 v[14:15], v3 offset:4096
    ds_read_b64_tr_b16 v[16:17], v3 offset:4608
    ds_read_b64_tr_b16 v[18:19], v4 offset:4096
    ds_read_b64_tr_b16 v[20:21], v4 offset:4608
    v_mfma_f32_32x32x16_bf16 v[238:253], v[26:29], v[150:153], v[238:253]
    s_waitcnt lgkmcnt(4)
    v_mfma_f32_32x32x16_bf16 v[222:237], v[6:9], v[154:157], v[222:237]
    ds_read_b64_tr_b16 v[22:23], v3 offset:6144
    ds_read_b64_tr_b16 v[24:25], v3 offset:6656
    ds_read_b64_tr_b16 v[26:27], v4 offset:6144
    ds_read_b64_tr_b16 v[28:29], v4 offset:6656
    v_mfma_f32_32x32x16_bf16 v[238:253], v[10:13], v[154:157], v[238:253]
    s_waitcnt lgkmcnt(4)
    v_mfma_f32_32x32x16_bf16 v[222:237], v[14:17], v[158:161], v[222:237]
    ds_read_b64_tr_b16 v[6:7], v3 offset:8192
    ds_read_b64_tr_b16 v[8:9], v3 offset:8704
    ds_read_b64_tr_b16 v[10:11], v4 offset:8192
    ds_read_b64_tr_b16 v[12:13], v4 offset:8704
    v_mfma_f32_32x32x16_bf16 v[238:253], v[18:21], v[158:161], v[238:253]
    s_waitcnt lgkmcnt(4)
    v_mfma_f32_32x32x16_bf16 v[222:237], v[22:25], v[162:165], v[222:237]
    ds_read_b64_tr_b16 v[14:15], v3 offset:10240
    ds_read_b64_tr_b16 v[16:17], v3 offset:10752
    ds_read_b64_tr_b16 v[18:19], v4 offset:10240
    ds_read_b64_tr_b16 v[20:21], v4 offset:10752
    v_mfma_f32_32x32x16_bf16 v[238:253], v[26:29], v[162:165], v[238:253]
    s_waitcnt lgkmcnt(4)
    v_mfma_f32_32x32x16_bf16 v[222:237], v[6:9], v[166:169], v[222:237]
    ds_read_b64_tr_b16 v[22:23], v3 offset:12288
    ds_read_b64_tr_b16 v[24:25], v3 offset:12800
    ds_read_b64_tr_b16 v[26:27], v4 offset:12288
    ds_read_b64_tr_b16 v[28:29], v4 offset:12800
    v_mfma_f32_32x32x16_bf16 v[238:253], v[10:13], v[166:169], v[238:253]
    s_waitcnt lgkmcnt(4)
    v_mfma_f32_32x32x16_bf16 v[222:237], v[14:17], v[170:173], v[222:237]
    ds_read_b64_tr_b16 v[6:7], v3 offset:14336
    ds_read_b64_tr_b16 v[8:9], v3 offset:14848
    ds_read_b64_tr_b16 v[10:11], v4 offset:14336
    ds_read_b64_tr_b16 v[12:13], v4 offset:14848
    v_mfma_f32_32x32x16_bf16 v[238:253], v[18:21], v[170:173], v[238:253]
    s_waitcnt lgkmcnt(4)
    v_mfma_f32_32x32x16_bf16 v[222:237], v[22:25], v[174:177], v[222:237]
    ds_read_b64_tr_b16 v[14:15], v3 offset:16384
    ds_read_b64_tr_b16 v[16:17], v3 offset:16896
    ds_read_b64_tr_b16 v[18:19], v4 offset:16384
    ds_read_b64_tr_b16 v[20:21], v4 offset:16896
    v_mfma_f32_32x32x16_bf16 v[238:253], v[26:29], v[174:177], v[238:253]
    s_waitcnt lgkmcnt(4)
    v_mfma_f32_32x32x16_bf16 v[222:237], v[6:9], v[178:181], v[222:237]
    ds_read_b64_tr_b16 v[22:23], v3 offset:18432
    ds_read_b64_tr_b16 v[24:25], v3 offset:18944
    ds_read_b64_tr_b16 v[26:27], v4 offset:18432
    ds_read_b64_tr_b16 v[28:29], v4 offset:18944
    v_mfma_f32_32x32x16_bf16 v[238:253], v[10:13], v[178:181], v[238:253]
    s_waitcnt lgkmcnt(4)
    v_mfma_f32_32x32x16_bf16 v[222:237], v[14:17], v[182:185], v[222:237]
    v_mfma_f32_32x32x16_bf16 v[238:253], v[18:21], v[182:185], v[238:253]
    s_waitcnt lgkmcnt(0)
    s_barrier
    ds_read_b64_tr_b16 v[6:7], v3 offset:20480
    ds_read_b64_tr_b16 v[8:9], v3 offset:20992
    ds_read_b64_tr_b16 v[10:11], v4 offset:20480
    ds_read_b64_tr_b16 v[12:13], v4 offset:20992
    s_waitcnt lgkmcnt(4)
    v_mfma_f32_32x32x16_bf16 v[222:237], v[22:25], v[186:189], v[222:237]
    ds_read_b64_tr_b16 v[14:15], v3 offset:22528
    ds_read_b64_tr_b16 v[16:17], v3 offset:23040
    ds_read_b64_tr_b16 v[18:19], v4 offset:22528
    ds_read_b64_tr_b16 v[20:21], v4 offset:23040
    v_mfma_f32_32x32x16_bf16 v[238:253], v[26:29], v[186:189], v[238:253]
    s_waitcnt lgkmcnt(4)
    v_mfma_f32_32x32x16_bf16 v[190:205], v[6:9], v[30:33], 0
    ds_read_b64_tr_b16 v[22:23], v3 offset:24576
    ds_read_b64_tr_b16 v[24:25], v3 offset:25088
    ds_read_b64_tr_b16 v[26:27], v4 offset:24576
    ds_read_b64_tr_b16 v[28:29], v4 offset:25088
    v_mfma_f32_32x32x16_bf16 v[206:221], v[10:13], v[30:33], 0
    s_waitcnt lgkmcnt(4)
    v_mfma_f32_32x32x16_bf16 v[190:205], v[14:17], v[34:37], v[190:205]
    ds_read_b64_tr_b16 v[6:7], v3 offset:26624
    ds_read_b64_tr_b16 v[8:9], v3 offset:27136
    ds_read_b64_tr_b16 v[10:11], v4 offset:26624
    ds_read_b64_tr_b16 v[12:13], v4 offset:27136
    v_mfma_f32_32x32x16_bf16 v[206:221], v[18:21], v[34:37], v[206:221]
    s_add_u32 s94, s94, 4096
    v_cvt_pk_bf16_f32 v222, v222, v223
    v_cvt_pk_bf16_f32 v223, v224, v225
    v_cvt_pk_bf16_f32 v224, v226, v227
    v_cvt_pk_bf16_f32 v225, v228, v229
    s_waitcnt lgkmcnt(4)
    v_mfma_f32_32x32x16_bf16 v[190:205], v[22:25], v[38:41], v[190:205]
    ds_read_b64_tr_b16 v[14:15], v3 offset:28672
    ds_read_b64_tr_b16 v[16:17], v3 offset:29184
    ds_read_b64_tr_b16 v[18:19], v4 offset:28672
    ds_read_b64_tr_b16 v[20:21], v4 offset:29184
    v_mfma_f32_32x32x16_bf16 v[206:221], v[26:29], v[38:41], v[206:221]
    v_pk_max_i16 v222, v222, 0
    v_pk_max_i16 v223, v223, 0
    v_pk_max_i16 v224, v224, 0
    v_pk_max_i16 v225, v225, 0
    s_waitcnt lgkmcnt(4)
    v_mfma_f32_32x32x16_bf16 v[190:205], v[6:9], v[42:45], v[190:205]
    ds_read_b64_tr_b16 v[22:23], v3 offset:30720
    ds_read_b64_tr_b16 v[24:25], v3 offset:31232
    ds_read_b64_tr_b16 v[26:27], v4 offset:30720
    ds_read_b64_tr_b16 v[28:29], v4 offset:31232
    v_mfma_f32_32x32x16_bf16 v[206:221], v[10:13], v[42:45], v[206:221]
    v_cvt_pk_bf16_f32 v230, v230, v231
    v_cvt_pk_bf16_f32 v231, v232, v233
    v_cvt_pk_bf16_f32 v232, v234, v235
    v_cvt_pk_bf16_f32 v233, v236, v237
    s_waitcnt lgkmcnt(4)
    v_mfma_f32_32x32x16_bf16 v[190:205], v[14:17], v[46:49], v[190:205]
    ds_read_b64_tr_b16 v[6:7], v3 offset:32768
    ds_read_b64_tr_b16 v[8:9], v3 offset:33280
    ds_read_b64_tr_b16 v[10:11], v4 offset:32768
    ds_read_b64_tr_b16 v[12:13], v4 offset:33280
    v_mfma_f32_32x32x16_bf16 v[206:221], v[18:21], v[46:49], v[206:221]
    v_pk_max_i16 v230, v230, 0
    v_pk_max_i16 v231, v231, 0
    v_pk_max_i16 v232, v232, 0
    v_pk_max_i16 v233, v233, 0
    s_waitcnt lgkmcnt(4)
    v_mfma_f32_32x32x16_bf16 v[190:205], v[22:25], v[50:53], v[190:205]
    ds_read_b64_tr_b16 v[14:15], v3 offset:34816
    ds_read_b64_tr_b16 v[16:17], v3 offset:35328
    ds_read_b64_tr_b16 v[18:19], v4 offset:34816
    ds_read_b64_tr_b16 v[20:21], v4 offset:35328
    v_mfma_f32_32x32x16_bf16 v[206:221], v[26:29], v[50:53], v[206:221]
    v_cvt_pk_bf16_f32 v238, v238, v239
    v_cvt_pk_bf16_f32 v239, v240, v241
    v_cvt_pk_bf16_f32 v240, v242, v243
    v_cvt_pk_bf16_f32 v241, v244, v245
    s_waitcnt lgkmcnt(4)
    v_mfma_f32_32x32x16_bf16 v[190:205], v[6:9], v[54:57], v[190:205]
    ds_read_b64_tr_b16 v[22:23], v3 offset:36864
    ds_read_b64_tr_b16 v[24:25], v3 offset:37376
    ds_read_b64_tr_b16 v[26:27], v4 offset:36864
    ds_read_b64_tr_b16 v[28:29], v4 offset:37376
    v_mfma_f32_32x32x16_bf16 v[206:221], v[10:13], v[54:57], v[206:221]
    v_pk_max_i16 v238, v238, 0
    v_pk_max_i16 v239, v239, 0
    v_pk_max_i16 v240, v240, 0
    v_pk_max_i16 v241, v241, 0
    s_waitcnt lgkmcnt(4)
    v_mfma_f32_32x32x16_bf16 v[190:205], v[14:17], v[58:61], v[190:205]
    ds_read_b64_tr_b16 v[6:7], v3 offset:38912
    ds_read_b64_tr_b16 v[8:9], v3 offset:39424
    ds_read_b64_tr_b16 v[10:11], v4 offset:38912
    ds_read_b64_tr_b16 v[12:13], v4 offset:39424
    v_mfma_f32_32x32x16_bf16 v[206:221], v[18:21], v[58:61], v[206:221]
    v_cvt_pk_bf16_f32 v246, v246, v247
    v_cvt_pk_bf16_f32 v247, v248, v249
    v_cvt_pk_bf16_f32 v248, v250, v251
    v_cvt_pk_bf16_f32 v249, v252, v253
    s_waitcnt lgkmcnt(4)
    v_mfma_f32_32x32x16_bf16 v[190:205], v[22:25], v[62:65], v[190:205]
    ds_read_b64_tr_b16 v[14:15], v3 offset:40960
    ds_read_b64_tr_b16 v[16:17], v3 offset:41472
    ds_read_b64_tr_b16 v[18:19], v4 offset:40960
    ds_read_b64_tr_b16 v[20:21], v4 offset:41472
    v_mfma_f32_32x32x16_bf16 v[206:221], v[26:29], v[62:65], v[206:221]
    v_pk_max_i16 v246, v246, 0
    v_pk_max_i16 v247, v247, 0
    v_pk_max_i16 v248, v248, 0
    v_pk_max_i16 v249, v249, 0
    s_waitcnt lgkmcnt(4)
    v_mfma_f32_32x32x16_bf16 v[190:205], v[6:9], v[66:69], v[190:205]
    ds_read_b64_tr_b16 v[22:23], v3 offset:43008
    ds_read_b64_tr_b16 v[24:25], v3 offset:43520
    ds_read_b64_tr_b16 v[26:27], v4 offset:43008
    ds_read_b64_tr_b16 v[28:29], v4 offset:43520
    v_mfma_f32_32x32x16_bf16 v[206:221], v[10:13], v[66:69], v[206:221]
    s_waitcnt lgkmcnt(4)
    v_mfma_f32_32x32x16_bf16 v[190:205], v[14:17], v[70:73], v[190:205]
    ds_read_b64_tr_b16 v[6:7], v3 offset:45056
    ds_read_b64_tr_b16 v[8:9], v3 offset:45568
    ds_read_b64_tr_b16 v[10:11], v4 offset:45056
    ds_read_b64_tr_b16 v[12:13], v4 offset:45568
    v_mfma_f32_32x32x16_bf16 v[206:221], v[18:21], v[70:73], v[206:221]
    s_waitcnt lgkmcnt(4)
    v_mfma_f32_32x32x16_bf16 v[190:205], v[22:25], v[74:77], v[190:205]
    ds_read_b64_tr_b16 v[14:15], v3 offset:47104
    ds_read_b64_tr_b16 v[16:17], v3 offset:47616
    ds_read_b64_tr_b16 v[18:19], v4 offset:47104
    ds_read_b64_tr_b16 v[20:21], v4 offset:47616
    v_mfma_f32_32x32x16_bf16 v[206:221], v[26:29], v[74:77], v[206:221]
    s_waitcnt lgkmcnt(4)
    v_mfma_f32_32x32x16_bf16 v[190:205], v[6:9], v[78:81], v[190:205]
    ds_read_b64_tr_b16 v[22:23], v3 offset:49152
    ds_read_b64_tr_b16 v[24:25], v3 offset:49664
    ds_read_b64_tr_b16 v[26:27], v4 offset:49152
    ds_read_b64_tr_b16 v[28:29], v4 offset:49664
    v_mfma_f32_32x32x16_bf16 v[206:221], v[10:13], v[78:81], v[206:221]
    s_waitcnt lgkmcnt(4)
    v_mfma_f32_32x32x16_bf16 v[190:205], v[14:17], v[82:85], v[190:205]
    ds_read_b64_tr_b16 v[6:7], v3 offset:51200
    ds_read_b64_tr_b16 v[8:9], v3 offset:51712
    ds_read_b64_tr_b16 v[10:11], v4 offset:51200
    ds_read_b64_tr_b16 v[12:13], v4 offset:51712
    v_mfma_f32_32x32x16_bf16 v[206:221], v[18:21], v[82:85], v[206:221]
    s_waitcnt lgkmcnt(4)
    v_mfma_f32_32x32x16_bf16 v[190:205], v[22:25], v[86:89], v[190:205]
    ds_read_b64_tr_b16 v[14:15], v3 offset:53248
    ds_read_b64_tr_b16 v[16:17], v3 offset:53760
    ds_read_b64_tr_b16 v[18:19], v4 offset:53248
    ds_read_b64_tr_b16 v[20:21], v4 offset:53760
    v_mfma_f32_32x32x16_bf16 v[206:221], v[26:29], v[86:89], v[206:221]
    s_waitcnt lgkmcnt(4)
    v_mfma_f32_32x32x16_bf16 v[190:205], v[6:9], v[90:93], v[190:205]
    ds_read_b64_tr_b16 v[22:23], v3 offset:55296
    ds_read_b64_tr_b16 v[24:25], v3 offset:55808
    ds_read_b64_tr_b16 v[26:27], v4 offset:55296
    ds_read_b64_tr_b16 v[28:29], v4 offset:55808
    v_mfma_f32_32x32x16_bf16 v[206:221], v[10:13], v[90:93], v[206:221]
    s_waitcnt lgkmcnt(4)
    v_mfma_f32_32x32x16_bf16 v[190:205], v[14:17], v[94:97], v[190:205]
    ds_read_b64_tr_b16 v[6:7], v3 offset:57344
    ds_read_b64_tr_b16 v[8:9], v3 offset:57856
    ds_read_b64_tr_b16 v[10:11], v4 offset:57344
    ds_read_b64_tr_b16 v[12:13], v4 offset:57856
    v_mfma_f32_32x32x16_bf16 v[206:221], v[18:21], v[94:97], v[206:221]
    s_waitcnt lgkmcnt(4)
    v_mfma_f32_32x32x16_bf16 v[190:205], v[22:25], v[98:101], v[190:205]
    ds_read_b64_tr_b16 v[14:15], v3 offset:59392
    ds_read_b64_tr_b16 v[16:17], v3 offset:59904
    ds_read_b64_tr_b16 v[18:19], v4 offset:59392
    ds_read_b64_tr_b16 v[20:21], v4 offset:59904
    v_mfma_f32_32x32x16_bf16 v[206:221], v[26:29], v[98:101], v[206:221]
    s_waitcnt lgkmcnt(4)
    v_mfma_f32_32x32x16_bf16 v[190:205], v[6:9], v[102:105], v[190:205]
    v_add_u32 v3, 61440, v3
    v_add_u32 v4, 61440, v4
    ds_read_b64_tr_b16 v[22:23], v3 offset:0
    ds_read_b64_tr_b16 v[24:25], v3 offset:512
    ds_read_b64_tr_b16 v[26:27], v4 offset:0
    ds_read_b64_tr_b16 v[28:29], v4 offset:512
    v_mfma_f32_32x32x16_bf16 v[206:221], v[10:13], v[102:105], v[206:221]
    s_waitcnt lgkmcnt(4)
    v_mfma_f32_32x32x16_bf16 v[190:205], v[14:17], v[106:109], v[190:205]
    ds_read_b64_tr_b16 v[6:7], v3 offset:2048
    ds_read_b64_tr_b16 v[8:9], v3 offset:2560
    ds_read_b64_tr_b16 v[10:11], v4 offset:2048
    ds_read_b64_tr_b16 v[12:13], v4 offset:2560
    v_mfma_f32_32x32x16_bf16 v[206:221], v[18:21], v[106:109], v[206:221]
    s_waitcnt lgkmcnt(4)
    v_mfma_f32_32x32x16_bf16 v[190:205], v[22:25], v[110:113], v[190:205]
    ds_read_b64_tr_b16 v[14:15], v3 offset:4096
    ds_read_b64_tr_b16 v[16:17], v3 offset:4608
    ds_read_b64_tr_b16 v[18:19], v4 offset:4096
    ds_read_b64_tr_b16 v[20:21], v4 offset:4608
    v_mfma_f32_32x32x16_bf16 v[206:221], v[26:29], v[110:113], v[206:221]
    s_waitcnt lgkmcnt(4)
    v_mfma_f32_32x32x16_bf16 v[190:205], v[6:9], v[114:117], v[190:205]
    ds_read_b64_tr_b16 v[22:23], v3 offset:6144
    ds_read_b64_tr_b16 v[24:25], v3 offset:6656
    ds_read_b64_tr_b16 v[26:27], v4 offset:6144
    ds_read_b64_tr_b16 v[28:29], v4 offset:6656
    v_mfma_f32_32x32x16_bf16 v[206:221], v[10:13], v[114:117], v[206:221]
    s_waitcnt lgkmcnt(4)
    v_mfma_f32_32x32x16_bf16 v[190:205], v[14:17], v[118:121], v[190:205]
    ds_read_b64_tr_b16 v[6:7], v3 offset:8192
    ds_read_b64_tr_b16 v[8:9], v3 offset:8704
    ds_read_b64_tr_b16 v[10:11], v4 offset:8192
    ds_read_b64_tr_b16 v[12:13], v4 offset:8704
    v_mfma_f32_32x32x16_bf16 v[206:221], v[18:21], v[118:121], v[206:221]
    s_waitcnt lgkmcnt(4)
    v_mfma_f32_32x32x16_bf16 v[190:205], v[22:25], v[122:125], v[190:205]
    ds_read_b64_tr_b16 v[14:15], v3 offset:10240
    ds_read_b64_tr_b16 v[16:17], v3 offset:10752
    ds_read_b64_tr_b16 v[18:19], v4 offset:10240
    ds_read_b64_tr_b16 v[20:21], v4 offset:10752
    v_mfma_f32_32x32x16_bf16 v[206:221], v[26:29], v[122:125], v[206:221]
    s_waitcnt lgkmcnt(4)
    v_mfma_f32_32x32x16_bf16 v[190:205], v[6:9], v[126:129], v[190:205]
    ds_read_b64_tr_b16 v[22:23], v3 offset:12288
    ds_read_b64_tr_b16 v[24:25], v3 offset:12800
    ds_read_b64_tr_b16 v[26:27], v4 offset:12288
    ds_read_b64_tr_b16 v[28:29], v4 offset:12800
    v_mfma_f32_32x32x16_bf16 v[206:221], v[10:13], v[126:129], v[206:221]
    s_waitcnt lgkmcnt(4)
    v_mfma_f32_32x32x16_bf16 v[190:205], v[14:17], v[130:133], v[190:205]
    ds_read_b64_tr_b16 v[6:7], v3 offset:14336
    ds_read_b64_tr_b16 v[8:9], v3 offset:14848
    ds_read_b64_tr_b16 v[10:11], v4 offset:14336
    ds_read_b64_tr_b16 v[12:13], v4 offset:14848
    v_mfma_f32_32x32x16_bf16 v[206:221], v[18:21], v[130:133], v[206:221]
    s_waitcnt lgkmcnt(4)
    v_mfma_f32_32x32x16_bf16 v[190:205], v[22:25], v[134:137], v[190:205]
    ds_read_b64_tr_b16 v[14:15], v3 offset:16384
    ds_read_b64_tr_b16 v[16:17], v3 offset:16896
    ds_read_b64_tr_b16 v[18:19], v4 offset:16384
    ds_read_b64_tr_b16 v[20:21], v4 offset:16896
    v_mfma_f32_32x32x16_bf16 v[206:221], v[26:29], v[134:137], v[206:221]
    s_waitcnt lgkmcnt(4)
    v_mfma_f32_32x32x16_bf16 v[190:205], v[6:9], v[138:141], v[190:205]
    ds_read_b64_tr_b16 v[22:23], v3 offset:18432
    ds_read_b64_tr_b16 v[24:25], v3 offset:18944
    ds_read_b64_tr_b16 v[26:27], v4 offset:18432
    ds_read_b64_tr_b16 v[28:29], v4 offset:18944
    v_mfma_f32_32x32x16_bf16 v[206:221], v[10:13], v[138:141], v[206:221]
    s_waitcnt lgkmcnt(4)
    v_mfma_f32_32x32x16_bf16 v[190:205], v[14:17], v[142:145], v[190:205]
    ds_read_b64_tr_b16 v[6:7], v3 offset:20480
    ds_read_b64_tr_b16 v[8:9], v3 offset:20992
    ds_read_b64_tr_b16 v[10:11], v4 offset:20480
    ds_read_b64_tr_b16 v[12:13], v4 offset:20992
    v_mfma_f32_32x32x16_bf16 v[206:221], v[18:21], v[142:145], v[206:221]
    s_waitcnt lgkmcnt(4)
    v_mfma_f32_32x32x16_bf16 v[190:205], v[22:25], v[146:149], v[190:205]
    ds_read_b64_tr_b16 v[14:15], v3 offset:22528
    ds_read_b64_tr_b16 v[16:17], v3 offset:23040
    ds_read_b64_tr_b16 v[18:19], v4 offset:22528
    ds_read_b64_tr_b16 v[20:21], v4 offset:23040
    v_mfma_f32_32x32x16_bf16 v[206:221], v[26:29], v[146:149], v[206:221]
    s_waitcnt lgkmcnt(4)
    v_mfma_f32_32x32x16_bf16 v[190:205], v[6:9], v[150:153], v[190:205]
    ds_read_b64_tr_b16 v[22:23], v3 offset:24576
    ds_read_b64_tr_b16 v[24:25], v3 offset:25088
    ds_read_b64_tr_b16 v[26:27], v4 offset:24576
    ds_read_b64_tr_b16 v[28:29], v4 offset:25088
    v_mfma_f32_32x32x16_bf16 v[206:221], v[10:13], v[150:153], v[206:221]
    s_waitcnt lgkmcnt(4)
    v_mfma_f32_32x32x16_bf16 v[190:205], v[14:17], v[154:157], v[190:205]
    ds_read_b64_tr_b16 v[6:7], v3 offset:26624
    ds_read_b64_tr_b16 v[8:9], v3 offset:27136
    ds_read_b64_tr_b16 v[10:11], v4 offset:26624
    ds_read_b64_tr_b16 v[12:13], v4 offset:27136
    v_mfma_f32_32x32x16_bf16 v[206:221], v[18:21], v[154:157], v[206:221]
    s_waitcnt lgkmcnt(4)
    v_mfma_f32_32x32x16_bf16 v[190:205], v[22:25], v[158:161], v[190:205]
    ds_read_b64_tr_b16 v[14:15], v3 offset:28672
    ds_read_b64_tr_b16 v[16:17], v3 offset:29184
    ds_read_b64_tr_b16 v[18:19], v4 offset:28672
    ds_read_b64_tr_b16 v[20:21], v4 offset:29184
    v_mfma_f32_32x32x16_bf16 v[206:221], v[26:29], v[158:161], v[206:221]
    s_waitcnt lgkmcnt(4)
    v_mfma_f32_32x32x16_bf16 v[190:205], v[6:9], v[162:165], v[190:205]
    ds_read_b64_tr_b16 v[22:23], v3 offset:30720
    ds_read_b64_tr_b16 v[24:25], v3 offset:31232
    ds_read_b64_tr_b16 v[26:27], v4 offset:30720
    ds_read_b64_tr_b16 v[28:29], v4 offset:31232
    v_mfma_f32_32x32x16_bf16 v[206:221], v[10:13], v[162:165], v[206:221]
    s_waitcnt lgkmcnt(4)
    v_mfma_f32_32x32x16_bf16 v[190:205], v[14:17], v[166:169], v[190:205]
    ds_read_b64_tr_b16 v[6:7], v3 offset:32768
    ds_read_b64_tr_b16 v[8:9], v3 offset:33280
    ds_read_b64_tr_b16 v[10:11], v4 offset:32768
    ds_read_b64_tr_b16 v[12:13], v4 offset:33280
    v_mfma_f32_32x32x16_bf16 v[206:221], v[18:21], v[166:169], v[206:221]
    s_waitcnt lgkmcnt(4)
    v_mfma_f32_32x32x16_bf16 v[190:205], v[22:25], v[170:173], v[190:205]
    ds_read_b64_tr_b16 v[14:15], v3 offset:34816
    ds_read_b64_tr_b16 v[16:17], v3 offset:35328
    ds_read_b64_tr_b16 v[18:19], v4 offset:34816
    ds_read_b64_tr_b16 v[20:21], v4 offset:35328
    v_mfma_f32_32x32x16_bf16 v[206:221], v[26:29], v[170:173], v[206:221]
    s_waitcnt lgkmcnt(4)
    v_mfma_f32_32x32x16_bf16 v[190:205], v[6:9], v[174:177], v[190:205]
    ds_read_b64_tr_b16 v[22:23], v3 offset:36864
    ds_read_b64_tr_b16 v[24:25], v3 offset:37376
    ds_read_b64_tr_b16 v[26:27], v4 offset:36864
    ds_read_b64_tr_b16 v[28:29], v4 offset:37376
    v_mfma_f32_32x32x16_bf16 v[206:221], v[10:13], v[174:177], v[206:221]
    s_waitcnt lgkmcnt(4)
    v_mfma_f32_32x32x16_bf16 v[190:205], v[14:17], v[178:181], v[190:205]
    ds_read_b64_tr_b16 v[6:7], v3 offset:38912
    ds_read_b64_tr_b16 v[8:9], v3 offset:39424
    ds_read_b64_tr_b16 v[10:11], v4 offset:38912
    ds_read_b64_tr_b16 v[12:13], v4 offset:39424
    v_mfma_f32_32x32x16_bf16 v[206:221], v[18:21], v[178:181], v[206:221]
    s_waitcnt lgkmcnt(4)
    v_mfma_f32_32x32x16_bf16 v[190:205], v[22:25], v[182:185], v[190:205]
    v_mfma_f32_32x32x16_bf16 v[206:221], v[26:29], v[182:185], v[206:221]
    s_waitcnt lgkmcnt(0)
    v_mfma_f32_32x32x16_bf16 v[190:205], v[6:9], v[186:189], v[190:205]
    v_mfma_f32_32x32x16_bf16 v[206:221], v[10:13], v[186:189], v[206:221]
    s_nop 3
    s_movk_i32 s44, 0x400
    v_lshlrev_b32 v2, 4, v1
    v_mov_b32 v5, v2
    v_and_b32 v8, 31, v1
    v_lshrrev_b32 v9, 5, v1
    v_lshlrev_b32_e64 v11, 3, v8
    v_mul_u32_u24 v3, 2560, v9
    v_add3_u32 v3, v3, v11, s44
    v_mov_b32 v20, 0
    v_mov_b32 v21, 0
    v_mov_b32 v22, 0
    v_mov_b32 v23, 0
    v_mov_b32 v6, 0
    v_mov_b32 v7, 0
    v_mov_b32 v254, 0
    v_mov_b32 v255, 0
    v_lshrrev_b32 v4, 3, v8
    v_xor_b32 v4, v4, v9
    v_and_b32 v4, 1, v4
    v_lshlrev_b32 v4, 6, v4
    v_lshrrev_b32_e64 v10, 2, v8
    v_lshl_add_u32 v4, v10, 7, v4
    v_and_b32_e64 v10, 3, v8
    v_lshl_add_u32 v4, v10, 4, v4
    v_add_u32 v4, 1280, v4
    v_cmp_eq_u32_e64 vcc, 20, v8
    v_cmp_eq_u32 s[58:59], 24, v8
    s_mul_i32 s42, s74, 2560
    s_add_u32 s42, s42, 71680
    s_or_b64 vcc, vcc, s[58:59]
    v_mov_b32 v10, 0x3f803f80
    s_nop 1
    v_cndmask_b32 v10, 0, v10, vcc
    v_mov_b32 v30, v10
    v_mov_b32 v31, v10
    v_mov_b32 v32, v10
    v_mov_b32 v33, v10
    v_mov_b32 v34, v10
    v_mov_b32 v35, v10
    v_mov_b32 v36, v10
    v_mov_b32 v37, v10
    v_add_u32 v10, s42, v2
    v_add_u32_e64 v11, s42, v11
    s_nop 1
    s_add_u32 s101, s94, s101
    v_cvt_pk_bf16_f32 v190, v190, v191
    v_cvt_pk_bf16_f32 v191, v192, v193
    v_cvt_pk_bf16_f32 v192, v194, v195
    v_cvt_pk_bf16_f32 v193, v196, v197
    s_nop 1
    v_pk_max_i16 v190, v190, 0
    v_pk_max_i16 v191, v191, 0
    v_pk_max_i16 v192, v192, 0
    v_pk_max_i16 v193, v193, 0
    s_nop 1
    v_cvt_pk_bf16_f32 v198, v198, v199
    v_cvt_pk_bf16_f32 v199, v200, v201
    v_cvt_pk_bf16_f32 v200, v202, v203
    v_cvt_pk_bf16_f32 v201, v204, v205
    s_nop 1
    v_pk_max_i16 v198, v198, 0
    v_pk_max_i16 v199, v199, 0
    v_pk_max_i16 v200, v200, 0
    v_pk_max_i16 v201, v201, 0
    s_nop 1
    v_cvt_pk_bf16_f32 v206, v206, v207
    v_cvt_pk_bf16_f32 v207, v208, v209
    v_cvt_pk_bf16_f32 v208, v210, v211
    v_cvt_pk_bf16_f32 v209, v212, v213
    s_nop 1
    v_pk_max_i16 v206, v206, 0
    v_pk_max_i16 v207, v207, 0
    v_pk_max_i16 v208, v208, 0
    v_pk_max_i16 v209, v209, 0
    s_nop 1
    v_cvt_pk_bf16_f32 v214, v214, v215
    v_cvt_pk_bf16_f32 v215, v216, v217
    v_cvt_pk_bf16_f32 v216, v218, v219
    v_cvt_pk_bf16_f32 v217, v220, v221
    s_nop 1
    v_pk_max_i16 v214, v214, 0
    v_pk_max_i16 v215, v215, 0
    v_pk_max_i16 v216, v216, 0
    v_pk_max_i16 v217, v217, 0
    s_branch g_att1
g_cv:
    s_barrier
    ds_read_b128 v[30:33], v174 offset:0
    ds_read_b64_tr_b16 v[6:7], v3 offset:16384
    ds_read_b64_tr_b16 v[8:9], v3 offset:16896
    ds_read_b64_tr_b16 v[10:11], v4 offset:16384
    ds_read_b64_tr_b16 v[12:13], v4 offset:16896
    ds_read_b64_tr_b16 v[14:15], v3 offset:24576
    ds_read_b64_tr_b16 v[16:17], v3 offset:25088
    ds_read_b64_tr_b16 v[18:19], v4 offset:24576
    ds_read_b64_tr_b16 v[20:21], v4 offset:25088
    s_waitcnt lgkmcnt(4)
    v_mfma_f32_32x32x16_bf16 v[222:237], v[30:33], v[6:9], 0
    ds_read_b128 v[34:37], v178 offset:0
    ds_read_b64_tr_b16 v[22:23], v3 offset:18432
    ds_read_b64_tr_b16 v[24:25], v3 offset:18944
    ds_read_b64_tr_b16 v[26:27], v4 offset:18432
    ds_read_b64_tr_b16 v[28:29], v4 offset:18944
    s_lshl_b32 s42, s2, 2
    s_add_u32 s42, s42, s3
    s_cmp_lt_u32 s42, 740
    s_cselect_b32 s89, 0, 0x7f000000
    s_min_u32 s42, s42, 739
    s_mul_i32 s43, s42, 205
    v_mfma_f32_32x32x16_bf16 v[238:253], v[30:33], v[10:13], 0
    s_lshr_b32 s43, s43, 10
    s_mul_i32 s44, s43, 5
    s_sub_u32 s44, s42, s44
    s_mul_i32 s88, s43, 20
    s_lshl_b32 s42, s44, 2
    s_add_u32 s88, s88, s42
    s_waitcnt lgkmcnt(5)
    v_mfma_f32_32x32x16_bf16 v[190:205], v[30:33], v[14:17], 0
    ds_read_b64_tr_b16 v[6:7], v3 offset:26624
    ds_read_b64_tr_b16 v[8:9], v3 offset:27136
    ds_read_b64_tr_b16 v[10:11], v4 offset:26624
    ds_read_b64_tr_b16 v[12:13], v4 offset:27136
    s_lshl_b32 s88, s88, 10
    s_add_u32 s88, s88, s89
    s_sub_u32 s42, s43, 108
    s_mul_i32 s93, s42, 103
    s_lshr_b32 s93, s93, 10
    s_mul_i32 s94, s93, 10
    v_mfma_f32_32x32x16_bf16 v[206:221], v[30:33], v[18:21], 0
    s_sub_u32 s42, s42, s94
    s_mul_i32 s93, s93, 160
    s_mul_i32 s94, s42, 20
    s_mul_i32 s95, s42, 80
    s_sub_u32 s95, s95, 624
    s_cmp_lt_u32 s42, 8
    s_waitcnt lgkmcnt(4)
    v_mfma_f32_32x32x16_bf16 v[222:237], v[34:37], v[22:25], v[222:237]
    ds_read_b128 v[38:41], v182 offset:0
    ds_read_b64_tr_b16 v[14:15], v3 offset:20480
    ds_read_b64_tr_b16 v[16:17], v3 offset:20992
    ds_read_b64_tr_b16 v[18:19], v4 offset:20480
    ds_read_b64_tr_b16 v[20:21], v4 offset:20992
    s_cselect_b32 s94, s94, s95
    s_movk_i32 s90, 25600
    s_cselect_b32 s90, 5120, s90
    s_add_u32 s42, s93, s94
    s_lshl_b32 s93, s43, 4
    s_cmp_lt_u32 s43, 108
    v_mfma_f32_32x32x16_bf16 v[238:253], v[34:37], v[26:29], v[238:253]
    s_cselect_b32 s43, s93, s42
    s_cselect_b32 s90, 5120, s90
    s_cselect_b32 s4, s26, s20
    s_cselect_b32 s5, s27, s21
    s_mov_b32 s42, 819200
    s_cselect_b32 s6, 2211840, s42
    s_waitcnt lgkmcnt(5)
    v_mfma_f32_32x32x16_bf16 v[190:205], v[34:37], v[6:9], v[190:205]
    ds_read_b64_tr_b16 v[22:23], v3 offset:28672
    ds_read_b64_tr_b16 v[24:25], v3 offset:29184
    ds_read_b64_tr_b16 v[26:27], v4 offset:28672
    ds_read_b64_tr_b16 v[28:29], v4 offset:29184
    s_mov_b32 s7, 0x00020000
    s_mul_i32 s43, s43, 1280
    s_lshl_b32 s44, s44, 8
    s_add_u32 s43, s43, s44
    s_mov_b32 s8, s28
    s_mov_b32 s9, s29
    v_mfma_f32_32x32x16_bf16 v[206:221], v[34:37], v[10:13], v[206:221]
    s_mov_b32 s10, 1280
    s_mov_b32 s11, 0x00020000
    s_mov_b32 s64, s16
    s_mov_b32 s65, s17
    s_mov_b32 s66, 2621440
    s_mov_b32 s67, 0x00020000
    s_waitcnt lgkmcnt(4)
    v_mfma_f32_32x32x16_bf16 v[222:237], v[38:41], v[14:17], v[222:237]
    ds_read_b128 v[42:45], v186 offset:0
    ds_read_b64_tr_b16 v[6:7], v3 offset:22528
    ds_read_b64_tr_b16 v[8:9], v3 offset:23040
    ds_read_b64_tr_b16 v[10:11], v4 offset:22528
    ds_read_b64_tr_b16 v[12:13], v4 offset:23040
    s_cmp_lt_u32 s3, 2
    s_cselect_b32 s91, 0, 0x7f000000
    v_and_b32 v145, 15, v1
    v_lshrrev_b32 v143, 4, v1
    v_lshlrev_b32 v142, 4, v145
    v_mul_u32_u24 v146, 1280, v143
    v_mfma_f32_32x32x16_bf16 v[238:253], v[38:41], v[18:21], v[238:253]
    v_add_u32_e64 v146, v142, v146
    v_add_u32 v144, s89, v146
    s_lshl_b32 s42, s60, 4
    s_add_u32 s42, s42, s61
    s_lshl_b32 s42, s42, 1
    s_and_b32 s44, s3, 1
    s_waitcnt lgkmcnt(5)
    v_mfma_f32_32x32x16_bf16 v[190:205], v[38:41], v[22:25], v[190:205]
    ds_read_b64_tr_b16 v[14:15], v3 offset:30720
    ds_read_b64_tr_b16 v[16:17], v3 offset:31232
    ds_read_b64_tr_b16 v[18:19], v4 offset:30720
    ds_read_b64_tr_b16 v[20:21], v4 offset:31232
    s_add_u32 s42, s42, s44
    s_lshl_b32 s95, s42, 4
    s_mul_i32 s93, s42, 5120
    buffer_load_dwordx4 v[158:161], v144, s[4:7], s43 offen
    s_add_u32 s43, s43, s90
    v_mfma_f32_32x32x16_bf16 v[206:221], v[38:41], v[26:29], v[206:221]
    buffer_load_dwordx4 v[162:165], v144, s[4:7], s43 offen
    s_add_u32 s43, s43, s90
    buffer_load_dwordx4 v[166:169], v144, s[4:7], s43 offen
    s_add_u32 s43, s43, s90
    s_waitcnt lgkmcnt(4)
    v_mfma_f32_32x32x16_bf16 v[222:237], v[42:45], v[6:9], v[222:237]
    buffer_load_dwordx4 v[170:173], v144, s[4:7], s43 offen
    s_add_u32 s95, s95, s91
    s_add_u32 s95, s95, 5242880
    v_lshlrev_b32 v136, 2, v143
    v_add_u32_e64 v136, s95, v136
    v_mfma_f32_32x32x16_bf16 v[238:253], v[42:45], v[10:13], v[238:253]
    v_mov_b32 v137, 0x7f000000
    v_cmp_eq_u32 vcc, 0, v145
    v_lshlrev_b32 v134, 5, v143
    v_cndmask_b32 v136, v137, v136, vcc
    v_cmp_gt_u32 vcc, 8, v145
    v_and_b32 v135, 3, v1
    s_barrier
    ds_read_b128 v[46:49], v174 offset:32768
    ds_read_b64_tr_b16 v[22:23], v3 offset:49152
    ds_read_b64_tr_b16 v[24:25], v3 offset:49664
    ds_read_b64_tr_b16 v[26:27], v4 offset:49152
    ds_read_b64_tr_b16 v[28:29], v4 offset:49664
    s_waitcnt lgkmcnt(5)
    v_mfma_f32_32x32x16_bf16 v[190:205], v[42:45], v[14:17], v[190:205]
    ds_read_b64_tr_b16 v[6:7], v3 offset:57344
    ds_read_b64_tr_b16 v[8:9], v3 offset:57856
    ds_read_b64_tr_b16 v[10:11], v4 offset:57344
    ds_read_b64_tr_b16 v[12:13], v4 offset:57856
    v_lshl_add_u32 v134, v135, 7, v134
    v_bfe_u32 v135, v1, 2, 1
    v_lshl_add_u32 v134, v135, 10, v134
    v_lshrrev_b32 v135, 3, v145
    v_lshl_add_u32 v134, v135, 4, v134
    v_add_u32_e64 v134, s88, v134
    v_mfma_f32_32x32x16_bf16 v[206:221], v[42:45], v[18:21], v[206:221]
    v_mov_b32 v135, 0x05040100
    v_mov_b32 v137, 0x07060302
    v_cndmask_b32_e64 v135, v135, v137, vcc
    s_mul_i32 s42, s2, 10240
    s_lshl_b32 s43, s3, 10
    s_add_u32 s42, s42, s43
    s_waitcnt lgkmcnt(4)
    v_mfma_f32_32x32x16_bf16 v[222:237], v[46:49], v[22:25], v[222:237]
    ds_read_b128 v[50:53], v178 offset:32768
    ds_read_b64_tr_b16 v[14:15], v3 offset:51200
    ds_read_b64_tr_b16 v[16:17], v3 offset:51712
    ds_read_b64_tr_b16 v[18:19], v4 offset:51200
    ds_read_b64_tr_b16 v[20:21], v4 offset:51712
    v_lshlrev_b32 v137, 4, v1
    v_add_u32 v137, s42, v137
    v_add_u32 v138, s91, v137
    s_mul_i32 s94, s92, 110592
    s_mul_i32 s43, s61, 6144
    s_cmp_lt_u32 s61, 15
    v_mfma_f32_32x32x16_bf16 v[238:253], v[46:49], v[26:29], v[238:253]
    s_cselect_b32 s43, s43, 94208
    s_add_u32 s94, s94, s43
    s_and_b32 s43, s43, 2048
    s_add_u32 s94, s94, s43
    s_mul_i32 s43, s43, 3
    s_sub_u32 s101, 4096, s43
    s_waitcnt lgkmcnt(5)
    v_mfma_f32_32x32x16_bf16 v[190:205], v[46:49], v[6:9], v[190:205]
    ds_read_b64_tr_b16 v[22:23], v3 offset:59392
    ds_read_b64_tr_b16 v[24:25], v3 offset:59904
    ds_read_b64_tr_b16 v[26:27], v4 offset:59392
    ds_read_b64_tr_b16 v[28:29], v4 offset:59904
    s_mov_b32 s42, 1051011932
    s_cmp_lt_u32 s61, 5
    s_cselect_b32 s96, s42, 1.0
    s_mov_b32 s97, s96
    s_movk_i32 s44, 2560
    s_cselect_b32 s44, 1280, s44
    v_mfma_f32_32x32x16_bf16 v[206:221], v[46:49], v[10:13], v[206:221]
    s_mov_b32 s42, 2621440
    s_cselect_b32 s42, 0, s42
    s_mov_b32 s43, 5242880
    s_cselect_b32 s90, 2621440, s43
    s_add_u32 s88, s34, s42
    s_addc_u32 s89, s35, 0
    s_waitcnt lgkmcnt(4)
    v_mfma_f32_32x32x16_bf16 v[222:237], v[50:53], v[14:17], v[222:237]
    ds_read_b128 v[54:57], v182 offset:32768
    ds_read_b64_tr_b16 v[6:7], v3 offset:53248
    ds_read_b64_tr_b16 v[8:9], v3 offset:53760
    ds_read_b64_tr_b16 v[10:11], v4 offset:53248
    ds_read_b64_tr_b16 v[12:13], v4 offset:53760
    s_mov_b32 s91, 0x00020000
    s_mul_i32 s92, s92, s44
    s_lshl_b32 s93, s44, 6
    s_and_b32 s42, s2, 7
    s_lshl_b32 s42, s42, 2
    s_lshr_b32 s43, s2, 3
    v_mfma_f32_32x32x16_bf16 v[238:253], v[50:53], v[18:21], v[238:253]
    s_and_b32 s43, s43, 3
    s_add_u32 s37, s42, s43
    s_lshr_b32 s42, s2, 5
    s_lshl_b32 s42, s42, 3
    s_and_b32 s74, s36, 3
    s_lshl_b32 s43, s74, 1
    s_waitcnt lgkmcnt(5)
    v_mfma_f32_32x32x16_bf16 v[190:205], v[50:53], v[22:25], v[190:205]
    ds_read_b64_tr_b16 v[14:15], v3 offset:61440
    ds_read_b64_tr_b16 v[16:17], v3 offset:61952
    ds_read_b64_tr_b16 v[18:19], v4 offset:61440
    ds_read_b64_tr_b16 v[20:21], v4 offset:61952
    s_add_u32 s38, s42, s43
    s_lshr_b32 s42, s36, 2
    s_add_u32 s38, s38, s42
    s_and_b32 s42, s2, 7
    s_lshl_b32 s42, s42, 3
    s_bfe_u32 s43, s2, 0x30003
    v_mfma_f32_32x32x16_bf16 v[206:221], v[50:53], v[26:29], v[206:221]
    s_add_u32 s45, s42, s43
    s_lshr_b32 s46, s2, 6
    s_mul_i32 s72, s45, 108
    s_add_u32 s72, s72, s36
    s_lshl_b32 s72, s72, 10
    s_mul_i32 s73, s36, 20
    s_waitcnt lgkmcnt(4)
    v_mfma_f32_32x32x16_bf16 v[222:237], v[54:57], v[6:9], v[222:237]
    ds_read_b128 v[58:61], v186 offset:32768
    ds_read_b64_tr_b16 v[22:23], v3 offset:55296
    ds_read_b64_tr_b16 v[24:25], v3 offset:55808
    ds_read_b64_tr_b16 v[26:27], v4 offset:55296
    ds_read_b64_tr_b16 v[28:29], v4 offset:55808
    s_mul_i32 s42, s46, 5
    s_add_u32 s73, s73, s42
    s_lshl_b32 s73, s73, 10
    s_add_u32 s4, s34, 2621440
    s_addc_u32 s5, s35, 0
    s_mov_b32 s6, 5242880
    v_mfma_f32_32x32x16_bf16 v[238:253], v[54:57], v[10:13], v[238:253]
    s_mov_b32 s7, 0x00020000
    s_mov_b32 s8, s34
    s_mov_b32 s9, s35
    s_mov_b32 s10, 7864320
    s_mov_b32 s11, 0x00020000
    s_lshl_b32 s41, s36, 10
    s_waitcnt lgkmcnt(5)
    v_mfma_f32_32x32x16_bf16 v[190:205], v[54:57], v[14:17], v[190:205]
    ds_read_b64_tr_b16 v[6:7], v3 offset:63488
    ds_read_b64_tr_b16 v[8:9], v3 offset:64000
    ds_read_b64_tr_b16 v[10:11], v4 offset:63488
    ds_read_b64_tr_b16 v[12:13], v4 offset:64000
    s_mul_i32 s39, s37, 163840
    s_add_u32 s39, s39, s41
    s_add_u32 s64, s34, 7864320
    s_addc_u32 s65, s35, 0
    s_mov_b32 s66, 7077888
    s_mov_b32 s67, 0x00020000
    v_mfma_f32_32x32x16_bf16 v[206:221], v[54:57], v[18:21], v[206:221]
    s_add_u32 s68, s34, 20971520
    s_addc_u32 s69, s35, 0
    s_mov_b32 s70, 3031040
    s_mov_b32 s71, 0x00020000
    s_add_u32 s12, s34, 14942208
    s_addc_u32 s13, s35, 0
    s_waitcnt lgkmcnt(4)
    v_mfma_f32_32x32x16_bf16 v[222:237], v[58:61], v[22:25], v[222:237]
    s_mov_b32 s14, 5251072
    s_mov_b32 s15, 0x00020000
    s_mul_i32 s75, s74, 200
    s_add_u32 s75, s75, 4
    s_cmp_lt_u32 s36, 4
    s_cselect_b32 s75, s75, s74
    v_mfma_f32_32x32x16_bf16 v[238:253], v[58:61], v[26:29], v[238:253]
    s_mul_i32 s42, s46, 5
    s_add_u32 s75, s75, s42
    s_add_u32 s75, s75, 2160
    s_lshl_b32 s75, s75, 10
    s_mul_i32 s47, s36, 10240
    s_mov_b32 s62, 0x000fffff
    s_barrier
    v_add_u32 v174, 65536, v174
    v_add_u32 v178, 65536, v178
    v_add_u32 v182, 65536, v182
    v_add_u32 v186, 65536, v186
    ds_read_b128 v[62:65], v174 offset:0
    v_add_u32 v3, 65536, v3
    v_add_u32 v4, 65536, v4
    ds_read_b64_tr_b16 v[14:15], v3 offset:16384
    ds_read_b64_tr_b16 v[16:17], v3 offset:16896
    ds_read_b64_tr_b16 v[18:19], v4 offset:16384
    ds_read_b64_tr_b16 v[20:21], v4 offset:16896
    s_waitcnt lgkmcnt(5)
    v_mfma_f32_32x32x16_bf16 v[190:205], v[58:61], v[6:9], v[190:205]
    ds_read_b64_tr_b16 v[22:23], v3 offset:24576
    ds_read_b64_tr_b16 v[24:25], v3 offset:25088
    ds_read_b64_tr_b16 v[26:27], v4 offset:24576
    ds_read_b64_tr_b16 v[28:29], v4 offset:25088
    s_mov_b32 s63, 0x000fffff
    s_add_u32 s48, s34, 20316160
    s_addc_u32 s49, s35, 0
    s_mov_b32 s50, 73728
    s_mov_b32 s51, 0x00020000
    s_mov_b32 s52, s32
    v_mfma_f32_32x32x16_bf16 v[206:221], v[58:61], v[10:13], v[206:221]
    s_mov_b32 s53, s33
    s_mov_b32 s54, 256
    s_mov_b32 s55, 0x00020000
    s_mov_b32 s58, 0x55555555
    s_mov_b32 s59, 0x55555555
    v_lshrrev_b32 v187, 5, v1
    s_waitcnt lgkmcnt(4)
    v_mfma_f32_32x32x16_bf16 v[222:237], v[62:65], v[14:17], v[222:237]
    ds_read_b128 v[66:69], v178 offset:0
    ds_read_b64_tr_b16 v[6:7], v3 offset:18432
    ds_read_b64_tr_b16 v[8:9], v3 offset:18944
    ds_read_b64_tr_b16 v[10:11], v4 offset:18432
    ds_read_b64_tr_b16 v[12:13], v4 offset:18944
    v_and_b32 v254, 3, v1
    v_lshlrev_b32 v254, 4, v254
    v_lshl_add_u32 v254, v187, 6, v254
    v_add_u32 v254, 1280, v254
    s_movk_i32 s95, 3277
    s_mov_b32 s93, 163200
    v_mfma_f32_32x32x16_bf16 v[238:253], v[62:65], v[18:21], v[238:253]
    s_lshl_b32 s42, s57, 7
    v_add_u32 v0, s42, v0
    s_waitcnt lgkmcnt(5)
    v_mfma_f32_32x32x16_bf16 v[190:205], v[62:65], v[22:25], v[190:205]
    ds_read_b64_tr_b16 v[14:15], v3 offset:26624
    ds_read_b64_tr_b16 v[16:17], v3 offset:27136
    ds_read_b64_tr_b16 v[18:19], v4 offset:26624
    ds_read_b64_tr_b16 v[20:21], v4 offset:27136
    s_cmp_ge_u32 s3, 2
    s_cbranch_scc0 g_br3
    s_mov_b32 s8, s24
    s_mov_b32 s9, s25
    s_mov_b32 s10, 2211840
    s_mov_b32 s11, 0x00020000
    buffer_load_dword v124, v122, s[8:11], 0 offen
g_br3:
    v_mfma_f32_32x32x16_bf16 v[206:221], v[62:65], v[26:29], v[206:221]
    s_waitcnt lgkmcnt(4)
    v_mfma_f32_32x32x16_bf16 v[222:237], v[66:69], v[6:9], v[222:237]
    ds_read_b128 v[70:73], v182 offset:0
    ds_read_b64_tr_b16 v[22:23], v3 offset:20480
    ds_read_b64_tr_b16 v[24:25], v3 offset:20992
    ds_read_b64_tr_b16 v[26:27], v4 offset:20480
    ds_read_b64_tr_b16 v[28:29], v4 offset:20992
    v_mfma_f32_32x32x16_bf16 v[238:253], v[66:69], v[10:13], v[238:253]
    s_waitcnt lgkmcnt(5)
    v_mfma_f32_32x32x16_bf16 v[190:205], v[66:69], v[14:17], v[190:205]
    ds_read_b64_tr_b16 v[6:7], v3 offset:28672
    ds_read_b64_tr_b16 v[8:9], v3 offset:29184
    ds_read_b64_tr_b16 v[10:11], v4 offset:28672
    ds_read_b64_tr_b16 v[12:13], v4 offset:29184
    v_mfma_f32_32x32x16_bf16 v[206:221], v[66:69], v[18:21], v[206:221]
    s_waitcnt lgkmcnt(4)
    v_mfma_f32_32x32x16_bf16 v[222:237], v[70:73], v[22:25], v[222:237]
    ds_read_b128 v[74:77], v186 offset:0
    ds_read_b64_tr_b16 v[14:15], v3 offset:22528
    ds_read_b64_tr_b16 v[16:17], v3 offset:23040
    ds_read_b64_tr_b16 v[18:19], v4 offset:22528
    ds_read_b64_tr_b16 v[20:21], v4 offset:23040
    v_mfma_f32_32x32x16_bf16 v[238:253], v[70:73], v[26:29], v[238:253]
    s_waitcnt lgkmcnt(5)
    v_mfma_f32_32x32x16_bf16 v[190:205], v[70:73], v[6:9], v[190:205]
    ds_read_b64_tr_b16 v[22:23], v3 offset:30720
    ds_read_b64_tr_b16 v[24:25], v3 offset:31232
    ds_read_b64_tr_b16 v[26:27], v4 offset:30720
    ds_read_b64_tr_b16 v[28:29], v4 offset:31232
    v_mfma_f32_32x32x16_bf16 v[206:221], v[70:73], v[10:13], v[206:221]
    s_waitcnt lgkmcnt(4)
    v_mfma_f32_32x32x16_bf16 v[222:237], v[74:77], v[14:17], v[222:237]
    v_mfma_f32_32x32x16_bf16 v[238:253], v[74:77], v[18:21], v[238:253]
    s_barrier
    ds_read_b128 v[78:81], v174 offset:32768
    ds_read_b64_tr_b16 v[6:7], v3 offset:49152
    ds_read_b64_tr_b16 v[8:9], v3 offset:49664
    ds_read_b64_tr_b16 v[10:11], v4 offset:49152
    ds_read_b64_tr_b16 v[12:13], v4 offset:49664
    s_waitcnt lgkmcnt(5)
    v_mfma_f32_32x32x16_bf16 v[190:205], v[74:77], v[22:25], v[190:205]
    ds_read_b64_tr_b16 v[14:15], v3 offset:57344
    ds_read_b64_tr_b16 v[16:17], v3 offset:57856
    ds_read_b64_tr_b16 v[18:19], v4 offset:57344
    ds_read_b64_tr_b16 v[20:21], v4 offset:57856
    v_mfma_f32_32x32x16_bf16 v[206:221], v[74:77], v[26:29], v[206:221]
    s_waitcnt lgkmcnt(4)
    v_mfma_f32_32x32x16_bf16 v[222:237], v[78:81], v[6:9], v[222:237]
    ds_read_b128 v[82:85], v178 offset:32768
    ds_read_b64_tr_b16 v[22:23], v3 offset:51200
    ds_read_b64_tr_b16 v[24:25], v3 offset:51712
    ds_read_b64_tr_b16 v[26:27], v4 offset:51200
    ds_read_b64_tr_b16 v[28:29], v4 offset:51712
    v_mfma_f32_32x32x16_bf16 v[238:253], v[78:81], v[10:13], v[238:253]
    s_waitcnt lgkmcnt(5)
    v_mfma_f32_32x32x16_bf16 v[190:205], v[78:81], v[14:17], v[190:205]
    ds_read_b64_tr_b16 v[6:7], v3 offset:59392
    ds_read_b64_tr_b16 v[8:9], v3 offset:59904
    ds_read_b64_tr_b16 v[10:11], v4 offset:59392
    ds_read_b64_tr_b16 v[12:13], v4 offset:59904
    v_mfma_f32_32x32x16_bf16 v[206:221], v[78:81], v[18:21], v[206:221]
    s_waitcnt lgkmcnt(4)
    v_mfma_f32_32x32x16_bf16 v[222:237], v[82:85], v[22:25], v[222:237]
    ds_read_b128 v[86:89], v182 offset:32768
    ds_read_b64_tr_b16 v[14:15], v3 offset:53248
    ds_read_b64_tr_b16 v[16:17], v3 offset:53760
    ds_read_b64_tr_b16 v[18:19], v4 offset:53248
    ds_read_b64_tr_b16 v[20:21], v4 offset:53760
    v_mfma_f32_32x32x16_bf16 v[238:253], v[82:85], v[26:29], v[238:253]
    s_waitcnt lgkmcnt(5)
    v_mfma_f32_32x32x16_bf16 v[190:205], v[82:85], v[6:9], v[190:205]
    ds_read_b64_tr_b16 v[22:23], v3 offset:61440
    ds_read_b64_tr_b16 v[24:25], v3 offset:61952
    ds_read_b64_tr_b16 v[26:27], v4 offset:61440
    ds_read_b64_tr_b16 v[28:29], v4 offset:61952
    v_mfma_f32_32x32x16_bf16 v[206:221], v[82:85], v[10:13], v[206:221]
    s_waitcnt lgkmcnt(4)
    v_mfma_f32_32x32x16_bf16 v[222:237], v[86:89], v[14:17], v[222:237]
    ds_read_b128 v[90:93], v186 offset:32768
    ds_read_b64_tr_b16 v[6:7], v3 offset:55296
    ds_read_b64_tr_b16 v[8:9], v3 offset:55808
    ds_read_b64_tr_b16 v[10:11], v4 offset:55296
    ds_read_b64_tr_b16 v[12:13], v4 offset:55808
    v_mfma_f32_32x32x16_bf16 v[238:253], v[86:89], v[18:21], v[238:253]
    s_waitcnt lgkmcnt(5)
    v_mfma_f32_32x32x16_bf16 v[190:205], v[86:89], v[22:25], v[190:205]
    ds_read_b64_tr_b16 v[14:15], v3 offset:63488
    ds_read_b64_tr_b16 v[16:17], v3 offset:64000
    ds_read_b64_tr_b16 v[18:19], v4 offset:63488
    ds_read_b64_tr_b16 v[20:21], v4 offset:64000
    v_mfma_f32_32x32x16_bf16 v[206:221], v[86:89], v[26:29], v[206:221]
    s_waitcnt lgkmcnt(4)
    v_mfma_f32_32x32x16_bf16 v[222:237], v[90:93], v[6:9], v[222:237]
    s_mov_b32 s42, 0x05040100
    s_mov_b32 s43, 0x07060302
    v_mfma_f32_32x32x16_bf16 v[238:253], v[90:93], v[10:13], v[238:253]
    s_waitcnt vmcnt(0)
    v_permlane32_swap_b32 v158, v160
    v_permlane32_swap_b32 v159, v161
    v_permlane32_swap_b32 v162, v164
    v_permlane32_swap_b32 v163, v165
    v_permlane32_swap_b32 v166, v168
    s_barrier
    v_add_u32 v174, 65536, v174
    v_add_u32 v178, 65536, v178
    v_add_u32 v182, 65536, v182
    v_add_u32 v186, 65536, v186
    ds_read_b128 v[94:97], v174 offset:0
    v_add_u32 v3, 65536, v3
    v_add_u32 v4, 65536, v4
    ds_read_b64_tr_b16 v[22:23], v3 offset:16384
    ds_read_b64_tr_b16 v[24:25], v3 offset:16896
    ds_read_b64_tr_b16 v[26:27], v4 offset:16384
    ds_read_b64_tr_b16 v[28:29], v4 offset:16896
    s_waitcnt lgkmcnt(5)
    v_mfma_f32_32x32x16_bf16 v[190:205], v[90:93], v[14:17], v[190:205]
    ds_read_b64_tr_b16 v[6:7], v3 offset:24576
    ds_read_b64_tr_b16 v[8:9], v3 offset:25088
    ds_read_b64_tr_b16 v[10:11], v4 offset:24576
    ds_read_b64_tr_b16 v[12:13], v4 offset:25088
    v_permlane32_swap_b32 v167, v169
    v_permlane32_swap_b32 v170, v172
    v_permlane32_swap_b32 v171, v173
    v_permlane16_swap_b32 v158, v159
    v_permlane16_swap_b32 v160, v161
    v_permlane16_swap_b32 v162, v163
    v_mfma_f32_32x32x16_bf16 v[206:221], v[90:93], v[18:21], v[206:221]
    v_permlane16_swap_b32 v164, v165
    v_permlane16_swap_b32 v166, v167
    v_permlane16_swap_b32 v168, v169
    v_permlane16_swap_b32 v170, v171
    v_permlane16_swap_b32 v172, v173
    s_nop 1
    v_perm_b32 v142, v159, v158, s42
    s_waitcnt lgkmcnt(4)
    v_mfma_f32_32x32x16_bf16 v[222:237], v[94:97], v[22:25], v[222:237]
    ds_read_b128 v[98:101], v178 offset:0
    ds_read_b64_tr_b16 v[14:15], v3 offset:18432
    ds_read_b64_tr_b16 v[16:17], v3 offset:18944
    ds_read_b64_tr_b16 v[18:19], v4 offset:18432
    ds_read_b64_tr_b16 v[20:21], v4 offset:18944
    v_perm_b32 v146, v159, v158, s43
    v_perm_b32 v158, v159, v158, v135
    v_perm_b32 v143, v161, v160, s42
    v_perm_b32 v147, v161, v160, s43
    v_perm_b32 v160, v161, v160, v135
    v_perm_b32 v144, v167, v166, s42
    v_mfma_f32_32x32x16_bf16 v[238:253], v[94:97], v[26:29], v[238:253]
    v_perm_b32 v148, v167, v166, s43
    v_perm_b32 v166, v167, v166, v135
    v_perm_b32 v145, v169, v168, s42
    v_perm_b32 v149, v169, v168, s43
    v_perm_b32 v168, v169, v168, v135
    s_nop 1
    v_mov_b32_dpp v142, v158 row_ror:8 row_mask:0xf bank_mask:0xc
    s_waitcnt lgkmcnt(5)
    v_mfma_f32_32x32x16_bf16 v[190:205], v[94:97], v[6:9], v[190:205]
    ds_read_b64_tr_b16 v[22:23], v3 offset:26624
    ds_read_b64_tr_b16 v[24:25], v3 offset:27136
    ds_read_b64_tr_b16 v[26:27], v4 offset:26624
    ds_read_b64_tr_b16 v[28:29], v4 offset:27136
    v_mov_b32_dpp v146, v158 row_ror:8 row_mask:0xf bank_mask:0x3
    v_mov_b32_dpp v143, v160 row_ror:8 row_mask:0xf bank_mask:0xc
    v_mov_b32_dpp v147, v160 row_ror:8 row_mask:0xf bank_mask:0x3
    v_mov_b32_dpp v144, v166 row_ror:8 row_mask:0xf bank_mask:0xc
    v_mov_b32_dpp v148, v166 row_ror:8 row_mask:0xf bank_mask:0x3
    v_mov_b32_dpp v145, v168 row_ror:8 row_mask:0xf bank_mask:0xc
    v_mfma_f32_32x32x16_bf16 v[206:221], v[94:97], v[10:13], v[206:221]
    v_mov_b32_dpp v149, v168 row_ror:8 row_mask:0xf bank_mask:0x3
    buffer_store_dwordx4 v[142:145], v134, s[68:71], 0 offen offset:0 sc1
    buffer_store_dwordx4 v[146:149], v134, s[68:71], 0 offen offset:2048 sc1
    v_perm_b32 v150, v163, v162, s42
    s_waitcnt lgkmcnt(4)
    v_mfma_f32_32x32x16_bf16 v[222:237], v[98:101], v[14:17], v[222:237]
    ds_read_b128 v[102:105], v182 offset:0
    ds_read_b64_tr_b16 v[6:7], v3 offset:20480
    ds_read_b64_tr_b16 v[8:9], v3 offset:20992
    ds_read_b64_tr_b16 v[10:11], v4 offset:20480
    ds_read_b64_tr_b16 v[12:13], v4 offset:20992
    v_perm_b32 v154, v163, v162, s43
    v_perm_b32 v162, v163, v162, v135
    v_perm_b32 v151, v165, v164, s42
    v_perm_b32 v155, v165, v164, s43
    v_perm_b32 v164, v165, v164, v135
    v_perm_b32 v152, v171, v170, s42
    v_mfma_f32_32x32x16_bf16 v[238:253], v[98:101], v[18:21], v[238:253]
    v_perm_b32 v156, v171, v170, s43
    v_perm_b32 v170, v171, v170, v135
    v_perm_b32 v153, v173, v172, s42
    v_perm_b32 v157, v173, v172, s43
    v_perm_b32 v172, v173, v172, v135
    s_nop 1
    v_mov_b32_dpp v150, v162 row_ror:8 row_mask:0xf bank_mask:0xc
    s_waitcnt lgkmcnt(5)
    v_mfma_f32_32x32x16_bf16 v[190:205], v[98:101], v[22:25], v[190:205]
    ds_read_b64_tr_b16 v[14:15], v3 offset:28672
    ds_read_b64_tr_b16 v[16:17], v3 offset:29184
    ds_read_b64_tr_b16 v[18:19], v4 offset:28672
    ds_read_b64_tr_b16 v[20:21], v4 offset:29184
    v_mov_b32_dpp v154, v162 row_ror:8 row_mask:0xf bank_mask:0x3
    v_mov_b32_dpp v151, v164 row_ror:8 row_mask:0xf bank_mask:0xc
    v_mov_b32_dpp v155, v164 row_ror:8 row_mask:0xf bank_mask:0x3
    v_mov_b32_dpp v152, v170 row_ror:8 row_mask:0xf bank_mask:0xc
    v_mov_b32_dpp v156, v170 row_ror:8 row_mask:0xf bank_mask:0x3
    v_mov_b32_dpp v153, v172 row_ror:8 row_mask:0xf bank_mask:0xc
    v_mfma_f32_32x32x16_bf16 v[206:221], v[98:101], v[26:29], v[206:221]
    v_mov_b32_dpp v157, v172 row_ror:8 row_mask:0xf bank_mask:0x3
    buffer_store_dwordx4 v[150:153], v134, s[68:71], 0 offen offset:512 sc1
    buffer_store_dwordx4 v[154:157], v134, s[68:71], 0 offen offset:2560 sc1
    s_waitcnt lgkmcnt(4)
    v_mfma_f32_32x32x16_bf16 v[222:237], v[102:105], v[6:9], v[222:237]
    ds_read_b128 v[106:109], v186 offset:0
    ds_read_b64_tr_b16 v[22:23], v3 offset:22528
    ds_read_b64_tr_b16 v[24:25], v3 offset:23040
    ds_read_b64_tr_b16 v[26:27], v4 offset:22528
    ds_read_b64_tr_b16 v[28:29], v4 offset:23040
    v_mfma_f32_32x32x16_bf16 v[238:253], v[102:105], v[10:13], v[238:253]
    s_waitcnt lgkmcnt(5)
    v_mfma_f32_32x32x16_bf16 v[190:205], v[102:105], v[14:17], v[190:205]
    ds_read_b64_tr_b16 v[6:7], v3 offset:30720
    ds_read_b64_tr_b16 v[8:9], v3 offset:31232
    ds_read_b64_tr_b16 v[10:11], v4 offset:30720
    ds_read_b64_tr_b16 v[12:13], v4 offset:31232
    v_mfma_f32_32x32x16_bf16 v[206:221], v[102:105], v[18:21], v[206:221]
    s_waitcnt lgkmcnt(4)
    v_mfma_f32_32x32x16_bf16 v[222:237], v[106:109], v[22:25], v[222:237]
    v_mfma_f32_32x32x16_bf16 v[238:253], v[106:109], v[26:29], v[238:253]
    s_barrier
    v_add_u32 v174, -131072, v174
    v_add_u32 v178, -131072, v178
    v_add_u32 v182, -131072, v182
    v_add_u32 v186, -131072, v186
    ds_read_b128 v[110:113], v174 offset:0
    v_add_u32 v3, -131072, v3
    v_add_u32 v4, -131072, v4
    ds_read_b64_tr_b16 v[14:15], v3 offset:16384
    ds_read_b64_tr_b16 v[16:17], v3 offset:16896
    ds_read_b64_tr_b16 v[18:19], v4 offset:16384
    ds_read_b64_tr_b16 v[20:21], v4 offset:16896
    s_waitcnt lgkmcnt(5)
    v_mfma_f32_32x32x16_bf16 v[190:205], v[106:109], v[6:9], v[190:205]
    ds_read_b64_tr_b16 v[22:23], v3 offset:24576
    ds_read_b64_tr_b16 v[24:25], v3 offset:25088
    ds_read_b64_tr_b16 v[26:27], v4 offset:24576
    ds_read_b64_tr_b16 v[28:29], v4 offset:25088
    v_mfma_f32_32x32x16_bf16 v[206:221], v[106:109], v[10:13], v[206:221]
    s_waitcnt lgkmcnt(4)
    v_mfma_f32_32x32x16_bf16 v[222:237], v[110:113], v[14:17], v[222:237]
    ds_read_b128 v[114:117], v178 offset:0
    ds_read_b64_tr_b16 v[6:7], v3 offset:18432
    ds_read_b64_tr_b16 v[8:9], v3 offset:18944
    ds_read_b64_tr_b16 v[10:11], v4 offset:18432
    ds_read_b64_tr_b16 v[12:13], v4 offset:18944
    v_mfma_f32_32x32x16_bf16 v[238:253], v[110:113], v[18:21], v[238:253]
    s_waitcnt lgkmcnt(5)
    v_mfma_f32_32x32x16_bf16 v[190:205], v[110:113], v[22:25], v[190:205]
    ds_read_b64_tr_b16 v[14:15], v3 offset:26624
    ds_read_b64_tr_b16 v[16:17], v3 offset:27136
    ds_read_b64_tr_b16 v[18:19], v4 offset:26624
    ds_read_b64_tr_b16 v[20:21], v4 offset:27136
    v_mfma_f32_32x32x16_bf16 v[206:221], v[110:113], v[26:29], v[206:221]
    s_waitcnt lgkmcnt(4)
    v_mfma_f32_32x32x16_bf16 v[222:237], v[114:117], v[6:9], v[222:237]
    ds_read_b128 v[118:121], v182 offset:0
    ds_read_b64_tr_b16 v[22:23], v3 offset:20480
    ds_read_b64_tr_b16 v[24:25], v3 offset:20992
    ds_read_b64_tr_b16 v[26:27], v4 offset:20480
    ds_read_b64_tr_b16 v[28:29], v4 offset:20992
    v_mfma_f32_32x32x16_bf16 v[238:253], v[114:117], v[10:13], v[238:253]
    s_waitcnt lgkmcnt(5)
    v_mfma_f32_32x32x16_bf16 v[190:205], v[114:117], v[14:17], v[190:205]
    ds_read_b64_tr_b16 v[6:7], v3 offset:28672
    ds_read_b64_tr_b16 v[8:9], v3 offset:29184
    ds_read_b64_tr_b16 v[10:11], v4 offset:28672
    ds_read_b64_tr_b16 v[12:13], v4 offset:29184
    v_mfma_f32_32x32x16_bf16 v[206:221], v[114:117], v[18:21], v[206:221]
    s_waitcnt lgkmcnt(4)
    v_mfma_f32_32x32x16_bf16 v[222:237], v[118:121], v[22:25], v[222:237]
    ds_read_b128 v[122:125], v186 offset:0
    ds_read_b64_tr_b16 v[14:15], v3 offset:22528
    ds_read_b64_tr_b16 v[16:17], v3 offset:23040
    ds_read_b64_tr_b16 v[18:19], v4 offset:22528
    ds_read_b64_tr_b16 v[20:21], v4 offset:23040
    v_mfma_f32_32x32x16_bf16 v[238:253], v[118:121], v[26:29], v[238:253]
    s_waitcnt lgkmcnt(5)
    v_mfma_f32_32x32x16_bf16 v[190:205], v[118:121], v[6:9], v[190:205]
    ds_read_b64_tr_b16 v[22:23], v3 offset:30720
    ds_read_b64_tr_b16 v[24:25], v3 offset:31232
    ds_read_b64_tr_b16 v[26:27], v4 offset:30720
    ds_read_b64_tr_b16 v[28:29], v4 offset:31232
    v_mfma_f32_32x32x16_bf16 v[206:221], v[118:121], v[10:13], v[206:221]
    s_waitcnt lgkmcnt(4)
    v_mfma_f32_32x32x16_bf16 v[222:237], v[122:125], v[14:17], v[222:237]
    v_mfma_f32_32x32x16_bf16 v[238:253], v[122:125], v[18:21], v[238:253]
    s_waitcnt vmcnt(0)
    s_barrier
    ds_read_b128 v[126:129], v174 offset:32768
    ds_read_b64_tr_b16 v[6:7], v3 offset:49152
    ds_read_b64_tr_b16 v[8:9], v3 offset:49664
    ds_read_b64_tr_b16 v[10:11], v4 offset:49152
    ds_read_b64_tr_b16 v[12:13], v4 offset:49664
    s_cmp_lg_u32 s3, 0
    s_cbranch_scc1 g_nava
    s_and_b32 s43, s2, 3
    s_lshl_b32 s43, s43, 6
    v_mov_b32 v187, 1
    s_mov_b64 exec, 1
    buffer_atomic_add v187, off, s[52:55], s43 offset:0 sc1
    s_mov_b64 exec, -1
g_nava:
    s_waitcnt lgkmcnt(5)
    v_mfma_f32_32x32x16_bf16 v[190:205], v[122:125], v[22:25], v[190:205]
    ds_read_b64_tr_b16 v[14:15], v3 offset:57344
    ds_read_b64_tr_b16 v[16:17], v3 offset:57856
    ds_read_b64_tr_b16 v[18:19], v4 offset:57344
    ds_read_b64_tr_b16 v[20:21], v4 offset:57856
    v_mfma_f32_32x32x16_bf16 v[206:221], v[122:125], v[26:29], v[206:221]
    s_waitcnt lgkmcnt(4)
    v_mfma_f32_32x32x16_bf16 v[222:237], v[126:129], v[6:9], v[222:237]
    ds_read_b128 v[130:133], v178 offset:32768
    ds_read_b64_tr_b16 v[22:23], v3 offset:51200
    ds_read_b64_tr_b16 v[24:25], v3 offset:51712
    ds_read_b64_tr_b16 v[26:27], v4 offset:51200
    ds_read_b64_tr_b16 v[28:29], v4 offset:51712
    v_mfma_f32_32x32x16_bf16 v[238:253], v[126:129], v[10:13], v[238:253]
    s_waitcnt lgkmcnt(5)
    v_mfma_f32_32x32x16_bf16 v[190:205], v[126:129], v[14:17], v[190:205]
    ds_read_b64_tr_b16 v[6:7], v3 offset:59392
    ds_read_b64_tr_b16 v[8:9], v3 offset:59904
    ds_read_b64_tr_b16 v[10:11], v4 offset:59392
    ds_read_b64_tr_b16 v[12:13], v4 offset:59904
    v_mfma_f32_32x32x16_bf16 v[206:221], v[126:129], v[18:21], v[206:221]
    s_waitcnt lgkmcnt(4)
    v_mfma_f32_32x32x16_bf16 v[222:237], v[130:133], v[22:25], v[222:237]
    ds_read_b128 v[134:137], v182 offset:32768
    ds_read_b64_tr_b16 v[14:15], v3 offset:53248
    ds_read_b64_tr_b16 v[16:17], v3 offset:53760
    ds_read_b64_tr_b16 v[18:19], v4 offset:53248
    ds_read_b64_tr_b16 v[20:21], v4 offset:53760
    v_mfma_f32_32x32x16_bf16 v[238:253], v[130:133], v[26:29], v[238:253]
    s_waitcnt lgkmcnt(5)
    v_mfma_f32_32x32x16_bf16 v[190:205], v[130:133], v[6:9], v[190:205]
    ds_read_b64_tr_b16 v[22:23], v3 offset:61440
    ds_read_b64_tr_b16 v[24:25], v3 offset:61952
    ds_read_b64_tr_b16 v[26:27], v4 offset:61440
    ds_read_b64_tr_b16 v[28:29], v4 offset:61952
    v_mfma_f32_32x32x16_bf16 v[206:221], v[130:133], v[10:13], v[206:221]
    s_waitcnt lgkmcnt(4)
    v_mfma_f32_32x32x16_bf16 v[222:237], v[134:137], v[14:17], v[222:237]
    ds_read_b128 v[138:141], v186 offset:32768
    ds_read_b64_tr_b16 v[6:7], v3 offset:55296
    ds_read_b64_tr_b16 v[8:9], v3 offset:55808
    ds_read_b64_tr_b16 v[10:11], v4 offset:55296
    ds_read_b64_tr_b16 v[12:13], v4 offset:55808
    v_mfma_f32_32x32x16_bf16 v[238:253], v[134:137], v[18:21], v[238:253]
    s_waitcnt lgkmcnt(5)
    v_mfma_f32_32x32x16_bf16 v[190:205], v[134:137], v[22:25], v[190:205]
    ds_read_b64_tr_b16 v[14:15], v3 offset:63488
    ds_read_b64_tr_b16 v[16:17], v3 offset:64000
    ds_read_b64_tr_b16 v[18:19], v4 offset:63488
    ds_read_b64_tr_b16 v[20:21], v4 offset:64000
    v_mfma_f32_32x32x16_bf16 v[206:221], v[134:137], v[26:29], v[206:221]
    s_waitcnt lgkmcnt(4)
    v_mfma_f32_32x32x16_bf16 v[222:237], v[138:141], v[6:9], v[222:237]
    v_mfma_f32_32x32x16_bf16 v[238:253], v[138:141], v[10:13], v[238:253]
    s_barrier
    v_add_u32 v174, 65536, v174
    v_add_u32 v178, 65536, v178
    v_add_u32 v182, 65536, v182
    v_add_u32 v186, 65536, v186
    ds_read_b128 v[142:145], v174 offset:0
    v_add_u32 v3, 65536, v3
    v_add_u32 v4, 65536, v4
    ds_read_b64_tr_b16 v[22:23], v3 offset:16384
    ds_read_b64_tr_b16 v[24:25], v3 offset:16896
    ds_read_b64_tr_b16 v[26:27], v4 offset:16384
    ds_read_b64_tr_b16 v[28:29], v4 offset:16896
    s_waitcnt lgkmcnt(5)
    v_mfma_f32_32x32x16_bf16 v[190:205], v[138:141], v[14:17], v[190:205]
    ds_read_b64_tr_b16 v[6:7], v3 offset:24576
    ds_read_b64_tr_b16 v[8:9], v3 offset:25088
    ds_read_b64_tr_b16 v[10:11], v4 offset:24576
    ds_read_b64_tr_b16 v[12:13], v4 offset:25088
    v_mfma_f32_32x32x16_bf16 v[206:221], v[138:141], v[18:21], v[206:221]
    s_waitcnt lgkmcnt(4)
    v_mfma_f32_32x32x16_bf16 v[222:237], v[142:145], v[22:25], v[222:237]
    ds_read_b128 v[146:149], v178 offset:0
    ds_read_b64_tr_b16 v[14:15], v3 offset:18432
    ds_read_b64_tr_b16 v[16:17], v3 offset:18944
    ds_read_b64_tr_b16 v[18:19], v4 offset:18432
    ds_read_b64_tr_b16 v[20:21], v4 offset:18944
    v_mfma_f32_32x32x16_bf16 v[238:253], v[142:145], v[26:29], v[238:253]
    s_waitcnt lgkmcnt(5)
    v_mfma_f32_32x32x16_bf16 v[190:205], v[142:145], v[6:9], v[190:205]
    ds_read_b64_tr_b16 v[22:23], v3 offset:26624
    ds_read_b64_tr_b16 v[24:25], v3 offset:27136
    ds_read_b64_tr_b16 v[26:27], v4 offset:26624
    ds_read_b64_tr_b16 v[28:29], v4 offset:27136
    v_mfma_f32_32x32x16_bf16 v[206:221], v[142:145], v[10:13], v[206:221]
    s_waitcnt lgkmcnt(4)
    v_mfma_f32_32x32x16_bf16 v[222:237], v[146:149], v[14:17], v[222:237]
    ds_read_b128 v[150:153], v182 offset:0
    ds_read_b64_tr_b16 v[6:7], v3 offset:20480
    ds_read_b64_tr_b16 v[8:9], v3 offset:20992
    ds_read_b64_tr_b16 v[10:11], v4 offset:20480
    ds_read_b64_tr_b16 v[12:13], v4 offset:20992
    v_mfma_f32_32x32x16_bf16 v[238:253], v[146:149], v[18:21], v[238:253]
    s_waitcnt lgkmcnt(5)
    v_mfma_f32_32x32x16_bf16 v[190:205], v[146:149], v[22:25], v[190:205]
    ds_read_b64_tr_b16 v[14:15], v3 offset:28672
    ds_read_b64_tr_b16 v[16:17], v3 offset:29184
    ds_read_b64_tr_b16 v[18:19], v4 offset:28672
    ds_read_b64_tr_b16 v[20:21], v4 offset:29184
    v_mfma_f32_32x32x16_bf16 v[206:221], v[146:149], v[26:29], v[206:221]
    s_waitcnt lgkmcnt(4)
    v_mfma_f32_32x32x16_bf16 v[222:237], v[150:153], v[6:9], v[222:237]
    ds_read_b128 v[154:157], v186 offset:0
    ds_read_b64_tr_b16 v[22:23], v3 offset:22528
    ds_read_b64_tr_b16 v[24:25], v3 offset:23040
    ds_read_b64_tr_b16 v[26:27], v4 offset:22528
    ds_read_b64_tr_b16 v[28:29], v4 offset:23040
    v_mfma_f32_32x32x16_bf16 v[238:253], v[150:153], v[10:13], v[238:253]
    s_waitcnt lgkmcnt(5)
    v_mfma_f32_32x32x16_bf16 v[190:205], v[150:153], v[14:17], v[190:205]
    ds_read_b64_tr_b16 v[6:7], v3 offset:30720
    ds_read_b64_tr_b16 v[8:9], v3 offset:31232
    ds_read_b64_tr_b16 v[10:11], v4 offset:30720
    ds_read_b64_tr_b16 v[12:13], v4 offset:31232
    v_mfma_f32_32x32x16_bf16 v[206:221], v[150:153], v[18:21], v[206:221]
    s_waitcnt lgkmcnt(4)
    v_mfma_f32_32x32x16_bf16 v[222:237], v[154:157], v[22:25], v[222:237]
    v_mfma_f32_32x32x16_bf16 v[238:253], v[154:157], v[26:29], v[238:253]
    s_barrier
    ds_read_b128 v[158:161], v174 offset:32768
    ds_read_b64_tr_b16 v[14:15], v3 offset:49152
    ds_read_b64_tr_b16 v[16:17], v3 offset:49664
    ds_read_b64_tr_b16 v[18:19], v4 offset:49152
    ds_read_b64_tr_b16 v[20:21], v4 offset:49664
    s_waitcnt lgkmcnt(5)
    v_mfma_f32_32x32x16_bf16 v[190:205], v[154:157], v[6:9], v[190:205]
    ds_read_b64_tr_b16 v[22:23], v3 offset:57344
    ds_read_b64_tr_b16 v[24:25], v3 offset:57856
    ds_read_b64_tr_b16 v[26:27], v4 offset:57344
    ds_read_b64_tr_b16 v[28:29], v4 offset:57856
    v_mfma_f32_32x32x16_bf16 v[206:221], v[154:157], v[10:13], v[206:221]
    s_waitcnt lgkmcnt(4)
    v_mfma_f32_32x32x16_bf16 v[222:237], v[158:161], v[14:17], v[222:237]
    ds_read_b128 v[162:165], v178 offset:32768
    ds_read_b64_tr_b16 v[6:7], v3 offset:51200
    ds_read_b64_tr_b16 v[8:9], v3 offset:51712
    ds_read_b64_tr_b16 v[10:11], v4 offset:51200
    ds_read_b64_tr_b16 v[12:13], v4 offset:51712
    v_mfma_f32_32x32x16_bf16 v[238:253], v[158:161], v[18:21], v[238:253]
    s_waitcnt lgkmcnt(5)
    v_mfma_f32_32x32x16_bf16 v[190:205], v[158:161], v[22:25], v[190:205]
    ds_read_b64_tr_b16 v[14:15], v3 offset:59392
    ds_read_b64_tr_b16 v[16:17], v3 offset:59904
    ds_read_b64_tr_b16 v[18:19], v4 offset:59392
    ds_read_b64_tr_b16 v[20:21], v4 offset:59904
    v_mfma_f32_32x32x16_bf16 v[206:221], v[158:161], v[26:29], v[206:221]
    s_waitcnt lgkmcnt(4)
    v_mfma_f32_32x32x16_bf16 v[222:237], v[162:165], v[6:9], v[222:237]
    ds_read_b128 v[166:169], v182 offset:32768
    ds_read_b64_tr_b16 v[22:23], v3 offset:53248
    ds_read_b64_tr_b16 v[24:25], v3 offset:53760
    ds_read_b64_tr_b16 v[26:27], v4 offset:53248
    ds_read_b64_tr_b16 v[28:29], v4 offset:53760
    v_mfma_f32_32x32x16_bf16 v[238:253], v[162:165], v[10:13], v[238:253]
    s_waitcnt lgkmcnt(5)
    v_mfma_f32_32x32x16_bf16 v[190:205], v[162:165], v[14:17], v[190:205]
    ds_read_b64_tr_b16 v[6:7], v3 offset:61440
    ds_read_b64_tr_b16 v[8:9], v3 offset:61952
    ds_read_b64_tr_b16 v[10:11], v4 offset:61440
    ds_read_b64_tr_b16 v[12:13], v4 offset:61952
    v_mfma_f32_32x32x16_bf16 v[206:221], v[162:165], v[18:21], v[206:221]
    s_waitcnt lgkmcnt(4)
    v_mfma_f32_32x32x16_bf16 v[222:237], v[166:169], v[22:25], v[222:237]
    ds_read_b128 v[170:173], v186 offset:32768
    ds_read_b64_tr_b16 v[14:15], v3 offset:55296
    ds_read_b64_tr_b16 v[16:17], v3 offset:55808
    ds_read_b64_tr_b16 v[18:19], v4 offset:55296
    ds_read_b64_tr_b16 v[20:21], v4 offset:55808
    v_mfma_f32_32x32x16_bf16 v[238:253], v[166:169], v[26:29], v[238:253]
    s_waitcnt lgkmcnt(5)
    v_mfma_f32_32x32x16_bf16 v[190:205], v[166:169], v[6:9], v[190:205]
    ds_read_b64_tr_b16 v[22:23], v3 offset:63488
    ds_read_b64_tr_b16 v[24:25], v3 offset:64000
    ds_read_b64_tr_b16 v[26:27], v4 offset:63488
    ds_read_b64_tr_b16 v[28:29], v4 offset:64000
    v_mfma_f32_32x32x16_bf16 v[206:221], v[166:169], v[10:13], v[206:221]
    s_waitcnt lgkmcnt(4)
    v_mfma_f32_32x32x16_bf16 v[222:237], v[170:173], v[14:17], v[222:237]
    v_mfma_f32_32x32x16_bf16 v[238:253], v[170:173], v[18:21], v[238:253]
    s_barrier
    v_add_u32 v174, 65536, v174
    v_add_u32 v178, 65536, v178
    v_add_u32 v182, 65536, v182
    v_add_u32 v186, 65536, v186
    ds_read_b128 v[174:177], v174 offset:0
    v_add_u32 v3, 65536, v3
    v_add_u32 v4, 65536, v4
    ds_read_b64_tr_b16 v[6:7], v3 offset:16384
    ds_read_b64_tr_b16 v[8:9], v3 offset:16896
    ds_read_b64_tr_b16 v[10:11], v4 offset:16384
    ds_read_b64_tr_b16 v[12:13], v4 offset:16896
    s_waitcnt lgkmcnt(5)
    v_mfma_f32_32x32x16_bf16 v[190:205], v[170:173], v[22:25], v[190:205]
    ds_read_b128 v[178:181], v178 offset:0
    ds_read_b64_tr_b16 v[14:15], v3 offset:18432
    ds_read_b64_tr_b16 v[16:17], v3 offset:18944
    ds_read_b64_tr_b16 v[18:19], v4 offset:18432
    ds_read_b64_tr_b16 v[20:21], v4 offset:18944
    v_mfma_f32_32x32x16_bf16 v[206:221], v[170:173], v[26:29], v[206:221]
    s_cmp_eq_u32 s61, 14
    s_cbranch_scc1 g_cv4
    s_waitcnt lgkmcnt(5)
    v_mfma_f32_32x32x16_bf16 v[222:237], v[174:177], v[6:9], v[222:237]
    ds_read_b128 v[182:185], v182 offset:0
    ds_read_b64_tr_b16 v[22:23], v3 offset:20480
    ds_read_b64_tr_b16 v[24:25], v3 offset:20992
    ds_read_b64_tr_b16 v[26:27], v4 offset:20480
    ds_read_b64_tr_b16 v[28:29], v4 offset:20992
    v_mfma_f32_32x32x16_bf16 v[238:253], v[174:177], v[10:13], v[238:253]
    s_waitcnt lgkmcnt(5)
    v_mfma_f32_32x32x16_bf16 v[222:237], v[178:181], v[14:17], v[222:237]
    ds_read_b128 v[186:189], v186 offset:0
    ds_read_b64_tr_b16 v[6:7], v3 offset:22528
    ds_read_b64_tr_b16 v[8:9], v3 offset:23040
    ds_read_b64_tr_b16 v[10:11], v4 offset:22528
    ds_read_b64_tr_b16 v[12:13], v4 offset:23040
    v_mfma_f32_32x32x16_bf16 v[238:253], v[178:181], v[18:21], v[238:253]
    s_waitcnt lgkmcnt(5)
    v_mfma_f32_32x32x16_bf16 v[222:237], v[182:185], v[22:25], v[222:237]
    ds_read_b64_tr_b16 v[14:15], v3 offset:24576
    ds_read_b64_tr_b16 v[16:17], v3 offset:25088
    ds_read_b64_tr_b16 v[18:19], v4 offset:24576
    ds_read_b64_tr_b16 v[20:21], v4 offset:25088
    v_mfma_f32_32x32x16_bf16 v[238:253], v[182:185], v[26:29], v[238:253]
    s_waitcnt lgkmcnt(4)
    v_mfma_f32_32x32x16_bf16 v[222:237], v[186:189], v[6:9], v[222:237]
    ds_read_b64_tr_b16 v[22:23], v3 offset:26624
    ds_read_b64_tr_b16 v[24:25], v3 offset:27136
    ds_read_b64_tr_b16 v[26:27], v4 offset:26624
    ds_read_b64_tr_b16 v[28:29], v4 offset:27136
    v_mfma_f32_32x32x16_bf16 v[238:253], v[186:189], v[10:13], v[238:253]
    s_waitcnt lgkmcnt(4)
    v_mfma_f32_32x32x16_bf16 v[190:205], v[174:177], v[14:17], v[190:205]
    ds_read_b64_tr_b16 v[6:7], v3 offset:28672
    ds_read_b64_tr_b16 v[8:9], v3 offset:29184
    ds_read_b64_tr_b16 v[10:11], v4 offset:28672
    ds_read_b64_tr_b16 v[12:13], v4 offset:29184
    v_mfma_f32_32x32x16_bf16 v[206:221], v[174:177], v[18:21], v[206:221]
    s_waitcnt lgkmcnt(4)
    v_mfma_f32_32x32x16_bf16 v[190:205], v[178:181], v[22:25], v[190:205]
    ds_read_b64_tr_b16 v[14:15], v3 offset:30720
    ds_read_b64_tr_b16 v[16:17], v3 offset:31232
    ds_read_b64_tr_b16 v[18:19], v4 offset:30720
    ds_read_b64_tr_b16 v[20:21], v4 offset:31232
    v_cvt_pk_bf16_f32 v222, v222, v223
    v_cvt_pk_bf16_f32 v223, v224, v225
    v_cvt_pk_bf16_f32 v224, v226, v227
    v_cvt_pk_bf16_f32 v225, v228, v229
    s_nop 1
    v_mfma_f32_32x32x16_bf16 v[206:221], v[178:181], v[26:29], v[206:221]
    v_add_u32 v226, 0, v0
    v_mul_u32_u24 v227, s95, v226
    v_lshrrev_b32 v227, 16, v227
    v_lshrrev_b32 v226, 2, v226
    v_mad_i32_i24 v228, v227, -5, v226
    v_mul_lo_u32 v227, v227, s93
    v_and_b32_e64 v228, 2, v228
    v_lshl_add_u32 v226, v226, 7, v227
    v_lshlrev_b32 v228, 5, v228
    v_xor_b32 v228, v228, v254
    v_add_u32_e64 v226, v226, v228
    buffer_store_dwordx4 v[222:225], v226, s[88:91], s92 offen sc1
    s_nop 1
    v_cvt_pk_bf16_f32 v230, v230, v231
    v_cvt_pk_bf16_f32 v231, v232, v233
    v_cvt_pk_bf16_f32 v232, v234, v235
    v_cvt_pk_bf16_f32 v233, v236, v237
    buffer_store_dwordx4 v[230:233], v226, s[88:91], s92 offen offset:640 sc1
    s_waitcnt lgkmcnt(4)
    v_mfma_f32_32x32x16_bf16 v[190:205], v[182:185], v[6:9], v[190:205]
    v_cvt_pk_bf16_f32 v238, v238, v239
    v_cvt_pk_bf16_f32 v239, v240, v241
    v_cvt_pk_bf16_f32 v240, v242, v243
    v_cvt_pk_bf16_f32 v241, v244, v245
    s_nop 1
    v_mfma_f32_32x32x16_bf16 v[206:221], v[182:185], v[10:13], v[206:221]
    v_add_u32 v242, 32, v0
    v_mul_u32_u24 v243, s95, v242
    v_lshrrev_b32 v243, 16, v243
    v_lshrrev_b32_e64 v242, 2, v242
    v_mad_i32_i24 v244, v243, -5, v242
    v_mul_lo_u32 v243, v243, s93
    v_and_b32_e64 v244, 2, v244
    v_lshl_add_u32 v242, v242, 7, v243
    v_lshlrev_b32 v244, 5, v244
    v_xor_b32 v244, v244, v254
    v_add_u32_e64 v242, v242, v244
    buffer_store_dwordx4 v[238:241], v242, s[88:91], s92 offen sc1
    s_nop 1
    s_barrier
    v_add_u32 v3, -131072, v3
    v_add_u32 v4, -131072, v4
    ds_read_b64_tr_b16 v[22:23], v3 offset:0
    ds_read_b64_tr_b16 v[24:25], v3 offset:512
    ds_read_b64_tr_b16 v[26:27], v4 offset:0
    ds_read_b64_tr_b16 v[28:29], v4 offset:512
    v_cvt_pk_bf16_f32 v246, v246, v247
    v_cvt_pk_bf16_f32 v247, v248, v249
    v_cvt_pk_bf16_f32 v248, v250, v251
    v_cvt_pk_bf16_f32 v249, v252, v253
    buffer_store_dwordx4 v[246:249], v242, s[88:91], s92 offen offset:640 sc1
    s_waitcnt lgkmcnt(4)
    v_mfma_f32_32x32x16_bf16 v[190:205], v[186:189], v[14:17], v[190:205]
    ds_read_b64_tr_b16 v[6:7], v3 offset:2048
    ds_read_b64_tr_b16 v[8:9], v3 offset:2560
    ds_read_b64_tr_b16 v[10:11], v4 offset:2048
    ds_read_b64_tr_b16 v[12:13], v4 offset:2560
    v_mfma_f32_32x32x16_bf16 v[206:221], v[186:189], v[18:21], v[206:221]
    s_waitcnt lgkmcnt(4)
    v_mfma_f32_32x32x16_bf16 v[222:237], v[22:25], v[30:33], 0
    ds_read_b64_tr_b16 v[14:15], v3 offset:4096
    ds_read_b64_tr_b16 v[16:17], v3 offset:4608
    ds_read_b64_tr_b16 v[18:19], v4 offset:4096
    ds_read_b64_tr_b16 v[20:21], v4 offset:4608
    v_mfma_f32_32x32x16_bf16 v[238:253], v[26:29], v[30:33], 0
    s_waitcnt lgkmcnt(4)
    v_mfma_f32_32x32x16_bf16 v[222:237], v[6:9], v[34:37], v[222:237]
    ds_read_b64_tr_b16 v[22:23], v3 offset:6144
    ds_read_b64_tr_b16 v[24:25], v3 offset:6656
    ds_read_b64_tr_b16 v[26:27], v4 offset:6144
    ds_read_b64_tr_b16 v[28:29], v4 offset:6656
    v_cvt_pk_bf16_f32 v190, v190, v191
    v_cvt_pk_bf16_f32 v191, v192, v193
    v_cvt_pk_bf16_f32 v192, v194, v195
    v_cvt_pk_bf16_f32 v193, v196, v197
    s_nop 1
    v_mfma_f32_32x32x16_bf16 v[238:253], v[10:13], v[34:37], v[238:253]
    v_add_u32 v194, 64, v0
    v_mul_u32_u24 v195, s95, v194
    v_lshrrev_b32 v195, 16, v195
    v_lshrrev_b32 v194, 2, v194
    v_mad_i32_i24 v196, v195, -5, v194
    v_mul_lo_u32 v195, v195, s93
    v_and_b32_e64 v196, 2, v196
    v_lshl_add_u32 v194, v194, 7, v195
    v_lshlrev_b32 v196, 5, v196
    v_xor_b32 v196, v196, v254
    v_add_u32_e64 v194, v194, v196
    buffer_store_dwordx4 v[190:193], v194, s[88:91], s92 offen sc1
    s_waitcnt lgkmcnt(4)
    v_mfma_f32_32x32x16_bf16 v[222:237], v[14:17], v[38:41], v[222:237]
    ds_read_b64_tr_b16 v[6:7], v3 offset:8192
    ds_read_b64_tr_b16 v[8:9], v3 offset:8704
    ds_read_b64_tr_b16 v[10:11], v4 offset:8192
    ds_read_b64_tr_b16 v[12:13], v4 offset:8704
    v_cvt_pk_bf16_f32 v198, v198, v199
    v_cvt_pk_bf16_f32 v199, v200, v201
    v_cvt_pk_bf16_f32 v200, v202, v203
    v_cvt_pk_bf16_f32 v201, v204, v205
    buffer_store_dwordx4 v[198:201], v194, s[88:91], s92 offen offset:640 sc1
    s_nop 1
    v_mfma_f32_32x32x16_bf16 v[238:253], v[18:21], v[38:41], v[238:253]
    v_cvt_pk_bf16_f32 v206, v206, v207
    v_cvt_pk_bf16_f32 v207, v208, v209
    v_cvt_pk_bf16_f32 v208, v210, v211
    v_cvt_pk_bf16_f32 v209, v212, v213
    s_waitcnt lgkmcnt(4)
    v_mfma_f32_32x32x16_bf16 v[222:237], v[22:25], v[42:45], v[222:237]
    ds_read_b64_tr_b16 v[14:15], v3 offset:10240
    ds_read_b64_tr_b16 v[16:17], v3 offset:10752
    ds_read_b64_tr_b16 v[18:19], v4 offset:10240
    ds_read_b64_tr_b16 v[20:21], v4 offset:10752
    v_add_u32 v210, 96, v0
    v_mul_u32_u24 v211, s95, v210
    v_lshrrev_b32 v211, 16, v211
    v_lshrrev_b32 v210, 2, v210
    v_mad_i32_i24 v212, v211, -5, v210
    v_mul_lo_u32 v211, v211, s93
    v_and_b32_e64 v212, 2, v212
    v_lshl_add_u32 v210, v210, 7, v211
    v_lshlrev_b32 v212, 5, v212
    v_xor_b32 v212, v212, v254
    v_add_u32_e64 v210, v210, v212
    buffer_store_dwordx4 v[206:209], v210, s[88:91], s92 offen sc1
    s_nop 1
    v_mfma_f32_32x32x16_bf16 v[238:253], v[26:29], v[42:45], v[238:253]
    v_cvt_pk_bf16_f32 v214, v214, v215
    v_cvt_pk_bf16_f32 v215, v216, v217
    v_cvt_pk_bf16_f32 v216, v218, v219
    v_cvt_pk_bf16_f32 v217, v220, v221
    buffer_store_dwordx4 v[214:217], v210, s[88:91], s92 offen offset:640 sc1
    s_waitcnt lgkmcnt(4)
    v_mfma_f32_32x32x16_bf16 v[222:237], v[6:9], v[46:49], v[222:237]
    ds_read_b64_tr_b16 v[22:23], v3 offset:12288
    ds_read_b64_tr_b16 v[24:25], v3 offset:12800
    ds_read_b64_tr_b16 v[26:27], v4 offset:12288
    ds_read_b64_tr_b16 v[28:29], v4 offset:12800
    v_mfma_f32_32x32x16_bf16 v[238:253], v[10:13], v[46:49], v[238:253]
    s_waitcnt lgkmcnt(4)
    v_mfma_f32_32x32x16_bf16 v[222:237], v[14:17], v[50:53], v[222:237]
    ds_read_b64_tr_b16 v[6:7], v3 offset:14336
    ds_read_b64_tr_b16 v[8:9], v3 offset:14848
    ds_read_b64_tr_b16 v[10:11], v4 offset:14336
    ds_read_b64_tr_b16 v[12:13], v4 offset:14848
    v_mfma_f32_32x32x16_bf16 v[238:253], v[18:21], v[50:53], v[238:253]
    s_waitcnt lgkmcnt(4)
    v_mfma_f32_32x32x16_bf16 v[222:237], v[22:25], v[54:57], v[222:237]
    ds_read_b64_tr_b16 v[14:15], v3 offset:16384
    ds_read_b64_tr_b16 v[16:17], v3 offset:16896
    ds_read_b64_tr_b16 v[18:19], v4 offset:16384
    ds_read_b64_tr_b16 v[20:21], v4 offset:16896
    v_mfma_f32_32x32x16_bf16 v[238:253], v[26:29], v[54:57], v[238:253]
    s_waitcnt lgkmcnt(4)
    v_mfma_f32_32x32x16_bf16 v[222:237], v[6:9], v[58:61], v[222:237]
    ds_read_b64_tr_b16 v[22:23], v3 offset:18432
    ds_read_b64_tr_b16 v[24:25], v3 offset:18944
    ds_read_b64_tr_b16 v[26:27], v4 offset:18432
    ds_read_b64_tr_b16 v[28:29], v4 offset:18944
    v_mfma_f32_32x32x16_bf16 v[238:253], v[10:13], v[58:61], v[238:253]
    s_waitcnt lgkmcnt(4)
    v_mfma_f32_32x32x16_bf16 v[222:237], v[14:17], v[62:65], v[222:237]
    v_mfma_f32_32x32x16_bf16 v[238:253], v[18:21], v[62:65], v[238:253]
    s_barrier
    ds_read_b64_tr_b16 v[6:7], v3 offset:20480
    ds_read_b64_tr_b16 v[8:9], v3 offset:20992
    ds_read_b64_tr_b16 v[10:11], v4 offset:20480
    ds_read_b64_tr_b16 v[12:13], v4 offset:20992
    s_waitcnt lgkmcnt(4)
    v_mfma_f32_32x32x16_bf16 v[222:237], v[22:25], v[66:69], v[222:237]
    ds_read_b64_tr_b16 v[14:15], v3 offset:22528
    ds_read_b64_tr_b16 v[16:17], v3 offset:23040
    ds_read_b64_tr_b16 v[18:19], v4 offset:22528
    ds_read_b64_tr_b16 v[20:21], v4 offset:23040
    v_mfma_f32_32x32x16_bf16 v[238:253], v[26:29], v[66:69], v[238:253]
    s_waitcnt lgkmcnt(4)
    v_mfma_f32_32x32x16_bf16 v[222:237], v[6:9], v[70:73], v[222:237]
    ds_read_b64_tr_b16 v[22:23], v3 offset:24576
    ds_read_b64_tr_b16 v[24:25], v3 offset:25088
    ds_read_b64_tr_b16 v[26:27], v4 offset:24576
    ds_read_b64_tr_b16 v[28:29], v4 offset:25088
    v_mfma_f32_32x32x16_bf16 v[238:253], v[10:13], v[70:73], v[238:253]
    s_waitcnt lgkmcnt(4)
    v_mfma_f32_32x32x16_bf16 v[222:237], v[14:17], v[74:77], v[222:237]
    ds_read_b64_tr_b16 v[6:7], v3 offset:26624
    ds_read_b64_tr_b16 v[8:9], v3 offset:27136
    ds_read_b64_tr_b16 v[10:11], v4 offset:26624
    ds_read_b64_tr_b16 v[12:13], v4 offset:27136
    v_mfma_f32_32x32x16_bf16 v[238:253], v[18:21], v[74:77], v[238:253]
    s_waitcnt lgkmcnt(4)
    v_mfma_f32_32x32x16_bf16 v[222:237], v[22:25], v[78:81], v[222:237]
    ds_read_b64_tr_b16 v[14:15], v3 offset:28672
    ds_read_b64_tr_b16 v[16:17], v3 offset:29184
    ds_read_b64_tr_b16 v[18:19], v4 offset:28672
    ds_read_b64_tr_b16 v[20:21], v4 offset:29184
    v_mfma_f32_32x32x16_bf16 v[238:253], v[26:29], v[78:81], v[238:253]
    s_waitcnt lgkmcnt(4)
    v_mfma_f32_32x32x16_bf16 v[222:237], v[6:9], v[82:85], v[222:237]
    ds_read_b64_tr_b16 v[22:23], v3 offset:30720
    ds_read_b64_tr_b16 v[24:25], v3 offset:31232
    ds_read_b64_tr_b16 v[26:27], v4 offset:30720
    ds_read_b64_tr_b16 v[28:29], v4 offset:31232
    v_mfma_f32_32x32x16_bf16 v[238:253], v[10:13], v[82:85], v[238:253]
    s_waitcnt lgkmcnt(4)
    v_mfma_f32_32x32x16_bf16 v[222:237], v[14:17], v[86:89], v[222:237]
    ds_read_b64_tr_b16 v[6:7], v3 offset:32768
    ds_read_b64_tr_b16 v[8:9], v3 offset:33280
    ds_read_b64_tr_b16 v[10:11], v4 offset:32768
    ds_read_b64_tr_b16 v[12:13], v4 offset:33280
    v_mfma_f32_32x32x16_bf16 v[238:253], v[18:21], v[86:89], v[238:253]
    s_waitcnt lgkmcnt(4)
    v_mfma_f32_32x32x16_bf16 v[222:237], v[22:25], v[90:93], v[222:237]
    ds_read_b64_tr_b16 v[14:15], v3 offset:34816
    ds_read_b64_tr_b16 v[16:17], v3 offset:35328
    ds_read_b64_tr_b16 v[18:19], v4 offset:34816
    ds_read_b64_tr_b16 v[20:21], v4 offset:35328
    v_mfma_f32_32x32x16_bf16 v[238:253], v[26:29], v[90:93], v[238:253]
    s_waitcnt lgkmcnt(4)
    v_mfma_f32_32x32x16_bf16 v[222:237], v[6:9], v[94:97], v[222:237]
    ds_read_b64_tr_b16 v[22:23], v3 offset:36864
    ds_read_b64_tr_b16 v[24:25], v3 offset:37376
    ds_read_b64_tr_b16 v[26:27], v4 offset:36864
    ds_read_b64_tr_b16 v[28:29], v4 offset:37376
    v_mfma_f32_32x32x16_bf16 v[238:253], v[10:13], v[94:97], v[238:253]
    s_waitcnt lgkmcnt(4)
    v_mfma_f32_32x32x16_bf16 v[222:237], v[14:17], v[98:101], v[222:237]
    ds_read_b64_tr_b16 v[6:7], v3 offset:38912
    ds_read_b64_tr_b16 v[8:9], v3 offset:39424
    ds_read_b64_tr_b16 v[10:11], v4 offset:38912
    ds_read_b64_tr_b16 v[12:13], v4 offset:39424
    v_mfma_f32_32x32x16_bf16 v[238:253], v[18:21], v[98:101], v[238:253]
    s_waitcnt lgkmcnt(4)
    v_mfma_f32_32x32x16_bf16 v[222:237], v[22:25], v[102:105], v[222:237]
    v_mfma_f32_32x32x16_bf16 v[238:253], v[26:29], v[102:105], v[238:253]
    s_waitcnt vmcnt(0)
    s_barrier
    v_mov_b32 v254, 1
    buffer_store_dword v254, v255, s[48:51], s98 offen sc1
    ds_read_b64_tr_b16 v[14:15], v3 offset:40960
    ds_read_b64_tr_b16 v[16:17], v3 offset:41472
    ds_read_b64_tr_b16 v[18:19], v4 offset:40960
    ds_read_b64_tr_b16 v[20:21], v4 offset:41472
    s_waitcnt lgkmcnt(4)
    v_mfma_f32_32x32x16_bf16 v[222:237], v[6:9], v[106:109], v[222:237]
    ds_read_b64_tr_b16 v[22:23], v3 offset:43008
    ds_read_b64_tr_b16 v[24:25], v3 offset:43520
    ds_read_b64_tr_b16 v[26:27], v4 offset:43008
    ds_read_b64_tr_b16 v[28:29], v4 offset:43520
    v_mfma_f32_32x32x16_bf16 v[238:253], v[10:13], v[106:109], v[238:253]
    s_waitcnt lgkmcnt(4)
    v_mfma_f32_32x32x16_bf16 v[222:237], v[14:17], v[110:113], v[222:237]
    ds_read_b64_tr_b16 v[6:7], v3 offset:45056
    ds_read_b64_tr_b16 v[8:9], v3 offset:45568
    ds_read_b64_tr_b16 v[10:11], v4 offset:45056
    ds_read_b64_tr_b16 v[12:13], v4 offset:45568
    v_mfma_f32_32x32x16_bf16 v[238:253], v[18:21], v[110:113], v[238:253]
    s_waitcnt lgkmcnt(4)
    v_mfma_f32_32x32x16_bf16 v[222:237], v[22:25], v[114:117], v[222:237]
    ds_read_b64_tr_b16 v[14:15], v3 offset:47104
    ds_read_b64_tr_b16 v[16:17], v3 offset:47616
    ds_read_b64_tr_b16 v[18:19], v4 offset:47104
    ds_read_b64_tr_b16 v[20:21], v4 offset:47616
    v_mfma_f32_32x32x16_bf16 v[238:253], v[26:29], v[114:117], v[238:253]
    s_waitcnt lgkmcnt(4)
    v_mfma_f32_32x32x16_bf16 v[222:237], v[6:9], v[118:121], v[222:237]
    ds_read_b64_tr_b16 v[22:23], v3 offset:49152
    ds_read_b64_tr_b16 v[24:25], v3 offset:49664
    ds_read_b64_tr_b16 v[26:27], v4 offset:49152
    ds_read_b64_tr_b16 v[28:29], v4 offset:49664
    v_mfma_f32_32x32x16_bf16 v[238:253], v[10:13], v[118:121], v[238:253]
    s_waitcnt lgkmcnt(4)
    v_mfma_f32_32x32x16_bf16 v[222:237], v[14:17], v[122:125], v[222:237]
    ds_read_b64_tr_b16 v[6:7], v3 offset:51200
    ds_read_b64_tr_b16 v[8:9], v3 offset:51712
    ds_read_b64_tr_b16 v[10:11], v4 offset:51200
    ds_read_b64_tr_b16 v[12:13], v4 offset:51712
    v_mfma_f32_32x32x16_bf16 v[238:253], v[18:21], v[122:125], v[238:253]
    s_waitcnt lgkmcnt(4)
    v_mfma_f32_32x32x16_bf16 v[222:237], v[22:25], v[126:129], v[222:237]
    ds_read_b64_tr_b16 v[14:15], v3 offset:53248
    ds_read_b64_tr_b16 v[16:17], v3 offset:53760
    ds_read_b64_tr_b16 v[18:19], v4 offset:53248
    ds_read_b64_tr_b16 v[20:21], v4 offset:53760
    v_mfma_f32_32x32x16_bf16 v[238:253], v[26:29], v[126:129], v[238:253]
    s_waitcnt lgkmcnt(4)
    v_mfma_f32_32x32x16_bf16 v[222:237], v[6:9], v[130:133], v[222:237]
    ds_read_b64_tr_b16 v[22:23], v3 offset:55296
    ds_read_b64_tr_b16 v[24:25], v3 offset:55808
    ds_read_b64_tr_b16 v[26:27], v4 offset:55296
    ds_read_b64_tr_b16 v[28:29], v4 offset:55808
    v_mfma_f32_32x32x16_bf16 v[238:253], v[10:13], v[130:133], v[238:253]
    s_waitcnt lgkmcnt(4)
    v_mfma_f32_32x32x16_bf16 v[222:237], v[14:17], v[134:137], v[222:237]
    ds_read_b64_tr_b16 v[6:7], v3 offset:57344
    ds_read_b64_tr_b16 v[8:9], v3 offset:57856
    ds_read_b64_tr_b16 v[10:11], v4 offset:57344
    ds_read_b64_tr_b16 v[12:13], v4 offset:57856
    v_mfma_f32_32x32x16_bf16 v[238:253], v[18:21], v[134:137], v[238:253]
    s_waitcnt lgkmcnt(4)
    v_mfma_f32_32x32x16_bf16 v[222:237], v[22:25], v[138:141], v[222:237]
    ds_read_b64_tr_b16 v[14:15], v3 offset:59392
    ds_read_b64_tr_b16 v[16:17], v3 offset:59904
    ds_read_b64_tr_b16 v[18:19], v4 offset:59392
    ds_read_b64_tr_b16 v[20:21], v4 offset:59904
    v_mfma_f32_32x32x16_bf16 v[238:253], v[26:29], v[138:141], v[238:253]
    s_waitcnt lgkmcnt(4)
    v_mfma_f32_32x32x16_bf16 v[222:237], v[6:9], v[142:145], v[222:237]
    v_mfma_f32_32x32x16_bf16 v[238:253], v[10:13], v[142:145], v[238:253]
    s_barrier
    v_add_u32 v3, 61440, v3
    v_add_u32 v4, 61440, v4
    ds_read_b64_tr_b16 v[22:23], v3 offset:0
    ds_read_b64_tr_b16 v[24:25], v3 offset:512
    ds_read_b64_tr_b16 v[26:27], v4 offset:0
    ds_read_b64_tr_b16 v[28:29], v4 offset:512
    s_waitcnt lgkmcnt(4)
    v_mfma_f32_32x32x16_bf16 v[222:237], v[14:17], v[146:149], v[222:237]
    ds_read_b64_tr_b16 v[6:7], v3 offset:2048
    ds_read_b64_tr_b16 v[8:9], v3 offset:2560
    ds_read_b64_tr_b16 v[10:11], v4 offset:2048
    ds_read_b64_tr_b16 v[12:13], v4 offset:2560
    v_mfma_f32_32x32x16_bf16 v[238:253], v[18:21], v[146:149], v[238:253]
    s_waitcnt lgkmcnt(4)
    v_mfma_f32_32x32x16_bf16 v[222:237], v[22:25], v[150:153], v[222:237]
    ds_read_b64_tr_b16 v[14:15], v3 offset:4096
    ds_read_b64_tr_b16 v[16:17], v3 offset:4608
    ds_read_b64_tr_b16 v[18:19], v4 offset:4096
    ds_read_b64_tr_b16 v[20:21], v4 offset:4608
    v_mfma_f32_32x32x16_bf16 v[238:253], v[26:29], v[150:153], v[238:253]
    s_waitcnt lgkmcnt(4)
    v_mfma_f32_32x32x16_bf16 v[222:237], v[6:9], v[154:157], v[222:237]
    ds_read_b64_tr_b16 v[22:23], v3 offset:6144
    ds_read_b64_tr_b16 v[24:25], v3 offset:6656
    ds_read_b64_tr_b16 v[26:27], v4 offset:6144
    ds_read_b64_tr_b16 v[28:29], v4 offset:6656
    v_mfma_f32_32x32x16_bf16 v[238:253], v[10:13], v[154:157], v[238:253]
    s_waitcnt lgkmcnt(4)
    v_mfma_f32_32x32x16_bf16 v[222:237], v[14:17], v[158:161], v[222:237]
    ds_read_b64_tr_b16 v[6:7], v3 offset:8192
    ds_read_b64_tr_b16 v[8:9], v3 offset:8704
    ds_read_b64_tr_b16 v[10:11], v4 offset:8192
    ds_read_b64_tr_b16 v[12:13], v4 offset:8704
    v_mfma_f32_32x32x16_bf16 v[238:253], v[18:21], v[158:161], v[238:253]
    s_waitcnt lgkmcnt(4)
    v_mfma_f32_32x32x16_bf16 v[222:237], v[22:25], v[162:165], v[222:237]
    ds_read_b64_tr_b16 v[14:15], v3 offset:10240
    ds_read_b64_tr_b16 v[16:17], v3 offset:10752
    ds_read_b64_tr_b16 v[18:19], v4 offset:10240
    ds_read_b64_tr_b16 v[20:21], v4 offset:10752
    v_mfma_f32_32x32x16_bf16 v[238:253], v[26:29], v[162:165], v[238:253]
    s_waitcnt lgkmcnt(4)
    v_mfma_f32_32x32x16_bf16 v[222:237], v[6:9], v[166:169], v[222:237]
    ds_read_b64_tr_b16 v[22:23], v3 offset:12288
    ds_read_b64_tr_b16 v[24:25], v3 offset:12800
    ds_read_b64_tr_b16 v[26:27], v4 offset:12288
    ds_read_b64_tr_b16 v[28:29], v4 offset:12800
    v_mfma_f32_32x32x16_bf16 v[238:253], v[10:13], v[166:169], v[238:253]
    s_waitcnt lgkmcnt(4)
    v_mfma_f32_32x32x16_bf16 v[222:237], v[14:17], v[170:173], v[222:237]
    ds_read_b64_tr_b16 v[6:7], v3 offset:14336
    ds_read_b64_tr_b16 v[8:9], v3 offset:14848
    ds_read_b64_tr_b16 v[10:11], v4 offset:14336
    ds_read_b64_tr_b16 v[12:13], v4 offset:14848
    v_mfma_f32_32x32x16_bf16 v[238:253], v[18:21], v[170:173], v[238:253]
    s_waitcnt lgkmcnt(4)
    v_mfma_f32_32x32x16_bf16 v[222:237], v[22:25], v[174:177], v[222:237]
    ds_read_b64_tr_b16 v[14:15], v3 offset:16384
    ds_read_b64_tr_b16 v[16:17], v3 offset:16896
    ds_read_b64_tr_b16 v[18:19], v4 offset:16384
    ds_read_b64_tr_b16 v[20:21], v4 offset:16896
    v_mfma_f32_32x32x16_bf16 v[238:253], v[26:29], v[174:177], v[238:253]
    s_waitcnt lgkmcnt(4)
    v_mfma_f32_32x32x16_bf16 v[222:237], v[6:9], v[178:181], v[222:237]
    ds_read_b64_tr_b16 v[22:23], v3 offset:18432
    ds_read_b64_tr_b16 v[24:25], v3 offset:18944
    ds_read_b64_tr_b16 v[26:27], v4 offset:18432
    ds_read_b64_tr_b16 v[28:29], v4 offset:18944
    v_mfma_f32_32x32x16_bf16 v[238:253], v[10:13], v[178:181], v[238:253]
    s_waitcnt lgkmcnt(4)
    v_mfma_f32_32x32x16_bf16 v[222:237], v[14:17], v[182:185], v[222:237]
    v_mfma_f32_32x32x16_bf16 v[238:253], v[18:21], v[182:185], v[238:253]
    s_waitcnt lgkmcnt(0)
    s_barrier
    ds_read_b64_tr_b16 v[6:7], v5 offset:0
    ds_read_b64_tr_b16 v[8:9], v5 offset:256
    s_waitcnt lgkmcnt(2)
    v_mfma_f32_32x32x16_bf16 v[222:237], v[22:25], v[186:189], v[222:237]
    ds_read_b64_tr_b16 v[14:15], v5 offset:1024
    ds_read_b64_tr_b16 v[16:17], v5 offset:1280
    v_mfma_f32_32x32x16_bf16 v[238:253], v[26:29], v[186:189], v[238:253]
    s_waitcnt lgkmcnt(2)
    v_mfma_f32_32x32x16_bf16 v[190:205], v[6:9], v[30:33], 0
    ds_read_b64_tr_b16 v[22:23], v5 offset:2048
    ds_read_b64_tr_b16 v[24:25], v5 offset:2304
    s_waitcnt lgkmcnt(2)
    v_mfma_f32_32x32x16_bf16 v[190:205], v[14:17], v[34:37], v[190:205]
    ds_read_b64_tr_b16 v[6:7], v5 offset:3072
    ds_read_b64_tr_b16 v[8:9], v5 offset:3328
    s_waitcnt lgkmcnt(2)
    v_mfma_f32_32x32x16_bf16 v[190:205], v[22:25], v[38:41], v[190:205]
    ds_read_b64_tr_b16 v[14:15], v5 offset:4096
    ds_read_b64_tr_b16 v[16:17], v5 offset:4352
    v_cvt_pk_bf16_f32 v222, v222, v223
    v_cvt_pk_bf16_f32 v223, v224, v225
    v_cvt_pk_bf16_f32 v224, v226, v227
    v_cvt_pk_bf16_f32 v225, v228, v229
    s_waitcnt lgkmcnt(2)
    v_mfma_f32_32x32x16_bf16 v[190:205], v[6:9], v[42:45], v[190:205]
    ds_read_b64_tr_b16 v[22:23], v5 offset:5120
    ds_read_b64_tr_b16 v[24:25], v5 offset:5376
    v_pk_max_i16 v222, v222, 0
    v_pk_max_i16 v223, v223, 0
    v_pk_max_i16 v224, v224, 0
    v_pk_max_i16 v225, v225, 0
    s_waitcnt lgkmcnt(2)
    v_mfma_f32_32x32x16_bf16 v[190:205], v[14:17], v[46:49], v[190:205]
    ds_read_b64_tr_b16 v[6:7], v5 offset:6144
    ds_read_b64_tr_b16 v[8:9], v5 offset:6400
    v_cvt_pk_bf16_f32 v230, v230, v231
    v_cvt_pk_bf16_f32 v231, v232, v233
    v_cvt_pk_bf16_f32 v232, v234, v235
    v_cvt_pk_bf16_f32 v233, v236, v237
    s_waitcnt lgkmcnt(2)
    v_mfma_f32_32x32x16_bf16 v[190:205], v[22:25], v[50:53], v[190:205]
    ds_read_b64_tr_b16 v[14:15], v5 offset:7168
    ds_read_b64_tr_b16 v[16:17], v5 offset:7424
    v_pk_max_i16 v230, v230, 0
    v_pk_max_i16 v231, v231, 0
    v_pk_max_i16 v232, v232, 0
    v_pk_max_i16 v233, v233, 0
    s_waitcnt lgkmcnt(2)
    v_mfma_f32_32x32x16_bf16 v[190:205], v[6:9], v[54:57], v[190:205]
    ds_read_b64_tr_b16 v[22:23], v5 offset:8192
    ds_read_b64_tr_b16 v[24:25], v5 offset:8448
    v_cvt_pk_bf16_f32 v238, v238, v239
    v_cvt_pk_bf16_f32 v239, v240, v241
    v_cvt_pk_bf16_f32 v240, v242, v243
    v_cvt_pk_bf16_f32 v241, v244, v245
    s_waitcnt lgkmcnt(2)
    v_mfma_f32_32x32x16_bf16 v[190:205], v[14:17], v[58:61], v[190:205]
    ds_read_b64_tr_b16 v[6:7], v5 offset:9216
    ds_read_b64_tr_b16 v[8:9], v5 offset:9472
    v_pk_max_i16 v238, v238, 0
    v_pk_max_i16 v239, v239, 0
    v_pk_max_i16 v240, v240, 0
    v_pk_max_i16 v241, v241, 0
    s_waitcnt lgkmcnt(2)
    v_mfma_f32_32x32x16_bf16 v[190:205], v[22:25], v[62:65], v[190:205]
    ds_read_b64_tr_b16 v[14:15], v5 offset:10240
    ds_read_b64_tr_b16 v[16:17], v5 offset:10496
    v_cvt_pk_bf16_f32 v246, v246, v247
    v_cvt_pk_bf16_f32 v247, v248, v249
    v_cvt_pk_bf16_f32 v248, v250, v251
    v_cvt_pk_bf16_f32 v249, v252, v253
    s_waitcnt lgkmcnt(2)
    v_mfma_f32_32x32x16_bf16 v[190:205], v[6:9], v[66:69], v[190:205]
    ds_read_b64_tr_b16 v[22:23], v5 offset:11264
    ds_read_b64_tr_b16 v[24:25], v5 offset:11520
    v_pk_max_i16 v246, v246, 0
    v_pk_max_i16 v247, v247, 0
    v_pk_max_i16 v248, v248, 0
    v_pk_max_i16 v249, v249, 0
    s_waitcnt lgkmcnt(2)
    v_mfma_f32_32x32x16_bf16 v[190:205], v[14:17], v[70:73], v[190:205]
    ds_read_b64_tr_b16 v[6:7], v5 offset:12288
    ds_read_b64_tr_b16 v[8:9], v5 offset:12544
    s_waitcnt lgkmcnt(2)
    v_mfma_f32_32x32x16_bf16 v[190:205], v[22:25], v[74:77], v[190:205]
    ds_read_b64_tr_b16 v[14:15], v5 offset:13312
    ds_read_b64_tr_b16 v[16:17], v5 offset:13568
    s_waitcnt lgkmcnt(2)
    v_mfma_f32_32x32x16_bf16 v[190:205], v[6:9], v[78:81], v[190:205]
    ds_read_b64_tr_b16 v[22:23], v5 offset:14336
    ds_read_b64_tr_b16 v[24:25], v5 offset:14592
    s_waitcnt lgkmcnt(2)
    v_mfma_f32_32x32x16_bf16 v[190:205], v[14:17], v[82:85], v[190:205]
    ds_read_b64_tr_b16 v[6:7], v5 offset:15360
    ds_read_b64_tr_b16 v[8:9], v5 offset:15616
    s_waitcnt lgkmcnt(2)
    v_mfma_f32_32x32x16_bf16 v[190:205], v[22:25], v[86:89], v[190:205]
    ds_read_b64_tr_b16 v[14:15], v5 offset:16384
    ds_read_b64_tr_b16 v[16:17], v5 offset:16640
    s_waitcnt lgkmcnt(2)
    v_mfma_f32_32x32x16_bf16 v[190:205], v[6:9], v[90:93], v[190:205]
    ds_read_b64_tr_b16 v[22:23], v5 offset:17408
    ds_read_b64_tr_b16 v[24:25], v5 offset:17664
    s_waitcnt lgkmcnt(2)
    v_mfma_f32_32x32x16_bf16 v[190:205], v[14:17], v[94:97], v[190:205]
    ds_read_b64_tr_b16 v[6:7], v5 offset:18432
    ds_read_b64_tr_b16 v[8:9], v5 offset:18688
    s_waitcnt lgkmcnt(2)
    v_mfma_f32_32x32x16_bf16 v[190:205], v[22:25], v[98:101], v[190:205]
    ds_read_b64_tr_b16 v[14:15], v5 offset:19456
    ds_read_b64_tr_b16 v[16:17], v5 offset:19712
    s_waitcnt lgkmcnt(2)
    v_mfma_f32_32x32x16_bf16 v[190:205], v[6:9], v[102:105], v[190:205]
    ds_read_b64_tr_b16 v[22:23], v5 offset:20480
    ds_read_b64_tr_b16 v[24:25], v5 offset:20736
    s_waitcnt lgkmcnt(2)
    v_mfma_f32_32x32x16_bf16 v[190:205], v[14:17], v[106:109], v[190:205]
    ds_read_b64_tr_b16 v[6:7], v5 offset:21504
    ds_read_b64_tr_b16 v[8:9], v5 offset:21760
    s_waitcnt lgkmcnt(2)
    v_mfma_f32_32x32x16_bf16 v[190:205], v[22:25], v[110:113], v[190:205]
    ds_read_b64_tr_b16 v[14:15], v5 offset:22528
    ds_read_b64_tr_b16 v[16:17], v5 offset:22784
    s_waitcnt lgkmcnt(2)
    v_mfma_f32_32x32x16_bf16 v[190:205], v[6:9], v[114:117], v[190:205]
    ds_read_b64_tr_b16 v[22:23], v5 offset:23552
    ds_read_b64_tr_b16 v[24:25], v5 offset:23808
    s_waitcnt lgkmcnt(2)
    v_mfma_f32_32x32x16_bf16 v[190:205], v[14:17], v[118:121], v[190:205]
    ds_read_b64_tr_b16 v[6:7], v5 offset:24576
    ds_read_b64_tr_b16 v[8:9], v5 offset:24832
    s_waitcnt lgkmcnt(2)
    v_mfma_f32_32x32x16_bf16 v[190:205], v[22:25], v[122:125], v[190:205]
    ds_read_b64_tr_b16 v[14:15], v5 offset:25600
    ds_read_b64_tr_b16 v[16:17], v5 offset:25856
    s_waitcnt lgkmcnt(2)
    v_mfma_f32_32x32x16_bf16 v[190:205], v[6:9], v[126:129], v[190:205]
    ds_read_b64_tr_b16 v[22:23], v5 offset:26624
    ds_read_b64_tr_b16 v[24:25], v5 offset:26880
    s_waitcnt lgkmcnt(2)
    v_mfma_f32_32x32x16_bf16 v[190:205], v[14:17], v[130:133], v[190:205]
    ds_read_b64_tr_b16 v[6:7], v5 offset:27648
    ds_read_b64_tr_b16 v[8:9], v5 offset:27904
    s_waitcnt lgkmcnt(2)
    v_mfma_f32_32x32x16_bf16 v[190:205], v[22:25], v[134:137], v[190:205]
    ds_read_b64_tr_b16 v[14:15], v5 offset:28672
    ds_read_b64_tr_b16 v[16:17], v5 offset:28928
    s_waitcnt lgkmcnt(2)
    v_mfma_f32_32x32x16_bf16 v[190:205], v[6:9], v[138:141], v[190:205]
    ds_read_b64_tr_b16 v[22:23], v5 offset:29696
    ds_read_b64_tr_b16 v[24:25], v5 offset:29952
    s_waitcnt lgkmcnt(2)
    v_mfma_f32_32x32x16_bf16 v[190:205], v[14:17], v[142:145], v[190:205]
    ds_read_b64_tr_b16 v[6:7], v5 offset:30720
    ds_read_b64_tr_b16 v[8:9], v5 offset:30976
    s_waitcnt lgkmcnt(2)
    v_mfma_f32_32x32x16_bf16 v[190:205], v[22:25], v[146:149], v[190:205]
    ds_read_b64_tr_b16 v[14:15], v5 offset:31744
    ds_read_b64_tr_b16 v[16:17], v5 offset:32000
    s_waitcnt lgkmcnt(2)
    v_mfma_f32_32x32x16_bf16 v[190:205], v[6:9], v[150:153], v[190:205]
    ds_read_b64_tr_b16 v[22:23], v5 offset:32768
    ds_read_b64_tr_b16 v[24:25], v5 offset:33024
    s_waitcnt lgkmcnt(2)
    v_mfma_f32_32x32x16_bf16 v[190:205], v[14:17], v[154:157], v[190:205]
    ds_read_b64_tr_b16 v[6:7], v5 offset:33792
    ds_read_b64_tr_b16 v[8:9], v5 offset:34048
    s_waitcnt lgkmcnt(2)
    v_mfma_f32_32x32x16_bf16 v[190:205], v[22:25], v[158:161], v[190:205]
    ds_read_b64_tr_b16 v[14:15], v5 offset:34816
    ds_read_b64_tr_b16 v[16:17], v5 offset:35072
    s_waitcnt lgkmcnt(2)
    v_mfma_f32_32x32x16_bf16 v[190:205], v[6:9], v[162:165], v[190:205]
    ds_read_b64_tr_b16 v[22:23], v5 offset:35840
    ds_read_b64_tr_b16 v[24:25], v5 offset:36096
    s_waitcnt lgkmcnt(2)
    v_mfma_f32_32x32x16_bf16 v[190:205], v[14:17], v[166:169], v[190:205]
    ds_read_b64_tr_b16 v[6:7], v5 offset:36864
    ds_read_b64_tr_b16 v[8:9], v5 offset:37120
    s_waitcnt lgkmcnt(2)
    v_mfma_f32_32x32x16_bf16 v[190:205], v[22:25], v[170:173], v[190:205]
    ds_read_b64_tr_b16 v[14:15], v5 offset:37888
    ds_read_b64_tr_b16 v[16:17], v5 offset:38144
    s_waitcnt lgkmcnt(2)
    v_mfma_f32_32x32x16_bf16 v[190:205], v[6:9], v[174:177], v[190:205]
    ds_read_b64_tr_b16 v[22:23], v5 offset:38912
    ds_read_b64_tr_b16 v[24:25], v5 offset:39168
    s_waitcnt lgkmcnt(2)
    v_mfma_f32_32x32x16_bf16 v[190:205], v[14:17], v[178:181], v[190:205]
    ds_read_b64_tr_b16 v[6:7], v5 offset:39936
    ds_read_b64_tr_b16 v[8:9], v5 offset:40192
    s_waitcnt lgkmcnt(2)
    v_mfma_f32_32x32x16_bf16 v[190:205], v[22:25], v[182:185], v[190:205]
    s_waitcnt lgkmcnt(0)
    v_mfma_f32_32x32x16_bf16 v[190:205], v[6:9], v[186:189], v[190:205]
    s_nop 3
    s_movk_i32 s44, 0x400
    v_lshlrev_b32 v2, 4, v1
    v_mov_b32 v5, v2
    v_and_b32 v8, 31, v1
    v_lshrrev_b32 v9, 5, v1
    v_lshlrev_b32_e64 v11, 3, v8
    v_mul_u32_u24 v3, 2560, v9
    v_add3_u32 v3, v3, v11, s44
    v_mov_b32 v20, 0
    v_mov_b32 v21, 0
    v_mov_b32 v22, 0
    v_mov_b32 v23, 0
    v_mov_b32 v6, 0
    v_mov_b32 v7, 0
    v_mov_b32 v254, 0
    v_mov_b32 v255, 0
    v_lshrrev_b32 v4, 3, v8
    v_xor_b32 v4, v4, v9
    v_and_b32 v4, 1, v4
    v_lshlrev_b32 v4, 6, v4
    v_lshrrev_b32_e64 v10, 2, v8
    v_lshl_add_u32 v4, v10, 7, v4
    v_and_b32_e64 v10, 3, v8
    v_lshl_add_u32 v4, v10, 4, v4
    v_add_u32 v4, 1280, v4
    v_cmp_eq_u32_e64 vcc, 20, v8
    v_cmp_eq_u32 s[58:59], 24, v8
    s_mul_i32 s42, s74, 2560
    s_add_u32 s42, s42, 71680
    s_or_b64 vcc, vcc, s[58:59]
    v_mov_b32 v10, 0x3f803f80
    s_nop 1
    v_cndmask_b32 v10, 0, v10, vcc
    v_mov_b32 v30, v10
    v_mov_b32 v31, v10
    v_mov_b32 v32, v10
    v_mov_b32 v33, v10
    v_mov_b32 v34, v10
    v_mov_b32 v35, v10
    v_mov_b32 v36, v10
    v_mov_b32 v37, v10
    v_add_u32 v10, s42, v2
    v_add_u32_e64 v11, s42, v11
    s_nop 1
    s_add_u32 s101, s94, s101
    v_cvt_pk_bf16_f32 v190, v190, v191
    v_cvt_pk_bf16_f32 v191, v192, v193
    v_cvt_pk_bf16_f32 v192, v194, v195
    v_cvt_pk_bf16_f32 v193, v196, v197
    s_nop 1
    v_pk_max_i16 v190, v190, 0
    v_pk_max_i16 v191, v191, 0
    v_pk_max_i16 v192, v192, 0
    v_pk_max_i16 v193, v193, 0
    s_nop 1
    v_cvt_pk_bf16_f32 v198, v198, v199
    v_cvt_pk_bf16_f32 v199, v200, v201
    v_cvt_pk_bf16_f32 v200, v202, v203
    v_cvt_pk_bf16_f32 v201, v204, v205
    s_nop 1
    v_pk_max_i16 v198, v198, 0
    v_pk_max_i16 v199, v199, 0
    v_pk_max_i16 v200, v200, 0
    v_pk_max_i16 v201, v201, 0
    s_branch g_att1
g_cv4:
    s_waitcnt lgkmcnt(5)
    v_mfma_f32_32x32x16_bf16 v[222:237], v[174:177], v[6:9], v[222:237]
    ds_read_b128 v[182:185], v182 offset:0
    ds_read_b64_tr_b16 v[22:23], v3 offset:20480
    ds_read_b64_tr_b16 v[24:25], v3 offset:20992
    ds_read_b64_tr_b16 v[26:27], v4 offset:20480
    ds_read_b64_tr_b16 v[28:29], v4 offset:20992
    v_mfma_f32_32x32x16_bf16 v[238:253], v[174:177], v[10:13], v[238:253]
    s_waitcnt lgkmcnt(5)
    v_mfma_f32_32x32x16_bf16 v[222:237], v[178:181], v[14:17], v[222:237]
    ds_read_b128 v[186:189], v186 offset:0
    ds_read_b64_tr_b16 v[6:7], v3 offset:22528
    ds_read_b64_tr_b16 v[8:9], v3 offset:23040
    ds_read_b64_tr_b16 v[10:11], v4 offset:22528
    ds_read_b64_tr_b16 v[12:13], v4 offset:23040
    v_mfma_f32_32x32x16_bf16 v[238:253], v[178:181], v[18:21], v[238:253]
    s_waitcnt lgkmcnt(5)
    v_mfma_f32_32x32x16_bf16 v[222:237], v[182:185], v[22:25], v[222:237]
    ds_read_b64_tr_b16 v[14:15], v3 offset:24576
    ds_read_b64_tr_b16 v[16:17], v3 offset:25088
    ds_read_b64_tr_b16 v[18:19], v4 offset:24576
    ds_read_b64_tr_b16 v[20:21], v4 offset:25088
    v_mfma_f32_32x32x16_bf16 v[238:253], v[182:185], v[26:29], v[238:253]
    s_waitcnt lgkmcnt(4)
    v_mfma_f32_32x32x16_bf16 v[222:237], v[186:189], v[6:9], v[222:237]
    ds_read_b64_tr_b16 v[22:23], v3 offset:26624
    ds_read_b64_tr_b16 v[24:25], v3 offset:27136
    ds_read_b64_tr_b16 v[26:27], v4 offset:26624
    ds_read_b64_tr_b16 v[28:29], v4 offset:27136
    v_mfma_f32_32x32x16_bf16 v[238:253], v[186:189], v[10:13], v[238:253]
    s_waitcnt lgkmcnt(4)
    v_mfma_f32_32x32x16_bf16 v[190:205], v[174:177], v[14:17], v[190:205]
    ds_read_b64_tr_b16 v[6:7], v3 offset:28672
    ds_read_b64_tr_b16 v[8:9], v3 offset:29184
    ds_read_b64_tr_b16 v[10:11], v4 offset:28672
    ds_read_b64_tr_b16 v[12:13], v4 offset:29184
    v_mfma_f32_32x32x16_bf16 v[206:221], v[174:177], v[18:21], v[206:221]
    s_waitcnt lgkmcnt(4)
    v_mfma_f32_32x32x16_bf16 v[190:205], v[178:181], v[22:25], v[190:205]
    ds_read_b64_tr_b16 v[14:15], v3 offset:30720
    ds_read_b64_tr_b16 v[16:17], v3 offset:31232
    ds_read_b64_tr_b16 v[18:19], v4 offset:30720
    ds_read_b64_tr_b16 v[20:21], v4 offset:31232
    v_cvt_pk_bf16_f32 v222, v222, v223
    v_cvt_pk_bf16_f32 v223, v224, v225
    v_cvt_pk_bf16_f32 v224, v226, v227
    v_cvt_pk_bf16_f32 v225, v228, v229
    s_nop 1
    v_mfma_f32_32x32x16_bf16 v[206:221], v[178:181], v[26:29], v[206:221]
    v_add_u32 v226, 0, v0
    v_mul_u32_u24 v227, s95, v226
    v_lshrrev_b32 v227, 16, v227
    v_lshrrev_b32_e64 v226, 2, v226
    v_mad_i32_i24 v228, v227, -5, v226
    v_mul_lo_u32 v227, v227, s93
    v_and_b32_e64 v228, 2, v228
    v_lshl_add_u32 v226, v226, 7, v227
    v_lshlrev_b32 v228, 5, v228
    v_xor_b32 v228, v228, v254
    v_add_u32_e64 v226, v226, v228
    buffer_store_dwordx4 v[222:225], v226, s[88:91], s92 offen sc1
    s_nop 1
    v_cvt_pk_bf16_f32 v230, v230, v231
    v_cvt_pk_bf16_f32 v231, v232, v233
    v_cvt_pk_bf16_f32 v232, v234, v235
    v_cvt_pk_bf16_f32 v233, v236, v237
    buffer_store_dwordx4 v[230:233], v226, s[88:91], s92 offen offset:640 sc1
    s_waitcnt lgkmcnt(4)
    v_mfma_f32_32x32x16_bf16 v[190:205], v[182:185], v[6:9], v[190:205]
    v_cvt_pk_bf16_f32 v238, v238, v239
    v_cvt_pk_bf16_f32 v239, v240, v241
    v_cvt_pk_bf16_f32 v240, v242, v243
    v_cvt_pk_bf16_f32 v241, v244, v245
    s_nop 1
    v_mfma_f32_32x32x16_bf16 v[206:221], v[182:185], v[10:13], v[206:221]
    v_add_u32 v242, 32, v0
    v_mul_u32_u24 v243, s95, v242
    v_lshrrev_b32 v243, 16, v243
    v_lshrrev_b32_e64 v242, 2, v242
    v_mad_i32_i24 v244, v243, -5, v242
    v_mul_lo_u32 v243, v243, s93
    v_and_b32_e64 v244, 2, v244
    v_lshl_add_u32 v242, v242, 7, v243
    v_lshlrev_b32 v244, 5, v244
    v_xor_b32 v244, v244, v254
    v_add_u32_e64 v242, v242, v244
    buffer_store_dwordx4 v[238:241], v242, s[88:91], s92 offen sc1
    s_nop 1
    s_barrier
    v_add_u32 v3, -131072, v3
    v_add_u32 v4, -131072, v4
    ds_read_b64_tr_b16 v[22:23], v3 offset:0
    ds_read_b64_tr_b16 v[24:25], v3 offset:512
    ds_read_b64_tr_b16 v[26:27], v4 offset:0
    ds_read_b64_tr_b16 v[28:29], v4 offset:512
    v_cvt_pk_bf16_f32 v246, v246, v247
    v_cvt_pk_bf16_f32 v247, v248, v249
    v_cvt_pk_bf16_f32 v248, v250, v251
    v_cvt_pk_bf16_f32 v249, v252, v253
    buffer_store_dwordx4 v[246:249], v242, s[88:91], s92 offen offset:640 sc1
    s_waitcnt lgkmcnt(4)
    v_mfma_f32_32x32x16_bf16 v[190:205], v[186:189], v[14:17], v[190:205]
    ds_read_b64_tr_b16 v[6:7], v3 offset:2048
    ds_read_b64_tr_b16 v[8:9], v3 offset:2560
    ds_read_b64_tr_b16 v[10:11], v4 offset:2048
    ds_read_b64_tr_b16 v[12:13], v4 offset:2560
    v_mfma_f32_32x32x16_bf16 v[206:221], v[186:189], v[18:21], v[206:221]
    s_waitcnt lgkmcnt(4)
    v_mfma_f32_32x32x16_bf16 v[222:237], v[22:25], v[30:33], 0
    ds_read_b64_tr_b16 v[14:15], v3 offset:4096
    ds_read_b64_tr_b16 v[16:17], v3 offset:4608
    ds_read_b64_tr_b16 v[18:19], v4 offset:4096
    ds_read_b64_tr_b16 v[20:21], v4 offset:4608
    v_mfma_f32_32x32x16_bf16 v[238:253], v[26:29], v[30:33], 0
    s_waitcnt lgkmcnt(4)
    v_mfma_f32_32x32x16_bf16 v[222:237], v[6:9], v[34:37], v[222:237]
    ds_read_b64_tr_b16 v[22:23], v3 offset:6144
    ds_read_b64_tr_b16 v[24:25], v3 offset:6656
    ds_read_b64_tr_b16 v[26:27], v4 offset:6144
    ds_read_b64_tr_b16 v[28:29], v4 offset:6656
    v_cvt_pk_bf16_f32 v190, v190, v191
    v_cvt_pk_bf16_f32 v191, v192, v193
    v_cvt_pk_bf16_f32 v192, v194, v195
    v_cvt_pk_bf16_f32 v193, v196, v197
    s_nop 1
    v_mfma_f32_32x32x16_bf16 v[238:253], v[10:13], v[34:37], v[238:253]
    v_add_u32 v194, 64, v0
    v_mul_u32_u24 v195, s95, v194
    v_lshrrev_b32 v195, 16, v195
    v_lshrrev_b32 v194, 2, v194
    v_mad_i32_i24 v196, v195, -5, v194
    v_mul_lo_u32 v195, v195, s93
    v_and_b32_e64 v196, 2, v196
    v_lshl_add_u32 v194, v194, 7, v195
    v_lshlrev_b32 v196, 5, v196
    v_xor_b32 v196, v196, v254
    v_add_u32_e64 v194, v194, v196
    buffer_store_dwordx4 v[190:193], v194, s[88:91], s92 offen sc1
    s_waitcnt lgkmcnt(4)
    v_mfma_f32_32x32x16_bf16 v[222:237], v[14:17], v[38:41], v[222:237]
    ds_read_b64_tr_b16 v[6:7], v3 offset:8192
    ds_read_b64_tr_b16 v[8:9], v3 offset:8704
    ds_read_b64_tr_b16 v[10:11], v4 offset:8192
    ds_read_b64_tr_b16 v[12:13], v4 offset:8704
    v_cvt_pk_bf16_f32 v198, v198, v199
    v_cvt_pk_bf16_f32 v199, v200, v201
    v_cvt_pk_bf16_f32 v200, v202, v203
    v_cvt_pk_bf16_f32 v201, v204, v205
    buffer_store_dwordx4 v[198:201], v194, s[88:91], s92 offen offset:640 sc1
    s_nop 1
    v_mfma_f32_32x32x16_bf16 v[238:253], v[18:21], v[38:41], v[238:253]
    v_cvt_pk_bf16_f32 v206, v206, v207
    v_cvt_pk_bf16_f32 v207, v208, v209
    v_cvt_pk_bf16_f32 v208, v210, v211
    v_cvt_pk_bf16_f32 v209, v212, v213
    s_waitcnt lgkmcnt(4)
    v_mfma_f32_32x32x16_bf16 v[222:237], v[22:25], v[42:45], v[222:237]
    ds_read_b64_tr_b16 v[14:15], v3 offset:10240
    ds_read_b64_tr_b16 v[16:17], v3 offset:10752
    ds_read_b64_tr_b16 v[18:19], v4 offset:10240
    ds_read_b64_tr_b16 v[20:21], v4 offset:10752
    v_add_u32 v210, 96, v0
    v_mul_u32_u24 v211, s95, v210
    v_lshrrev_b32 v211, 16, v211
    v_lshrrev_b32 v210, 2, v210
    v_mad_i32_i24 v212, v211, -5, v210
    v_mul_lo_u32 v211, v211, s93
    v_and_b32_e64 v212, 2, v212
    v_lshl_add_u32 v210, v210, 7, v211
    v_lshlrev_b32 v212, 5, v212
    v_xor_b32 v212, v212, v254
    v_add_u32_e64 v210, v210, v212
    buffer_store_dwordx4 v[206:209], v210, s[88:91], s92 offen sc1
    s_nop 1
    v_mfma_f32_32x32x16_bf16 v[238:253], v[26:29], v[42:45], v[238:253]
    v_cvt_pk_bf16_f32 v214, v214, v215
    v_cvt_pk_bf16_f32 v215, v216, v217
    v_cvt_pk_bf16_f32 v216, v218, v219
    v_cvt_pk_bf16_f32 v217, v220, v221
    buffer_store_dwordx4 v[214:217], v210, s[88:91], s92 offen offset:640 sc1
    s_waitcnt lgkmcnt(4)
    v_mfma_f32_32x32x16_bf16 v[222:237], v[6:9], v[46:49], v[222:237]
    ds_read_b64_tr_b16 v[22:23], v3 offset:12288
    ds_read_b64_tr_b16 v[24:25], v3 offset:12800
    ds_read_b64_tr_b16 v[26:27], v4 offset:12288
    ds_read_b64_tr_b16 v[28:29], v4 offset:12800
    v_mfma_f32_32x32x16_bf16 v[238:253], v[10:13], v[46:49], v[238:253]
    s_waitcnt lgkmcnt(4)
    v_mfma_f32_32x32x16_bf16 v[222:237], v[14:17], v[50:53], v[222:237]
    ds_read_b64_tr_b16 v[6:7], v3 offset:14336
    ds_read_b64_tr_b16 v[8:9], v3 offset:14848
    ds_read_b64_tr_b16 v[10:11], v4 offset:14336
    ds_read_b64_tr_b16 v[12:13], v4 offset:14848
    v_mfma_f32_32x32x16_bf16 v[238:253], v[18:21], v[50:53], v[238:253]
    s_waitcnt lgkmcnt(4)
    v_mfma_f32_32x32x16_bf16 v[222:237], v[22:25], v[54:57], v[222:237]
    ds_read_b64_tr_b16 v[14:15], v3 offset:16384
    ds_read_b64_tr_b16 v[16:17], v3 offset:16896
    ds_read_b64_tr_b16 v[18:19], v4 offset:16384
    ds_read_b64_tr_b16 v[20:21], v4 offset:16896
    v_mfma_f32_32x32x16_bf16 v[238:253], v[26:29], v[54:57], v[238:253]
    s_waitcnt lgkmcnt(4)
    v_mfma_f32_32x32x16_bf16 v[222:237], v[6:9], v[58:61], v[222:237]
    ds_read_b64_tr_b16 v[22:23], v3 offset:18432
    ds_read_b64_tr_b16 v[24:25], v3 offset:18944
    ds_read_b64_tr_b16 v[26:27], v4 offset:18432
    ds_read_b64_tr_b16 v[28:29], v4 offset:18944
    v_mfma_f32_32x32x16_bf16 v[238:253], v[10:13], v[58:61], v[238:253]
    s_waitcnt lgkmcnt(4)
    v_mfma_f32_32x32x16_bf16 v[222:237], v[14:17], v[62:65], v[222:237]
    v_mfma_f32_32x32x16_bf16 v[238:253], v[18:21], v[62:65], v[238:253]
    s_barrier
    ds_read_b64_tr_b16 v[6:7], v3 offset:20480
    ds_read_b64_tr_b16 v[8:9], v3 offset:20992
    ds_read_b64_tr_b16 v[10:11], v4 offset:20480
    ds_read_b64_tr_b16 v[12:13], v4 offset:20992
    s_waitcnt lgkmcnt(4)
    v_mfma_f32_32x32x16_bf16 v[222:237], v[22:25], v[66:69], v[222:237]
    ds_read_b64_tr_b16 v[14:15], v3 offset:22528
    ds_read_b64_tr_b16 v[16:17], v3 offset:23040
    ds_read_b64_tr_b16 v[18:19], v4 offset:22528
    ds_read_b64_tr_b16 v[20:21], v4 offset:23040
    v_mfma_f32_32x32x16_bf16 v[238:253], v[26:29], v[66:69], v[238:253]
    s_waitcnt lgkmcnt(4)
    v_mfma_f32_32x32x16_bf16 v[222:237], v[6:9], v[70:73], v[222:237]
    ds_read_b64_tr_b16 v[22:23], v3 offset:24576
    ds_read_b64_tr_b16 v[24:25], v3 offset:25088
    ds_read_b64_tr_b16 v[26:27], v4 offset:24576
    ds_read_b64_tr_b16 v[28:29], v4 offset:25088
    v_mfma_f32_32x32x16_bf16 v[238:253], v[10:13], v[70:73], v[238:253]
    s_waitcnt lgkmcnt(4)
    v_mfma_f32_32x32x16_bf16 v[222:237], v[14:17], v[74:77], v[222:237]
    ds_read_b64_tr_b16 v[6:7], v3 offset:26624
    ds_read_b64_tr_b16 v[8:9], v3 offset:27136
    ds_read_b64_tr_b16 v[10:11], v4 offset:26624
    ds_read_b64_tr_b16 v[12:13], v4 offset:27136
    v_mfma_f32_32x32x16_bf16 v[238:253], v[18:21], v[74:77], v[238:253]
    s_waitcnt lgkmcnt(4)
    v_mfma_f32_32x32x16_bf16 v[222:237], v[22:25], v[78:81], v[222:237]
    ds_read_b64_tr_b16 v[14:15], v3 offset:28672
    ds_read_b64_tr_b16 v[16:17], v3 offset:29184
    ds_read_b64_tr_b16 v[18:19], v4 offset:28672
    ds_read_b64_tr_b16 v[20:21], v4 offset:29184
    v_mfma_f32_32x32x16_bf16 v[238:253], v[26:29], v[78:81], v[238:253]
    s_waitcnt lgkmcnt(4)
    v_mfma_f32_32x32x16_bf16 v[222:237], v[6:9], v[82:85], v[222:237]
    ds_read_b64_tr_b16 v[22:23], v3 offset:30720
    ds_read_b64_tr_b16 v[24:25], v3 offset:31232
    ds_read_b64_tr_b16 v[26:27], v4 offset:30720
    ds_read_b64_tr_b16 v[28:29], v4 offset:31232
    v_mfma_f32_32x32x16_bf16 v[238:253], v[10:13], v[82:85], v[238:253]
    s_waitcnt lgkmcnt(4)
    v_mfma_f32_32x32x16_bf16 v[222:237], v[14:17], v[86:89], v[222:237]
    ds_read_b64_tr_b16 v[6:7], v3 offset:32768
    ds_read_b64_tr_b16 v[8:9], v3 offset:33280
    ds_read_b64_tr_b16 v[10:11], v4 offset:32768
    ds_read_b64_tr_b16 v[12:13], v4 offset:33280
    v_mfma_f32_32x32x16_bf16 v[238:253], v[18:21], v[86:89], v[238:253]
    s_waitcnt lgkmcnt(4)
    v_mfma_f32_32x32x16_bf16 v[222:237], v[22:25], v[90:93], v[222:237]
    ds_read_b64_tr_b16 v[14:15], v3 offset:34816
    ds_read_b64_tr_b16 v[16:17], v3 offset:35328
    ds_read_b64_tr_b16 v[18:19], v4 offset:34816
    ds_read_b64_tr_b16 v[20:21], v4 offset:35328
    v_mfma_f32_32x32x16_bf16 v[238:253], v[26:29], v[90:93], v[238:253]
    s_waitcnt lgkmcnt(4)
    v_mfma_f32_32x32x16_bf16 v[222:237], v[6:9], v[94:97], v[222:237]
    ds_read_b64_tr_b16 v[22:23], v3 offset:36864
    ds_read_b64_tr_b16 v[24:25], v3 offset:37376
    ds_read_b64_tr_b16 v[26:27], v4 offset:36864
    ds_read_b64_tr_b16 v[28:29], v4 offset:37376
    v_mfma_f32_32x32x16_bf16 v[238:253], v[10:13], v[94:97], v[238:253]
    s_waitcnt lgkmcnt(4)
    v_mfma_f32_32x32x16_bf16 v[222:237], v[14:17], v[98:101], v[222:237]
    ds_read_b64_tr_b16 v[6:7], v3 offset:38912
    ds_read_b64_tr_b16 v[8:9], v3 offset:39424
    ds_read_b64_tr_b16 v[10:11], v4 offset:38912
    ds_read_b64_tr_b16 v[12:13], v4 offset:39424
    v_mfma_f32_32x32x16_bf16 v[238:253], v[18:21], v[98:101], v[238:253]
    s_waitcnt lgkmcnt(4)
    v_mfma_f32_32x32x16_bf16 v[222:237], v[22:25], v[102:105], v[222:237]
    v_mfma_f32_32x32x16_bf16 v[238:253], v[26:29], v[102:105], v[238:253]
    s_waitcnt vmcnt(0)
    s_barrier
    v_mov_b32 v254, 1
    buffer_store_dword v254, v255, s[48:51], s98 offen sc1
    ds_read_b64_tr_b16 v[14:15], v3 offset:40960
    ds_read_b64_tr_b16 v[16:17], v3 offset:41472
    ds_read_b64_tr_b16 v[18:19], v4 offset:40960
    ds_read_b64_tr_b16 v[20:21], v4 offset:41472
    s_waitcnt lgkmcnt(4)
    v_mfma_f32_32x32x16_bf16 v[222:237], v[6:9], v[106:109], v[222:237]
    ds_read_b64_tr_b16 v[22:23], v3 offset:43008
    ds_read_b64_tr_b16 v[24:25], v3 offset:43520
    ds_read_b64_tr_b16 v[26:27], v4 offset:43008
    ds_read_b64_tr_b16 v[28:29], v4 offset:43520
    v_mfma_f32_32x32x16_bf16 v[238:253], v[10:13], v[106:109], v[238:253]
    s_waitcnt lgkmcnt(4)
    v_mfma_f32_32x32x16_bf16 v[222:237], v[14:17], v[110:113], v[222:237]
    ds_read_b64_tr_b16 v[6:7], v3 offset:45056
    ds_read_b64_tr_b16 v[8:9], v3 offset:45568
    ds_read_b64_tr_b16 v[10:11], v4 offset:45056
    ds_read_b64_tr_b16 v[12:13], v4 offset:45568
    v_mfma_f32_32x32x16_bf16 v[238:253], v[18:21], v[110:113], v[238:253]
    s_waitcnt lgkmcnt(4)
    v_mfma_f32_32x32x16_bf16 v[222:237], v[22:25], v[114:117], v[222:237]
    ds_read_b64_tr_b16 v[14:15], v3 offset:47104
    ds_read_b64_tr_b16 v[16:17], v3 offset:47616
    ds_read_b64_tr_b16 v[18:19], v4 offset:47104
    ds_read_b64_tr_b16 v[20:21], v4 offset:47616
    v_mfma_f32_32x32x16_bf16 v[238:253], v[26:29], v[114:117], v[238:253]
    s_waitcnt lgkmcnt(4)
    v_mfma_f32_32x32x16_bf16 v[222:237], v[6:9], v[118:121], v[222:237]
    ds_read_b64_tr_b16 v[22:23], v3 offset:49152
    ds_read_b64_tr_b16 v[24:25], v3 offset:49664
    ds_read_b64_tr_b16 v[26:27], v4 offset:49152
    ds_read_b64_tr_b16 v[28:29], v4 offset:49664
    v_mfma_f32_32x32x16_bf16 v[238:253], v[10:13], v[118:121], v[238:253]
    s_waitcnt lgkmcnt(4)
    v_mfma_f32_32x32x16_bf16 v[222:237], v[14:17], v[122:125], v[222:237]
    ds_read_b64_tr_b16 v[6:7], v3 offset:51200
    ds_read_b64_tr_b16 v[8:9], v3 offset:51712
    ds_read_b64_tr_b16 v[10:11], v4 offset:51200
    ds_read_b64_tr_b16 v[12:13], v4 offset:51712
    v_mfma_f32_32x32x16_bf16 v[238:253], v[18:21], v[122:125], v[238:253]
    s_waitcnt lgkmcnt(4)
    v_mfma_f32_32x32x16_bf16 v[222:237], v[22:25], v[126:129], v[222:237]
    ds_read_b64_tr_b16 v[14:15], v3 offset:53248
    ds_read_b64_tr_b16 v[16:17], v3 offset:53760
    ds_read_b64_tr_b16 v[18:19], v4 offset:53248
    ds_read_b64_tr_b16 v[20:21], v4 offset:53760
    v_mfma_f32_32x32x16_bf16 v[238:253], v[26:29], v[126:129], v[238:253]
    s_waitcnt lgkmcnt(4)
    v_mfma_f32_32x32x16_bf16 v[222:237], v[6:9], v[130:133], v[222:237]
    ds_read_b64_tr_b16 v[22:23], v3 offset:55296
    ds_read_b64_tr_b16 v[24:25], v3 offset:55808
    ds_read_b64_tr_b16 v[26:27], v4 offset:55296
    ds_read_b64_tr_b16 v[28:29], v4 offset:55808
    v_mfma_f32_32x32x16_bf16 v[238:253], v[10:13], v[130:133], v[238:253]
    s_waitcnt lgkmcnt(4)
    v_mfma_f32_32x32x16_bf16 v[222:237], v[14:17], v[134:137], v[222:237]
    ds_read_b64_tr_b16 v[6:7], v3 offset:57344
    ds_read_b64_tr_b16 v[8:9], v3 offset:57856
    ds_read_b64_tr_b16 v[10:11], v4 offset:57344
    ds_read_b64_tr_b16 v[12:13], v4 offset:57856
    v_mfma_f32_32x32x16_bf16 v[238:253], v[18:21], v[134:137], v[238:253]
    s_waitcnt lgkmcnt(4)
    v_mfma_f32_32x32x16_bf16 v[222:237], v[22:25], v[138:141], v[222:237]
    ds_read_b64_tr_b16 v[14:15], v3 offset:59392
    ds_read_b64_tr_b16 v[16:17], v3 offset:59904
    ds_read_b64_tr_b16 v[18:19], v4 offset:59392
    ds_read_b64_tr_b16 v[20:21], v4 offset:59904
    v_mfma_f32_32x32x16_bf16 v[238:253], v[26:29], v[138:141], v[238:253]
    s_waitcnt lgkmcnt(4)
    v_mfma_f32_32x32x16_bf16 v[222:237], v[6:9], v[142:145], v[222:237]
    v_mfma_f32_32x32x16_bf16 v[238:253], v[10:13], v[142:145], v[238:253]
    s_barrier
    v_add_u32 v3, 61440, v3
    v_add_u32 v4, 61440, v4
    ds_read_b64_tr_b16 v[22:23], v3 offset:0
    ds_read_b64_tr_b16 v[24:25], v3 offset:512
    ds_read_b64_tr_b16 v[26:27], v4 offset:0
    ds_read_b64_tr_b16 v[28:29], v4 offset:512
    s_waitcnt lgkmcnt(4)
    v_mfma_f32_32x32x16_bf16 v[222:237], v[14:17], v[146:149], v[222:237]
    ds_read_b64_tr_b16 v[6:7], v3 offset:2048
    ds_read_b64_tr_b16 v[8:9], v3 offset:2560
    ds_read_b64_tr_b16 v[10:11], v4 offset:2048
    ds_read_b64_tr_b16 v[12:13], v4 offset:2560
    v_mfma_f32_32x32x16_bf16 v[238:253], v[18:21], v[146:149], v[238:253]
    s_waitcnt lgkmcnt(4)
    v_mfma_f32_32x32x16_bf16 v[222:237], v[22:25], v[150:153], v[222:237]
    ds_read_b64_tr_b16 v[14:15], v3 offset:4096
    ds_read_b64_tr_b16 v[16:17], v3 offset:4608
    ds_read_b64_tr_b16 v[18:19], v4 offset:4096
    ds_read_b64_tr_b16 v[20:21], v4 offset:4608
    v_mfma_f32_32x32x16_bf16 v[238:253], v[26:29], v[150:153], v[238:253]
    s_waitcnt lgkmcnt(4)
    v_mfma_f32_32x32x16_bf16 v[222:237], v[6:9], v[154:157], v[222:237]
    ds_read_b64_tr_b16 v[22:23], v3 offset:6144
    ds_read_b64_tr_b16 v[24:25], v3 offset:6656
    ds_read_b64_tr_b16 v[26:27], v4 offset:6144
    ds_read_b64_tr_b16 v[28:29], v4 offset:6656
    v_mfma_f32_32x32x16_bf16 v[238:253], v[10:13], v[154:157], v[238:253]
    s_waitcnt lgkmcnt(4)
    v_mfma_f32_32x32x16_bf16 v[222:237], v[14:17], v[158:161], v[222:237]
    ds_read_b64_tr_b16 v[6:7], v3 offset:8192
    ds_read_b64_tr_b16 v[8:9], v3 offset:8704
    ds_read_b64_tr_b16 v[10:11], v4 offset:8192
    ds_read_b64_tr_b16 v[12:13], v4 offset:8704
    v_mfma_f32_32x32x16_bf16 v[238:253], v[18:21], v[158:161], v[238:253]
    s_waitcnt lgkmcnt(4)
    v_mfma_f32_32x32x16_bf16 v[222:237], v[22:25], v[162:165], v[222:237]
    ds_read_b64_tr_b16 v[14:15], v3 offset:10240
    ds_read_b64_tr_b16 v[16:17], v3 offset:10752
    ds_read_b64_tr_b16 v[18:19], v4 offset:10240
    ds_read_b64_tr_b16 v[20:21], v4 offset:10752
    v_mfma_f32_32x32x16_bf16 v[238:253], v[26:29], v[162:165], v[238:253]
    s_waitcnt lgkmcnt(4)
    v_mfma_f32_32x32x16_bf16 v[222:237], v[6:9], v[166:169], v[222:237]
    ds_read_b64_tr_b16 v[22:23], v3 offset:12288
    ds_read_b64_tr_b16 v[24:25], v3 offset:12800
    ds_read_b64_tr_b16 v[26:27], v4 offset:12288
    ds_read_b64_tr_b16 v[28:29], v4 offset:12800
    v_mfma_f32_32x32x16_bf16 v[238:253], v[10:13], v[166:169], v[238:253]
    s_waitcnt lgkmcnt(4)
    v_mfma_f32_32x32x16_bf16 v[222:237], v[14:17], v[170:173], v[222:237]
    ds_read_b64_tr_b16 v[6:7], v3 offset:14336
    ds_read_b64_tr_b16 v[8:9], v3 offset:14848
    ds_read_b64_tr_b16 v[10:11], v4 offset:14336
    ds_read_b64_tr_b16 v[12:13], v4 offset:14848
    v_mfma_f32_32x32x16_bf16 v[238:253], v[18:21], v[170:173], v[238:253]
    s_waitcnt lgkmcnt(4)
    v_mfma_f32_32x32x16_bf16 v[222:237], v[22:25], v[174:177], v[222:237]
    ds_read_b64_tr_b16 v[14:15], v3 offset:16384
    ds_read_b64_tr_b16 v[16:17], v3 offset:16896
    ds_read_b64_tr_b16 v[18:19], v4 offset:16384
    ds_read_b64_tr_b16 v[20:21], v4 offset:16896
    v_mfma_f32_32x32x16_bf16 v[238:253], v[26:29], v[174:177], v[238:253]
    s_waitcnt lgkmcnt(4)
    v_mfma_f32_32x32x16_bf16 v[222:237], v[6:9], v[178:181], v[222:237]
    ds_read_b64_tr_b16 v[22:23], v3 offset:18432
    ds_read_b64_tr_b16 v[24:25], v3 offset:18944
    ds_read_b64_tr_b16 v[26:27], v4 offset:18432
    ds_read_b64_tr_b16 v[28:29], v4 offset:18944
    v_mfma_f32_32x32x16_bf16 v[238:253], v[10:13], v[178:181], v[238:253]
    s_waitcnt lgkmcnt(4)
    v_mfma_f32_32x32x16_bf16 v[222:237], v[14:17], v[182:185], v[222:237]
    v_mfma_f32_32x32x16_bf16 v[238:253], v[18:21], v[182:185], v[238:253]
    s_waitcnt lgkmcnt(0)
    s_barrier
    ds_read_b64_tr_b16 v[6:7], v3 offset:20480
    ds_read_b64_tr_b16 v[8:9], v3 offset:20992
    ds_read_b64_tr_b16 v[10:11], v4 offset:20480
    ds_read_b64_tr_b16 v[12:13], v4 offset:20992
    s_waitcnt lgkmcnt(4)
    v_mfma_f32_32x32x16_bf16 v[222:237], v[22:25], v[186:189], v[222:237]
    ds_read_b64_tr_b16 v[14:15], v3 offset:22528
    ds_read_b64_tr_b16 v[16:17], v3 offset:23040
    ds_read_b64_tr_b16 v[18:19], v4 offset:22528
    ds_read_b64_tr_b16 v[20:21], v4 offset:23040
    v_mfma_f32_32x32x16_bf16 v[238:253], v[26:29], v[186:189], v[238:253]
    s_waitcnt lgkmcnt(4)
    v_mfma_f32_32x32x16_bf16 v[190:205], v[6:9], v[30:33], 0
    ds_read_b64_tr_b16 v[22:23], v3 offset:24576
    ds_read_b64_tr_b16 v[24:25], v3 offset:25088
    ds_read_b64_tr_b16 v[26:27], v4 offset:24576
    ds_read_b64_tr_b16 v[28:29], v4 offset:25088
    v_mfma_f32_32x32x16_bf16 v[206:221], v[10:13], v[30:33], 0
    s_waitcnt lgkmcnt(4)
    v_mfma_f32_32x32x16_bf16 v[190:205], v[14:17], v[34:37], v[190:205]
    ds_read_b64_tr_b16 v[6:7], v3 offset:26624
    ds_read_b64_tr_b16 v[8:9], v3 offset:27136
    ds_read_b64_tr_b16 v[10:11], v4 offset:26624
    ds_read_b64_tr_b16 v[12:13], v4 offset:27136
    v_mfma_f32_32x32x16_bf16 v[206:221], v[18:21], v[34:37], v[206:221]
    v_cvt_pk_bf16_f32 v222, v222, v223
    v_cvt_pk_bf16_f32 v223, v224, v225
    v_cvt_pk_bf16_f32 v224, v226, v227
    v_cvt_pk_bf16_f32 v225, v228, v229
    s_waitcnt lgkmcnt(4)
    v_mfma_f32_32x32x16_bf16 v[190:205], v[22:25], v[38:41], v[190:205]
    ds_read_b64_tr_b16 v[14:15], v3 offset:28672
    ds_read_b64_tr_b16 v[16:17], v3 offset:29184
    ds_read_b64_tr_b16 v[18:19], v4 offset:28672
    ds_read_b64_tr_b16 v[20:21], v4 offset:29184
    v_mfma_f32_32x32x16_bf16 v[206:221], v[26:29], v[38:41], v[206:221]
    v_pk_max_i16 v222, v222, 0
    v_pk_max_i16 v223, v223, 0
    v_pk_max_i16 v224, v224, 0
    v_pk_max_i16 v225, v225, 0
    s_waitcnt lgkmcnt(4)
    v_mfma_f32_32x32x16_bf16 v[190:205], v[6:9], v[42:45], v[190:205]
    ds_read_b64_tr_b16 v[22:23], v3 offset:30720
    ds_read_b64_tr_b16 v[24:25], v3 offset:31232
    ds_read_b64_tr_b16 v[26:27], v4 offset:30720
    ds_read_b64_tr_b16 v[28:29], v4 offset:31232
    v_mfma_f32_32x32x16_bf16 v[206:221], v[10:13], v[42:45], v[206:221]
    v_cvt_pk_bf16_f32 v230, v230, v231
    v_cvt_pk_bf16_f32 v231, v232, v233
    v_cvt_pk_bf16_f32 v232, v234, v235
    v_cvt_pk_bf16_f32 v233, v236, v237
    s_waitcnt lgkmcnt(4)
    v_mfma_f32_32x32x16_bf16 v[190:205], v[14:17], v[46:49], v[190:205]
    ds_read_b64_tr_b16 v[6:7], v3 offset:32768
    ds_read_b64_tr_b16 v[8:9], v3 offset:33280
    ds_read_b64_tr_b16 v[10:11], v4 offset:32768
    ds_read_b64_tr_b16 v[12:13], v4 offset:33280
    v_mfma_f32_32x32x16_bf16 v[206:221], v[18:21], v[46:49], v[206:221]
    v_pk_max_i16 v230, v230, 0
    v_pk_max_i16 v231, v231, 0
    v_pk_max_i16 v232, v232, 0
    v_pk_max_i16 v233, v233, 0
    s_waitcnt lgkmcnt(4)
    v_mfma_f32_32x32x16_bf16 v[190:205], v[22:25], v[50:53], v[190:205]
    ds_read_b64_tr_b16 v[14:15], v3 offset:34816
    ds_read_b64_tr_b16 v[16:17], v3 offset:35328
    ds_read_b64_tr_b16 v[18:19], v4 offset:34816
    ds_read_b64_tr_b16 v[20:21], v4 offset:35328
    v_mfma_f32_32x32x16_bf16 v[206:221], v[26:29], v[50:53], v[206:221]
    v_cvt_pk_bf16_f32 v238, v238, v239
    v_cvt_pk_bf16_f32 v239, v240, v241
    v_cvt_pk_bf16_f32 v240, v242, v243
    v_cvt_pk_bf16_f32 v241, v244, v245
    s_waitcnt lgkmcnt(4)
    v_mfma_f32_32x32x16_bf16 v[190:205], v[6:9], v[54:57], v[190:205]
    ds_read_b64_tr_b16 v[22:23], v3 offset:36864
    ds_read_b64_tr_b16 v[24:25], v3 offset:37376
    ds_read_b64_tr_b16 v[26:27], v4 offset:36864
    ds_read_b64_tr_b16 v[28:29], v4 offset:37376
    v_mfma_f32_32x32x16_bf16 v[206:221], v[10:13], v[54:57], v[206:221]
    v_pk_max_i16 v238, v238, 0
    v_pk_max_i16 v239, v239, 0
    v_pk_max_i16 v240, v240, 0
    v_pk_max_i16 v241, v241, 0
    s_waitcnt lgkmcnt(4)
    v_mfma_f32_32x32x16_bf16 v[190:205], v[14:17], v[58:61], v[190:205]
    ds_read_b64_tr_b16 v[6:7], v3 offset:38912
    ds_read_b64_tr_b16 v[8:9], v3 offset:39424
    ds_read_b64_tr_b16 v[10:11], v4 offset:38912
    ds_read_b64_tr_b16 v[12:13], v4 offset:39424
    v_mfma_f32_32x32x16_bf16 v[206:221], v[18:21], v[58:61], v[206:221]
    v_cvt_pk_bf16_f32 v246, v246, v247
    v_cvt_pk_bf16_f32 v247, v248, v249
    v_cvt_pk_bf16_f32 v248, v250, v251
    v_cvt_pk_bf16_f32 v249, v252, v253
    s_waitcnt lgkmcnt(4)
    v_mfma_f32_32x32x16_bf16 v[190:205], v[22:25], v[62:65], v[190:205]
    ds_read_b64_tr_b16 v[14:15], v3 offset:40960
    ds_read_b64_tr_b16 v[16:17], v3 offset:41472
    ds_read_b64_tr_b16 v[18:19], v4 offset:40960
    ds_read_b64_tr_b16 v[20:21], v4 offset:41472
    v_mfma_f32_32x32x16_bf16 v[206:221], v[26:29], v[62:65], v[206:221]
    v_pk_max_i16 v246, v246, 0
    v_pk_max_i16 v247, v247, 0
    v_pk_max_i16 v248, v248, 0
    v_pk_max_i16 v249, v249, 0
    s_waitcnt lgkmcnt(4)
    v_mfma_f32_32x32x16_bf16 v[190:205], v[6:9], v[66:69], v[190:205]
    ds_read_b64_tr_b16 v[22:23], v3 offset:43008
    ds_read_b64_tr_b16 v[24:25], v3 offset:43520
    ds_read_b64_tr_b16 v[26:27], v4 offset:43008
    ds_read_b64_tr_b16 v[28:29], v4 offset:43520
    v_mfma_f32_32x32x16_bf16 v[206:221], v[10:13], v[66:69], v[206:221]
    s_waitcnt lgkmcnt(4)
    v_mfma_f32_32x32x16_bf16 v[190:205], v[14:17], v[70:73], v[190:205]
    ds_read_b64_tr_b16 v[6:7], v3 offset:45056
    ds_read_b64_tr_b16 v[8:9], v3 offset:45568
    ds_read_b64_tr_b16 v[10:11], v4 offset:45056
    ds_read_b64_tr_b16 v[12:13], v4 offset:45568
    v_mfma_f32_32x32x16_bf16 v[206:221], v[18:21], v[70:73], v[206:221]
    s_waitcnt lgkmcnt(4)
    v_mfma_f32_32x32x16_bf16 v[190:205], v[22:25], v[74:77], v[190:205]
    ds_read_b64_tr_b16 v[14:15], v3 offset:47104
    ds_read_b64_tr_b16 v[16:17], v3 offset:47616
    ds_read_b64_tr_b16 v[18:19], v4 offset:47104
    ds_read_b64_tr_b16 v[20:21], v4 offset:47616
    v_mfma_f32_32x32x16_bf16 v[206:221], v[26:29], v[74:77], v[206:221]
    s_waitcnt lgkmcnt(4)
    v_mfma_f32_32x32x16_bf16 v[190:205], v[6:9], v[78:81], v[190:205]
    ds_read_b64_tr_b16 v[22:23], v3 offset:49152
    ds_read_b64_tr_b16 v[24:25], v3 offset:49664
    ds_read_b64_tr_b16 v[26:27], v4 offset:49152
    ds_read_b64_tr_b16 v[28:29], v4 offset:49664
    v_mfma_f32_32x32x16_bf16 v[206:221], v[10:13], v[78:81], v[206:221]
    s_waitcnt lgkmcnt(4)
    v_mfma_f32_32x32x16_bf16 v[190:205], v[14:17], v[82:85], v[190:205]
    ds_read_b64_tr_b16 v[6:7], v3 offset:51200
    ds_read_b64_tr_b16 v[8:9], v3 offset:51712
    ds_read_b64_tr_b16 v[10:11], v4 offset:51200
    ds_read_b64_tr_b16 v[12:13], v4 offset:51712
    v_mfma_f32_32x32x16_bf16 v[206:221], v[18:21], v[82:85], v[206:221]
    s_waitcnt lgkmcnt(4)
    v_mfma_f32_32x32x16_bf16 v[190:205], v[22:25], v[86:89], v[190:205]
    ds_read_b64_tr_b16 v[14:15], v3 offset:53248
    ds_read_b64_tr_b16 v[16:17], v3 offset:53760
    ds_read_b64_tr_b16 v[18:19], v4 offset:53248
    ds_read_b64_tr_b16 v[20:21], v4 offset:53760
    v_mfma_f32_32x32x16_bf16 v[206:221], v[26:29], v[86:89], v[206:221]
    s_waitcnt lgkmcnt(4)
    v_mfma_f32_32x32x16_bf16 v[190:205], v[6:9], v[90:93], v[190:205]
    ds_read_b64_tr_b16 v[22:23], v3 offset:55296
    ds_read_b64_tr_b16 v[24:25], v3 offset:55808
    ds_read_b64_tr_b16 v[26:27], v4 offset:55296
    ds_read_b64_tr_b16 v[28:29], v4 offset:55808
    v_mfma_f32_32x32x16_bf16 v[206:221], v[10:13], v[90:93], v[206:221]
    s_waitcnt lgkmcnt(4)
    v_mfma_f32_32x32x16_bf16 v[190:205], v[14:17], v[94:97], v[190:205]
    ds_read_b64_tr_b16 v[6:7], v3 offset:57344
    ds_read_b64_tr_b16 v[8:9], v3 offset:57856
    ds_read_b64_tr_b16 v[10:11], v4 offset:57344
    ds_read_b64_tr_b16 v[12:13], v4 offset:57856
    v_mfma_f32_32x32x16_bf16 v[206:221], v[18:21], v[94:97], v[206:221]
    s_waitcnt lgkmcnt(4)
    v_mfma_f32_32x32x16_bf16 v[190:205], v[22:25], v[98:101], v[190:205]
    ds_read_b64_tr_b16 v[14:15], v3 offset:59392
    ds_read_b64_tr_b16 v[16:17], v3 offset:59904
    ds_read_b64_tr_b16 v[18:19], v4 offset:59392
    ds_read_b64_tr_b16 v[20:21], v4 offset:59904
    v_mfma_f32_32x32x16_bf16 v[206:221], v[26:29], v[98:101], v[206:221]
    s_waitcnt lgkmcnt(4)
    v_mfma_f32_32x32x16_bf16 v[190:205], v[6:9], v[102:105], v[190:205]
    v_add_u32 v3, 61440, v3
    v_add_u32 v4, 61440, v4
    ds_read_b64_tr_b16 v[22:23], v3 offset:0
    ds_read_b64_tr_b16 v[24:25], v3 offset:512
    ds_read_b64_tr_b16 v[26:27], v4 offset:0
    ds_read_b64_tr_b16 v[28:29], v4 offset:512
    v_mfma_f32_32x32x16_bf16 v[206:221], v[10:13], v[102:105], v[206:221]
    s_waitcnt lgkmcnt(4)
    v_mfma_f32_32x32x16_bf16 v[190:205], v[14:17], v[106:109], v[190:205]
    ds_read_b64_tr_b16 v[6:7], v3 offset:2048
    ds_read_b64_tr_b16 v[8:9], v3 offset:2560
    ds_read_b64_tr_b16 v[10:11], v4 offset:2048
    ds_read_b64_tr_b16 v[12:13], v4 offset:2560
    v_mfma_f32_32x32x16_bf16 v[206:221], v[18:21], v[106:109], v[206:221]
    s_waitcnt lgkmcnt(4)
    v_mfma_f32_32x32x16_bf16 v[190:205], v[22:25], v[110:113], v[190:205]
    ds_read_b64_tr_b16 v[14:15], v3 offset:4096
    ds_read_b64_tr_b16 v[16:17], v3 offset:4608
    ds_read_b64_tr_b16 v[18:19], v4 offset:4096
    ds_read_b64_tr_b16 v[20:21], v4 offset:4608
    v_mfma_f32_32x32x16_bf16 v[206:221], v[26:29], v[110:113], v[206:221]
    s_waitcnt lgkmcnt(4)
    v_mfma_f32_32x32x16_bf16 v[190:205], v[6:9], v[114:117], v[190:205]
    ds_read_b64_tr_b16 v[22:23], v3 offset:6144
    ds_read_b64_tr_b16 v[24:25], v3 offset:6656
    ds_read_b64_tr_b16 v[26:27], v4 offset:6144
    ds_read_b64_tr_b16 v[28:29], v4 offset:6656
    v_mfma_f32_32x32x16_bf16 v[206:221], v[10:13], v[114:117], v[206:221]
    s_waitcnt lgkmcnt(4)
    v_mfma_f32_32x32x16_bf16 v[190:205], v[14:17], v[118:121], v[190:205]
    ds_read_b64_tr_b16 v[6:7], v3 offset:8192
    ds_read_b64_tr_b16 v[8:9], v3 offset:8704
    ds_read_b64_tr_b16 v[10:11], v4 offset:8192
    ds_read_b64_tr_b16 v[12:13], v4 offset:8704
    v_mfma_f32_32x32x16_bf16 v[206:221], v[18:21], v[118:121], v[206:221]
    s_waitcnt lgkmcnt(4)
    v_mfma_f32_32x32x16_bf16 v[190:205], v[22:25], v[122:125], v[190:205]
    ds_read_b64_tr_b16 v[14:15], v3 offset:10240
    ds_read_b64_tr_b16 v[16:17], v3 offset:10752
    ds_read_b64_tr_b16 v[18:19], v4 offset:10240
    ds_read_b64_tr_b16 v[20:21], v4 offset:10752
    v_mfma_f32_32x32x16_bf16 v[206:221], v[26:29], v[122:125], v[206:221]
    s_waitcnt lgkmcnt(4)
    v_mfma_f32_32x32x16_bf16 v[190:205], v[6:9], v[126:129], v[190:205]
    ds_read_b64_tr_b16 v[22:23], v3 offset:12288
    ds_read_b64_tr_b16 v[24:25], v3 offset:12800
    ds_read_b64_tr_b16 v[26:27], v4 offset:12288
    ds_read_b64_tr_b16 v[28:29], v4 offset:12800
    v_mfma_f32_32x32x16_bf16 v[206:221], v[10:13], v[126:129], v[206:221]
    s_waitcnt lgkmcnt(4)
    v_mfma_f32_32x32x16_bf16 v[190:205], v[14:17], v[130:133], v[190:205]
    ds_read_b64_tr_b16 v[6:7], v3 offset:14336
    ds_read_b64_tr_b16 v[8:9], v3 offset:14848
    ds_read_b64_tr_b16 v[10:11], v4 offset:14336
    ds_read_b64_tr_b16 v[12:13], v4 offset:14848
    v_mfma_f32_32x32x16_bf16 v[206:221], v[18:21], v[130:133], v[206:221]
    s_waitcnt lgkmcnt(4)
    v_mfma_f32_32x32x16_bf16 v[190:205], v[22:25], v[134:137], v[190:205]
    ds_read_b64_tr_b16 v[14:15], v3 offset:16384
    ds_read_b64_tr_b16 v[16:17], v3 offset:16896
    ds_read_b64_tr_b16 v[18:19], v4 offset:16384
    ds_read_b64_tr_b16 v[20:21], v4 offset:16896
    v_mfma_f32_32x32x16_bf16 v[206:221], v[26:29], v[134:137], v[206:221]
    s_waitcnt lgkmcnt(4)
    v_mfma_f32_32x32x16_bf16 v[190:205], v[6:9], v[138:141], v[190:205]
    ds_read_b64_tr_b16 v[22:23], v3 offset:18432
    ds_read_b64_tr_b16 v[24:25], v3 offset:18944
    ds_read_b64_tr_b16 v[26:27], v4 offset:18432
    ds_read_b64_tr_b16 v[28:29], v4 offset:18944
    v_mfma_f32_32x32x16_bf16 v[206:221], v[10:13], v[138:141], v[206:221]
    s_waitcnt lgkmcnt(4)
    v_mfma_f32_32x32x16_bf16 v[190:205], v[14:17], v[142:145], v[190:205]
    ds_read_b64_tr_b16 v[6:7], v3 offset:20480
    ds_read_b64_tr_b16 v[8:9], v3 offset:20992
    ds_read_b64_tr_b16 v[10:11], v4 offset:20480
    ds_read_b64_tr_b16 v[12:13], v4 offset:20992
    v_mfma_f32_32x32x16_bf16 v[206:221], v[18:21], v[142:145], v[206:221]
    s_waitcnt lgkmcnt(4)
    v_mfma_f32_32x32x16_bf16 v[190:205], v[22:25], v[146:149], v[190:205]
    ds_read_b64_tr_b16 v[14:15], v3 offset:22528
    ds_read_b64_tr_b16 v[16:17], v3 offset:23040
    ds_read_b64_tr_b16 v[18:19], v4 offset:22528
    ds_read_b64_tr_b16 v[20:21], v4 offset:23040
    v_mfma_f32_32x32x16_bf16 v[206:221], v[26:29], v[146:149], v[206:221]
    s_waitcnt lgkmcnt(4)
    v_mfma_f32_32x32x16_bf16 v[190:205], v[6:9], v[150:153], v[190:205]
    ds_read_b64_tr_b16 v[22:23], v3 offset:24576
    ds_read_b64_tr_b16 v[24:25], v3 offset:25088
    ds_read_b64_tr_b16 v[26:27], v4 offset:24576
    ds_read_b64_tr_b16 v[28:29], v4 offset:25088
    v_mfma_f32_32x32x16_bf16 v[206:221], v[10:13], v[150:153], v[206:221]
    s_waitcnt lgkmcnt(4)
    v_mfma_f32_32x32x16_bf16 v[190:205], v[14:17], v[154:157], v[190:205]
    ds_read_b64_tr_b16 v[6:7], v3 offset:26624
    ds_read_b64_tr_b16 v[8:9], v3 offset:27136
    ds_read_b64_tr_b16 v[10:11], v4 offset:26624
    ds_read_b64_tr_b16 v[12:13], v4 offset:27136
    v_mfma_f32_32x32x16_bf16 v[206:221], v[18:21], v[154:157], v[206:221]
    s_waitcnt lgkmcnt(4)
    v_mfma_f32_32x32x16_bf16 v[190:205], v[22:25], v[158:161], v[190:205]
    ds_read_b64_tr_b16 v[14:15], v3 offset:28672
    ds_read_b64_tr_b16 v[16:17], v3 offset:29184
    ds_read_b64_tr_b16 v[18:19], v4 offset:28672
    ds_read_b64_tr_b16 v[20:21], v4 offset:29184
    v_mfma_f32_32x32x16_bf16 v[206:221], v[26:29], v[158:161], v[206:221]
    s_waitcnt lgkmcnt(4)
    v_mfma_f32_32x32x16_bf16 v[190:205], v[6:9], v[162:165], v[190:205]
    ds_read_b64_tr_b16 v[22:23], v3 offset:30720
    ds_read_b64_tr_b16 v[24:25], v3 offset:31232
    ds_read_b64_tr_b16 v[26:27], v4 offset:30720
    ds_read_b64_tr_b16 v[28:29], v4 offset:31232
    v_mfma_f32_32x32x16_bf16 v[206:221], v[10:13], v[162:165], v[206:221]
    s_waitcnt lgkmcnt(4)
    v_mfma_f32_32x32x16_bf16 v[190:205], v[14:17], v[166:169], v[190:205]
    ds_read_b64_tr_b16 v[6:7], v3 offset:32768
    ds_read_b64_tr_b16 v[8:9], v3 offset:33280
    ds_read_b64_tr_b16 v[10:11], v4 offset:32768
    ds_read_b64_tr_b16 v[12:13], v4 offset:33280
    v_mfma_f32_32x32x16_bf16 v[206:221], v[18:21], v[166:169], v[206:221]
    s_waitcnt lgkmcnt(4)
    v_mfma_f32_32x32x16_bf16 v[190:205], v[22:25], v[170:173], v[190:205]
    ds_read_b64_tr_b16 v[14:15], v3 offset:34816
    ds_read_b64_tr_b16 v[16:17], v3 offset:35328
    ds_read_b64_tr_b16 v[18:19], v4 offset:34816
    ds_read_b64_tr_b16 v[20:21], v4 offset:35328
    v_mfma_f32_32x32x16_bf16 v[206:221], v[26:29], v[170:173], v[206:221]
    s_waitcnt lgkmcnt(4)
    v_mfma_f32_32x32x16_bf16 v[190:205], v[6:9], v[174:177], v[190:205]
    ds_read_b64_tr_b16 v[22:23], v3 offset:36864
    ds_read_b64_tr_b16 v[24:25], v3 offset:37376
    ds_read_b64_tr_b16 v[26:27], v4 offset:36864
    ds_read_b64_tr_b16 v[28:29], v4 offset:37376
    v_mfma_f32_32x32x16_bf16 v[206:221], v[10:13], v[174:177], v[206:221]
    s_waitcnt lgkmcnt(4)
    v_mfma_f32_32x32x16_bf16 v[190:205], v[14:17], v[178:181], v[190:205]
    ds_read_b64_tr_b16 v[6:7], v3 offset:38912
    ds_read_b64_tr_b16 v[8:9], v3 offset:39424
    ds_read_b64_tr_b16 v[10:11], v4 offset:38912
    ds_read_b64_tr_b16 v[12:13], v4 offset:39424
    v_mfma_f32_32x32x16_bf16 v[206:221], v[18:21], v[178:181], v[206:221]
    s_waitcnt lgkmcnt(4)
    v_mfma_f32_32x32x16_bf16 v[190:205], v[22:25], v[182:185], v[190:205]
    v_mfma_f32_32x32x16_bf16 v[206:221], v[26:29], v[182:185], v[206:221]
    s_waitcnt lgkmcnt(0)
    v_mfma_f32_32x32x16_bf16 v[190:205], v[6:9], v[186:189], v[190:205]
    v_mfma_f32_32x32x16_bf16 v[206:221], v[10:13], v[186:189], v[206:221]
    s_nop 3
    s_movk_i32 s44, 0x400
    v_lshlrev_b32 v2, 4, v1
    v_mov_b32 v5, v2
    v_and_b32 v8, 31, v1
    v_lshrrev_b32 v9, 5, v1
    v_lshlrev_b32_e64 v11, 3, v8
    v_mul_u32_u24 v3, 2560, v9
    v_add3_u32 v3, v3, v11, s44
    v_mov_b32 v20, 0
    v_mov_b32 v21, 0
    v_mov_b32 v22, 0
    v_mov_b32 v23, 0
    v_mov_b32 v6, 0
    v_mov_b32 v7, 0
    v_mov_b32 v254, 0
    v_mov_b32 v255, 0
    v_lshrrev_b32 v4, 3, v8
    v_xor_b32 v4, v4, v9
    v_and_b32 v4, 1, v4
    v_lshlrev_b32 v4, 6, v4
    v_lshrrev_b32_e64 v10, 2, v8
    v_lshl_add_u32 v4, v10, 7, v4
    v_and_b32_e64 v10, 3, v8
    v_lshl_add_u32 v4, v10, 4, v4
    v_add_u32 v4, 1280, v4
    v_cmp_eq_u32_e64 vcc, 20, v8
    v_cmp_eq_u32 s[58:59], 24, v8
    s_mul_i32 s42, s74, 2560
    s_add_u32 s42, s42, 71680
    s_or_b64 vcc, vcc, s[58:59]
    v_mov_b32 v10, 0x3f803f80
    s_nop 1
    v_cndmask_b32 v10, 0, v10, vcc
    v_mov_b32 v30, v10
    v_mov_b32 v31, v10
    v_mov_b32 v32, v10
    v_mov_b32 v33, v10
    v_mov_b32 v34, v10
    v_mov_b32 v35, v10
    v_mov_b32 v36, v10
    v_mov_b32 v37, v10
    v_add_u32 v10, s42, v2
    v_add_u32_e64 v11, s42, v11
    s_nop 1
    s_add_u32 s101, s94, s101
    v_cvt_pk_bf16_f32 v190, v190, v191
    v_cvt_pk_bf16_f32 v191, v192, v193
    v_cvt_pk_bf16_f32 v192, v194, v195
    v_cvt_pk_bf16_f32 v193, v196, v197
    s_nop 1
    v_pk_max_i16 v190, v190, 0
    v_pk_max_i16 v191, v191, 0
    v_pk_max_i16 v192, v192, 0
    v_pk_max_i16 v193, v193, 0
    s_nop 1
    v_cvt_pk_bf16_f32 v198, v198, v199
    v_cvt_pk_bf16_f32 v199, v200, v201
    v_cvt_pk_bf16_f32 v200, v202, v203
    v_cvt_pk_bf16_f32 v201, v204, v205
    s_nop 1
    v_pk_max_i16 v198, v198, 0
    v_pk_max_i16 v199, v199, 0
    v_pk_max_i16 v200, v200, 0
    v_pk_max_i16 v201, v201, 0
    s_nop 1
    v_cvt_pk_bf16_f32 v206, v206, v207
    v_cvt_pk_bf16_f32 v207, v208, v209
    v_cvt_pk_bf16_f32 v208, v210, v211
    v_cvt_pk_bf16_f32 v209, v212, v213
    s_nop 1
    v_pk_max_i16 v206, v206, 0
    v_pk_max_i16 v207, v207, 0
    v_pk_max_i16 v208, v208, 0
    v_pk_max_i16 v209, v209, 0
    s_nop 1
    v_cvt_pk_bf16_f32 v214, v214, v215
    v_cvt_pk_bf16_f32 v215, v216, v217
    v_cvt_pk_bf16_f32 v216, v218, v219
    v_cvt_pk_bf16_f32 v217, v220, v221
    s_nop 1
    v_pk_max_i16 v214, v214, 0
    v_pk_max_i16 v215, v215, 0
    v_pk_max_i16 v216, v216, 0
    v_pk_max_i16 v217, v217, 0
g_att1:
    s_barrier
    ds_read_b128 v[12:15], v10
    ds_read_b128 v[24:27], v5 offset:5120
    s_mov_b32 exec_hi, 0
    ds_read_b64 v[20:21], v11 offset:1024
    ds_read_b64 v[22:23], v11 offset:2304
    s_mov_b32 exec_hi, -1
    ds_read_b64 v[28:29], v3 offset:5120
    ds_read_b128 v[16:19], v10 offset:1280
    s_mov_b32 exec_lo, 0
    ds_read_b64 v[6:7], v11 offset:1024
    ds_read_b64 v[254:255], v11 offset:2304
    s_mov_b32 exec_lo, -1
    s_mov_b64 exec, s[62:63]
    ds_read_b128 v[30:33], v4 offset:5120
    s_mov_b64 exec, -1
    s_waitcnt lgkmcnt(7)
    v_mfma_f32_32x32x16_bf16 v[46:61], v[24:27], v[12:15], 0
    s_waitcnt lgkmcnt(4)
    v_mfma_f32_32x32x8_bf16 v[46:61], v[28:29], v[20:21], v[46:61]
    s_cmp_lt_u32 s61, 14
    s_cbranch_scc1 g_hsc
    buffer_store_dwordx4 v[206:209], v2, s[64:67], s101 offen offset:2048 sc1
    buffer_store_dwordx4 v[214:217], v2, s[64:67], s101 offen offset:3072 sc1
g_hsc:
    buffer_store_dwordx4 v[222:225], v2, s[64:67], s94 offen offset:0 sc1
    s_waitcnt lgkmcnt(1)
    s_nop 4
    v_mfma_f32_32x32x16_bf16 v[62:77], v[24:27], v[16:19], 0
    v_exp_f32 v46, v46
    v_exp_f32 v47, v47
    v_exp_f32 v48, v48
    v_exp_f32 v49, v49
    s_setprio 3
    s_mov_b64 exec, s[62:63]
    ds_read_b128 v[34:37], v4 offset:5760
    s_or_b64 exec, -1, 0x70000000
    ds_read_b128 v[24:27], v5 offset:7680
    v_exp_f32 v50, v50
    v_exp_f32 v51, v51
    v_exp_f32 v52, v52
    v_exp_f32 v53, v53
    v_mfma_f32_32x32x8_bf16 v[62:77], v[28:29], v[22:23], v[62:77]
    v_cvt_pk_bf16_f32 v38, v46, v47
    v_cvt_pk_bf16_f32 v39, v48, v49
    v_cvt_pk_bf16_f32 v40, v50, v51
    v_cvt_pk_bf16_f32 v41, v52, v53
    buffer_store_dwordx4 v[230:233], v2, s[64:67], s94 offen offset:1024 sc1
    buffer_store_dwordx4 v[238:241], v2, s[64:67], s94 offen offset:2048 sc1
    buffer_store_dwordx4 v[246:249], v2, s[64:67], s94 offen offset:3072 sc1
    v_exp_f32_e64 v54, v54
    v_exp_f32 v55, v55
    s_waitcnt lgkmcnt(2)
    v_mfma_f32_32x32x16_bf16 v[78:93], v[30:33], v[38:41], 0
    v_exp_f32 v56, v56
    v_exp_f32 v57, v57
    v_exp_f32 v58, v58
    v_exp_f32 v59, v59
    v_exp_f32_e64 v60, v60
    v_exp_f32 v61, v61
    s_waitcnt lgkmcnt(0)
    v_cvt_pk_bf16_f32 v42, v54, v55
    v_cvt_pk_bf16_f32 v43, v56, v57
    v_cvt_pk_bf16_f32 v44, v58, v59
    v_cvt_pk_bf16_f32 v45, v60, v61
    v_mfma_f32_32x32x16_bf16 v[46:61], v[24:27], v[12:15], 0
    v_exp_f32 v62, v62
    v_exp_f32 v63, v63
    v_exp_f32 v64, v64
    v_exp_f32 v65, v65
    v_mfma_f32_32x32x16_bf16 v[78:93], v[34:37], v[42:45], v[78:93]
    v_exp_f32 v66, v66
    v_exp_f32 v67, v67
    v_exp_f32 v68, v68
    v_exp_f32 v69, v69
    v_mfma_f32_32x32x8_bf16 v[46:61], v[28:29], v[6:7], v[46:61]
    v_cvt_pk_bf16_f32 v38, v62, v63
    v_cvt_pk_bf16_f32 v39, v64, v65
    v_cvt_pk_bf16_f32 v40, v66, v67
    v_cvt_pk_bf16_f32 v41, v68, v69
    buffer_store_dwordx4 v[190:193], v2, s[64:67], s101 offen offset:0 sc1
    buffer_store_dwordx4 v[198:201], v2, s[64:67], s101 offen offset:1024 sc1
    s_add_u32 m0, s41, 81920
    s_add_u32 s42, s39, 81920
    buffer_load_dwordx4 v2, s[4:7], s42 offen sc1 lds
    v_exp_f32 v70, v70
    v_exp_f32 v71, v71
    v_mfma_f32_32x32x16_bf16 v[94:109], v[30:33], v[38:41], 0
    s_andn2_b64 exec, s[62:63], 0x70000000
    ds_read_b128 v[30:33], v4 offset:7680
    s_mov_b64 exec, -1
    v_exp_f32 v72, v72
    v_exp_f32 v73, v73
    v_exp_f32 v74, v74
    v_exp_f32 v75, v75
    v_exp_f32 v76, v76
    v_exp_f32_e64 v77, v77
    v_cvt_pk_bf16_f32 v42, v70, v71
    v_cvt_pk_bf16_f32 v43, v72, v73
    v_cvt_pk_bf16_f32 v44, v74, v75
    v_cvt_pk_bf16_f32 v45, v76, v77
    v_mfma_f32_32x32x16_bf16 v[62:77], v[24:27], v[16:19], 0
    v_exp_f32 v46, v46
    v_exp_f32 v47, v47
    v_exp_f32 v48, v48
    v_exp_f32 v49, v49
    v_mfma_f32_32x32x16_bf16 v[94:109], v[34:37], v[42:45], v[94:109]
    s_barrier
    s_mov_b64 exec, s[62:63]
    ds_read_b128 v[34:37], v4 offset:8320
    s_or_b64 exec, -1, 0x70000000
    ds_read_b128 v[24:27], v5 offset:15360
    v_exp_f32 v50, v50
    v_exp_f32 v51, v51
    v_exp_f32 v52, v52
    v_exp_f32 v53, v53
    v_mfma_f32_32x32x8_bf16 v[62:77], v[28:29], v[254:255], v[62:77]
    ds_read_b64 v[28:29], v3 offset:15360
    v_cvt_pk_bf16_f32 v38, v46, v47
    v_cvt_pk_bf16_f32 v39, v48, v49
    v_cvt_pk_bf16_f32 v40, v50, v51
    v_cvt_pk_bf16_f32 v41, v52, v53
    s_add_u32 m0, s41, 65536
    s_add_u32 s42, s39, 65536
    buffer_load_dwordx4 v2, s[4:7], s42 offen sc1 lds
    s_add_u32 m0, s41, 73728
    s_add_u32 s42, s39, 73728
    buffer_load_dwordx4 v2, s[4:7], s42 offen sc1 lds
    s_add_u32 m0, s41, 90112
    s_add_u32 s42, s39, 90112
    buffer_load_dwordx4 v2, s[4:7], s42 offen sc1 lds
    v_exp_f32_e64 v54, v54
    v_exp_f32 v55, v55
    s_waitcnt lgkmcnt(3)
    v_mfma_f32_32x32x16_bf16 v[78:93], v[30:33], v[38:41], v[78:93]
    v_exp_f32 v56, v56
    v_exp_f32 v57, v57
    v_exp_f32 v58, v58
    v_exp_f32 v59, v59
    v_exp_f32_e64 v60, v60
    v_exp_f32 v61, v61
    s_waitcnt lgkmcnt(1)
    v_cvt_pk_bf16_f32 v42, v54, v55
    v_cvt_pk_bf16_f32 v43, v56, v57
    v_cvt_pk_bf16_f32 v44, v58, v59
    v_cvt_pk_bf16_f32 v45, v60, v61
    v_mfma_f32_32x32x16_bf16 v[46:61], v[24:27], v[12:15], 0
    v_exp_f32 v62, v62
    v_exp_f32 v63, v63
    v_exp_f32 v64, v64
    v_exp_f32 v65, v65
    v_mfma_f32_32x32x16_bf16 v[78:93], v[34:37], v[42:45], v[78:93]
    v_exp_f32 v66, v66
    v_exp_f32 v67, v67
    v_exp_f32_e64 v68, v68
    v_exp_f32 v69, v69
    s_waitcnt lgkmcnt(0)
    v_mfma_f32_32x32x8_bf16 v[46:61], v[28:29], v[20:21], v[46:61]
    v_cvt_pk_bf16_f32 v38, v62, v63
    v_cvt_pk_bf16_f32 v39, v64, v65
    v_cvt_pk_bf16_f32 v40, v66, v67
    v_cvt_pk_bf16_f32 v41, v68, v69
    s_add_u32 m0, s41, 98304
    s_add_u32 s42, s39, 98304
    buffer_load_dwordx4 v2, s[4:7], s42 offen sc1 lds
    s_add_u32 m0, s41, 106496
    s_add_u32 s42, s39, 106496
    buffer_load_dwordx4 v2, s[4:7], s42 offen sc1 lds
    s_add_u32 m0, s41, 114688
    s_add_u32 s42, s39, 114688
    buffer_load_dwordx4 v2, s[4:7], s42 offen sc1 lds
    v_exp_f32 v70, v70
    v_exp_f32 v71, v71
    v_mfma_f32_32x32x16_bf16 v[94:109], v[30:33], v[38:41], v[94:109]
    s_andn2_b64 exec, s[62:63], 0x70000000
    ds_read_b128 v[30:33], v4 offset:15360
    s_mov_b64 exec, -1
    v_exp_f32 v72, v72
    v_exp_f32 v73, v73
    v_exp_f32 v74, v74
    v_exp_f32 v75, v75
    v_exp_f32 v76, v76
    v_exp_f32_e64 v77, v77
    v_cvt_pk_bf16_f32 v42, v70, v71
    v_cvt_pk_bf16_f32 v43, v72, v73
    v_cvt_pk_bf16_f32 v44, v74, v75
    v_cvt_pk_bf16_f32 v45, v76, v77
    v_mfma_f32_32x32x16_bf16 v[62:77], v[24:27], v[16:19], 0
    v_exp_f32 v46, v46
    v_exp_f32 v47, v47
    v_exp_f32 v48, v48
    v_exp_f32 v49, v49
    v_mfma_f32_32x32x16_bf16 v[94:109], v[34:37], v[42:45], v[94:109]
    s_andn2_b64 exec, s[62:63], 0x70000000
    ds_read_b128 v[34:37], v4 offset:16000
    s_or_b64 exec, -1, 0x70000000
    ds_read_b128 v[24:27], v5 offset:17920
    v_exp_f32 v50, v50
    v_exp_f32 v51, v51
    v_exp_f32 v52, v52
    v_exp_f32 v53, v53
    v_mfma_f32_32x32x8_bf16 v[62:77], v[28:29], v[22:23], v[62:77]
    v_cvt_pk_bf16_f32 v38, v46, v47
    v_cvt_pk_bf16_f32 v39, v48, v49
    v_cvt_pk_bf16_f32 v40, v50, v51
    v_cvt_pk_bf16_f32 v41, v52, v53
    s_add_u32 m0, s41, 122880
    s_add_u32 s42, s39, 122880
    buffer_load_dwordx4 v2, s[4:7], s42 offen sc1 lds
    s_add_u32 m0, s41, 131072
    s_add_u32 s42, s39, 131072
    buffer_load_dwordx4 v2, s[4:7], s42 offen sc1 lds
    s_add_u32 m0, s41, 139264
    s_add_u32 s42, s39, 139264
    buffer_load_dwordx4 v2, s[4:7], s42 offen sc1 lds
    v_exp_f32_e64 v54, v54
    v_exp_f32 v55, v55
    s_waitcnt lgkmcnt(2)
    v_mfma_f32_32x32x16_bf16 v[78:93], v[30:33], v[38:41], v[78:93]
    v_exp_f32 v56, v56
    v_exp_f32 v57, v57
    v_exp_f32 v58, v58
    v_exp_f32 v59, v59
    v_exp_f32_e64 v60, v60
    v_exp_f32 v61, v61
    s_waitcnt lgkmcnt(0)
    v_cvt_pk_bf16_f32 v42, v54, v55
    v_cvt_pk_bf16_f32 v43, v56, v57
    v_cvt_pk_bf16_f32 v44, v58, v59
    v_cvt_pk_bf16_f32 v45, v60, v61
    v_mfma_f32_32x32x16_bf16 v[46:61], v[24:27], v[12:15], 0
    v_exp_f32 v62, v62
    v_exp_f32 v63, v63
    v_exp_f32 v64, v64
    v_exp_f32 v65, v65
    v_mfma_f32_32x32x16_bf16 v[78:93], v[34:37], v[42:45], v[78:93]
    v_mov_b32_e64 v110, 1
    s_waitcnt vmcnt(10)
    s_mov_b64 exec, 1
    buffer_store_dword v110, off, s[48:51], s99 sc1
    s_mov_b64 exec, -1
    s_setprio 2
    v_exp_f32 v66, v66
    v_exp_f32 v67, v67
    v_exp_f32 v68, v68
    v_exp_f32 v69, v69
    v_mfma_f32_32x32x8_bf16 v[46:61], v[28:29], v[6:7], v[46:61]
    v_cvt_pk_bf16_f32 v38, v62, v63
    v_cvt_pk_bf16_f32 v39, v64, v65
    v_cvt_pk_bf16_f32 v40, v66, v67
    v_cvt_pk_bf16_f32 v41, v68, v69
    s_add_u32 m0, s41, 147456
    s_add_u32 s42, s39, 147456
    buffer_load_dwordx4 v2, s[4:7], s42 offen sc1 lds
    s_add_u32 m0, s41, 155648
    s_add_u32 s42, s39, 155648
    buffer_load_dwordx4 v2, s[4:7], s42 offen sc1 lds
    v_exp_f32 v70, v70
    v_exp_f32 v71, v71
    v_mfma_f32_32x32x16_bf16 v[94:109], v[30:33], v[38:41], v[94:109]
    s_andn2_b64 exec, s[62:63], 0x70000000
    ds_read_b128 v[30:33], v4 offset:17920
    s_mov_b64 exec, -1
    v_exp_f32 v72, v72
    v_exp_f32 v73, v73
    v_exp_f32 v74, v74
    v_exp_f32 v75, v75
    v_exp_f32 v76, v76
    v_exp_f32_e64 v77, v77
    v_cvt_pk_bf16_f32 v42, v70, v71
    v_cvt_pk_bf16_f32 v43, v72, v73
    v_cvt_pk_bf16_f32 v44, v74, v75
    v_cvt_pk_bf16_f32 v45, v76, v77
    v_mfma_f32_32x32x16_bf16 v[62:77], v[24:27], v[16:19], 0
    v_exp_f32 v46, v46
    v_exp_f32 v47, v47
    v_exp_f32 v48, v48
    v_exp_f32 v49, v49
    v_mfma_f32_32x32x16_bf16 v[94:109], v[34:37], v[42:45], v[94:109]
    s_andn2_b64 exec, s[62:63], 0x70000000
    ds_read_b128 v[34:37], v4 offset:18560
    s_or_b64 exec, -1, 0x70000000
    ds_read_b128 v[24:27], v5 offset:25600
    v_exp_f32 v50, v50
    v_exp_f32 v51, v51
    v_exp_f32 v52, v52
    v_exp_f32 v53, v53
    v_mfma_f32_32x32x8_bf16 v[62:77], v[28:29], v[254:255], v[62:77]
    ds_read_b64 v[28:29], v3 offset:25600
    v_cvt_pk_bf16_f32 v38, v46, v47
    v_cvt_pk_bf16_f32 v39, v48, v49
    v_cvt_pk_bf16_f32 v40, v50, v51
    v_cvt_pk_bf16_f32 v41, v52, v53
    v_exp_f32_e64 v54, v54
    v_exp_f32 v55, v55
    s_waitcnt lgkmcnt(3)
    v_mfma_f32_32x32x16_bf16 v[78:93], v[30:33], v[38:41], v[78:93]
    v_exp_f32 v56, v56
    v_exp_f32 v57, v57
    v_exp_f32 v58, v58
    v_exp_f32 v59, v59
    v_exp_f32_e64 v60, v60
    v_exp_f32 v61, v61
    s_waitcnt lgkmcnt(1)
    v_cvt_pk_bf16_f32 v42, v54, v55
    v_cvt_pk_bf16_f32 v43, v56, v57
    v_cvt_pk_bf16_f32 v44, v58, v59
    v_cvt_pk_bf16_f32 v45, v60, v61
    v_mfma_f32_32x32x16_bf16 v[46:61], v[24:27], v[12:15], 0
    v_exp_f32 v62, v62
    v_exp_f32 v63, v63
    v_exp_f32 v64, v64
    v_exp_f32 v65, v65
    v_mfma_f32_32x32x16_bf16 v[78:93], v[34:37], v[42:45], v[78:93]
    v_exp_f32 v66, v66
    v_exp_f32 v67, v67
    v_exp_f32_e64 v68, v68
    v_exp_f32 v69, v69
    s_waitcnt lgkmcnt(0)
    v_mfma_f32_32x32x8_bf16 v[46:61], v[28:29], v[20:21], v[46:61]
    v_cvt_pk_bf16_f32 v38, v62, v63
    v_cvt_pk_bf16_f32 v39, v64, v65
    v_cvt_pk_bf16_f32 v40, v66, v67
    v_cvt_pk_bf16_f32 v41, v68, v69
    v_exp_f32 v70, v70
    v_exp_f32 v71, v71
    v_mfma_f32_32x32x16_bf16 v[94:109], v[30:33], v[38:41], v[94:109]
    s_andn2_b64 exec, s[62:63], 0x70000000
    ds_read_b128 v[30:33], v4 offset:25600
    s_mov_b64 exec, -1
    v_exp_f32 v72, v72
    v_exp_f32 v73, v73
    v_exp_f32 v74, v74
    v_exp_f32 v75, v75
    v_exp_f32 v76, v76
    v_exp_f32_e64 v77, v77
    v_cvt_pk_bf16_f32 v42, v70, v71
    v_cvt_pk_bf16_f32 v43, v72, v73
    v_cvt_pk_bf16_f32 v44, v74, v75
    v_cvt_pk_bf16_f32 v45, v76, v77
    v_mfma_f32_32x32x16_bf16 v[62:77], v[24:27], v[16:19], 0
    v_exp_f32 v46, v46
    v_exp_f32 v47, v47
    v_exp_f32 v48, v48
    v_exp_f32 v49, v49
    v_mfma_f32_32x32x16_bf16 v[94:109], v[34:37], v[42:45], v[94:109]
    s_andn2_b64 exec, s[62:63], 0x70000000
    ds_read_b128 v[34:37], v4 offset:26240
    s_or_b64 exec, -1, 0x70000000
    ds_read_b128 v[24:27], v5 offset:28160
    v_exp_f32 v50, v50
    v_exp_f32 v51, v51
    v_exp_f32 v52, v52
    v_exp_f32 v53, v53
    v_mfma_f32_32x32x8_bf16 v[62:77], v[28:29], v[22:23], v[62:77]
    v_cvt_pk_bf16_f32 v38, v46, v47
    v_cvt_pk_bf16_f32 v39, v48, v49
    v_cvt_pk_bf16_f32 v40, v50, v51
    v_cvt_pk_bf16_f32 v41, v52, v53
    v_exp_f32_e64 v54, v54
    v_exp_f32 v55, v55
    s_waitcnt lgkmcnt(2)
    v_mfma_f32_32x32x16_bf16 v[78:93], v[30:33], v[38:41], v[78:93]
    v_exp_f32 v56, v56
    v_exp_f32 v57, v57
    v_exp_f32 v58, v58
    v_exp_f32 v59, v59
    v_exp_f32_e64 v60, v60
    v_exp_f32 v61, v61
    s_waitcnt lgkmcnt(0)
    v_cvt_pk_bf16_f32 v42, v54, v55
    v_cvt_pk_bf16_f32 v43, v56, v57
    v_cvt_pk_bf16_f32 v44, v58, v59
    v_cvt_pk_bf16_f32 v45, v60, v61
    v_mfma_f32_32x32x16_bf16 v[46:61], v[24:27], v[12:15], 0
    v_exp_f32 v62, v62
    v_exp_f32 v63, v63
    v_exp_f32 v64, v64
    v_exp_f32 v65, v65
    v_mfma_f32_32x32x16_bf16 v[78:93], v[34:37], v[42:45], v[78:93]
    v_exp_f32 v66, v66
    v_exp_f32 v67, v67
    v_exp_f32 v68, v68
    v_exp_f32 v69, v69
    v_mfma_f32_32x32x8_bf16 v[46:61], v[28:29], v[6:7], v[46:61]
    v_cvt_pk_bf16_f32 v38, v62, v63
    v_cvt_pk_bf16_f32 v39, v64, v65
    v_cvt_pk_bf16_f32 v40, v66, v67
    v_cvt_pk_bf16_f32 v41, v68, v69
    v_exp_f32 v70, v70
    v_exp_f32 v71, v71
    v_mfma_f32_32x32x16_bf16 v[94:109], v[30:33], v[38:41], v[94:109]
    s_andn2_b64 exec, s[62:63], 0x70000000
    ds_read_b128 v[30:33], v4 offset:28160
    s_mov_b64 exec, -1
    v_exp_f32 v72, v72
    v_exp_f32 v73, v73
    v_exp_f32 v74, v74
    v_exp_f32 v75, v75
    v_exp_f32 v76, v76
    v_exp_f32_e64 v77, v77
    v_cvt_pk_bf16_f32 v42, v70, v71
    v_cvt_pk_bf16_f32 v43, v72, v73
    v_cvt_pk_bf16_f32 v44, v74, v75
    v_cvt_pk_bf16_f32 v45, v76, v77
    v_mfma_f32_32x32x16_bf16 v[62:77], v[24:27], v[16:19], 0
    v_exp_f32 v46, v46
    v_exp_f32 v47, v47
    v_exp_f32 v48, v48
    v_exp_f32 v49, v49
    v_mfma_f32_32x32x16_bf16 v[94:109], v[34:37], v[42:45], v[94:109]
    s_setprio 1
    s_mov_b64 exec, s[62:63]
    ds_read_b128 v[34:37], v4 offset:28800
    s_or_b64 exec, -1, 0x70000000
    ds_read_b128 v[24:27], v5 offset:35840
    v_exp_f32 v50, v50
    v_exp_f32 v51, v51
    v_exp_f32 v52, v52
    v_exp_f32 v53, v53
    v_mfma_f32_32x32x8_bf16 v[62:77], v[28:29], v[254:255], v[62:77]
    ds_read_b64 v[28:29], v3 offset:35840
    v_cvt_pk_bf16_f32 v38, v46, v47
    v_cvt_pk_bf16_f32 v39, v48, v49
    v_cvt_pk_bf16_f32 v40, v50, v51
    v_cvt_pk_bf16_f32 v41, v52, v53
    v_exp_f32_e64 v54, v54
    v_exp_f32 v55, v55
    s_waitcnt lgkmcnt(3)
    v_mfma_f32_32x32x16_bf16 v[78:93], v[30:33], v[38:41], v[78:93]
    v_exp_f32 v56, v56
    v_exp_f32 v57, v57
    v_exp_f32 v58, v58
    v_exp_f32 v59, v59
    v_exp_f32_e64 v60, v60
    v_exp_f32 v61, v61
    s_waitcnt lgkmcnt(1)
    v_cvt_pk_bf16_f32 v42, v54, v55
    v_cvt_pk_bf16_f32 v43, v56, v57
    v_cvt_pk_bf16_f32 v44, v58, v59
    v_cvt_pk_bf16_f32 v45, v60, v61
    v_mfma_f32_32x32x16_bf16 v[46:61], v[24:27], v[12:15], 0
    v_exp_f32 v62, v62
    v_exp_f32 v63, v63
    v_exp_f32 v64, v64
    v_exp_f32 v65, v65
    v_mfma_f32_32x32x16_bf16 v[78:93], v[34:37], v[42:45], v[78:93]
    v_exp_f32 v66, v66
    v_exp_f32 v67, v67
    v_exp_f32_e64 v68, v68
    v_exp_f32 v69, v69
    s_waitcnt lgkmcnt(0)
    v_mfma_f32_32x32x8_bf16 v[46:61], v[28:29], v[20:21], v[46:61]
    v_cvt_pk_bf16_f32 v38, v62, v63
    v_cvt_pk_bf16_f32 v39, v64, v65
    v_cvt_pk_bf16_f32 v40, v66, v67
    v_cvt_pk_bf16_f32 v41, v68, v69
    v_exp_f32 v70, v70
    v_exp_f32 v71, v71
    v_mfma_f32_32x32x16_bf16 v[94:109], v[30:33], v[38:41], v[94:109]
    s_andn2_b64 exec, s[62:63], 0x70000000
    ds_read_b128 v[30:33], v4 offset:35840
    s_mov_b64 exec, -1
    v_exp_f32 v72, v72
    v_exp_f32 v73, v73
    v_exp_f32 v74, v74
    v_exp_f32 v75, v75
    v_exp_f32 v76, v76
    v_exp_f32_e64 v77, v77
    v_cvt_pk_bf16_f32 v42, v70, v71
    v_cvt_pk_bf16_f32 v43, v72, v73
    v_cvt_pk_bf16_f32 v44, v74, v75
    v_cvt_pk_bf16_f32 v45, v76, v77
    v_mfma_f32_32x32x16_bf16 v[62:77], v[24:27], v[16:19], 0
    v_exp_f32 v46, v46
    v_exp_f32 v47, v47
    v_exp_f32 v48, v48
    v_exp_f32 v49, v49
    v_mfma_f32_32x32x16_bf16 v[94:109], v[34:37], v[42:45], v[94:109]
    s_andn2_b64 exec, s[62:63], 0x70000000
    ds_read_b128 v[34:37], v4 offset:36480
    s_or_b64 exec, -1, 0x70000000
    ds_read_b128 v[24:27], v5 offset:38400
    v_exp_f32 v50, v50
    v_exp_f32 v51, v51
    v_exp_f32 v52, v52
    v_exp_f32 v53, v53
    v_mfma_f32_32x32x8_bf16 v[62:77], v[28:29], v[22:23], v[62:77]
    v_cvt_pk_bf16_f32 v38, v46, v47
    v_cvt_pk_bf16_f32 v39, v48, v49
    v_cvt_pk_bf16_f32 v40, v50, v51
    v_cvt_pk_bf16_f32 v41, v52, v53
    v_exp_f32_e64 v54, v54
    v_exp_f32 v55, v55
    s_waitcnt lgkmcnt(2)
    v_mfma_f32_32x32x16_bf16 v[78:93], v[30:33], v[38:41], v[78:93]
    v_exp_f32 v56, v56
    v_exp_f32 v57, v57
    v_exp_f32 v58, v58
    v_exp_f32 v59, v59
    v_exp_f32_e64 v60, v60
    v_exp_f32 v61, v61
    s_waitcnt lgkmcnt(0)
    v_cvt_pk_bf16_f32 v42, v54, v55
    v_cvt_pk_bf16_f32 v43, v56, v57
    v_cvt_pk_bf16_f32 v44, v58, v59
    v_cvt_pk_bf16_f32 v45, v60, v61
    v_mfma_f32_32x32x16_bf16 v[46:61], v[24:27], v[12:15], 0
    v_exp_f32 v62, v62
    v_exp_f32 v63, v63
    v_exp_f32 v64, v64
    v_exp_f32 v65, v65
    v_mfma_f32_32x32x16_bf16 v[78:93], v[34:37], v[42:45], v[78:93]
    s_setprio 0
    v_exp_f32 v66, v66
    v_exp_f32 v67, v67
    v_exp_f32 v68, v68
    v_exp_f32_e64 v69, v69
    v_mfma_f32_32x32x8_bf16 v[46:61], v[28:29], v[6:7], v[46:61]
    v_cvt_pk_bf16_f32 v38, v62, v63
    v_cvt_pk_bf16_f32 v39, v64, v65
    v_cvt_pk_bf16_f32 v40, v66, v67
    v_cvt_pk_bf16_f32 v41, v68, v69
    v_exp_f32 v70, v70
    v_exp_f32 v71, v71
    v_mfma_f32_32x32x16_bf16 v[94:109], v[30:33], v[38:41], v[94:109]
    s_andn2_b64 exec, s[62:63], 0x70000000
    ds_read_b128 v[30:33], v4 offset:38400
    s_mov_b64 exec, -1
    v_exp_f32 v72, v72
    v_exp_f32 v73, v73
    v_exp_f32 v74, v74
    v_exp_f32 v75, v75
    v_exp_f32 v76, v76
    v_exp_f32_e64 v77, v77
    v_cvt_pk_bf16_f32 v42, v70, v71
    v_cvt_pk_bf16_f32 v43, v72, v73
    v_cvt_pk_bf16_f32 v44, v74, v75
    v_cvt_pk_bf16_f32 v45, v76, v77
    v_mfma_f32_32x32x16_bf16 v[62:77], v[24:27], v[16:19], 0
    v_exp_f32 v46, v46
    v_exp_f32 v47, v47
    v_exp_f32 v48, v48
    v_exp_f32 v49, v49
    v_mfma_f32_32x32x16_bf16 v[94:109], v[34:37], v[42:45], v[94:109]
    s_waitcnt vmcnt(10)
    s_barrier
    s_cmp_lg_u32 s3, 0
    s_cbranch_scc1 g_nab
    s_and_b32 s43, s2, 3
    s_lshl_b32 s43, s43, 6
    v_mov_b32 v111, 1
    s_mov_b64 exec, 1
    buffer_atomic_add v111, off, s[52:55], s43 offset:4 sc1
    s_mov_b64 exec, -1
g_nab:
    s_setprio 3
    s_andn2_b64 exec, s[62:63], 0x70000000
    ds_read_b128 v[34:37], v4 offset:39040
    s_or_b64 exec, -1, 0x70000000
    ds_read_b128 v[24:27], v5 offset:46080
    v_exp_f32 v50, v50
    v_exp_f32 v51, v51
    v_exp_f32 v52, v52
    v_exp_f32 v53, v53
    v_mfma_f32_32x32x8_bf16 v[62:77], v[28:29], v[254:255], v[62:77]
    ds_read_b64 v[28:29], v3 offset:46080
    v_cvt_pk_bf16_f32 v38, v46, v47
    v_cvt_pk_bf16_f32 v39, v48, v49
    v_cvt_pk_bf16_f32 v40, v50, v51
    v_cvt_pk_bf16_f32 v41, v52, v53
    v_exp_f32_e64 v54, v54
    v_exp_f32 v55, v55
    s_waitcnt lgkmcnt(3)
    v_mfma_f32_32x32x16_bf16 v[78:93], v[30:33], v[38:41], v[78:93]
    v_exp_f32 v56, v56
    v_exp_f32 v57, v57
    v_exp_f32 v58, v58
    v_exp_f32 v59, v59
    v_exp_f32_e64 v60, v60
    v_exp_f32 v61, v61
    s_waitcnt lgkmcnt(1)
    v_cvt_pk_bf16_f32 v42, v54, v55
    v_cvt_pk_bf16_f32 v43, v56, v57
    v_cvt_pk_bf16_f32 v44, v58, v59
    v_cvt_pk_bf16_f32 v45, v60, v61
    v_mfma_f32_32x32x16_bf16 v[46:61], v[24:27], v[12:15], 0
    v_exp_f32 v62, v62
    v_exp_f32 v63, v63
    v_exp_f32 v64, v64
    v_exp_f32 v65, v65
    v_mfma_f32_32x32x16_bf16 v[78:93], v[34:37], v[42:45], v[78:93]
    v_exp_f32 v66, v66
    v_exp_f32 v67, v67
    v_exp_f32_e64 v68, v68
    v_exp_f32 v69, v69
    s_waitcnt lgkmcnt(0)
    v_mfma_f32_32x32x8_bf16 v[46:61], v[28:29], v[20:21], v[46:61]
    v_cvt_pk_bf16_f32 v38, v62, v63
    v_cvt_pk_bf16_f32 v39, v64, v65
    v_cvt_pk_bf16_f32 v40, v66, v67
    v_cvt_pk_bf16_f32 v41, v68, v69
    v_exp_f32 v70, v70
    v_exp_f32 v71, v71
    v_mfma_f32_32x32x16_bf16 v[94:109], v[30:33], v[38:41], v[94:109]
    s_andn2_b64 exec, s[62:63], 0x70000000
    ds_read_b128 v[30:33], v4 offset:46080
    s_mov_b64 exec, -1
    v_exp_f32 v72, v72
    v_exp_f32 v73, v73
    v_exp_f32 v74, v74
    v_exp_f32 v75, v75
    v_exp_f32 v76, v76
    v_exp_f32_e64 v77, v77
    v_cvt_pk_bf16_f32 v42, v70, v71
    v_cvt_pk_bf16_f32 v43, v72, v73
    v_cvt_pk_bf16_f32 v44, v74, v75
    v_cvt_pk_bf16_f32 v45, v76, v77
    v_mfma_f32_32x32x16_bf16 v[62:77], v[24:27], v[16:19], 0
    v_exp_f32 v46, v46
    v_exp_f32 v47, v47
    v_exp_f32 v48, v48
    v_exp_f32 v49, v49
    v_mfma_f32_32x32x16_bf16 v[94:109], v[34:37], v[42:45], v[94:109]
    s_andn2_b64 exec, s[62:63], 0x70000000
    ds_read_b128 v[34:37], v4 offset:46720
    s_or_b64 exec, -1, 0x70000000
    ds_read_b128 v[24:27], v5 offset:48640
    v_exp_f32 v50, v50
    v_exp_f32 v51, v51
    v_exp_f32 v52, v52
    v_exp_f32 v53, v53
    v_mfma_f32_32x32x8_bf16 v[62:77], v[28:29], v[22:23], v[62:77]
    v_cvt_pk_bf16_f32 v38, v46, v47
    v_cvt_pk_bf16_f32 v39, v48, v49
    v_cvt_pk_bf16_f32 v40, v50, v51
    v_cvt_pk_bf16_f32 v41, v52, v53
    v_exp_f32_e64 v54, v54
    v_exp_f32 v55, v55
    s_waitcnt lgkmcnt(2)
    v_mfma_f32_32x32x16_bf16 v[78:93], v[30:33], v[38:41], v[78:93]
    v_exp_f32 v56, v56
    v_exp_f32 v57, v57
    v_exp_f32 v58, v58
    v_exp_f32 v59, v59
    v_exp_f32_e64 v60, v60
    v_exp_f32 v61, v61
    s_waitcnt lgkmcnt(0)
    v_cvt_pk_bf16_f32 v42, v54, v55
    v_cvt_pk_bf16_f32 v43, v56, v57
    v_cvt_pk_bf16_f32 v44, v58, v59
    v_cvt_pk_bf16_f32 v45, v60, v61
    v_mfma_f32_32x32x16_bf16 v[46:61], v[24:27], v[12:15], 0
    v_exp_f32 v62, v62
    v_exp_f32 v63, v63
    v_exp_f32 v64, v64
    v_exp_f32 v65, v65
    v_mfma_f32_32x32x16_bf16 v[78:93], v[34:37], v[42:45], v[78:93]
    v_exp_f32 v66, v66
    v_exp_f32 v67, v67
    v_exp_f32 v68, v68
    v_exp_f32 v69, v69
    v_mfma_f32_32x32x8_bf16 v[46:61], v[28:29], v[6:7], v[46:61]
    v_cvt_pk_bf16_f32 v38, v62, v63
    v_cvt_pk_bf16_f32 v39, v64, v65
    v_cvt_pk_bf16_f32 v40, v66, v67
    v_cvt_pk_bf16_f32 v41, v68, v69
    v_exp_f32 v70, v70
    v_exp_f32 v71, v71
    v_mfma_f32_32x32x16_bf16 v[94:109], v[30:33], v[38:41], v[94:109]
    s_andn2_b64 exec, s[62:63], 0x70000000
    ds_read_b128 v[30:33], v4 offset:48640
    s_mov_b64 exec, -1
    v_exp_f32 v72, v72
    v_exp_f32 v73, v73
    v_exp_f32 v74, v74
    v_exp_f32 v75, v75
    v_exp_f32 v76, v76
    v_exp_f32_e64 v77, v77
    v_cvt_pk_bf16_f32 v42, v70, v71
    v_cvt_pk_bf16_f32 v43, v72, v73
    v_cvt_pk_bf16_f32 v44, v74, v75
    v_cvt_pk_bf16_f32 v45, v76, v77
    v_mfma_f32_32x32x16_bf16 v[62:77], v[24:27], v[16:19], 0
    v_exp_f32 v46, v46
    v_exp_f32 v47, v47
    v_exp_f32 v48, v48
    v_exp_f32 v49, v49
    v_mfma_f32_32x32x16_bf16 v[94:109], v[34:37], v[42:45], v[94:109]
    s_andn2_b64 exec, s[62:63], 0x70000000
    ds_read_b128 v[34:37], v4 offset:49280
    s_or_b64 exec, -1, 0x70000000
    ds_read_b128 v[24:27], v5 offset:56320
    v_exp_f32 v50, v50
    v_exp_f32 v51, v51
    v_exp_f32 v52, v52
    v_exp_f32 v53, v53
    v_mfma_f32_32x32x8_bf16 v[62:77], v[28:29], v[254:255], v[62:77]
    ds_read_b64 v[28:29], v3 offset:56320
    v_cvt_pk_bf16_f32 v38, v46, v47
    v_cvt_pk_bf16_f32 v39, v48, v49
    v_cvt_pk_bf16_f32 v40, v50, v51
    v_cvt_pk_bf16_f32 v41, v52, v53
    v_exp_f32_e64 v54, v54
    v_exp_f32 v55, v55
    s_waitcnt lgkmcnt(3)
    v_mfma_f32_32x32x16_bf16 v[78:93], v[30:33], v[38:41], v[78:93]
    v_exp_f32 v56, v56
    v_exp_f32 v57, v57
    v_exp_f32 v58, v58
    v_exp_f32 v59, v59
    v_exp_f32_e64 v60, v60
    v_exp_f32 v61, v61
    s_waitcnt lgkmcnt(1)
    v_cvt_pk_bf16_f32 v42, v54, v55
    v_cvt_pk_bf16_f32 v43, v56, v57
    v_cvt_pk_bf16_f32 v44, v58, v59
    v_cvt_pk_bf16_f32 v45, v60, v61
    v_mfma_f32_32x32x16_bf16 v[46:61], v[24:27], v[12:15], 0
    v_exp_f32 v62, v62
    v_exp_f32 v63, v63
    v_exp_f32 v64, v64
    v_exp_f32 v65, v65
    v_mfma_f32_32x32x16_bf16 v[78:93], v[34:37], v[42:45], v[78:93]
    v_exp_f32 v66, v66
    v_exp_f32 v67, v67
    v_exp_f32_e64 v68, v68
    v_exp_f32 v69, v69
    s_waitcnt lgkmcnt(0)
    v_mfma_f32_32x32x8_bf16 v[46:61], v[28:29], v[20:21], v[46:61]
    v_cvt_pk_bf16_f32 v38, v62, v63
    v_cvt_pk_bf16_f32 v39, v64, v65
    v_cvt_pk_bf16_f32 v40, v66, v67
    v_cvt_pk_bf16_f32 v41, v68, v69
    s_add_u32 s42, s75, 0
    buffer_load_dwordx4 v[110:113], v2, s[68:71], s42 offen sc1
    s_add_u32 s42, s75, 20480
    buffer_load_dwordx4 v[114:117], v2, s[68:71], s42 offen sc1
    v_exp_f32 v70, v70
    v_exp_f32_e64 v71, v71
    v_mfma_f32_32x32x16_bf16 v[94:109], v[30:33], v[38:41], v[94:109]
    s_andn2_b64 exec, s[62:63], 0x70000000
    ds_read_b128 v[30:33], v4 offset:56320
    s_mov_b64 exec, -1
    v_exp_f32 v72, v72
    v_exp_f32 v73, v73
    v_exp_f32 v74, v74
    v_exp_f32 v75, v75
    v_exp_f32 v76, v76
    v_exp_f32_e64 v77, v77
    v_cvt_pk_bf16_f32 v42, v70, v71
    v_cvt_pk_bf16_f32 v43, v72, v73
    v_cvt_pk_bf16_f32 v44, v74, v75
    v_cvt_pk_bf16_f32 v45, v76, v77
    v_mfma_f32_32x32x16_bf16 v[62:77], v[24:27], v[16:19], 0
    v_exp_f32 v46, v46
    v_exp_f32 v47, v47
    v_exp_f32 v48, v48
    v_exp_f32 v49, v49
    v_mfma_f32_32x32x16_bf16 v[94:109], v[34:37], v[42:45], v[94:109]
    s_andn2_b64 exec, s[62:63], 0x70000000
    ds_read_b128 v[34:37], v4 offset:56960
    s_or_b64 exec, -1, 0x70000000
    ds_read_b128 v[24:27], v5 offset:58880
    v_exp_f32 v50, v50
    v_exp_f32 v51, v51
    v_exp_f32 v52, v52
    v_exp_f32 v53, v53
    v_mfma_f32_32x32x8_bf16 v[62:77], v[28:29], v[22:23], v[62:77]
    v_cvt_pk_bf16_f32 v38, v46, v47
    v_cvt_pk_bf16_f32 v39, v48, v49
    v_cvt_pk_bf16_f32 v40, v50, v51
    v_cvt_pk_bf16_f32 v41, v52, v53
    s_add_u32 s42, s75, 40960
    buffer_load_dwordx4 v[118:121], v2, s[68:71], s42 offen sc1
    v_exp_f32_e64 v54, v54
    v_exp_f32 v55, v55
    s_waitcnt lgkmcnt(2)
    v_mfma_f32_32x32x16_bf16 v[78:93], v[30:33], v[38:41], v[78:93]
    v_exp_f32 v56, v56
    v_exp_f32 v57, v57
    v_exp_f32 v58, v58
    v_exp_f32 v59, v59
    v_exp_f32_e64 v60, v60
    v_exp_f32 v61, v61
    s_waitcnt lgkmcnt(0)
    v_cvt_pk_bf16_f32 v42, v54, v55
    v_cvt_pk_bf16_f32 v43, v56, v57
    v_cvt_pk_bf16_f32 v44, v58, v59
    v_cvt_pk_bf16_f32 v45, v60, v61
    v_mfma_f32_32x32x16_bf16 v[46:61], v[24:27], v[12:15], 0
    v_exp_f32 v62, v62
    v_exp_f32 v63, v63
    v_exp_f32 v64, v64
    v_exp_f32 v65, v65
    v_mfma_f32_32x32x16_bf16 v[78:93], v[34:37], v[42:45], v[78:93]
    s_setprio 2
    v_exp_f32 v66, v66
    v_exp_f32 v67, v67
    v_exp_f32 v68, v68
    v_exp_f32_e64 v69, v69
    v_mfma_f32_32x32x8_bf16 v[46:61], v[28:29], v[6:7], v[46:61]
    v_cvt_pk_bf16_f32 v38, v62, v63
    v_cvt_pk_bf16_f32 v39, v64, v65
    v_cvt_pk_bf16_f32 v40, v66, v67
    v_cvt_pk_bf16_f32 v41, v68, v69
    s_add_u32 s42, s75, 61440
    buffer_load_dwordx4 v[122:125], v2, s[68:71], s42 offen sc1
    v_exp_f32 v70, v70
    v_exp_f32 v71, v71
    v_mfma_f32_32x32x16_bf16 v[94:109], v[30:33], v[38:41], v[94:109]
    s_andn2_b64 exec, s[62:63], 0x70000000
    ds_read_b128 v[30:33], v4 offset:58880
    s_mov_b64 exec, -1
    v_exp_f32 v72, v72
    v_exp_f32 v73, v73
    v_exp_f32 v74, v74
    v_exp_f32 v75, v75
    v_exp_f32 v76, v76
    v_exp_f32_e64 v77, v77
    v_cvt_pk_bf16_f32 v42, v70, v71
    v_cvt_pk_bf16_f32 v43, v72, v73
    v_cvt_pk_bf16_f32 v44, v74, v75
    v_cvt_pk_bf16_f32 v45, v76, v77
    v_mfma_f32_32x32x16_bf16 v[62:77], v[24:27], v[16:19], 0
    v_exp_f32 v46, v46
    v_exp_f32 v47, v47
    v_exp_f32 v48, v48
    v_exp_f32 v49, v49
    v_mfma_f32_32x32x16_bf16 v[94:109], v[34:37], v[42:45], v[94:109]
    s_andn2_b64 exec, s[62:63], 0x70000000
    ds_read_b128 v[34:37], v4 offset:59520
    s_or_b64 exec, -1, 0x70000000
    v_add_u32 v5, 61440, v5
    ds_read_b128 v[24:27], v5 offset:5120
    v_exp_f32 v50, v50
    v_exp_f32 v51, v51
    v_exp_f32 v52, v52
    v_exp_f32 v53, v53
    v_mfma_f32_32x32x8_bf16 v[62:77], v[28:29], v[254:255], v[62:77]
    v_add_u32 v3, 61440, v3
    ds_read_b64 v[28:29], v3 offset:5120
    v_cvt_pk_bf16_f32 v38, v46, v47
    v_cvt_pk_bf16_f32 v39, v48, v49
    v_cvt_pk_bf16_f32 v40, v50, v51
    v_cvt_pk_bf16_f32 v41, v52, v53
    s_add_u32 s42, s75, 163840
    buffer_load_dwordx4 v[126:129], v2, s[68:71], s42 offen sc1
    v_exp_f32_e64 v54, v54
    v_exp_f32 v55, v55
    s_waitcnt lgkmcnt(3)
    v_mfma_f32_32x32x16_bf16 v[78:93], v[30:33], v[38:41], v[78:93]
    v_exp_f32 v56, v56
    v_exp_f32 v57, v57
    v_exp_f32 v58, v58
    v_exp_f32 v59, v59
    v_exp_f32_e64 v60, v60
    v_exp_f32 v61, v61
    s_waitcnt lgkmcnt(1)
    v_cvt_pk_bf16_f32 v42, v54, v55
    v_cvt_pk_bf16_f32 v43, v56, v57
    v_cvt_pk_bf16_f32 v44, v58, v59
    v_cvt_pk_bf16_f32 v45, v60, v61
    v_mfma_f32_32x32x16_bf16 v[46:61], v[24:27], v[12:15], 0
    v_exp_f32 v62, v62
    v_exp_f32 v63, v63
    v_exp_f32 v64, v64
    v_exp_f32 v65, v65
    v_mfma_f32_32x32x16_bf16 v[78:93], v[34:37], v[42:45], v[78:93]
    v_exp_f32 v66, v66
    v_exp_f32 v67, v67
    v_exp_f32_e64 v68, v68
    v_exp_f32 v69, v69
    s_waitcnt lgkmcnt(0)
    v_mfma_f32_32x32x8_bf16 v[46:61], v[28:29], v[20:21], v[46:61]
    v_cvt_pk_bf16_f32 v38, v62, v63
    v_cvt_pk_bf16_f32 v39, v64, v65
    v_cvt_pk_bf16_f32 v40, v66, v67
    v_cvt_pk_bf16_f32 v41, v68, v69
    s_add_u32 s42, s75, 204800
    buffer_load_dwordx4 v[130:133], v2, s[68:71], s42 offen sc1
    v_exp_f32 v70, v70
    v_exp_f32 v71, v71
    v_mfma_f32_32x32x16_bf16 v[94:109], v[30:33], v[38:41], v[94:109]
    v_add_u32 v4, 61440, v4
    s_andn2_b64 exec, s[62:63], 0x70000000
    ds_read_b128 v[30:33], v4 offset:5120
    s_mov_b64 exec, -1
    v_exp_f32 v72, v72
    v_exp_f32 v73, v73
    v_exp_f32 v74, v74
    v_exp_f32 v75, v75
    v_exp_f32 v76, v76
    v_exp_f32_e64 v77, v77
    v_cvt_pk_bf16_f32 v42, v70, v71
    v_cvt_pk_bf16_f32 v43, v72, v73
    v_cvt_pk_bf16_f32 v44, v74, v75
    v_cvt_pk_bf16_f32 v45, v76, v77
    v_mfma_f32_32x32x16_bf16 v[62:77], v[24:27], v[16:19], 0
    v_exp_f32 v46, v46
    v_exp_f32 v47, v47
    v_exp_f32 v48, v48
    v_exp_f32 v49, v49
    v_mfma_f32_32x32x16_bf16 v[94:109], v[34:37], v[42:45], v[94:109]
    s_andn2_b64 exec, s[62:63], 0x70000000
    ds_read_b128 v[34:37], v4 offset:5760
    s_or_b64 exec, -1, 0x70000000
    ds_read_b128 v[24:27], v5 offset:7680
    v_exp_f32 v50, v50
    v_exp_f32 v51, v51
    v_exp_f32 v52, v52
    v_exp_f32 v53, v53
    v_mfma_f32_32x32x8_bf16 v[62:77], v[28:29], v[22:23], v[62:77]
    v_cvt_pk_bf16_f32 v38, v46, v47
    v_cvt_pk_bf16_f32 v39, v48, v49
    v_cvt_pk_bf16_f32 v40, v50, v51
    v_cvt_pk_bf16_f32 v41, v52, v53
    s_add_u32 s42, s75, 225280
    buffer_load_dwordx4 v[134:137], v2, s[68:71], s42 offen sc1
    v_exp_f32_e64 v54, v54
    v_exp_f32 v55, v55
    s_waitcnt lgkmcnt(2)
    v_mfma_f32_32x32x16_bf16 v[78:93], v[30:33], v[38:41], v[78:93]
    v_exp_f32 v56, v56
    v_exp_f32 v57, v57
    v_exp_f32 v58, v58
    v_exp_f32 v59, v59
    v_exp_f32_e64 v60, v60
    v_exp_f32 v61, v61
    s_waitcnt lgkmcnt(0)
    v_cvt_pk_bf16_f32 v42, v54, v55
    v_cvt_pk_bf16_f32 v43, v56, v57
    v_cvt_pk_bf16_f32 v44, v58, v59
    v_cvt_pk_bf16_f32 v45, v60, v61
    v_mfma_f32_32x32x16_bf16 v[46:61], v[24:27], v[12:15], 0
    v_exp_f32 v62, v62
    v_exp_f32 v63, v63
    v_exp_f32 v64, v64
    v_exp_f32 v65, v65
    v_mfma_f32_32x32x16_bf16 v[78:93], v[34:37], v[42:45], v[78:93]
    v_exp_f32 v66, v66
    v_exp_f32 v67, v67
    v_exp_f32 v68, v68
    v_exp_f32 v69, v69
    v_mfma_f32_32x32x8_bf16 v[46:61], v[28:29], v[6:7], v[46:61]
    v_cvt_pk_bf16_f32 v38, v62, v63
    v_cvt_pk_bf16_f32 v39, v64, v65
    v_cvt_pk_bf16_f32 v40, v66, v67
    v_cvt_pk_bf16_f32 v41, v68, v69
    s_add_u32 s42, s75, 245760
    buffer_load_dwordx4 v[138:141], v2, s[68:71], s42 offen sc1
    v_exp_f32 v70, v70
    v_exp_f32 v71, v71
    v_mfma_f32_32x32x16_bf16 v[94:109], v[30:33], v[38:41], v[94:109]
    s_andn2_b64 exec, s[62:63], 0x70000000
    ds_read_b128 v[30:33], v4 offset:7680
    s_mov_b64 exec, -1
    v_exp_f32 v72, v72
    v_exp_f32 v73, v73
    v_exp_f32 v74, v74
    v_exp_f32 v75, v75
    v_exp_f32 v76, v76
    v_exp_f32_e64 v77, v77
    v_cvt_pk_bf16_f32 v42, v70, v71
    v_cvt_pk_bf16_f32 v43, v72, v73
    v_cvt_pk_bf16_f32 v44, v74, v75
    v_cvt_pk_bf16_f32 v45, v76, v77
    v_mfma_f32_32x32x16_bf16 v[62:77], v[24:27], v[16:19], 0
    v_exp_f32 v46, v46
    v_exp_f32 v47, v47
    v_exp_f32 v48, v48
    v_exp_f32 v49, v49
    v_mfma_f32_32x32x16_bf16 v[94:109], v[34:37], v[42:45], v[94:109]
    s_setprio 1
    s_mov_b64 exec, s[62:63]
    ds_read_b128 v[34:37], v4 offset:8320
    s_or_b64 exec, -1, 0x70000000
    ds_read_b128 v[24:27], v5 offset:15360
    v_exp_f32 v50, v50
    v_exp_f32 v51, v51
    v_exp_f32 v52, v52
    v_exp_f32 v53, v53
    v_mfma_f32_32x32x8_bf16 v[62:77], v[28:29], v[254:255], v[62:77]
    ds_read_b64 v[28:29], v3 offset:15360
    v_cvt_pk_bf16_f32 v38, v46, v47
    v_cvt_pk_bf16_f32 v39, v48, v49
    v_cvt_pk_bf16_f32 v40, v50, v51
    v_cvt_pk_bf16_f32 v41, v52, v53
    s_add_u32 s42, s75, 266240
    buffer_load_dwordx4 v[142:145], v2, s[68:71], s42 offen sc1
    v_exp_f32_e64 v54, v54
    v_exp_f32 v55, v55
    s_waitcnt lgkmcnt(3)
    v_mfma_f32_32x32x16_bf16 v[78:93], v[30:33], v[38:41], v[78:93]
    v_exp_f32 v56, v56
    v_exp_f32 v57, v57
    v_exp_f32 v58, v58
    v_exp_f32 v59, v59
    v_exp_f32_e64 v60, v60
    v_exp_f32 v61, v61
    s_waitcnt lgkmcnt(1)
    v_cvt_pk_bf16_f32 v42, v54, v55
    v_cvt_pk_bf16_f32 v43, v56, v57
    v_cvt_pk_bf16_f32 v44, v58, v59
    v_cvt_pk_bf16_f32 v45, v60, v61
    v_mfma_f32_32x32x16_bf16 v[46:61], v[24:27], v[12:15], 0
    v_exp_f32 v62, v62
    v_exp_f32 v63, v63
    v_exp_f32 v64, v64
    v_exp_f32 v65, v65
    v_mfma_f32_32x32x16_bf16 v[78:93], v[34:37], v[42:45], v[78:93]
    v_lshlrev_b32 v250, 6, v1
    v_mov_b32 v251, 64
    s_cmp_eq_u32 s3, 0
    s_cselect_b64 exec, 15, 0
    buffer_load_dword v251, v250, s[52:55], 0 offen offset:4 sc1
    s_mov_b64 exec, -1
    v_exp_f32 v66, v66
    v_exp_f32 v67, v67
    v_exp_f32 v68, v68
    v_exp_f32 v69, v69
    s_waitcnt lgkmcnt(0)
    v_mfma_f32_32x32x8_bf16 v[46:61], v[28:29], v[20:21], v[46:61]
    v_cvt_pk_bf16_f32 v38, v62, v63
    v_cvt_pk_bf16_f32 v39, v64, v65
    v_cvt_pk_bf16_f32 v40, v66, v67
    v_cvt_pk_bf16_f32 v41, v68, v69
    s_add_u32 s42, s75, 368640
    buffer_load_dwordx4 v[146:149], v2, s[68:71], s42 offen sc1
    v_exp_f32 v70, v70
    v_exp_f32 v71, v71
    v_mfma_f32_32x32x16_bf16 v[94:109], v[30:33], v[38:41], v[94:109]
    s_andn2_b64 exec, s[62:63], 0x70000000
    ds_read_b128 v[30:33], v4 offset:15360
    s_mov_b64 exec, -1
    v_exp_f32 v72, v72
    v_exp_f32 v73, v73
    v_exp_f32 v74, v74
    v_exp_f32 v75, v75
    v_exp_f32 v76, v76
    v_exp_f32_e64 v77, v77
    v_cvt_pk_bf16_f32 v42, v70, v71
    v_cvt_pk_bf16_f32 v43, v72, v73
    v_cvt_pk_bf16_f32 v44, v74, v75
    v_cvt_pk_bf16_f32 v45, v76, v77
    v_mfma_f32_32x32x16_bf16 v[62:77], v[24:27], v[16:19], 0
    v_exp_f32 v46, v46
    v_exp_f32 v47, v47
    v_exp_f32 v48, v48
    v_exp_f32 v49, v49
    v_mfma_f32_32x32x16_bf16 v[94:109], v[34:37], v[42:45], v[94:109]
    s_andn2_b64 exec, s[62:63], 0x70000000
    ds_read_b128 v[34:37], v4 offset:16000
    s_or_b64 exec, -1, 0x70000000
    ds_read_b128 v[24:27], v5 offset:17920
    v_exp_f32 v50, v50
    v_exp_f32 v51, v51
    v_exp_f32 v52, v52
    v_exp_f32 v53, v53
    v_mfma_f32_32x32x8_bf16 v[62:77], v[28:29], v[22:23], v[62:77]
    v_cvt_pk_bf16_f32 v38, v46, v47
    v_cvt_pk_bf16_f32 v39, v48, v49
    v_cvt_pk_bf16_f32 v40, v50, v51
    v_cvt_pk_bf16_f32 v41, v52, v53
    s_add_u32 s42, s75, 409600
    buffer_load_dwordx4 v[150:153], v2, s[68:71], s42 offen sc1
    v_exp_f32_e64 v54, v54
    v_exp_f32 v55, v55
    s_waitcnt lgkmcnt(2)
    v_mfma_f32_32x32x16_bf16 v[78:93], v[30:33], v[38:41], v[78:93]
    v_exp_f32 v56, v56
    v_exp_f32 v57, v57
    v_exp_f32 v58, v58
    v_exp_f32 v59, v59
    v_exp_f32_e64 v60, v60
    v_exp_f32 v61, v61
    s_waitcnt lgkmcnt(0)
    v_cvt_pk_bf16_f32 v42, v54, v55
    v_cvt_pk_bf16_f32 v43, v56, v57
    v_cvt_pk_bf16_f32 v44, v58, v59
    v_cvt_pk_bf16_f32 v45, v60, v61
    v_mfma_f32_32x32x16_bf16 v[46:61], v[24:27], v[12:15], 0
    v_exp_f32 v62, v62
    v_exp_f32 v63, v63
    v_exp_f32 v64, v64
    v_exp_f32 v65, v65
    v_mfma_f32_32x32x16_bf16 v[78:93], v[34:37], v[42:45], v[78:93]
    s_setprio 0
    v_exp_f32 v66, v66
    v_exp_f32 v67, v67
    v_exp_f32 v68, v68
    v_exp_f32_e64 v69, v69
    v_mfma_f32_32x32x8_bf16 v[46:61], v[28:29], v[6:7], v[46:61]
    v_cvt_pk_bf16_f32 v38, v62, v63
    v_cvt_pk_bf16_f32 v39, v64, v65
    v_cvt_pk_bf16_f32 v40, v66, v67
    v_cvt_pk_bf16_f32 v41, v68, v69
    s_add_u32 s42, s75, 430080
    buffer_load_dwordx4 v[154:157], v2, s[68:71], s42 offen sc1
    v_exp_f32 v70, v70
    v_exp_f32 v71, v71
    v_mfma_f32_32x32x16_bf16 v[94:109], v[30:33], v[38:41], v[94:109]
    s_andn2_b64 exec, s[62:63], 0x70000000
    ds_read_b128 v[30:33], v4 offset:17920
    s_mov_b64 exec, -1
    v_exp_f32 v72, v72
    v_exp_f32 v73, v73
    v_exp_f32 v74, v74
    v_exp_f32 v75, v75
    v_exp_f32 v76, v76
    v_exp_f32_e64 v77, v77
    v_cvt_pk_bf16_f32 v42, v70, v71
    v_cvt_pk_bf16_f32 v43, v72, v73
    v_cvt_pk_bf16_f32 v44, v74, v75
    v_cvt_pk_bf16_f32 v45, v76, v77
    v_mfma_f32_32x32x16_bf16 v[62:77], v[24:27], v[16:19], 0
    v_exp_f32 v46, v46
    v_exp_f32 v47, v47
    v_exp_f32 v48, v48
    v_exp_f32 v49, v49
    v_mfma_f32_32x32x16_bf16 v[94:109], v[34:37], v[42:45], v[94:109]
    s_waitcnt vmcnt(3)
g_cb:
    v_cmp_ne_u32 vcc, 64, v251
    s_cbranch_vccnz g_cbr
g_cbok:
    s_barrier
    s_setprio 3
    s_mov_b64 exec, s[62:63]
    ds_read_b128 v[34:37], v4 offset:18560
    s_or_b64 exec, -1, 0x70000000
    ds_read_b128 v[24:27], v5 offset:25600
    v_exp_f32 v50, v50
    v_exp_f32 v51, v51
    v_exp_f32 v52, v52
    v_exp_f32 v53, v53
    v_mfma_f32_32x32x8_bf16 v[62:77], v[28:29], v[254:255], v[62:77]
    ds_read_b64 v[28:29], v3 offset:25600
    v_cvt_pk_bf16_f32 v38, v46, v47
    v_cvt_pk_bf16_f32 v39, v48, v49
    v_cvt_pk_bf16_f32 v40, v50, v51
    v_cvt_pk_bf16_f32 v41, v52, v53
    s_add_u32 s52, s34, 20185088
    s_addc_u32 s53, s35, 0
    s_mov_b32 s54, 8192
    s_mov_b32 s55, 0x00020000
    v_lshlrev_b32_e64 v11, 2, v8
    s_lshl_b32 s42, s38, 7
    buffer_load_dword v9, v11, s[52:55], s42 offen sc1
    s_lshr_b32 s43, s37, 3
    s_mul_i32 s43, s43, 10
    s_mul_i32 s42, s38, 40
    s_add_u32 s43, s43, s42
    s_and_b32 s44, s37, 7
    s_add_u32 s42, s43, s44
    s_lshl_b32 s89, s42, 10
    s_lshl_b32 s43, s43, 10
    s_lshl_b32 s44, s44, 8
    s_add_u32 s43, s43, s44
    s_add_u32 s90, s43, 8192
    s_mul_i32 s94, s74, 10240
    s_mul_i32 s91, s45, 40960
    s_add_u32 s88, s91, s94
    s_mul_i32 s42, s46, 320
    s_add_u32 s91, s91, s42
    s_lshl_b32 s42, s74, 6
    s_add_u32 s91, s91, s42
    s_mov_b32 s8, s30
    s_mov_b32 s9, s31
    s_mov_b32 s10, 2621440
    s_mov_b32 s11, 0x00020000
    s_mov_b32 s92, 3
    s_mov_b32 s93, 0
    s_lshl_b32 s42, s74, 12
    s_add_u32 s42, s42, 81920
    v_add_u32 v10, s42, v2
    v_lshlrev_b32 v11, 3, v1
    v_lshlrev_b32 v8, 7, v1
    v_add_u32 v8, 8192, v8
    v_add_u32 v0, s94, v2
    v_mov_b32 v250, -1
    v_mov_b32 v251, -1
    v_mov_b32 v252, -1
    v_mov_b32 v253, -1
    v_exp_f32 v54, v54
    v_exp_f32 v55, v55
    s_waitcnt lgkmcnt(3)
    v_mfma_f32_32x32x16_bf16 v[78:93], v[30:33], v[38:41], v[78:93]
    v_exp_f32 v56, v56
    v_exp_f32 v57, v57
    v_exp_f32 v58, v58
    v_exp_f32 v59, v59
    v_exp_f32_e64 v60, v60
    v_exp_f32 v61, v61
    s_waitcnt lgkmcnt(1)
    v_cvt_pk_bf16_f32 v42, v54, v55
    v_cvt_pk_bf16_f32 v43, v56, v57
    v_cvt_pk_bf16_f32 v44, v58, v59
    v_cvt_pk_bf16_f32 v45, v60, v61
    v_mfma_f32_32x32x16_bf16 v[46:61], v[24:27], v[12:15], 0
    v_exp_f32 v62, v62
    v_exp_f32 v63, v63
    v_exp_f32 v64, v64
    v_exp_f32 v65, v65
    v_mfma_f32_32x32x16_bf16 v[78:93], v[34:37], v[42:45], v[78:93]
    v_exp_f32 v66, v66
    v_exp_f32 v67, v67
    v_exp_f32_e64 v68, v68
    v_exp_f32 v69, v69
    s_waitcnt lgkmcnt(0)
    v_mfma_f32_32x32x8_bf16 v[46:61], v[28:29], v[20:21], v[46:61]
    v_cvt_pk_bf16_f32 v38, v62, v63
    v_cvt_pk_bf16_f32 v39, v64, v65
    v_cvt_pk_bf16_f32 v40, v66, v67
    v_cvt_pk_bf16_f32 v41, v68, v69
    s_add_u32 s42, s75, 450560
    buffer_load_dwordx4 v[158:161], v2, s[68:71], s42 offen sc1
    v_exp_f32 v70, v70
    v_exp_f32 v71, v71
    v_mfma_f32_32x32x16_bf16 v[94:109], v[30:33], v[38:41], v[94:109]
    s_andn2_b64 exec, s[62:63], 0x70000000
    ds_read_b128 v[30:33], v4 offset:25600
    s_mov_b64 exec, -1
    v_exp_f32 v72, v72
    v_exp_f32 v73, v73
    v_exp_f32 v74, v74
    v_exp_f32 v75, v75
    v_exp_f32 v76, v76
    v_exp_f32_e64 v77, v77
    v_cvt_pk_bf16_f32 v42, v70, v71
    v_cvt_pk_bf16_f32 v43, v72, v73
    v_cvt_pk_bf16_f32 v44, v74, v75
    v_cvt_pk_bf16_f32 v45, v76, v77
    v_mfma_f32_32x32x16_bf16 v[62:77], v[24:27], v[16:19], 0
    v_exp_f32 v46, v46
    v_exp_f32 v47, v47
    v_exp_f32 v48, v48
    v_exp_f32 v49, v49
    v_mfma_f32_32x32x16_bf16 v[94:109], v[34:37], v[42:45], v[94:109]
    s_andn2_b64 exec, s[62:63], 0x70000000
    ds_read_b128 v[34:37], v4 offset:26240
    s_or_b64 exec, -1, 0x70000000
    ds_read_b128 v[24:27], v5 offset:28160
    v_exp_f32 v50, v50
    v_exp_f32 v51, v51
    v_exp_f32 v52, v52
    v_exp_f32 v53, v53
    v_mfma_f32_32x32x8_bf16 v[62:77], v[28:29], v[22:23], v[62:77]
    v_cvt_pk_bf16_f32 v38, v46, v47
    v_cvt_pk_bf16_f32 v39, v48, v49
    v_cvt_pk_bf16_f32 v40, v50, v51
    v_cvt_pk_bf16_f32 v41, v52, v53
    s_add_u32 s42, s75, 471040
    buffer_load_dwordx4 v[162:165], v2, s[68:71], s42 offen sc1
    ds_write_b128 v0, v[250:253] offset:0
    ds_write_b128 v0, v[250:253] offset:1024
    v_exp_f32_e64 v54, v54
    v_exp_f32 v55, v55
    s_waitcnt lgkmcnt(4)
    v_mfma_f32_32x32x16_bf16 v[78:93], v[30:33], v[38:41], v[78:93]
    v_exp_f32 v56, v56
    v_exp_f32 v57, v57
    v_exp_f32 v58, v58
    v_exp_f32 v59, v59
    v_exp_f32_e64 v60, v60
    v_exp_f32 v61, v61
    s_waitcnt lgkmcnt(0)
    v_cvt_pk_bf16_f32 v42, v54, v55
    v_cvt_pk_bf16_f32 v43, v56, v57
    v_cvt_pk_bf16_f32 v44, v58, v59
    v_cvt_pk_bf16_f32 v45, v60, v61
    v_mfma_f32_32x32x16_bf16 v[46:61], v[24:27], v[12:15], 0
    v_exp_f32 v62, v62
    v_exp_f32 v63, v63
    v_exp_f32 v64, v64
    v_exp_f32 v65, v65
    v_mfma_f32_32x32x16_bf16 v[78:93], v[34:37], v[42:45], v[78:93]
    v_exp_f32 v66, v66
    v_exp_f32 v67, v67
    v_exp_f32 v68, v68
    v_exp_f32 v69, v69
    v_mfma_f32_32x32x8_bf16 v[46:61], v[28:29], v[6:7], v[46:61]
    v_cvt_pk_bf16_f32 v38, v62, v63
    v_cvt_pk_bf16_f32 v39, v64, v65
    v_cvt_pk_bf16_f32 v40, v66, v67
    v_cvt_pk_bf16_f32 v41, v68, v69
    s_add_u32 s42, s75, 573440
    buffer_load_dwordx4 v[166:169], v2, s[68:71], s42 offen sc1
    v_exp_f32 v70, v70
    v_exp_f32 v71, v71
    v_mfma_f32_32x32x16_bf16 v[94:109], v[30:33], v[38:41], v[94:109]
    s_andn2_b64 exec, s[62:63], 0x70000000
    ds_read_b128 v[30:33], v4 offset:28160
    s_mov_b64 exec, -1
    v_exp_f32 v72, v72
    v_exp_f32 v73, v73
    v_exp_f32 v74, v74
    v_exp_f32 v75, v75
    v_exp_f32 v76, v76
    v_exp_f32_e64 v77, v77
    v_cvt_pk_bf16_f32 v42, v70, v71
    v_cvt_pk_bf16_f32 v43, v72, v73
    v_cvt_pk_bf16_f32 v44, v74, v75
    v_cvt_pk_bf16_f32 v45, v76, v77
    v_mfma_f32_32x32x16_bf16 v[62:77], v[24:27], v[16:19], 0
    v_exp_f32 v46, v46
    v_exp_f32 v47, v47
    v_exp_f32 v48, v48
    v_exp_f32 v49, v49
    v_mfma_f32_32x32x16_bf16 v[94:109], v[34:37], v[42:45], v[94:109]
    s_andn2_b64 exec, s[62:63], 0x70000000
    ds_read_b128 v[34:37], v4 offset:28800
    s_or_b64 exec, -1, 0x70000000
    ds_read_b128 v[24:27], v5 offset:35840
    v_exp_f32 v50, v50
    v_exp_f32 v51, v51
    v_exp_f32 v52, v52
    v_exp_f32 v53, v53
    v_mfma_f32_32x32x8_bf16 v[62:77], v[28:29], v[254:255], v[62:77]
    ds_read_b64 v[28:29], v3 offset:35840
    v_cvt_pk_bf16_f32 v38, v46, v47
    v_cvt_pk_bf16_f32 v39, v48, v49
    v_cvt_pk_bf16_f32 v40, v50, v51
    v_cvt_pk_bf16_f32 v41, v52, v53
    s_add_u32 s42, s75, 614400
    buffer_load_dwordx4 v[170:173], v2, s[68:71], s42 offen sc1
    v_exp_f32_e64 v54, v54
    v_exp_f32 v55, v55
    s_waitcnt lgkmcnt(3)
    v_mfma_f32_32x32x16_bf16 v[78:93], v[30:33], v[38:41], v[78:93]
    v_exp_f32 v56, v56
    v_exp_f32 v57, v57
    v_exp_f32 v58, v58
    v_exp_f32 v59, v59
    v_exp_f32_e64 v60, v60
    v_exp_f32 v61, v61
    s_waitcnt lgkmcnt(1)
    v_cvt_pk_bf16_f32 v42, v54, v55
    v_cvt_pk_bf16_f32 v43, v56, v57
    v_cvt_pk_bf16_f32 v44, v58, v59
    v_cvt_pk_bf16_f32 v45, v60, v61
    v_mfma_f32_32x32x16_bf16 v[46:61], v[24:27], v[12:15], 0
    v_exp_f32 v62, v62
    v_exp_f32 v63, v63
    v_exp_f32 v64, v64
    v_exp_f32 v65, v65
    v_mfma_f32_32x32x16_bf16 v[78:93], v[34:37], v[42:45], v[78:93]
    v_exp_f32 v66, v66
    v_exp_f32 v67, v67
    v_exp_f32_e64 v68, v68
    v_exp_f32 v69, v69
    s_waitcnt lgkmcnt(0)
    v_mfma_f32_32x32x8_bf16 v[46:61], v[28:29], v[20:21], v[46:61]
    v_cvt_pk_bf16_f32 v38, v62, v63
    v_cvt_pk_bf16_f32 v39, v64, v65
    v_cvt_pk_bf16_f32 v40, v66, v67
    v_cvt_pk_bf16_f32 v41, v68, v69
    s_add_u32 s42, s75, 634880
    buffer_load_dwordx4 v[174:177], v2, s[68:71], s42 offen sc1
    v_exp_f32 v70, v70
    v_exp_f32 v71, v71
    v_mfma_f32_32x32x16_bf16 v[94:109], v[30:33], v[38:41], v[94:109]
    s_andn2_b64 exec, s[62:63], 0x70000000
    ds_read_b128 v[30:33], v4 offset:35840
    s_mov_b64 exec, -1
    v_exp_f32 v72, v72
    v_exp_f32 v73, v73
    v_exp_f32 v74, v74
    v_exp_f32 v75, v75
    v_exp_f32 v76, v76
    v_exp_f32_e64 v77, v77
    v_cvt_pk_bf16_f32 v42, v70, v71
    v_cvt_pk_bf16_f32 v43, v72, v73
    v_cvt_pk_bf16_f32 v44, v74, v75
    v_cvt_pk_bf16_f32 v45, v76, v77
    v_mfma_f32_32x32x16_bf16 v[62:77], v[24:27], v[16:19], 0
    v_exp_f32 v46, v46
    v_exp_f32 v47, v47
    v_exp_f32 v48, v48
    v_exp_f32 v49, v49
    v_mfma_f32_32x32x16_bf16 v[94:109], v[34:37], v[42:45], v[94:109]
    s_andn2_b64 exec, s[62:63], 0x70000000
    ds_read_b128 v[34:37], v4 offset:36480
    s_or_b64 exec, -1, 0x70000000
    ds_read_b128 v[24:27], v5 offset:38400
    v_exp_f32 v50, v50
    v_exp_f32 v51, v51
    v_exp_f32 v52, v52
    v_exp_f32 v53, v53
    v_mfma_f32_32x32x8_bf16 v[62:77], v[28:29], v[22:23], v[62:77]
    v_cvt_pk_bf16_f32 v38, v46, v47
    v_cvt_pk_bf16_f32 v39, v48, v49
    v_cvt_pk_bf16_f32 v40, v50, v51
    v_cvt_pk_bf16_f32 v41, v52, v53
    s_add_u32 s42, s75, 655360
    buffer_load_dwordx4 v[178:181], v2, s[68:71], s42 offen sc1
    ds_write_b128 v0, v[250:253] offset:2048
    ds_write_b128 v0, v[250:253] offset:3072
    v_exp_f32_e64 v54, v54
    v_exp_f32 v55, v55
    s_waitcnt lgkmcnt(4)
    v_mfma_f32_32x32x16_bf16 v[78:93], v[30:33], v[38:41], v[78:93]
    v_exp_f32 v56, v56
    v_exp_f32 v57, v57
    v_exp_f32 v58, v58
    v_exp_f32 v59, v59
    v_exp_f32_e64 v60, v60
    v_exp_f32 v61, v61
    s_waitcnt lgkmcnt(0)
    v_cvt_pk_bf16_f32 v42, v54, v55
    v_cvt_pk_bf16_f32 v43, v56, v57
    v_cvt_pk_bf16_f32 v44, v58, v59
    v_cvt_pk_bf16_f32 v45, v60, v61
    v_mfma_f32_32x32x16_bf16 v[46:61], v[24:27], v[12:15], 0
    v_exp_f32 v62, v62
    v_exp_f32 v63, v63
    v_exp_f32 v64, v64
    v_exp_f32 v65, v65
    v_mfma_f32_32x32x16_bf16 v[78:93], v[34:37], v[42:45], v[78:93]
    s_setprio 2
    v_exp_f32 v66, v66
    v_exp_f32 v67, v67
    v_exp_f32 v68, v68
    v_exp_f32_e64 v69, v69
    v_mfma_f32_32x32x8_bf16 v[46:61], v[28:29], v[6:7], v[46:61]
    v_cvt_pk_bf16_f32 v38, v62, v63
    v_cvt_pk_bf16_f32 v39, v64, v65
    v_cvt_pk_bf16_f32 v40, v66, v67
    v_cvt_pk_bf16_f32 v41, v68, v69
    s_add_u32 s42, s75, 675840
    buffer_load_dwordx4 v[182:185], v2, s[68:71], s42 offen sc1
    v_exp_f32 v70, v70
    v_exp_f32 v71, v71
    v_mfma_f32_32x32x16_bf16 v[94:109], v[30:33], v[38:41], v[94:109]
    s_andn2_b64 exec, s[62:63], 0x70000000
    ds_read_b128 v[30:33], v4 offset:38400
    s_mov_b64 exec, -1
    v_exp_f32 v72, v72
    v_exp_f32 v73, v73
    v_exp_f32 v74, v74
    v_exp_f32 v75, v75
    v_exp_f32 v76, v76
    v_exp_f32_e64 v77, v77
    v_cvt_pk_bf16_f32 v42, v70, v71
    v_cvt_pk_bf16_f32 v43, v72, v73
    v_cvt_pk_bf16_f32 v44, v74, v75
    v_cvt_pk_bf16_f32 v45, v76, v77
    v_mfma_f32_32x32x16_bf16 v[62:77], v[24:27], v[16:19], 0
    v_exp_f32 v46, v46
    v_exp_f32 v47, v47
    v_exp_f32 v48, v48
    v_exp_f32 v49, v49
    v_mfma_f32_32x32x16_bf16 v[94:109], v[34:37], v[42:45], v[94:109]
    s_andn2_b64 exec, s[62:63], 0x70000000
    ds_read_b128 v[34:37], v4 offset:39040
    s_or_b64 exec, -1, 0x70000000
    ds_read_b128 v[24:27], v5 offset:46080
    v_exp_f32 v50, v50
    v_exp_f32 v51, v51
    v_exp_f32 v52, v52
    v_exp_f32 v53, v53
    v_mfma_f32_32x32x8_bf16 v[62:77], v[28:29], v[254:255], v[62:77]
    ds_read_b64 v[28:29], v3 offset:46080
    v_cvt_pk_bf16_f32 v38, v46, v47
    v_cvt_pk_bf16_f32 v39, v48, v49
    v_cvt_pk_bf16_f32 v40, v50, v51
    v_cvt_pk_bf16_f32 v41, v52, v53
    s_add_u32 s42, s75, 778240
    buffer_load_dwordx4 v[186:189], v2, s[68:71], s42 offen sc1
    v_exp_f32_e64 v54, v54
    v_exp_f32 v55, v55
    s_waitcnt lgkmcnt(3)
    v_mfma_f32_32x32x16_bf16 v[78:93], v[30:33], v[38:41], v[78:93]
    v_exp_f32 v56, v56
    v_exp_f32 v57, v57
    v_exp_f32 v58, v58
    v_exp_f32 v59, v59
    v_exp_f32_e64 v60, v60
    v_exp_f32 v61, v61
    s_waitcnt lgkmcnt(1)
    v_cvt_pk_bf16_f32 v42, v54, v55
    v_cvt_pk_bf16_f32 v43, v56, v57
    v_cvt_pk_bf16_f32 v44, v58, v59
    v_cvt_pk_bf16_f32 v45, v60, v61
    v_mfma_f32_32x32x16_bf16 v[46:61], v[24:27], v[12:15], 0
    v_exp_f32 v62, v62
    v_exp_f32 v63, v63
    v_exp_f32 v64, v64
    v_exp_f32 v65, v65
    v_mfma_f32_32x32x16_bf16 v[78:93], v[34:37], v[42:45], v[78:93]
    v_exp_f32 v66, v66
    v_exp_f32 v67, v67
    v_exp_f32_e64 v68, v68
    v_exp_f32 v69, v69
    s_waitcnt lgkmcnt(0)
    v_mfma_f32_32x32x8_bf16 v[46:61], v[28:29], v[20:21], v[46:61]
    v_cvt_pk_bf16_f32 v38, v62, v63
    v_cvt_pk_bf16_f32 v39, v64, v65
    v_cvt_pk_bf16_f32 v40, v66, v67
    v_cvt_pk_bf16_f32 v41, v68, v69
    s_add_u32 s42, s75, 81920
    buffer_load_dwordx4 v[190:193], v2, s[68:71], s42 offen sc1
    v_exp_f32 v70, v70
    v_exp_f32 v71, v71
    v_mfma_f32_32x32x16_bf16 v[94:109], v[30:33], v[38:41], v[94:109]
    s_andn2_b64 exec, s[62:63], 0x70000000
    ds_read_b128 v[30:33], v4 offset:46080
    s_mov_b64 exec, -1
    v_exp_f32 v72, v72
    v_exp_f32 v73, v73
    v_exp_f32 v74, v74
    v_exp_f32 v75, v75
    v_exp_f32 v76, v76
    v_exp_f32_e64 v77, v77
    v_cvt_pk_bf16_f32 v42, v70, v71
    v_cvt_pk_bf16_f32 v43, v72, v73
    v_cvt_pk_bf16_f32 v44, v74, v75
    v_cvt_pk_bf16_f32 v45, v76, v77
    v_mfma_f32_32x32x16_bf16 v[62:77], v[24:27], v[16:19], 0
    v_exp_f32 v46, v46
    v_exp_f32 v47, v47
    v_exp_f32 v48, v48
    v_exp_f32 v49, v49
    v_mfma_f32_32x32x16_bf16 v[94:109], v[34:37], v[42:45], v[94:109]
    s_andn2_b64 exec, s[62:63], 0x70000000
    ds_read_b128 v[34:37], v4 offset:46720
    s_or_b64 exec, -1, 0x70000000
    ds_read_b128 v[24:27], v5 offset:48640
    v_exp_f32 v50, v50
    v_exp_f32 v51, v51
    v_exp_f32 v52, v52
    v_exp_f32 v53, v53
    v_mfma_f32_32x32x8_bf16 v[62:77], v[28:29], v[22:23], v[62:77]
    v_cvt_pk_bf16_f32 v38, v46, v47
    v_cvt_pk_bf16_f32 v39, v48, v49
    v_cvt_pk_bf16_f32 v40, v50, v51
    v_cvt_pk_bf16_f32 v41, v52, v53
    s_add_u32 s42, s75, 102400
    buffer_load_dwordx4 v[194:197], v2, s[68:71], s42 offen sc1
    ds_write_b128 v0, v[250:253] offset:4096
    ds_write_b128 v0, v[250:253] offset:5120
    v_exp_f32_e64 v54, v54
    v_exp_f32 v55, v55
    s_waitcnt lgkmcnt(4)
    v_mfma_f32_32x32x16_bf16 v[78:93], v[30:33], v[38:41], v[78:93]
    v_exp_f32 v56, v56
    v_exp_f32 v57, v57
    v_exp_f32 v58, v58
    v_exp_f32 v59, v59
    v_exp_f32_e64 v60, v60
    v_exp_f32 v61, v61
    s_waitcnt lgkmcnt(0)
    v_cvt_pk_bf16_f32 v42, v54, v55
    v_cvt_pk_bf16_f32 v43, v56, v57
    v_cvt_pk_bf16_f32 v44, v58, v59
    v_cvt_pk_bf16_f32 v45, v60, v61
    v_mfma_f32_32x32x16_bf16 v[46:61], v[24:27], v[12:15], 0
    v_exp_f32 v62, v62
    v_exp_f32 v63, v63
    v_exp_f32 v64, v64
    v_exp_f32 v65, v65
    v_mfma_f32_32x32x16_bf16 v[78:93], v[34:37], v[42:45], v[78:93]
    v_exp_f32 v66, v66
    v_exp_f32 v67, v67
    v_exp_f32 v68, v68
    v_exp_f32 v69, v69
    v_mfma_f32_32x32x8_bf16 v[46:61], v[28:29], v[6:7], v[46:61]
    v_cvt_pk_bf16_f32 v38, v62, v63
    v_cvt_pk_bf16_f32 v39, v64, v65
    v_cvt_pk_bf16_f32 v40, v66, v67
    v_cvt_pk_bf16_f32 v41, v68, v69
    s_add_u32 s42, s75, 122880
    buffer_load_dwordx4 v[198:201], v2, s[68:71], s42 offen sc1
    v_exp_f32 v70, v70
    v_exp_f32 v71, v71
    v_mfma_f32_32x32x16_bf16 v[94:109], v[30:33], v[38:41], v[94:109]
    s_andn2_b64 exec, s[62:63], 0x70000000
    ds_read_b128 v[30:33], v4 offset:48640
    s_mov_b64 exec, -1
    v_exp_f32 v72, v72
    v_exp_f32 v73, v73
    v_exp_f32 v74, v74
    v_exp_f32 v75, v75
    v_exp_f32 v76, v76
    v_exp_f32_e64 v77, v77
    v_cvt_pk_bf16_f32 v42, v70, v71
    v_cvt_pk_bf16_f32 v43, v72, v73
    v_cvt_pk_bf16_f32 v44, v74, v75
    v_cvt_pk_bf16_f32 v45, v76, v77
    v_mfma_f32_32x32x16_bf16 v[62:77], v[24:27], v[16:19], 0
    v_exp_f32 v46, v46
    v_exp_f32 v47, v47
    v_exp_f32 v48, v48
    v_exp_f32 v49, v49
    v_mfma_f32_32x32x16_bf16 v[94:109], v[34:37], v[42:45], v[94:109]
    s_setprio 1
    s_mov_b64 exec, s[62:63]
    ds_read_b128 v[34:37], v4 offset:49280
    s_or_b64 exec, -1, 0x70000000
    ds_read_b128 v[24:27], v5 offset:56320
    v_exp_f32 v50, v50
    v_exp_f32 v51, v51
    v_exp_f32 v52, v52
    v_exp_f32 v53, v53
    v_mfma_f32_32x32x8_bf16 v[62:77], v[28:29], v[254:255], v[62:77]
    ds_read_b64 v[28:29], v3 offset:56320
    v_cvt_pk_bf16_f32 v38, v46, v47
    v_cvt_pk_bf16_f32 v39, v48, v49
    v_cvt_pk_bf16_f32 v40, v50, v51
    v_cvt_pk_bf16_f32 v41, v52, v53
    s_add_u32 s42, s75, 143360
    buffer_load_dwordx4 v[202:205], v2, s[68:71], s42 offen sc1
    v_exp_f32_e64 v54, v54
    v_exp_f32 v55, v55
    s_waitcnt lgkmcnt(3)
    v_mfma_f32_32x32x16_bf16 v[78:93], v[30:33], v[38:41], v[78:93]
    v_exp_f32 v56, v56
    v_exp_f32 v57, v57
    v_exp_f32 v58, v58
    v_exp_f32 v59, v59
    v_exp_f32_e64 v60, v60
    v_exp_f32 v61, v61
    s_waitcnt lgkmcnt(1)
    v_cvt_pk_bf16_f32 v42, v54, v55
    v_cvt_pk_bf16_f32 v43, v56, v57
    v_cvt_pk_bf16_f32 v44, v58, v59
    v_cvt_pk_bf16_f32 v45, v60, v61
    v_mfma_f32_32x32x16_bf16 v[46:61], v[24:27], v[12:15], 0
    v_exp_f32 v62, v62
    v_exp_f32 v63, v63
    v_exp_f32 v64, v64
    v_exp_f32 v65, v65
    v_mfma_f32_32x32x16_bf16 v[78:93], v[34:37], v[42:45], v[78:93]
    v_exp_f32 v66, v66
    v_exp_f32 v67, v67
    v_exp_f32_e64 v68, v68
    v_exp_f32 v69, v69
    s_waitcnt lgkmcnt(0)
    v_mfma_f32_32x32x8_bf16 v[46:61], v[28:29], v[20:21], v[46:61]
    v_cvt_pk_bf16_f32 v38, v62, v63
    v_cvt_pk_bf16_f32 v39, v64, v65
    v_cvt_pk_bf16_f32 v40, v66, v67
    v_cvt_pk_bf16_f32 v41, v68, v69
    s_add_u32 s42, s75, 184320
    buffer_load_dwordx4 v[206:209], v2, s[68:71], s42 offen sc1
    v_exp_f32 v70, v70
    v_exp_f32 v71, v71
    v_mfma_f32_32x32x16_bf16 v[94:109], v[30:33], v[38:41], v[94:109]
    s_andn2_b64 exec, s[62:63], 0x70000000
    ds_read_b128 v[30:33], v4 offset:56320
    s_mov_b64 exec, -1
    v_exp_f32 v72, v72
    v_exp_f32 v73, v73
    v_exp_f32 v74, v74
    v_exp_f32 v75, v75
    v_exp_f32 v76, v76
    v_exp_f32_e64 v77, v77
    v_cvt_pk_bf16_f32 v42, v70, v71
    v_cvt_pk_bf16_f32 v43, v72, v73
    v_cvt_pk_bf16_f32 v44, v74, v75
    v_cvt_pk_bf16_f32 v45, v76, v77
    v_mfma_f32_32x32x16_bf16 v[62:77], v[24:27], v[16:19], 0
    v_exp_f32 v46, v46
    v_exp_f32 v47, v47
    v_exp_f32 v48, v48
    v_exp_f32 v49, v49
    v_mfma_f32_32x32x16_bf16 v[94:109], v[34:37], v[42:45], v[94:109]
    s_andn2_b64 exec, s[62:63], 0x70000000
    ds_read_b128 v[34:37], v4 offset:56960
    s_or_b64 exec, -1, 0x70000000
    ds_read_b128 v[24:27], v5 offset:58880
    v_exp_f32 v50, v50
    v_exp_f32 v51, v51
    v_exp_f32 v52, v52
    v_exp_f32 v53, v53
    v_mfma_f32_32x32x8_bf16 v[62:77], v[28:29], v[22:23], v[62:77]
    v_cvt_pk_bf16_f32 v38, v46, v47
    v_cvt_pk_bf16_f32 v39, v48, v49
    v_cvt_pk_bf16_f32 v40, v50, v51
    v_cvt_pk_bf16_f32 v41, v52, v53
    s_add_u32 s42, s75, 286720
    buffer_load_dwordx4 v[210:213], v2, s[68:71], s42 offen sc1
    ds_write_b128 v0, v[250:253] offset:6144
    ds_write_b128 v0, v[250:253] offset:7168
    v_exp_f32_e64 v54, v54
    v_exp_f32 v55, v55
    s_waitcnt lgkmcnt(4)
    v_mfma_f32_32x32x16_bf16 v[78:93], v[30:33], v[38:41], v[78:93]
    v_exp_f32 v56, v56
    v_exp_f32 v57, v57
    v_exp_f32 v58, v58
    v_exp_f32 v59, v59
    v_exp_f32_e64 v60, v60
    v_exp_f32 v61, v61
    s_waitcnt lgkmcnt(0)
    v_cvt_pk_bf16_f32 v42, v54, v55
    v_cvt_pk_bf16_f32 v43, v56, v57
    v_cvt_pk_bf16_f32 v44, v58, v59
    v_cvt_pk_bf16_f32 v45, v60, v61
    v_mfma_f32_32x32x16_bf16 v[46:61], v[24:27], v[12:15], 0
    v_exp_f32 v62, v62
    v_exp_f32 v63, v63
    v_exp_f32 v64, v64
    v_exp_f32 v65, v65
    v_mfma_f32_32x32x16_bf16 v[78:93], v[34:37], v[42:45], v[78:93]
    s_setprio 0
    v_exp_f32 v66, v66
    v_exp_f32 v67, v67
    v_exp_f32 v68, v68
    v_exp_f32_e64 v69, v69
    v_mfma_f32_32x32x8_bf16 v[46:61], v[28:29], v[6:7], v[46:61]
    v_cvt_pk_bf16_f32 v38, v62, v63
    v_cvt_pk_bf16_f32 v39, v64, v65
    v_cvt_pk_bf16_f32 v40, v66, v67
    v_cvt_pk_bf16_f32 v41, v68, v69
    s_add_u32 s42, s75, 307200
    buffer_load_dwordx4 v[214:217], v2, s[68:71], s42 offen sc1
    v_exp_f32 v70, v70
    v_exp_f32 v71, v71
    v_mfma_f32_32x32x16_bf16 v[94:109], v[30:33], v[38:41], v[94:109]
    s_andn2_b64 exec, s[62:63], 0x70000000
    ds_read_b128 v[30:33], v4 offset:58880
    s_mov_b64 exec, -1
    v_exp_f32 v72, v72
    v_exp_f32 v73, v73
    v_exp_f32 v74, v74
    v_exp_f32 v75, v75
    v_exp_f32 v76, v76
    v_exp_f32_e64 v77, v77
    v_cvt_pk_bf16_f32 v42, v70, v71
    v_cvt_pk_bf16_f32 v43, v72, v73
    v_cvt_pk_bf16_f32 v44, v74, v75
    v_cvt_pk_bf16_f32 v45, v76, v77
    v_mfma_f32_32x32x16_bf16 v[62:77], v[24:27], v[16:19], 0
    v_exp_f32 v46, v46
    v_exp_f32 v47, v47
    v_exp_f32 v48, v48
    v_exp_f32 v49, v49
    v_mfma_f32_32x32x16_bf16 v[94:109], v[34:37], v[42:45], v[94:109]
    s_waitcnt vmcnt(15)
    s_barrier
    s_setprio 3
    s_mov_b64 exec, s[62:63]
    ds_read_b128 v[34:37], v4 offset:59520
    s_or_b64 exec, -1, 0x70000000
    v_add_u32 v5, 61440, v5
    ds_read_b128 v[24:27], v5 offset:5120
    v_exp_f32 v50, v50
    v_exp_f32 v51, v51
    v_exp_f32 v52, v52
    v_exp_f32 v53, v53
    v_mfma_f32_32x32x8_bf16 v[62:77], v[28:29], v[254:255], v[62:77]
    v_add_u32 v3, 61440, v3
    ds_read_b64 v[28:29], v3 offset:5120
    v_cvt_pk_bf16_f32 v38, v46, v47
    v_cvt_pk_bf16_f32 v39, v48, v49
    v_cvt_pk_bf16_f32 v40, v50, v51
    v_cvt_pk_bf16_f32 v41, v52, v53
    s_add_u32 s42, s75, 327680
    buffer_load_dwordx4 v[218:221], v2, s[68:71], s42 offen sc1
    v_exp_f32_e64 v54, v54
    v_exp_f32 v55, v55
    s_waitcnt lgkmcnt(3)
    v_mfma_f32_32x32x16_bf16 v[78:93], v[30:33], v[38:41], v[78:93]
    v_exp_f32 v56, v56
    v_exp_f32 v57, v57
    v_exp_f32 v58, v58
    v_exp_f32 v59, v59
    v_exp_f32_e64 v60, v60
    v_exp_f32 v61, v61
    s_waitcnt lgkmcnt(1)
    v_cvt_pk_bf16_f32 v42, v54, v55
    v_cvt_pk_bf16_f32 v43, v56, v57
    v_cvt_pk_bf16_f32 v44, v58, v59
    v_cvt_pk_bf16_f32 v45, v60, v61
    v_mfma_f32_32x32x16_bf16 v[46:61], v[24:27], v[12:15], 0
    v_exp_f32 v62, v62
    v_exp_f32 v63, v63
    v_exp_f32 v64, v64
    v_exp_f32 v65, v65
    v_mfma_f32_32x32x16_bf16 v[78:93], v[34:37], v[42:45], v[78:93]
    v_exp_f32 v66, v66
    v_exp_f32 v67, v67
    v_exp_f32_e64 v68, v68
    v_exp_f32 v69, v69
    s_waitcnt lgkmcnt(0)
    v_mfma_f32_32x32x8_bf16 v[46:61], v[28:29], v[20:21], v[46:61]
    v_cvt_pk_bf16_f32 v38, v62, v63
    v_cvt_pk_bf16_f32 v39, v64, v65
    v_cvt_pk_bf16_f32 v40, v66, v67
    v_cvt_pk_bf16_f32 v41, v68, v69
    s_add_u32 s42, s75, 348160
    buffer_load_dwordx4 v[222:225], v2, s[68:71], s42 offen sc1
    v_exp_f32 v70, v70
    v_exp_f32 v71, v71
    v_mfma_f32_32x32x16_bf16 v[94:109], v[30:33], v[38:41], v[94:109]
    v_add_u32 v4, 61440, v4
    s_andn2_b64 exec, s[62:63], 0x70000000
    ds_read_b128 v[30:33], v4 offset:5120
    s_mov_b64 exec, -1
    v_exp_f32 v72, v72
    v_exp_f32 v73, v73
    v_exp_f32 v74, v74
    v_exp_f32 v75, v75
    v_exp_f32 v76, v76
    v_exp_f32_e64 v77, v77
    v_cvt_pk_bf16_f32 v42, v70, v71
    v_cvt_pk_bf16_f32 v43, v72, v73
    v_cvt_pk_bf16_f32 v44, v74, v75
    v_cvt_pk_bf16_f32 v45, v76, v77
    v_mfma_f32_32x32x16_bf16 v[62:77], v[24:27], v[16:19], 0
    v_exp_f32 v46, v46
    v_exp_f32 v47, v47
    v_exp_f32 v48, v48
    v_exp_f32 v49, v49
    v_mfma_f32_32x32x16_bf16 v[94:109], v[34:37], v[42:45], v[94:109]
    s_andn2_b64 exec, s[62:63], 0x70000000
    ds_read_b128 v[34:37], v4 offset:5760
    s_or_b64 exec, -1, 0x70000000
    ds_read_b128 v[24:27], v5 offset:7680
    v_exp_f32 v50, v50
    v_exp_f32 v51, v51
    v_exp_f32 v52, v52
    v_exp_f32 v53, v53
    v_mfma_f32_32x32x8_bf16 v[62:77], v[28:29], v[22:23], v[62:77]
    v_cvt_pk_bf16_f32 v38, v46, v47
    v_cvt_pk_bf16_f32 v39, v48, v49
    v_cvt_pk_bf16_f32 v40, v50, v51
    v_cvt_pk_bf16_f32 v41, v52, v53
    s_add_u32 s42, s75, 389120
    buffer_load_dwordx4 v[226:229], v2, s[68:71], s42 offen sc1
    ds_write_b128 v0, v[250:253] offset:8192
    ds_write_b128 v0, v[250:253] offset:9216
    v_exp_f32_e64 v54, v54
    v_exp_f32 v55, v55
    s_waitcnt lgkmcnt(4)
    v_mfma_f32_32x32x16_bf16 v[78:93], v[30:33], v[38:41], v[78:93]
    v_exp_f32 v56, v56
    v_exp_f32 v57, v57
    v_exp_f32 v58, v58
    v_exp_f32 v59, v59
    v_exp_f32_e64 v60, v60
    v_exp_f32 v61, v61
    s_waitcnt lgkmcnt(0)
    v_cvt_pk_bf16_f32 v42, v54, v55
    v_cvt_pk_bf16_f32 v43, v56, v57
    v_cvt_pk_bf16_f32 v44, v58, v59
    v_cvt_pk_bf16_f32 v45, v60, v61
    v_mfma_f32_32x32x16_bf16 v[46:61], v[24:27], v[12:15], 0
    v_exp_f32 v62, v62
    v_exp_f32 v63, v63
    v_exp_f32 v64, v64
    v_exp_f32 v65, v65
    v_mfma_f32_32x32x16_bf16 v[78:93], v[34:37], v[42:45], v[78:93]
    v_exp_f32 v66, v66
    v_exp_f32 v67, v67
    v_exp_f32 v68, v68
    v_exp_f32 v69, v69
    v_mfma_f32_32x32x8_bf16 v[46:61], v[28:29], v[6:7], v[46:61]
    v_cvt_pk_bf16_f32 v38, v62, v63
    v_cvt_pk_bf16_f32 v39, v64, v65
    v_cvt_pk_bf16_f32 v40, v66, v67
    v_cvt_pk_bf16_f32 v41, v68, v69
    s_add_u32 s42, s75, 491520
    buffer_load_dwordx4 v[230:233], v2, s[68:71], s42 offen sc1
    v_exp_f32 v70, v70
    v_exp_f32 v71, v71
    v_mfma_f32_32x32x16_bf16 v[94:109], v[30:33], v[38:41], v[94:109]
    s_andn2_b64 exec, s[62:63], 0x70000000
    ds_read_b128 v[30:33], v4 offset:7680
    s_mov_b64 exec, -1
    v_exp_f32 v72, v72
    v_exp_f32 v73, v73
    v_exp_f32 v74, v74
    v_exp_f32 v75, v75
    v_exp_f32 v76, v76
    v_exp_f32_e64 v77, v77
    v_cvt_pk_bf16_f32 v42, v70, v71
    v_cvt_pk_bf16_f32 v43, v72, v73
    v_cvt_pk_bf16_f32 v44, v74, v75
    v_cvt_pk_bf16_f32 v45, v76, v77
    v_mfma_f32_32x32x16_bf16 v[62:77], v[24:27], v[16:19], 0
    v_exp_f32 v46, v46
    v_exp_f32 v47, v47
    v_exp_f32 v48, v48
    v_exp_f32 v49, v49
    v_mfma_f32_32x32x16_bf16 v[94:109], v[34:37], v[42:45], v[94:109]
    s_andn2_b64 exec, s[62:63], 0x70000000
    ds_read_b128 v[34:37], v4 offset:8320
    s_or_b64 exec, -1, 0x70000000
    ds_read_b128 v[24:27], v5 offset:15360
    v_exp_f32 v50, v50
    v_exp_f32 v51, v51
    v_exp_f32 v52, v52
    v_exp_f32 v53, v53
    v_mfma_f32_32x32x8_bf16 v[62:77], v[28:29], v[254:255], v[62:77]
    ds_read_b64 v[28:29], v3 offset:15360
    v_cvt_pk_bf16_f32 v38, v46, v47
    v_cvt_pk_bf16_f32 v39, v48, v49
    v_cvt_pk_bf16_f32 v40, v50, v51
    v_cvt_pk_bf16_f32 v41, v52, v53
    s_add_u32 s42, s75, 512000
    buffer_load_dwordx4 v[234:237], v2, s[68:71], s42 offen sc1
    v_exp_f32_e64 v54, v54
    v_exp_f32 v55, v55
    s_waitcnt lgkmcnt(3)
    v_mfma_f32_32x32x16_bf16 v[78:93], v[30:33], v[38:41], v[78:93]
    v_exp_f32 v56, v56
    v_exp_f32 v57, v57
    v_exp_f32 v58, v58
    v_exp_f32 v59, v59
    v_exp_f32_e64 v60, v60
    v_exp_f32 v61, v61
    s_waitcnt lgkmcnt(1)
    v_cvt_pk_bf16_f32 v42, v54, v55
    v_cvt_pk_bf16_f32 v43, v56, v57
    v_cvt_pk_bf16_f32 v44, v58, v59
    v_cvt_pk_bf16_f32 v45, v60, v61
    v_mfma_f32_32x32x16_bf16 v[46:61], v[24:27], v[12:15], 0
    v_exp_f32 v62, v62
    v_exp_f32 v63, v63
    v_exp_f32 v64, v64
    v_exp_f32 v65, v65
    v_mfma_f32_32x32x16_bf16 v[78:93], v[34:37], v[42:45], v[78:93]
    v_exp_f32 v66, v66
    v_exp_f32 v67, v67
    v_exp_f32_e64 v68, v68
    v_exp_f32 v69, v69
    s_waitcnt lgkmcnt(0)
    v_mfma_f32_32x32x8_bf16 v[46:61], v[28:29], v[20:21], v[46:61]
    v_cvt_pk_bf16_f32 v38, v62, v63
    v_cvt_pk_bf16_f32 v39, v64, v65
    v_cvt_pk_bf16_f32 v40, v66, v67
    v_cvt_pk_bf16_f32 v41, v68, v69
    s_add_u32 s42, s75, 532480
    buffer_load_dwordx4 v[238:241], v2, s[68:71], s42 offen sc1
    v_exp_f32 v70, v70
    v_exp_f32 v71, v71
    v_mfma_f32_32x32x16_bf16 v[94:109], v[30:33], v[38:41], v[94:109]
    s_andn2_b64 exec, s[62:63], 0x70000000
    ds_read_b128 v[30:33], v4 offset:15360
    s_mov_b64 exec, -1
    v_exp_f32 v72, v72
    v_exp_f32 v73, v73
    v_exp_f32 v74, v74
    v_exp_f32 v75, v75
    v_exp_f32 v76, v76
    v_exp_f32_e64 v77, v77
    v_cvt_pk_bf16_f32 v42, v70, v71
    v_cvt_pk_bf16_f32 v43, v72, v73
    v_cvt_pk_bf16_f32 v44, v74, v75
    v_cvt_pk_bf16_f32 v45, v76, v77
    v_mfma_f32_32x32x16_bf16 v[62:77], v[24:27], v[16:19], 0
    v_exp_f32 v46, v46
    v_exp_f32 v47, v47
    v_exp_f32 v48, v48
    v_exp_f32 v49, v49
    v_mfma_f32_32x32x16_bf16 v[94:109], v[34:37], v[42:45], v[94:109]
    s_andn2_b64 exec, s[62:63], 0x70000000
    ds_read_b128 v[34:37], v4 offset:16000
    s_or_b64 exec, -1, 0x70000000
    ds_read_b128 v[24:27], v5 offset:17920
    v_exp_f32 v50, v50
    v_exp_f32 v51, v51
    v_exp_f32 v52, v52
    v_exp_f32 v53, v53
    v_mfma_f32_32x32x8_bf16 v[62:77], v[28:29], v[22:23], v[62:77]
    v_cvt_pk_bf16_f32 v38, v46, v47
    v_cvt_pk_bf16_f32 v39, v48, v49
    v_cvt_pk_bf16_f32 v40, v50, v51
    v_cvt_pk_bf16_f32 v41, v52, v53
    s_add_u32 s42, s75, 552960
    buffer_load_dwordx4 v[242:245], v2, s[68:71], s42 offen sc1
    v_exp_f32_e64 v54, v54
    v_exp_f32 v55, v55
    s_waitcnt lgkmcnt(2)
    v_mfma_f32_32x32x16_bf16 v[78:93], v[30:33], v[38:41], v[78:93]
    v_exp_f32 v56, v56
    v_exp_f32 v57, v57
    v_exp_f32 v58, v58
    v_exp_f32 v59, v59
    v_exp_f32_e64 v60, v60
    v_exp_f32 v61, v61
    s_waitcnt lgkmcnt(0)
    v_cvt_pk_bf16_f32 v42, v54, v55
    v_cvt_pk_bf16_f32 v43, v56, v57
    v_cvt_pk_bf16_f32 v44, v58, v59
    v_cvt_pk_bf16_f32 v45, v60, v61
    v_mfma_f32_32x32x16_bf16 v[46:61], v[24:27], v[12:15], 0
    v_exp_f32 v62, v62
    v_exp_f32 v63, v63
    v_exp_f32 v64, v64
    v_exp_f32 v65, v65
    v_mfma_f32_32x32x16_bf16 v[78:93], v[34:37], v[42:45], v[78:93]
    v_exp_f32 v66, v66
    v_exp_f32 v67, v67
    v_exp_f32 v68, v68
    v_exp_f32 v69, v69
    v_mfma_f32_32x32x8_bf16 v[46:61], v[28:29], v[6:7], v[46:61]
    v_cvt_pk_bf16_f32 v38, v62, v63
    v_cvt_pk_bf16_f32 v39, v64, v65
    v_cvt_pk_bf16_f32 v40, v66, v67
    v_cvt_pk_bf16_f32 v41, v68, v69
    s_add_u32 s42, s75, 593920
    buffer_load_dwordx4 v[246:249], v2, s[68:71], s42 offen sc1
    v_exp_f32 v70, v70
    v_exp_f32 v71, v71
    v_mfma_f32_32x32x16_bf16 v[94:109], v[30:33], v[38:41], v[94:109]
    s_andn2_b64 exec, s[62:63], 0x70000000
    ds_read_b128 v[30:33], v4 offset:17920
    s_mov_b64 exec, -1
    v_exp_f32 v72, v72
    v_exp_f32 v73, v73
    v_exp_f32 v74, v74
    v_exp_f32 v75, v75
    v_exp_f32 v76, v76
    v_exp_f32_e64 v77, v77
    v_cvt_pk_bf16_f32 v42, v70, v71
    v_cvt_pk_bf16_f32 v43, v72, v73
    v_cvt_pk_bf16_f32 v44, v74, v75
    v_cvt_pk_bf16_f32 v45, v76, v77
    v_mfma_f32_32x32x16_bf16 v[62:77], v[24:27], v[16:19], 0
    v_exp_f32 v46, v46
    v_exp_f32 v47, v47
    v_exp_f32 v48, v48
    v_exp_f32 v49, v49
    v_mfma_f32_32x32x16_bf16 v[94:109], v[34:37], v[42:45], v[94:109]
    s_andn2_b64 exec, s[62:63], 0x70000000
    ds_read_b128 v[34:37], v4 offset:18560
    s_or_b64 exec, -1, 0x70000000
    ds_read_b128 v[24:27], v5 offset:25600
    v_exp_f32 v50, v50
    v_exp_f32 v51, v51
    v_exp_f32 v52, v52
    v_exp_f32 v53, v53
    v_mfma_f32_32x32x8_bf16 v[62:77], v[28:29], v[254:255], v[62:77]
    ds_read_b64 v[28:29], v3 offset:25600
    v_cvt_pk_bf16_f32 v38, v46, v47
    v_cvt_pk_bf16_f32 v39, v48, v49
    v_cvt_pk_bf16_f32 v40, v50, v51
    v_cvt_pk_bf16_f32 v41, v52, v53
    s_add_u32 s42, s75, 696320
    buffer_load_dwordx4 v[250:253], v2, s[68:71], s42 offen sc1
    v_exp_f32_e64 v54, v54
    v_exp_f32 v55, v55
    s_waitcnt lgkmcnt(3)
    v_mfma_f32_32x32x16_bf16 v[78:93], v[30:33], v[38:41], v[78:93]
    v_exp_f32 v56, v56
    v_exp_f32 v57, v57
    v_exp_f32 v58, v58
    v_exp_f32 v59, v59
    v_exp_f32_e64 v60, v60
    v_exp_f32 v61, v61
    s_waitcnt lgkmcnt(1)
    v_cvt_pk_bf16_f32 v42, v54, v55
    v_cvt_pk_bf16_f32 v43, v56, v57
    v_cvt_pk_bf16_f32 v44, v58, v59
    v_cvt_pk_bf16_f32 v45, v60, v61
    v_mfma_f32_32x32x16_bf16 v[46:61], v[24:27], v[12:15], 0
    v_exp_f32 v62, v62
    v_exp_f32 v63, v63
    v_exp_f32 v64, v64
    v_exp_f32 v65, v65
    v_mfma_f32_32x32x16_bf16 v[78:93], v[34:37], v[42:45], v[78:93]
    s_setprio 2
    v_exp_f32 v66, v66
    v_exp_f32 v67, v67
    v_exp_f32 v68, v68
    v_exp_f32 v69, v69
    s_waitcnt lgkmcnt(0)
    v_mfma_f32_32x32x8_bf16 v[46:61], v[28:29], v[20:21], v[46:61]
    v_cvt_pk_bf16_f32 v38, v62, v63
    v_cvt_pk_bf16_f32 v39, v64, v65
    v_cvt_pk_bf16_f32 v40, v66, v67
    v_cvt_pk_bf16_f32 v41, v68, v69
    v_exp_f32 v70, v70
    v_exp_f32 v71, v71
    v_mfma_f32_32x32x16_bf16 v[94:109], v[30:33], v[38:41], v[94:109]
    s_andn2_b64 exec, s[62:63], 0x70000000
    ds_read_b128 v[30:33], v4 offset:25600
    s_mov_b64 exec, -1
    v_exp_f32 v72, v72
    v_exp_f32 v73, v73
    v_exp_f32 v74, v74
    v_exp_f32 v75, v75
    v_exp_f32 v76, v76
    v_exp_f32_e64 v77, v77
    v_cvt_pk_bf16_f32 v42, v70, v71
    v_cvt_pk_bf16_f32 v43, v72, v73
    v_cvt_pk_bf16_f32 v44, v74, v75
    v_cvt_pk_bf16_f32 v45, v76, v77
    v_mfma_f32_32x32x16_bf16 v[62:77], v[24:27], v[16:19], 0
    v_exp_f32 v46, v46
    v_exp_f32 v47, v47
    v_exp_f32 v48, v48
    v_exp_f32 v49, v49
    v_mfma_f32_32x32x16_bf16 v[94:109], v[34:37], v[42:45], v[94:109]
    s_andn2_b64 exec, s[62:63], 0x70000000
    ds_read_b128 v[34:37], v4 offset:26240
    s_or_b64 exec, -1, 0x70000000
    ds_read_b128 v[24:27], v5 offset:28160
    v_exp_f32 v50, v50
    v_exp_f32 v51, v51
    v_exp_f32 v52, v52
    v_exp_f32 v53, v53
    v_mfma_f32_32x32x8_bf16 v[62:77], v[28:29], v[22:23], v[62:77]
    v_cvt_pk_bf16_f32 v38, v46, v47
    v_cvt_pk_bf16_f32 v39, v48, v49
    v_cvt_pk_bf16_f32 v40, v50, v51
    v_cvt_pk_bf16_f32 v41, v52, v53
    v_exp_f32_e64 v54, v54
    v_exp_f32 v55, v55
    s_waitcnt lgkmcnt(2)
    v_mfma_f32_32x32x16_bf16 v[78:93], v[30:33], v[38:41], v[78:93]
    v_exp_f32 v56, v56
    v_exp_f32 v57, v57
    v_exp_f32 v58, v58
    v_exp_f32 v59, v59
    v_exp_f32_e64 v60, v60
    v_exp_f32 v61, v61
    s_waitcnt lgkmcnt(0)
    v_cvt_pk_bf16_f32 v42, v54, v55
    v_cvt_pk_bf16_f32 v43, v56, v57
    v_cvt_pk_bf16_f32 v44, v58, v59
    v_cvt_pk_bf16_f32 v45, v60, v61
    v_mfma_f32_32x32x16_bf16 v[46:61], v[24:27], v[12:15], 0
    v_exp_f32 v62, v62
    v_exp_f32 v63, v63
    v_exp_f32 v64, v64
    v_exp_f32 v65, v65
    v_mfma_f32_32x32x16_bf16 v[78:93], v[34:37], v[42:45], v[78:93]
    v_exp_f32 v66, v66
    v_exp_f32 v67, v67
    v_exp_f32 v68, v68
    v_exp_f32 v69, v69
    v_mfma_f32_32x32x8_bf16 v[46:61], v[28:29], v[6:7], v[46:61]
    v_cvt_pk_bf16_f32 v38, v62, v63
    v_cvt_pk_bf16_f32 v39, v64, v65
    v_cvt_pk_bf16_f32 v40, v66, v67
    v_cvt_pk_bf16_f32 v41, v68, v69
    v_exp_f32 v70, v70
    v_exp_f32 v71, v71
    v_mfma_f32_32x32x16_bf16 v[94:109], v[30:33], v[38:41], v[94:109]
    s_andn2_b64 exec, s[62:63], 0x70000000
    ds_read_b128 v[30:33], v4 offset:28160
    s_mov_b64 exec, -1
    v_exp_f32 v72, v72
    v_exp_f32 v73, v73
    v_exp_f32 v74, v74
    v_exp_f32 v75, v75
    v_exp_f32 v76, v76
    v_exp_f32_e64 v77, v77
    v_cvt_pk_bf16_f32 v42, v70, v71
    v_cvt_pk_bf16_f32 v43, v72, v73
    v_cvt_pk_bf16_f32 v44, v74, v75
    v_cvt_pk_bf16_f32 v45, v76, v77
    v_mfma_f32_32x32x16_bf16 v[62:77], v[24:27], v[16:19], 0
    v_exp_f32 v46, v46
    v_exp_f32 v47, v47
    v_exp_f32 v48, v48
    v_exp_f32 v49, v49
    v_mfma_f32_32x32x16_bf16 v[94:109], v[34:37], v[42:45], v[94:109]
    s_andn2_b64 exec, s[62:63], 0x70000000
    ds_read_b128 v[34:37], v4 offset:28800
    s_or_b64 exec, -1, 0x70000000
    ds_read_b128 v[24:27], v5 offset:35840
    v_exp_f32 v50, v50
    v_exp_f32 v51, v51
    v_exp_f32 v52, v52
    v_exp_f32 v53, v53
    v_mfma_f32_32x32x8_bf16 v[62:77], v[28:29], v[254:255], v[62:77]
    ds_read_b64 v[28:29], v3 offset:35840
    v_cvt_pk_bf16_f32 v38, v46, v47
    v_cvt_pk_bf16_f32 v39, v48, v49
    v_cvt_pk_bf16_f32 v40, v50, v51
    v_cvt_pk_bf16_f32 v41, v52, v53
    v_exp_f32_e64 v54, v54
    v_exp_f32 v55, v55
    s_waitcnt lgkmcnt(3)
    v_mfma_f32_32x32x16_bf16 v[78:93], v[30:33], v[38:41], v[78:93]
    v_exp_f32 v56, v56
    v_exp_f32 v57, v57
    v_exp_f32 v58, v58
    v_exp_f32 v59, v59
    v_exp_f32_e64 v60, v60
    v_exp_f32 v61, v61
    s_waitcnt lgkmcnt(1)
    v_cvt_pk_bf16_f32 v42, v54, v55
    v_cvt_pk_bf16_f32 v43, v56, v57
    v_cvt_pk_bf16_f32 v44, v58, v59
    v_cvt_pk_bf16_f32 v45, v60, v61
    v_mfma_f32_32x32x16_bf16 v[46:61], v[24:27], v[12:15], 0
    v_exp_f32 v62, v62
    v_exp_f32 v63, v63
    v_exp_f32 v64, v64
    v_exp_f32 v65, v65
    v_mfma_f32_32x32x16_bf16 v[78:93], v[34:37], v[42:45], v[78:93]
    v_exp_f32 v66, v66
    v_exp_f32 v67, v67
    v_exp_f32_e64 v68, v68
    v_exp_f32 v69, v69
    s_waitcnt lgkmcnt(0)
    v_mfma_f32_32x32x8_bf16 v[46:61], v[28:29], v[20:21], v[46:61]
    v_cvt_pk_bf16_f32 v38, v62, v63
    v_cvt_pk_bf16_f32 v39, v64, v65
    v_cvt_pk_bf16_f32 v40, v66, v67
    v_cvt_pk_bf16_f32 v41, v68, v69
    v_exp_f32 v70, v70
    v_exp_f32 v71, v71
    v_mfma_f32_32x32x16_bf16 v[94:109], v[30:33], v[38:41], v[94:109]
    s_andn2_b64 exec, s[62:63], 0x70000000
    ds_read_b128 v[30:33], v4 offset:35840
    s_mov_b64 exec, -1
    v_exp_f32 v72, v72
    v_exp_f32 v73, v73
    v_exp_f32 v74, v74
    v_exp_f32 v75, v75
    v_exp_f32 v76, v76
    v_exp_f32_e64 v77, v77
    v_cvt_pk_bf16_f32 v42, v70, v71
    v_cvt_pk_bf16_f32 v43, v72, v73
    v_cvt_pk_bf16_f32 v44, v74, v75
    v_cvt_pk_bf16_f32 v45, v76, v77
    v_mfma_f32_32x32x16_bf16 v[62:77], v[24:27], v[16:19], 0
    v_exp_f32 v46, v46
    v_exp_f32 v47, v47
    v_exp_f32 v48, v48
    v_exp_f32 v49, v49
    v_mfma_f32_32x32x16_bf16 v[94:109], v[34:37], v[42:45], v[94:109]
    s_setprio 1
    s_mov_b64 exec, s[62:63]
    ds_read_b128 v[34:37], v4 offset:36480
    s_or_b64 exec, -1, 0x70000000
    ds_read_b128 v[24:27], v5 offset:38400
    v_exp_f32 v50, v50
    v_exp_f32 v51, v51
    v_exp_f32 v52, v52
    v_exp_f32 v53, v53
    v_mfma_f32_32x32x8_bf16 v[62:77], v[28:29], v[22:23], v[62:77]
    v_cvt_pk_bf16_f32 v38, v46, v47
    v_cvt_pk_bf16_f32 v39, v48, v49
    v_cvt_pk_bf16_f32 v40, v50, v51
    v_cvt_pk_bf16_f32 v41, v52, v53
    v_exp_f32_e64 v54, v54
    v_exp_f32 v55, v55
    s_waitcnt lgkmcnt(2)
    v_mfma_f32_32x32x16_bf16 v[78:93], v[30:33], v[38:41], v[78:93]
    v_exp_f32 v56, v56
    v_exp_f32 v57, v57
    v_exp_f32 v58, v58
    v_exp_f32 v59, v59
    v_exp_f32_e64 v60, v60
    v_exp_f32 v61, v61
    s_waitcnt lgkmcnt(0)
    v_cvt_pk_bf16_f32 v42, v54, v55
    v_cvt_pk_bf16_f32 v43, v56, v57
    v_cvt_pk_bf16_f32 v44, v58, v59
    v_cvt_pk_bf16_f32 v45, v60, v61
    v_mfma_f32_32x32x16_bf16 v[46:61], v[24:27], v[12:15], 0
    v_exp_f32 v62, v62
    v_exp_f32 v63, v63
    v_exp_f32 v64, v64
    v_exp_f32 v65, v65
    v_mfma_f32_32x32x16_bf16 v[78:93], v[34:37], v[42:45], v[78:93]
    v_exp_f32 v66, v66
    v_exp_f32 v67, v67
    v_exp_f32 v68, v68
    v_exp_f32 v69, v69
    v_mfma_f32_32x32x8_bf16 v[46:61], v[28:29], v[6:7], v[46:61]
    v_cvt_pk_bf16_f32 v38, v62, v63
    v_cvt_pk_bf16_f32 v39, v64, v65
    v_cvt_pk_bf16_f32 v40, v66, v67
    v_cvt_pk_bf16_f32 v41, v68, v69
    v_exp_f32 v70, v70
    v_exp_f32 v71, v71
    v_mfma_f32_32x32x16_bf16 v[94:109], v[30:33], v[38:41], v[94:109]
    s_andn2_b64 exec, s[62:63], 0x70000000
    ds_read_b128 v[30:33], v4 offset:38400
    s_mov_b64 exec, -1
    v_exp_f32 v72, v72
    v_exp_f32 v73, v73
    v_exp_f32 v74, v74
    v_exp_f32 v75, v75
    v_exp_f32 v76, v76
    v_exp_f32_e64 v77, v77
    v_cvt_pk_bf16_f32 v42, v70, v71
    v_cvt_pk_bf16_f32 v43, v72, v73
    v_cvt_pk_bf16_f32 v44, v74, v75
    v_cvt_pk_bf16_f32 v45, v76, v77
    v_mfma_f32_32x32x16_bf16 v[62:77], v[24:27], v[16:19], 0
    v_exp_f32 v46, v46
    v_exp_f32 v47, v47
    v_exp_f32 v48, v48
    v_exp_f32 v49, v49
    v_mfma_f32_32x32x16_bf16 v[94:109], v[34:37], v[42:45], v[94:109]
    s_andn2_b64 exec, s[62:63], 0x70000000
    ds_read_b128 v[34:37], v4 offset:39040
    s_mov_b64 exec, -1
    v_exp_f32 v50, v50
    v_exp_f32 v51, v51
    v_exp_f32 v52, v52
    v_exp_f32_e64 v53, v53
    v_mfma_f32_32x32x8_bf16 v[62:77], v[28:29], v[254:255], v[62:77]
    v_cvt_pk_bf16_f32 v38, v46, v47
    v_cvt_pk_bf16_f32 v39, v48, v49
    v_cvt_pk_bf16_f32 v40, v50, v51
    v_cvt_pk_bf16_f32 v41, v52, v53
    v_exp_f32_e64 v54, v54
    v_exp_f32 v55, v55
    s_waitcnt lgkmcnt(1)
    v_mfma_f32_32x32x16_bf16 v[78:93], v[30:33], v[38:41], v[78:93]
    v_exp_f32 v56, v56
    v_exp_f32 v57, v57
    v_exp_f32 v58, v58
    v_exp_f32 v59, v59
    v_exp_f32 v60, v60
    v_exp_f32 v61, v61
    v_cvt_pk_bf16_f32 v42, v54, v55
    v_cvt_pk_bf16_f32 v43, v56, v57
    v_cvt_pk_bf16_f32 v44, v58, v59
    v_cvt_pk_bf16_f32 v45, v60, v61
    s_waitcnt lgkmcnt(0)
    v_exp_f32 v62, v62
    v_exp_f32 v63, v63
    v_exp_f32 v64, v64
    v_exp_f32_e64 v65, v65
    v_mfma_f32_32x32x16_bf16 v[78:93], v[34:37], v[42:45], v[78:93]
    s_setprio 0
    v_exp_f32 v66, v66
    v_exp_f32 v67, v67
    v_exp_f32 v68, v68
    v_exp_f32_e64 v69, v69
    v_cvt_pk_bf16_f32 v38, v62, v63
    v_cvt_pk_bf16_f32 v39, v64, v65
    v_cvt_pk_bf16_f32 v40, v66, v67
    v_cvt_pk_bf16_f32 v41, v68, v69
    s_add_u32 s42, s75, 716800
    buffer_load_dwordx4 v[46:49], v2, s[68:71], s42 offen sc1
    s_add_u32 s42, s75, 737280
    buffer_load_dwordx4 v[50:53], v2, s[68:71], s42 offen sc1
    s_add_u32 s42, s75, 757760
    buffer_load_dwordx4 v[54:57], v2, s[68:71], s42 offen sc1
    s_add_u32 s42, s75, 798720
    buffer_load_dwordx4 v[58:61], v2, s[68:71], s42 offen sc1
    v_exp_f32 v70, v70
    v_exp_f32 v71, v71
    v_mfma_f32_32x32x16_bf16 v[94:109], v[30:33], v[38:41], v[94:109]
    v_exp_f32 v72, v72
    v_exp_f32 v73, v73
    v_exp_f32 v74, v74
    v_exp_f32 v75, v75
    v_exp_f32 v76, v76
    v_exp_f32 v77, v77
    v_cvt_pk_bf16_f32 v42, v70, v71
    v_cvt_pk_bf16_f32 v43, v72, v73
    v_cvt_pk_bf16_f32 v44, v74, v75
    v_cvt_pk_bf16_f32 v45, v76, v77
    s_nop 1
    v_mfma_f32_32x32x16_bf16 v[94:109], v[34:37], v[42:45], v[94:109]
    s_lshl_b32 s43, s74, 2
    s_add_u32 s43, s43, 73728
    v_mov_b32_e64 v3, s43
    ds_write_b128 v10, v[78:81] offset:16384
    ds_write_b128 v10, v[82:85] offset:17408
    ds_write_b128 v10, v[86:89] offset:18432
    ds_write_b32 v10, v90 offset:19456
    v_mov_b32 v254, s93
    s_mov_b64 exec, 1
    ds_write_b32 v3, v254 offset:32
    s_mov_b64 exec, -1
    v_cmp_gt_u32 vcc, 32, v1
    s_mov_b32 s42, 0x5f800000
    s_mov_b32 s43, 0x1f800000
    s_waitcnt lgkmcnt(0)
    s_barrier
    ds_read_b128 v[24:27], v10 offset:0
    ds_read_b128 v[28:31], v10 offset:1024
    ds_read_b128 v[32:35], v10 offset:2048
    ds_read_b32 v36, v10 offset:3072
    s_waitcnt lgkmcnt(3)
    v_add_f32 v94, v94, v24
    v_add_f32 v95, v95, v25
    v_add_f32 v96, v96, v26
    v_add_f32 v97, v97, v27
    v_mul_f32 v37, 0, v94
    v_fmac_f32 v37, 0, v95
    v_fmac_f32 v37, 0, v96
    v_fmac_f32 v37, 0, v97
    s_waitcnt lgkmcnt(2)
    v_add_f32 v98, v98, v28
    v_add_f32 v99, v99, v29
    v_add_f32 v100, v100, v30
    v_add_f32 v101, v101, v31
    v_mul_f32 v38, 0, v98
    v_fmac_f32 v38, 0, v99
    v_fmac_f32 v38, 0, v100
    v_fmac_f32 v38, 0, v101
    s_waitcnt lgkmcnt(1)
    v_add_f32 v102, v102, v32
    v_add_f32 v103, v103, v33
    v_add_f32 v104, v104, v34
    v_add_f32 v105, v105, v35
    v_mul_f32 v39, 0, v102
    v_fmac_f32 v39, 0, v103
    v_fmac_f32 v39, 0, v104
    v_fmac_f32 v39, 0, v105
    s_waitcnt lgkmcnt(0)
    v_add_f32 v106, v106, v36
    v_cndmask_b32 v8, v102, v106, vcc
    v_add_f32 v37, v37, v38
    v_add_f32 v8, v8, v39
    v_add_f32_e64 v8, v8, v37
    v_cmp_nlt_f32 vcc, v8, s42
    v_cmp_ngt_f32 s[58:59], v8, s43
    v_rcp_f32_e64 v8, v8
    s_or_b64 vcc, vcc, s[58:59]
    s_cbranch_vccnz k2_fb_1
k2_norm_1:
    v_mul_f32 v8, v8, v9
    s_nop 0
    v_pk_mul_f32 v[94:95], v[94:95], v[8:9] op_sel_hi:[1,0]
    v_pk_mul_f32 v[96:97], v[96:97], v[8:9] op_sel_hi:[1,0]
    v_pk_mul_f32 v[98:99], v[98:99], v[8:9] op_sel_hi:[1,0]
    v_pk_mul_f32 v[100:101], v[100:101], v[8:9] op_sel_hi:[1,0]
    v_pk_mul_f32 v[102:103], v[102:103], v[8:9] op_sel_hi:[1,0]
    v_pk_mul_f32 v[104:105], v[104:105], v[8:9] op_sel_hi:[1,0]
    v_cvt_pk_bf16_f32 v94, v94, v95
    v_cvt_pk_bf16_f32 v95, v96, v97
    v_cvt_pk_bf16_f32 v96, v98, v99
    v_cvt_pk_bf16_f32 v97, v100, v101
    v_cvt_pk_bf16_f32 v98, v102, v103
    v_cvt_pk_bf16_f32 v99, v104, v105
    v_min_u32 v94, -2, v94
    v_min_u32 v95, -2, v95
    v_min_u32 v96, -2, v96
    v_min_u32 v97, -2, v97
    v_min_u32 v98, -2, v98
    v_min_u32 v99, -2, v99
    buffer_store_dwordx4 v[94:97], v2, s[12:15], s89 offen sc1
    s_mov_b32 exec_hi, 0
    buffer_store_dwordx2 v[98:99], v11, s[12:15], s90 offen sc1
    s_mov_b32 exec_hi, -1
    s_barrier
    v_mov_b32 v4, 73728
    s_lshl_b32 s42, s74, 14
    s_cmp_lt_u32 s74, 2
    s_cselect_b32 s43, 0, 40960
    s_add_u32 s42, s42, 40960
    s_add_u32 s42, s42, s43
    v_add_u32 v5, s42, v2
    v_and_b32 v6, 31, v1
    v_mul_u32_u24 v6, 1280, v6
    v_lshrrev_b32_e64 v44, 5, v1
    v_lshl_add_u32 v6, v44, 4, v6
k2_ns:
    ds_read_b128 v[106:109], v4
    s_waitcnt lgkmcnt(0)
    v_and_b32 v106, v106, v107
    v_and_b32 v108, v108, v109
    v_and_b32 v106, v106, v108
    v_cmp_ne_u32 vcc, 1, v106
    s_cbranch_vccnz k2_nt
k2_nu:
    ds_read_b128 v[82:85], v5 offset:0
    ds_read_b128 v[86:89], v5 offset:1024
    ds_read_b128 v[90:93], v5 offset:2048
    ds_read_b128 v[94:97], v5 offset:3072
    ds_read_b128 v[12:15], v5 offset:4096
    ds_read_b128 v[16:19], v5 offset:5120
    ds_read_b128 v[20:23], v5 offset:6144
    ds_read_b128 v[24:27], v5 offset:7168
    ds_read_b128 v[62:65], v5 offset:8192
    ds_read_b128 v[66:69], v5 offset:9216
    ds_read_b128 v[70:73], v5 offset:10240
    ds_read_b128 v[74:77], v5 offset:11264
    ds_read_b128 v[32:35], v5 offset:12288
    ds_read_b128 v[36:39], v5 offset:13312
    ds_read_b128 v[40:43], v5 offset:14336
    ds_read_b128 v[98:101], v5 offset:15360
    s_waitcnt lgkmcnt(8)
    v_pk_add_f32 v[82:83], v[82:83], v[12:13]
    v_pk_add_f32 v[84:85], v[84:85], v[14:15]
    v_pk_add_f32 v[86:87], v[86:87], v[16:17]
    v_pk_add_f32 v[88:89], v[88:89], v[18:19]
    v_pk_add_f32 v[90:91], v[90:91], v[20:21]
    v_pk_add_f32 v[92:93], v[92:93], v[22:23]
    v_pk_add_f32 v[94:95], v[94:95], v[24:25]
    v_pk_add_f32 v[96:97], v[96:97], v[26:27]
    ds_read_b128 v[12:15], v2 offset:0
    ds_read_b128 v[16:19], v2 offset:1024
    ds_read_b128 v[20:23], v2 offset:2048
    ds_read_b128 v[24:27], v2 offset:3072
    ds_read2st64_b64 v[28:31], v11 offset0:16 offset1:17
    s_waitcnt lgkmcnt(5)
    v_pk_add_f32 v[32:33], v[32:33], v[62:63]
    v_pk_add_f32 v[34:35], v[34:35], v[64:65]
    v_pk_add_f32 v[36:37], v[36:37], v[66:67]
    v_pk_add_f32 v[38:39], v[38:39], v[68:69]
    v_pk_add_f32 v[40:41], v[40:41], v[70:71]
    v_pk_add_f32 v[42:43], v[42:43], v[72:73]
    v_pk_add_f32 v[98:99], v[98:99], v[74:75]
    v_pk_add_f32 v[100:101], v[100:101], v[76:77]
    ds_read_b128 v[62:65], v2 offset:10240
    ds_read_b128 v[66:69], v2 offset:11264
    ds_read_b128 v[70:73], v2 offset:12288
    ds_read_b128 v[74:77], v2 offset:13312
    ds_read2st64_b64 v[78:81], v11 offset0:36 offset1:37
    v_pk_add_f32 v[82:83], v[82:83], v[32:33]
    v_pk_add_f32 v[84:85], v[84:85], v[34:35]
    v_pk_add_f32 v[86:87], v[86:87], v[36:37]
    v_pk_add_f32 v[88:89], v[88:89], v[38:39]
    v_pk_add_f32 v[90:91], v[90:91], v[40:41]
    v_pk_add_f32 v[92:93], v[92:93], v[42:43]
    v_pk_add_f32 v[94:95], v[94:95], v[98:99]
    v_pk_add_f32 v[96:97], v[96:97], v[100:101]
    s_waitcnt vmcnt(6) lgkmcnt(5)
    v_max3_u32 v44, v12, v13, v14
    v_max3_u32 v45, v22, v23, v24
    v_max3_u32 v44, v44, v15, v16
    v_max3_u32 v45, v45, v25, v26
    v_max3_u32 v44, v44, v17, v18
    v_max3_u32 v45, v45, v27, v28
    v_max3_u32 v44, v44, v19, v20
    v_max3_u32 v45, v45, v29, v30
    v_max3_u32 v44, v44, v21, v31
    v_max_u32 v44, v44, v45
k2_nc0:
    v_cmp_eq_u32 vcc, -1, v44
    s_cbranch_vccnz k2_nr0
k2_nk0:
    ds_read_b128 v[32:35], v2 offset:20480
    ds_read_b128 v[36:39], v2 offset:21504
    ds_read_b128 v[40:43], v2 offset:22528
    ds_read_b128 v[98:101], v2 offset:23552
    ds_read2st64_b64 v[102:105], v11 offset0:56 offset1:57
    v_mfma_f32_32x32x16_bf16 v[82:97], v[110:113], v[12:15], v[82:97]
    s_waitcnt lgkmcnt(5)
    v_max3_u32 v44, v62, v63, v64
    v_max3_u32 v45, v72, v73, v74
    v_mfma_f32_32x32x16_bf16 v[82:97], v[114:117], v[16:19], v[82:97]
    v_max3_u32 v44, v44, v65, v66
    v_max3_u32 v45, v45, v75, v76
    v_max3_u32 v44, v44, v67, v68
    v_mfma_f32_32x32x16_bf16 v[82:97], v[118:121], v[20:23], v[82:97]
    v_max3_u32 v45, v45, v77, v78
    v_max3_u32 v44, v44, v69, v70
    v_max3_u32 v45, v45, v79, v80
    v_mfma_f32_32x32x16_bf16 v[82:97], v[122:125], v[24:27], v[82:97]
    v_max3_u32 v44, v44, v71, v81
    v_max_u32 v44, v44, v45
    v_mfma_f32_32x32x16_bf16 v[82:97], v[126:129], v[28:31], v[82:97]
k2_nc1:
    v_cmp_eq_u32 vcc, -1, v44
    s_cbranch_vccnz k2_nr1
k2_nk1:
    ds_read_b128 v[12:15], v2 offset:30720
    ds_read_b128 v[16:19], v2 offset:31744
    ds_read_b128 v[20:23], v2 offset:32768
    ds_read_b128 v[24:27], v2 offset:33792
    ds_read2st64_b64 v[28:31], v11 offset0:76 offset1:77
    v_mfma_f32_32x32x16_bf16 v[82:97], v[130:133], v[62:65], v[82:97]
    s_waitcnt lgkmcnt(5)
    v_max3_u32 v44, v32, v33, v34
    v_max3_u32 v45, v42, v43, v98
    v_mfma_f32_32x32x16_bf16 v[82:97], v[134:137], v[66:69], v[82:97]
    v_max3_u32 v44, v44, v35, v36
    v_max3_u32 v45, v45, v99, v100
    v_max3_u32 v44, v44, v37, v38
    v_mfma_f32_32x32x16_bf16 v[82:97], v[138:141], v[70:73], v[82:97]
    v_max3_u32 v45, v45, v101, v102
    v_max3_u32 v44, v44, v39, v40
    v_max3_u32 v45, v45, v103, v104
    v_mfma_f32_32x32x16_bf16 v[82:97], v[142:145], v[74:77], v[82:97]
    v_max3_u32 v44, v44, v41, v105
    v_max_u32 v44, v44, v45
    v_mfma_f32_32x32x16_bf16 v[82:97], v[146:149], v[78:81], v[82:97]
k2_nc2:
    v_cmp_eq_u32 vcc, -1, v44
    s_cbranch_vccnz k2_nr2
k2_nk2:
    ds_read_b128 v[62:65], v2 offset:4096
    ds_read_b128 v[66:69], v2 offset:5120
    ds_read_b128 v[70:73], v2 offset:6144
    ds_read_b128 v[74:77], v2 offset:7168
    ds_read2st64_b64 v[78:81], v11 offset0:18 offset1:19
    v_mfma_f32_32x32x16_bf16 v[82:97], v[150:153], v[32:35], v[82:97]
    s_waitcnt lgkmcnt(5)
    v_max3_u32 v44, v12, v13, v14
    v_max3_u32 v45, v22, v23, v24
    v_mfma_f32_32x32x16_bf16 v[82:97], v[154:157], v[36:39], v[82:97]
    v_max3_u32 v44, v44, v15, v16
    v_max3_u32 v45, v45, v25, v26
    v_max3_u32 v44, v44, v17, v18
    v_mfma_f32_32x32x16_bf16 v[82:97], v[158:161], v[40:43], v[82:97]
    v_max3_u32 v45, v45, v27, v28
    v_max3_u32 v44, v44, v19, v20
    v_max3_u32 v45, v45, v29, v30
    v_mfma_f32_32x32x16_bf16 v[82:97], v[162:165], v[98:101], v[82:97]
    v_max3_u32 v44, v44, v21, v31
    v_max_u32 v44, v44, v45
    v_mfma_f32_32x32x16_bf16 v[82:97], v[166:169], v[102:105], v[82:97]
k2_nc3:
    v_cmp_eq_u32 vcc, -1, v44
    s_cbranch_vccnz k2_nr3
k2_nk3:
    ds_read_b128 v[32:35], v2 offset:14336
    ds_read_b128 v[36:39], v2 offset:15360
    ds_read_b128 v[40:43], v2 offset:16384
    ds_read_b128 v[98:101], v2 offset:17408
    ds_read2st64_b64 v[102:105], v11 offset0:38 offset1:39
    v_mfma_f32_32x32x16_bf16 v[82:97], v[170:173], v[12:15], v[82:97]
    s_waitcnt lgkmcnt(5)
    v_max3_u32 v44, v62, v63, v64
    v_max3_u32 v45, v72, v73, v74
    v_mfma_f32_32x32x16_bf16 v[82:97], v[174:177], v[16:19], v[82:97]
    v_max3_u32 v44, v44, v65, v66
    v_max3_u32 v45, v45, v75, v76
    v_max3_u32 v44, v44, v67, v68
    v_mfma_f32_32x32x16_bf16 v[82:97], v[178:181], v[20:23], v[82:97]
    v_max3_u32 v45, v45, v77, v78
    v_max3_u32 v44, v44, v69, v70
    v_max3_u32 v45, v45, v79, v80
    v_mfma_f32_32x32x16_bf16 v[82:97], v[182:185], v[24:27], v[82:97]
    v_max3_u32 v44, v44, v71, v81
    v_max_u32 v44, v44, v45
    v_mfma_f32_32x32x16_bf16 v[82:97], v[186:189], v[28:31], v[82:97]
k2_nc4:
    v_cmp_eq_u32 vcc, -1, v44
    s_cbranch_vccnz k2_nr4
k2_nk4:
    ds_read_b128 v[12:15], v2 offset:24576
    ds_read_b128 v[16:19], v2 offset:25600
    ds_read_b128 v[20:23], v2 offset:26624
    ds_read_b128 v[24:27], v2 offset:27648
    ds_read2st64_b64 v[28:31], v11 offset0:58 offset1:59
    v_mfma_f32_32x32x16_bf16 v[82:97], v[190:193], v[62:65], v[82:97]
    s_waitcnt lgkmcnt(5)
    v_max3_u32 v44, v32, v33, v34
    v_max3_u32 v45, v42, v43, v98
    v_mfma_f32_32x32x16_bf16 v[82:97], v[194:197], v[66:69], v[82:97]
    v_max3_u32 v44, v44, v35, v36
    v_max3_u32 v45, v45, v99, v100
    v_max3_u32 v44, v44, v37, v38
    v_mfma_f32_32x32x16_bf16 v[82:97], v[198:201], v[70:73], v[82:97]
    v_max3_u32 v45, v45, v101, v102
    v_max3_u32 v44, v44, v39, v40
    v_max3_u32 v45, v45, v103, v104
    v_mfma_f32_32x32x16_bf16 v[82:97], v[202:205], v[74:77], v[82:97]
    v_max3_u32 v44, v44, v41, v105
    v_max_u32 v44, v44, v45
    v_mfma_f32_32x32x16_bf16 v[82:97], v[206:209], v[78:81], v[82:97]
k2_nc5:
    v_cmp_eq_u32 vcc, -1, v44
    s_cbranch_vccnz k2_nr5
k2_nk5:
    ds_read_b128 v[62:65], v2 offset:34816
    ds_read_b128 v[66:69], v2 offset:35840
    ds_read_b128 v[70:73], v2 offset:36864
    ds_read_b128 v[74:77], v2 offset:37888
    ds_read2st64_b64 v[78:81], v11 offset0:78 offset1:79
    v_mfma_f32_32x32x16_bf16 v[82:97], v[210:213], v[32:35], v[82:97]
    s_waitcnt lgkmcnt(5)
    v_max3_u32 v44, v12, v13, v14
    v_max3_u32 v45, v22, v23, v24
    v_mfma_f32_32x32x16_bf16 v[82:97], v[214:217], v[36:39], v[82:97]
    v_max3_u32 v44, v44, v15, v16
    v_max3_u32 v45, v45, v25, v26
    v_max3_u32 v44, v44, v17, v18
    v_mfma_f32_32x32x16_bf16 v[82:97], v[218:221], v[40:43], v[82:97]
    v_max3_u32 v45, v45, v27, v28
    v_max3_u32 v44, v44, v19, v20
    v_max3_u32 v45, v45, v29, v30
    v_mfma_f32_32x32x16_bf16 v[82:97], v[222:225], v[98:101], v[82:97]
    v_max3_u32 v44, v44, v21, v31
    v_max_u32 v44, v44, v45
    v_mfma_f32_32x32x16_bf16 v[82:97], v[226:229], v[102:105], v[82:97]
k2_nc6:
    v_cmp_eq_u32 vcc, -1, v44
    s_cbranch_vccnz k2_nr6
k2_nk6:
    v_mfma_f32_32x32x16_bf16 v[82:97], v[230:233], v[12:15], v[82:97]
    s_waitcnt lgkmcnt(0)
    v_max3_u32 v44, v62, v63, v64
    v_max3_u32 v45, v72, v73, v74
    v_mfma_f32_32x32x16_bf16 v[82:97], v[234:237], v[16:19], v[82:97]
    v_max3_u32 v44, v44, v65, v66
    v_max3_u32 v45, v45, v75, v76
    v_max3_u32 v44, v44, v67, v68
    v_mfma_f32_32x32x16_bf16 v[82:97], v[238:241], v[20:23], v[82:97]
    v_max3_u32 v45, v45, v77, v78
    v_max3_u32 v44, v44, v69, v70
    v_max3_u32 v45, v45, v79, v80
    v_mfma_f32_32x32x16_bf16 v[82:97], v[242:245], v[24:27], v[82:97]
    v_max3_u32 v44, v44, v71, v81
    v_max_u32 v44, v44, v45
    v_mfma_f32_32x32x16_bf16 v[82:97], v[246:249], v[28:31], v[82:97]
k2_nc7:
    v_cmp_eq_u32_e64 vcc, -1, v44
    s_cbranch_vccnz k2_nr7
k2_nk7:
    s_waitcnt vmcnt(2)
    v_mfma_f32_32x32x16_bf16 v[82:97], v[250:253], v[62:65], v[82:97]
    v_mfma_f32_32x32x16_bf16 v[82:97], v[46:49], v[66:69], v[82:97]
    v_mfma_f32_32x32x16_bf16 v[82:97], v[50:53], v[70:73], v[82:97]
    v_mfma_f32_32x32x16_bf16 v[82:97], v[54:57], v[74:77], v[82:97]
    v_mfma_f32_32x32x16_bf16 v[82:97], v[58:61], v[78:81], v[82:97]
    s_nop 15
    v_cvt_pk_bf16_f32 v12, v82, v83
    v_cvt_pk_bf16_f32 v13, v84, v85
    v_cvt_pk_bf16_f32 v14, v86, v87
    v_cvt_pk_bf16_f32 v15, v88, v89
    v_cvt_pk_bf16_f32 v16, v90, v91
    v_cvt_pk_bf16_f32 v17, v92, v93
    v_cvt_pk_bf16_f32 v18, v94, v95
    v_cvt_pk_bf16_f32 v19, v96, v97
    s_nop 0
    v_permlane32_swap_b32 v12, v14
    v_permlane32_swap_b32 v13, v15
    buffer_store_dwordx4 v[12:15], v6, s[8:11], s91 offen offset:0
    s_nop 0
    v_permlane32_swap_b32 v16, v18
    v_permlane32_swap_b32 v17, v19
    buffer_store_dwordx4 v[16:19], v6, s[8:11], s91 offen offset:32
    s_endpgm
k2_nt:
    s_sleep 1
    s_branch k2_ns
k2_nr0:
    s_sleep 1
    ds_read_b128 v[12:15], v2 offset:0
    ds_read_b128 v[16:19], v2 offset:1024
    ds_read_b128 v[20:23], v2 offset:2048
    ds_read_b128 v[24:27], v2 offset:3072
    ds_read2st64_b64 v[28:31], v11 offset0:16 offset1:17
    ds_read_b128 v[62:65], v2 offset:10240
    ds_read_b128 v[66:69], v2 offset:11264
    ds_read_b128 v[70:73], v2 offset:12288
    ds_read_b128 v[74:77], v2 offset:13312
    ds_read2st64_b64 v[78:81], v11 offset0:36 offset1:37
    s_waitcnt lgkmcnt(5)
    v_max3_u32 v44, v12, v13, v14
    v_max3_u32 v45, v22, v23, v24
    v_max3_u32 v44, v44, v15, v16
    v_max3_u32 v45, v45, v25, v26
    v_max3_u32 v44, v44, v17, v18
    v_max3_u32 v45, v45, v27, v28
    v_max3_u32 v44, v44, v19, v20
    v_max3_u32 v45, v45, v29, v30
    v_max3_u32 v44, v44, v21, v31
    v_max_u32_e64 v44, v44, v45
    s_branch k2_nc0
k2_nr1:
    s_sleep 1
    ds_read_b128 v[62:65], v2 offset:10240
    ds_read_b128 v[66:69], v2 offset:11264
    ds_read_b128 v[70:73], v2 offset:12288
    ds_read_b128 v[74:77], v2 offset:13312
    ds_read2st64_b64 v[78:81], v11 offset0:36 offset1:37
    ds_read_b128 v[32:35], v2 offset:20480
    ds_read_b128 v[36:39], v2 offset:21504
    ds_read_b128 v[40:43], v2 offset:22528
    ds_read_b128 v[98:101], v2 offset:23552
    ds_read2st64_b64 v[102:105], v11 offset0:56 offset1:57
    s_waitcnt lgkmcnt(5)
    v_max3_u32 v44, v62, v63, v64
    v_max3_u32 v45, v72, v73, v74
    v_max3_u32 v44, v44, v65, v66
    v_max3_u32 v45, v45, v75, v76
    v_max3_u32 v44, v44, v67, v68
    v_max3_u32 v45, v45, v77, v78
    v_max3_u32 v44, v44, v69, v70
    v_max3_u32 v45, v45, v79, v80
    v_max3_u32 v44, v44, v71, v81
    v_max_u32 v44, v44, v45
    s_branch k2_nc1
k2_nr2:
    s_sleep 1
    ds_read_b128 v[32:35], v2 offset:20480
    ds_read_b128 v[36:39], v2 offset:21504
    ds_read_b128 v[40:43], v2 offset:22528
    ds_read_b128 v[98:101], v2 offset:23552
    ds_read2st64_b64 v[102:105], v11 offset0:56 offset1:57
    ds_read_b128 v[12:15], v2 offset:30720
    ds_read_b128 v[16:19], v2 offset:31744
    ds_read_b128 v[20:23], v2 offset:32768
    ds_read_b128 v[24:27], v2 offset:33792
    ds_read2st64_b64 v[28:31], v11 offset0:76 offset1:77
    s_waitcnt lgkmcnt(5)
    v_max3_u32 v44, v32, v33, v34
    v_max3_u32 v45, v42, v43, v98
    v_max3_u32 v44, v44, v35, v36
    v_max3_u32 v45, v45, v99, v100
    v_max3_u32 v44, v44, v37, v38
    v_max3_u32 v45, v45, v101, v102
    v_max3_u32 v44, v44, v39, v40
    v_max3_u32 v45, v45, v103, v104
    v_max3_u32 v44, v44, v41, v105
    v_max_u32 v44, v44, v45
    s_branch k2_nc2
k2_nr3:
    s_sleep 1
    ds_read_b128 v[12:15], v2 offset:30720
    ds_read_b128 v[16:19], v2 offset:31744
    ds_read_b128 v[20:23], v2 offset:32768
    ds_read_b128 v[24:27], v2 offset:33792
    ds_read2st64_b64 v[28:31], v11 offset0:76 offset1:77
    ds_read_b128 v[62:65], v2 offset:4096
    ds_read_b128 v[66:69], v2 offset:5120
    ds_read_b128 v[70:73], v2 offset:6144
    ds_read_b128 v[74:77], v2 offset:7168
    ds_read2st64_b64 v[78:81], v11 offset0:18 offset1:19
    s_waitcnt lgkmcnt(5)
    v_max3_u32 v44, v12, v13, v14
    v_max3_u32 v45, v22, v23, v24
    v_max3_u32 v44, v44, v15, v16
    v_max3_u32 v45, v45, v25, v26
    v_max3_u32 v44, v44, v17, v18
    v_max3_u32 v45, v45, v27, v28
    v_max3_u32 v44, v44, v19, v20
    v_max3_u32 v45, v45, v29, v30
    v_max3_u32 v44, v44, v21, v31
    v_max_u32 v44, v44, v45
    s_branch k2_nc3
k2_nr4:
    s_sleep 1
    ds_read_b128 v[62:65], v2 offset:4096
    ds_read_b128 v[66:69], v2 offset:5120
    ds_read_b128 v[70:73], v2 offset:6144
    ds_read_b128 v[74:77], v2 offset:7168
    ds_read2st64_b64 v[78:81], v11 offset0:18 offset1:19
    ds_read_b128 v[32:35], v2 offset:14336
    ds_read_b128 v[36:39], v2 offset:15360
    ds_read_b128 v[40:43], v2 offset:16384
    ds_read_b128 v[98:101], v2 offset:17408
    ds_read2st64_b64 v[102:105], v11 offset0:38 offset1:39
    s_waitcnt lgkmcnt(5)
    v_max3_u32 v44, v62, v63, v64
    v_max3_u32 v45, v72, v73, v74
    v_max3_u32 v44, v44, v65, v66
    v_max3_u32 v45, v45, v75, v76
    v_max3_u32 v44, v44, v67, v68
    v_max3_u32 v45, v45, v77, v78
    v_max3_u32 v44, v44, v69, v70
    v_max3_u32 v45, v45, v79, v80
    v_max3_u32 v44, v44, v71, v81
    v_max_u32 v44, v44, v45
    s_branch k2_nc4
k2_nr5:
    s_sleep 1
    ds_read_b128 v[32:35], v2 offset:14336
    ds_read_b128 v[36:39], v2 offset:15360
    ds_read_b128 v[40:43], v2 offset:16384
    ds_read_b128 v[98:101], v2 offset:17408
    ds_read2st64_b64 v[102:105], v11 offset0:38 offset1:39
    ds_read_b128 v[12:15], v2 offset:24576
    ds_read_b128 v[16:19], v2 offset:25600
    ds_read_b128 v[20:23], v2 offset:26624
    ds_read_b128 v[24:27], v2 offset:27648
    ds_read2st64_b64 v[28:31], v11 offset0:58 offset1:59
    s_waitcnt lgkmcnt(5)
    v_max3_u32 v44, v32, v33, v34
    v_max3_u32 v45, v42, v43, v98
    v_max3_u32 v44, v44, v35, v36
    v_max3_u32 v45, v45, v99, v100
    v_max3_u32 v44, v44, v37, v38
    v_max3_u32 v45, v45, v101, v102
    v_max3_u32 v44, v44, v39, v40
    v_max3_u32 v45, v45, v103, v104
    v_max3_u32 v44, v44, v41, v105
    v_max_u32 v44, v44, v45
    s_branch k2_nc5
k2_nr6:
    s_sleep 1
    ds_read_b128 v[12:15], v2 offset:24576
    ds_read_b128 v[16:19], v2 offset:25600
    ds_read_b128 v[20:23], v2 offset:26624
    ds_read_b128 v[24:27], v2 offset:27648
    ds_read2st64_b64 v[28:31], v11 offset0:58 offset1:59
    ds_read_b128 v[62:65], v2 offset:34816
    ds_read_b128 v[66:69], v2 offset:35840
    ds_read_b128 v[70:73], v2 offset:36864
    ds_read_b128 v[74:77], v2 offset:37888
    ds_read2st64_b64 v[78:81], v11 offset0:78 offset1:79
    s_waitcnt lgkmcnt(5)
    v_max3_u32 v44, v12, v13, v14
    v_max3_u32 v45, v22, v23, v24
    v_max3_u32 v44, v44, v15, v16
    v_max3_u32 v45, v45, v25, v26
    v_max3_u32 v44, v44, v17, v18
    v_max3_u32 v45, v45, v27, v28
    v_max3_u32 v44, v44, v19, v20
    v_max3_u32 v45, v45, v29, v30
    v_max3_u32 v44, v44, v21, v31
    v_max_u32 v44, v44, v45
    s_branch k2_nc6
k2_nr7:
    s_sleep 1
    ds_read_b128 v[62:65], v2 offset:34816
    ds_read_b128 v[66:69], v2 offset:35840
    ds_read_b128 v[70:73], v2 offset:36864
    ds_read_b128 v[74:77], v2 offset:37888
    ds_read2st64_b64 v[78:81], v11 offset0:78 offset1:79
    s_waitcnt lgkmcnt(0)
    v_max3_u32 v44, v62, v63, v64
    v_max3_u32 v45, v72, v73, v74
    v_max3_u32 v44, v44, v65, v66
    v_max3_u32 v45, v45, v75, v76
    v_max3_u32 v44, v44, v67, v68
    v_max3_u32 v45, v45, v77, v78
    v_max3_u32 v44, v44, v69, v70
    v_max3_u32 v45, v45, v79, v80
    v_max3_u32 v44, v44, v71, v81
    v_max_u32 v44, v44, v45
    s_branch k2_nc7
k2_fb_1:
    s_waitcnt vmcnt(0)
    v_mov_b32 v86, 0xff800000
    v_and_b32 v5, 31, v1
    v_cmp_eq_u32 vcc, 20, v5
    v_cmp_eq_u32 s[58:59], 24, v5
    v_lshlrev_b32_e64 v5, 3, v5
    v_subrev_u32 v4, 122880, v4
    s_or_b64 vcc, vcc, s[58:59]
    v_mov_b32 v8, 0x3f803f80
    s_nop 1
    v_cndmask_b32 v8, 0, v8, vcc
    v_mov_b32 v30, v8
    v_mov_b32 v31, v8
    v_mov_b32 v32, v8
    v_mov_b32 v33, v8
    v_mov_b32 v34, v8
    v_mov_b32 v35, v8
    v_mov_b32 v36, v8
    v_mov_b32 v37, v8
    v_mov_b32 v94, 0
    v_mov_b32 v95, 0
    v_mov_b32 v96, 0
    v_mov_b32 v97, 0
    v_mov_b32 v98, 0
    v_mov_b32 v99, 0
    v_mov_b32 v100, 0
    v_mov_b32 v101, 0
    v_mov_b32 v102, 0
    v_mov_b32 v103, 0
    v_mov_b32 v104, 0
    v_mov_b32 v105, 0
    v_mov_b32 v106, 0
    v_mov_b32 v107, 0
    v_mov_b32 v108, 0
    v_mov_b32_e64 v109, 0
    s_mul_i32 s42, s37, 163840
    s_mov_b32 s43, 64
k2_slow_1:
    buffer_load_dwordx4 v[24:27], v2, s[4:7], s42 offen sc1
    buffer_load_dwordx2 v[28:29], v5, s[4:7], s42 offen offset:1024 sc1
    s_mov_b64 exec, s[62:63]
    buffer_load_dwordx4 v[30:33], v4, s[4:7], s42 offen sc1
    buffer_load_dwordx4 v[34:37], v4, s[4:7], s42 offen offset:640 sc1
    s_mov_b64 exec, -1
    s_waitcnt vmcnt(0)
    v_mfma_f32_32x32x16_bf16 v[46:61], v[24:27], v[16:19], 0
    v_mfma_f32_32x32x8_bf16 v[46:61], v[28:29], v[22:23], v[46:61]
    s_nop 15
    s_nop 3
    v_max3_f32 v8, v46, v47, v48
    v_max3_f32 v8, v8, v49, v50
    v_max3_f32 v8, v8, v51, v52
    v_max3_f32 v8, v8, v53, v54
    v_max3_f32 v8, v8, v55, v56
    v_max3_f32 v8, v8, v57, v58
    v_max3_f32 v8, v8, v59, v60
    v_max_f32_e64 v8, v8, v61
    v_mov_b32 v87, v8
    s_nop 1
    v_permlane32_swap_b32 v8, v87
    s_nop 1
    v_max3_f32 v8, v8, v87, v86
    v_sub_f32 v87, v86, v8
    v_exp_f32 v87, v87
    v_mov_b32 v86, v8
    v_sub_f32 v46, v46, v8
    v_exp_f32 v46, v46
    v_sub_f32 v47, v47, v8
    v_exp_f32 v47, v47
    v_sub_f32 v48, v48, v8
    v_exp_f32 v48, v48
    v_sub_f32 v49, v49, v8
    v_exp_f32 v49, v49
    v_sub_f32 v50, v50, v8
    v_exp_f32 v50, v50
    v_sub_f32 v51, v51, v8
    v_exp_f32 v51, v51
    v_sub_f32 v52, v52, v8
    v_exp_f32 v52, v52
    v_sub_f32 v53, v53, v8
    v_exp_f32 v53, v53
    v_sub_f32 v54, v54, v8
    v_exp_f32 v54, v54
    v_sub_f32 v55, v55, v8
    v_exp_f32 v55, v55
    v_sub_f32 v56, v56, v8
    v_exp_f32 v56, v56
    v_sub_f32 v57, v57, v8
    v_exp_f32 v57, v57
    v_sub_f32 v58, v58, v8
    v_exp_f32 v58, v58
    v_sub_f32 v59, v59, v8
    v_exp_f32 v59, v59
    v_sub_f32 v60, v60, v8
    v_exp_f32 v60, v60
    v_sub_f32 v61, v61, v8
    v_exp_f32 v61, v61
    v_mul_f32 v94, v94, v87
    v_mul_f32 v95, v95, v87
    v_mul_f32 v96, v96, v87
    v_mul_f32 v97, v97, v87
    v_mul_f32 v98, v98, v87
    v_mul_f32 v99, v99, v87
    v_mul_f32 v100, v100, v87
    v_mul_f32 v101, v101, v87
    v_mul_f32 v102, v102, v87
    v_mul_f32 v103, v103, v87
    v_mul_f32 v104, v104, v87
    v_mul_f32 v105, v105, v87
    v_mul_f32 v106, v106, v87
    v_mul_f32 v107, v107, v87
    v_mul_f32 v108, v108, v87
    v_mul_f32_e64 v109, v109, v87
    v_cvt_pk_bf16_f32 v38, v46, v47
    v_cvt_pk_bf16_f32 v39, v48, v49
    v_cvt_pk_bf16_f32 v40, v50, v51
    v_cvt_pk_bf16_f32 v41, v52, v53
    v_cvt_pk_bf16_f32 v42, v54, v55
    v_cvt_pk_bf16_f32 v43, v56, v57
    v_cvt_pk_bf16_f32 v44, v58, v59
    v_cvt_pk_bf16_f32 v45, v60, v61
    s_nop 3
    v_mfma_f32_32x32x16_bf16 v[94:109], v[30:33], v[38:41], v[94:109]
    v_mfma_f32_32x32x16_bf16 v[94:109], v[34:37], v[42:45], v[94:109]
    s_nop 15
    s_nop 3
    s_add_u32 s42, s42, 2560
    s_sub_u32 s43, s43, 1
    s_cmp_lg_u32 s43, 0
    s_cbranch_scc1 k2_slow_1
    s_add_u32 s42, s75, 716800
    buffer_load_dwordx4 v[46:49], v2, s[68:71], s42 offen sc1
    s_add_u32 s42, s75, 737280
    buffer_load_dwordx4 v[50:53], v2, s[68:71], s42 offen sc1
    s_add_u32 s42, s75, 757760
    buffer_load_dwordx4 v[54:57], v2, s[68:71], s42 offen sc1
    s_add_u32 s42, s75, 798720
    buffer_load_dwordx4 v[58:61], v2, s[68:71], s42 offen sc1
    v_cmp_gt_u32 vcc, 32, v1
    s_nop 1
    v_cndmask_b32_e64 v8, v102, v106, vcc
    v_rcp_f32 v8, v8
    s_waitcnt vmcnt(0)
    s_branch k2_norm_1
g_cbr:
    s_sleep 16
    s_cmp_eq_u32 s3, 0
    s_cselect_b64 exec, 15, 0
    buffer_load_dword v251, v250, s[52:55], 0 offen offset:4 sc1
    s_mov_b64 exec, -1
    s_waitcnt vmcnt(0)
    s_branch g_cb
g_end:
.section .rodata,"a"
.p2align 6
.amdhsa_kernel gated_mix__mha_block__dense_activation_relu__prompt_kernel
  .amdhsa_next_free_vgpr 256
  .amdhsa_next_free_sgpr 102
  .amdhsa_accum_offset 256
  .amdhsa_group_segment_fixed_size 0
  .amdhsa_kernarg_size 80
  .amdhsa_user_sgpr_count 2
  .amdhsa_user_sgpr_kernarg_segment_ptr 1
  .amdhsa_system_sgpr_workgroup_id_x 1
.end_amdhsa_kernel
```
